```python
import torch

def _softmax(x, axis=-1):
    return torch.softmax(x, dim=axis)
def _gelu(x):
    return torch.nn.functional.gelu(x, approximate="tanh")
def _silu(x):
    return torch.nn.functional.silu(x)
def _sigmoid(x):
    return torch.sigmoid(x)
def _layernorm(x, axis=-1, eps=1e-5):
    m = x.mean(dim=axis, keepdim=True)
    v = x.var(dim=axis, keepdim=True, unbiased=False)
    return (x - m) / torch.sqrt(v + eps)
def _scatter_add(tgt, idx, src, axis=0):
    return tgt.clone().index_add_(axis, idx, src)
def _segment_sum(src, seg, n):
    out = torch.zeros((n,) + src.shape[1:], dtype=src.dtype)
    return out.index_add_(0, seg, src)
def _pad(x, pw):
    flat = tuple(v for pair in reversed(pw) for v in pair)
    return torch.nn.functional.pad(x, flat)

kernel_name = 'standalone__gqa_softmax__near_ridge'

def setup_inputs():

    _w = (lambda a: (lambda t: t.to(torch.bfloat16) if t.is_floating_point() else t)(torch.as_tensor(a)))
    B, Hq, Hkv, Sq, Sk, D = 8, 32, 32, 432, 1024, 192
    return {
        "q": _w((lambda *s: torch.randn(*s, dtype=torch.bfloat16) * 0.8)(B, Hq, Sq, D)),
        "k": _w((lambda *s: torch.randn(*s, dtype=torch.bfloat16) * 0.8)(B, Hkv, Sk, D)),
        "v": _w((lambda *s: torch.randn(*s, dtype=torch.bfloat16) * 0.05)(B, Hkv, Sk, D)),
    }

def reference(q, k, v):
    B, Hq, Sq, D = q.shape
    Hkv = k.shape[1]
    rep = Hq // Hkv
    k = (lambda x, n, axis: torch.repeat_interleave(x, n, dim=axis))(k, rep, axis=1)
    v = (lambda x, n, axis: torch.repeat_interleave(x, n, dim=axis))(v, rep, axis=1)
    scale = D ** -0.5
    scores = torch.einsum("bhqd,bhkd->bhqk", q, k) * scale
    p = _softmax(scores, axis=-1)
    return torch.einsum("bhqk,bhkd->bhqd", p, v)
```

```asm
; @launch grid=(256,1,1) block=(256,1,1) lds=163840
.amdgcn_target "amdgcn-amd-amdhsa--gfx950"
.text
.globl standalone__gqa_softmax__near_ridge_kernel
.p2align 8
.type standalone__gqa_softmax__near_ridge_kernel,@function
standalone__gqa_softmax__near_ridge_kernel:
    s_cmp_ge_u32 s2, 256
    s_cbranch_scc1 L_end
    s_load_dwordx4 s[4:7], s[0:1], 0
    s_load_dwordx4 s[8:11], s[0:1], 16
    s_getpc_b64 s[98:99]
L_pc:
    s_lshr_b32 s48, s2, 3
    s_lshl_b32 s48, s48, 12
    v_lshrrev_b32 v40, 3, v0
    v_lshl_add_u32 v40, v40, 7, s48
    v_min_u32 v40, L_hot_end-L_pc-4, v40
    global_load_dword v41, v40, s[98:99]
    v_lshrrev_b32 v24, 6, v0
    v_and_b32 v1, 63, v0
    v_readfirstlane_b32 s28, v24
    s_lshr_b32 s48, s2, 4
    s_and_b32 s49, s2, 7
    s_lshl_b32 s49, s49, 4
    s_add_u32 s48, s48, s49
    s_lshl_b32 s52, s48, 1
    s_lshr_b32 s53, s2, 3
    s_and_b32 s53, s53, 1
    s_mul_i32 s51, s48, 786432
    s_mul_i32 s33, s28, 3072
    s_mov_b32 s29, 0
    v_lshrrev_b32 v28, 3, v0
    v_mul_u32_u24 v29, 384, v28
    v_and_b32 v30, 7, v1
    v_bfe_u32 v31, v28, 1, 3
    v_xor_b32 v31, v31, v30
    v_lshl_add_u32 v8, v31, 4, v29
    v_bfe_u32 v31, v28, 1, 2
    v_lshlrev_b32 v31, 1, v31
    v_xor_b32 v31, v31, v30
    v_lshl_add_u32 v9, v31, 4, v29
    v_and_b32 v28, 15, v1
    v_lshrrev_b32 v29, 4, v1
    v_mul_u32_u24 v30, 384, v28
    v_lshl_add_u32 v10, v29, 4, v30
    s_xor_b32 s49, s53, 0
    s_mul_i32 s49, s49, 86016
    s_mul_i32 s50, s28, 18432
    s_add_u32 s39, s49, s50
    s_lshr_b32 s50, s28, 1
    s_mul_i32 s50, s50, 6144
    s_add_u32 s50, s50, 73728
    s_add_u32 s40, s49, s50
    s_mov_b32 s44, s39
    s_add_u32 s45, s39, 6144
    s_add_u32 s46, s39, 12288
    s_add_u32 s48, s52, 0
    s_mul_i32 s49, s48, 165888
    v_add_u32 v27, s40, v10
    v_lshrrev_b32 v30, 3, v1
    v_mul_u32_u24 v30, 384, v30
    v_and_b32 v31, 7, v1
    v_xor_b32 v31, v31, v29
    v_lshl_add_u32 v23, v31, 4, v30
    v_xor_b32 v26, 64, v23
    s_lshl_b32 s90, s28, 14
    s_add_u32 s90, s90, 98304
    s_mul_i32 s47, s28, 6144
    s_add_u32 s47, s47, 73728
    s_mov_b32 s18, 786432
    s_mov_b32 s19, 0x20000
    s_mov_b32 s14, 165888
    s_mov_b32 s15, 0x20000
    s_waitcnt lgkmcnt(0)
    s_add_u32 s16, s6, s51
    s_addc_u32 s17, s7, 0
    s_add_u32 s12, s4, s49
    s_addc_u32 s13, s5, 0
    s_add_u32 m0, s33, 0
    s_nop 0
    buffer_load_dwordx4 v8, s[16:19], s29 offen nt lds
    s_add_u32 m0, s33, 896
    s_nop 0
    buffer_load_dwordx4 v8, s[16:19], s29 offen offset:128 nt lds
    s_add_u32 m0, s33, 1792
    s_nop 0
    buffer_load_dwordx4 v8, s[16:19], s29 offen offset:256 nt lds
    s_add_u32 s29, s29, 12288
    s_add_u32 s54, s39, 0
    s_add_u32 m0, s90, 0
    s_nop 0
    buffer_load_dwordx4 v23, s[12:15], s54 offen nt lds
    s_add_u32 m0, s90, 896
    s_nop 0
    buffer_load_dwordx4 v23, s[12:15], s54 offen offset:128 nt lds
    s_add_u32 m0, s90, 1792
    s_nop 0
    buffer_load_dwordx4 v23, s[12:15], s54 offen offset:256 nt lds
    s_add_u32 s54, s39, 3072
    s_add_u32 m0, s90, 3072
    s_nop 0
    buffer_load_dwordx4 v26, s[12:15], s54 offen nt lds
    s_add_u32 m0, s90, 3968
    s_nop 0
    buffer_load_dwordx4 v26, s[12:15], s54 offen offset:128 nt lds
    s_add_u32 m0, s90, 4864
    s_nop 0
    buffer_load_dwordx4 v26, s[12:15], s54 offen offset:256 nt lds
    s_add_u32 m0, s33, 12288
    s_nop 0
    buffer_load_dwordx4 v8, s[16:19], s29 offen nt lds
    s_add_u32 m0, s33, 13184
    s_nop 0
    buffer_load_dwordx4 v8, s[16:19], s29 offen offset:128 nt lds
    s_add_u32 m0, s33, 14080
    s_nop 0
    buffer_load_dwordx4 v8, s[16:19], s29 offen offset:256 nt lds
    s_add_u32 s29, s29, 12288
    s_add_u32 s54, s39, 6144
    s_add_u32 m0, s90, 6144
    s_nop 0
    buffer_load_dwordx4 v23, s[12:15], s54 offen nt lds
    s_add_u32 m0, s90, 7040
    s_nop 0
    buffer_load_dwordx4 v23, s[12:15], s54 offen offset:128 nt lds
    s_add_u32 m0, s90, 7936
    s_nop 0
    buffer_load_dwordx4 v23, s[12:15], s54 offen offset:256 nt lds
    s_add_u32 s54, s39, 9216
    s_add_u32 m0, s90, 9216
    s_nop 0
    buffer_load_dwordx4 v26, s[12:15], s54 offen nt lds
    s_add_u32 m0, s90, 10112
    s_nop 0
    buffer_load_dwordx4 v26, s[12:15], s54 offen offset:128 nt lds
    s_add_u32 m0, s90, 11008
    s_nop 0
    buffer_load_dwordx4 v26, s[12:15], s54 offen offset:256 nt lds
    s_add_u32 s54, s39, 12288
    s_add_u32 m0, s47, 0
    s_nop 0
    buffer_load_dwordx4 v23, s[12:15], s54 offen nt lds
    s_add_u32 m0, s47, 896
    s_nop 0
    buffer_load_dwordx4 v23, s[12:15], s54 offen offset:128 nt lds
    s_add_u32 m0, s47, 1792
    s_nop 0
    buffer_load_dwordx4 v23, s[12:15], s54 offen offset:256 nt lds
    s_mov_b32 s30, 0
    s_mov_b32 s32, 12288
    s_mov_b32 s42, 0x3dd53b95
    s_mov_b32 s43, 0x3dd53b95
    s_mov_b32 s35, 0x4e800000
    s_add_u32 s20, s8, s51
    s_addc_u32 s21, s9, 0
    s_mov_b32 s22, 786432
    s_mov_b32 s23, 0x20000
    s_mov_b32 s85, 0
    s_mov_b32 s87, 0
    s_mov_b32 s91, 0
    s_mov_b32 s92, 0
    s_mov_b32 s26, 165888
    s_mov_b32 s27, 0x20000
    s_mov_b32 s83, 0x20000
    s_lshl_b32 s90, s28, 14
    s_add_u32 s90, s90, 98304
    v_and_b32 v28, 15, v1
    v_lshrrev_b32 v29, 4, v1
    v_mul_u32_u24 v30, 384, v28
    v_and_b32 v31, 1, v29
    v_lshl_add_u32 v30, v31, 5, v30
    v_lshrrev_b32 v31, 1, v29
    v_lshl_add_u32 v11, v31, 4, v30
    v_lshrrev_b32 v30, 3, v1
    v_mul_u32_u24 v30, 384, v30
    v_and_b32 v31, 7, v1
    v_xor_b32 v31, v31, v29
    v_lshl_add_u32 v23, v31, 4, v30
    v_lshrrev_b32 v30, 3, v28
    v_mul_u32_u24 v30, 3072, v30
    v_and_b32 v31, 7, v28
    v_lshl_add_u32 v30, v31, 7, v30
    v_lshrrev_b32 v31, 1, v28
    v_xor_b32 v31, v31, v29
    v_lshl_add_u32 v2, v31, 4, v30
    v_xor_b32 v3, 64, v2
    v_lshrrev_b32 v30, 2, v28
    v_and_b32 v31, 1, v29
    v_lshl_add_u32 v30, v31, 2, v30
    v_lshrrev_b32 v31, 1, v29
    v_mul_u32_u24 v31, 3072, v31
    v_lshl_add_u32 v31, v30, 7, v31
    v_and_b32 v28, 3, v1
    v_lshl_add_u32 v31, v28, 3, v31
    v_add_u32 v31, 49152, v31
    v_lshrrev_b32 v30, 1, v30
    v_lshl_add_u32 v4, v30, 5, v31
    v_xor_b32 v5, 32, v4
    v_xor_b32 v6, 64, v4
    v_xor_b32 v7, 96, v4
    v_lshlrev_b32 v47, 7, v1
    v_cmp_gt_u32 vcc, 24, v1
    v_mov_b32 v28, 0x40000000
    s_nop 0
    v_cndmask_b32 v47, v28, v47, vcc
    s_mov_b32 s56, 114432
    v_lshl_add_u32 v46, v1, 2, s56
    v_mov_b32 v30, 0
    ds_write_b32 v46, v30
    s_mov_b32 s93, 4
    s_and_b32 s48, s28, 1
    s_cmp_eq_u32 s48, 1
    s_cbranch_scc1 L_start_1
L_start_0:
    s_waitcnt vmcnt(9) lgkmcnt(0)
    s_barrier
    ds_read_b128 a[192:195], v2
    ds_read_b128 a[196:199], v3
    ds_read_b128 a[200:203], v2 offset:1024
    ds_read_b128 a[204:207], v3 offset:1024
    ds_read_b128 a[208:211], v2 offset:2048
    ds_read_b128 a[212:215], v3 offset:2048
    ds_read_b128 a[216:219], v2 offset:6144
    ds_read_b128 a[220:223], v3 offset:6144
    ds_read_b128 a[224:227], v2 offset:7168
    ds_read_b128 a[228:231], v3 offset:7168
    ds_read_b128 a[232:235], v2 offset:8192
    ds_read_b128 a[236:239], v3 offset:8192
    ds_read_b128 a[0:3], v2 offset:12288
    ds_read_b128 a[4:7], v3 offset:12288
    ds_read_b128 a[8:11], v2 offset:13312
    ds_read_b128 a[12:15], v3 offset:13312
    ds_read_b128 a[16:19], v2 offset:14336
    ds_read_b128 a[20:23], v3 offset:14336
    ds_read_b128 a[24:27], v2 offset:18432
    ds_read_b128 a[28:31], v3 offset:18432
    ds_read_b128 a[32:35], v2 offset:19456
    ds_read_b128 a[36:39], v3 offset:19456
    ds_read_b128 a[40:43], v2 offset:20480
    ds_read_b128 a[44:47], v3 offset:20480
    v_add_u32 v24, s90, v2
    v_add_u32 v25, s90, v3
    ds_read_b128 v[160:163], v24
    ds_read_b128 v[164:167], v25
    ds_read_b128 v[168:171], v24 offset:1024
    ds_read_b128 v[172:175], v25 offset:1024
    ds_read_b128 v[176:179], v24 offset:2048
    ds_read_b128 v[180:183], v25 offset:2048
    s_waitcnt lgkmcnt(5)
    v_lshlrev_b32 v152, 16, v160
    v_and_b32 v153, 0xffff0000, v160
    v_lshlrev_b32 v154, 16, v161
    v_and_b32 v155, 0xffff0000, v161
    v_lshlrev_b32 v156, 16, v162
    v_and_b32 v157, 0xffff0000, v162
    v_lshlrev_b32 v158, 16, v163
    v_and_b32 v159, 0xffff0000, v163
    v_pk_mul_f32 v[152:153], v[152:153], s[42:43]
    v_pk_mul_f32 v[154:155], v[154:155], s[42:43]
    v_pk_mul_f32 v[156:157], v[156:157], s[42:43]
    v_pk_mul_f32 v[158:159], v[158:159], s[42:43]
    v_cvt_pk_bf16_f32 v160, v152, v153
    v_cvt_pk_bf16_f32 v161, v154, v155
    v_cvt_pk_bf16_f32 v162, v156, v157
    v_cvt_pk_bf16_f32 v163, v158, v159
    s_add_u32 s54, s39, 15360
    s_add_u32 m0, s47, 3072
    s_nop 0
    buffer_load_dwordx4 v26, s[12:15], s54 offen nt lds
    s_waitcnt lgkmcnt(4)
    v_lshlrev_b32 v152, 16, v164
    v_and_b32 v153, 0xffff0000, v164
    v_lshlrev_b32 v154, 16, v165
    v_and_b32 v155, 0xffff0000, v165
    v_lshlrev_b32 v156, 16, v166
    v_and_b32 v157, 0xffff0000, v166
    v_lshlrev_b32 v158, 16, v167
    v_and_b32 v159, 0xffff0000, v167
    v_pk_mul_f32 v[152:153], v[152:153], s[42:43]
    v_pk_mul_f32 v[154:155], v[154:155], s[42:43]
    v_pk_mul_f32 v[156:157], v[156:157], s[42:43]
    v_pk_mul_f32 v[158:159], v[158:159], s[42:43]
    v_cvt_pk_bf16_f32 v164, v152, v153
    v_cvt_pk_bf16_f32 v165, v154, v155
    v_cvt_pk_bf16_f32 v166, v156, v157
    v_cvt_pk_bf16_f32 v167, v158, v159
    s_add_u32 m0, s47, 3968
    s_nop 0
    buffer_load_dwordx4 v26, s[12:15], s54 offen offset:128 nt lds
    s_waitcnt lgkmcnt(3)
    v_lshlrev_b32 v152, 16, v168
    v_and_b32 v153, 0xffff0000, v168
    v_lshlrev_b32 v154, 16, v169
    v_and_b32 v155, 0xffff0000, v169
    v_lshlrev_b32 v156, 16, v170
    v_and_b32 v157, 0xffff0000, v170
    v_lshlrev_b32 v158, 16, v171
    v_and_b32 v159, 0xffff0000, v171
    v_pk_mul_f32 v[152:153], v[152:153], s[42:43]
    v_pk_mul_f32 v[154:155], v[154:155], s[42:43]
    v_pk_mul_f32 v[156:157], v[156:157], s[42:43]
    v_pk_mul_f32 v[158:159], v[158:159], s[42:43]
    v_cvt_pk_bf16_f32 v168, v152, v153
    v_cvt_pk_bf16_f32 v169, v154, v155
    v_cvt_pk_bf16_f32 v170, v156, v157
    v_cvt_pk_bf16_f32 v171, v158, v159
    s_add_u32 m0, s47, 4864
    s_nop 0
    buffer_load_dwordx4 v26, s[12:15], s54 offen offset:256 nt lds
    s_waitcnt lgkmcnt(2)
    v_lshlrev_b32 v152, 16, v172
    v_and_b32 v153, 0xffff0000, v172
    v_lshlrev_b32 v154, 16, v173
    v_and_b32 v155, 0xffff0000, v173
    v_lshlrev_b32 v156, 16, v174
    v_and_b32 v157, 0xffff0000, v174
    v_lshlrev_b32 v158, 16, v175
    v_and_b32 v159, 0xffff0000, v175
    v_pk_mul_f32 v[152:153], v[152:153], s[42:43]
    v_pk_mul_f32 v[154:155], v[154:155], s[42:43]
    v_pk_mul_f32 v[156:157], v[156:157], s[42:43]
    v_pk_mul_f32 v[158:159], v[158:159], s[42:43]
    v_cvt_pk_bf16_f32 v172, v152, v153
    v_cvt_pk_bf16_f32 v173, v154, v155
    v_cvt_pk_bf16_f32 v174, v156, v157
    v_cvt_pk_bf16_f32 v175, v158, v159
    buffer_load_dwordx4 v[232:235], v27, s[12:15], 0 offen
    s_waitcnt lgkmcnt(1)
    v_lshlrev_b32 v152, 16, v176
    v_and_b32 v153, 0xffff0000, v176
    v_lshlrev_b32 v154, 16, v177
    v_and_b32 v155, 0xffff0000, v177
    v_lshlrev_b32 v156, 16, v178
    v_and_b32 v157, 0xffff0000, v178
    v_lshlrev_b32 v158, 16, v179
    v_and_b32 v159, 0xffff0000, v179
    v_pk_mul_f32 v[152:153], v[152:153], s[42:43]
    v_pk_mul_f32 v[154:155], v[154:155], s[42:43]
    v_pk_mul_f32 v[156:157], v[156:157], s[42:43]
    v_pk_mul_f32 v[158:159], v[158:159], s[42:43]
    v_cvt_pk_bf16_f32 v176, v152, v153
    v_cvt_pk_bf16_f32 v177, v154, v155
    v_cvt_pk_bf16_f32 v178, v156, v157
    v_cvt_pk_bf16_f32 v179, v158, v159
    buffer_load_dwordx4 v[236:239], v27, s[12:15], 0 offen offset:64
    s_waitcnt lgkmcnt(0)
    v_lshlrev_b32 v152, 16, v180
    v_and_b32 v153, 0xffff0000, v180
    v_lshlrev_b32 v154, 16, v181
    v_and_b32 v155, 0xffff0000, v181
    v_lshlrev_b32 v156, 16, v182
    v_and_b32 v157, 0xffff0000, v182
    v_lshlrev_b32 v158, 16, v183
    v_and_b32 v159, 0xffff0000, v183
    v_pk_mul_f32 v[152:153], v[152:153], s[42:43]
    v_pk_mul_f32 v[154:155], v[154:155], s[42:43]
    v_pk_mul_f32 v[156:157], v[156:157], s[42:43]
    v_pk_mul_f32 v[158:159], v[158:159], s[42:43]
    v_cvt_pk_bf16_f32 v180, v152, v153
    v_cvt_pk_bf16_f32 v181, v154, v155
    v_cvt_pk_bf16_f32 v182, v156, v157
    v_cvt_pk_bf16_f32 v183, v158, v159
    buffer_load_dwordx4 v[240:243], v27, s[12:15], 0 offen offset:128
    v_mfma_f32_16x16x32_bf16 v[64:67], a[192:195], v[160:163], 0
    v_mfma_f32_16x16x32_bf16 v[64:67], a[196:199], v[164:167], v[64:67]
    v_mfma_f32_16x16x32_bf16 v[64:67], a[200:203], v[168:171], v[64:67]
    v_mfma_f32_16x16x32_bf16 v[64:67], a[204:207], v[172:175], v[64:67]
    v_mfma_f32_16x16x32_bf16 v[64:67], a[208:211], v[176:179], v[64:67]
    v_mfma_f32_16x16x32_bf16 v[64:67], a[212:215], v[180:183], v[64:67]
    v_mfma_f32_16x16x32_bf16 v[68:71], a[216:219], v[160:163], 0
    v_mfma_f32_16x16x32_bf16 v[68:71], a[220:223], v[164:167], v[68:71]
    v_mfma_f32_16x16x32_bf16 v[68:71], a[224:227], v[168:171], v[68:71]
    v_mfma_f32_16x16x32_bf16 v[68:71], a[228:231], v[172:175], v[68:71]
    v_mfma_f32_16x16x32_bf16 v[68:71], a[232:235], v[176:179], v[68:71]
    v_mfma_f32_16x16x32_bf16 v[68:71], a[236:239], v[180:183], v[68:71]
    s_nop 1
    v_max3_f32 v32, v64, v65, v66
    s_nop 4
    v_max3_f32 v32, v32, v67, v68
    v_max3_f32 v32, v32, v69, v70
    v_max_f32 v32, v32, v71
    v_mov_b32 v33, v32
    s_nop 1
    v_permlane32_swap_b32 v32, v33
    v_max_f32 v32, v32, v33
    v_mov_b32 v33, v32
    s_nop 1
    v_permlane16_swap_b32 v32, v33
    v_max_f32 v32, v32, v33
    v_sub_f32 v64, v64, v32
    v_exp_f32 v64, v64
    v_sub_f32 v65, v65, v32
    v_exp_f32 v65, v65
    v_sub_f32 v66, v66, v32
    v_exp_f32 v66, v66
    v_sub_f32 v67, v67, v32
    v_exp_f32 v67, v67
    v_cvt_pk_bf16_f32 v96, v64, v65
    v_cvt_pk_bf16_f32 v97, v66, v67
    v_add_f32 v16, v64, v65
    v_add_f32 v16, v16, v66
    v_add_f32 v16, v16, v67
    v_sub_f32 v48, 0, v32
    v_sub_f32 v49, 0, v32
    v_sub_f32 v50, 0, v32
    v_sub_f32 v51, 0, v32
    v_sub_f32 v68, v68, v32
    v_sub_f32 v69, v69, v32
    v_sub_f32 v70, v70, v32
    v_sub_f32 v71, v71, v32
    v_mfma_f32_16x16x32_bf16 v[64:67], a[0:3], v[160:163], v[48:51]
    v_mfma_f32_16x16x32_bf16 v[64:67], a[4:7], v[164:167], v[64:67]
    v_mfma_f32_16x16x32_bf16 v[64:67], a[8:11], v[168:171], v[64:67]
    v_exp_f32 v68, v68
    v_exp_f32 v69, v69
    v_exp_f32 v70, v70
    v_exp_f32 v71, v71
    v_mfma_f32_16x16x32_bf16 v[64:67], a[12:15], v[172:175], v[64:67]
    v_cvt_pk_bf16_f32 v98, v68, v69
    v_cvt_pk_bf16_f32 v99, v70, v71
    v_mfma_f32_16x16x32_bf16 v[64:67], a[16:19], v[176:179], v[64:67]
    v_add_f32 v16, v16, v68
    v_add_f32 v16, v16, v69
    v_mfma_f32_16x16x32_bf16 v[64:67], a[20:23], v[180:183], v[64:67]
    v_add_f32 v16, v16, v70
    v_add_f32 v16, v16, v71
    v_mfma_f32_16x16x32_bf16 v[68:71], a[24:27], v[160:163], v[48:51]
    v_mfma_f32_16x16x32_bf16 v[68:71], a[28:31], v[164:167], v[68:71]
    v_mfma_f32_16x16x32_bf16 v[68:71], a[32:35], v[168:171], v[68:71]
    v_mfma_f32_16x16x32_bf16 v[68:71], a[36:39], v[172:175], v[68:71]
    s_nop 1
    v_exp_f32 v64, v64
    v_mfma_f32_16x16x32_bf16 v[68:71], a[40:43], v[176:179], v[68:71]
    v_exp_f32 v65, v65
    v_mfma_f32_16x16x32_bf16 v[68:71], a[44:47], v[180:183], v[68:71]
    v_exp_f32 v66, v66
    s_waitcnt vmcnt(9)
    ds_read_b128 v[184:187], v24 offset:6144
    ds_read_b128 v[188:191], v25 offset:6144
    ds_read_b128 v[192:195], v24 offset:7168
    ds_read_b128 v[196:199], v25 offset:7168
    ds_read_b128 v[200:203], v24 offset:8192
    ds_read_b128 v[204:207], v25 offset:8192
    s_waitcnt lgkmcnt(5)
    v_lshlrev_b32 v152, 16, v184
    v_and_b32 v153, 0xffff0000, v184
    v_lshlrev_b32 v154, 16, v185
    v_and_b32 v155, 0xffff0000, v185
    v_lshlrev_b32 v156, 16, v186
    v_and_b32 v157, 0xffff0000, v186
    v_lshlrev_b32 v158, 16, v187
    v_and_b32 v159, 0xffff0000, v187
    v_pk_mul_f32 v[152:153], v[152:153], s[42:43]
    v_pk_mul_f32 v[154:155], v[154:155], s[42:43]
    v_pk_mul_f32 v[156:157], v[156:157], s[42:43]
    v_pk_mul_f32 v[158:159], v[158:159], s[42:43]
    v_cvt_pk_bf16_f32 v184, v152, v153
    v_cvt_pk_bf16_f32 v185, v154, v155
    v_cvt_pk_bf16_f32 v186, v156, v157
    v_cvt_pk_bf16_f32 v187, v158, v159
    buffer_load_dwordx4 v[244:247], v27, s[12:15], 0 offen offset:192
    s_waitcnt lgkmcnt(4)
    v_lshlrev_b32 v152, 16, v188
    v_and_b32 v153, 0xffff0000, v188
    v_lshlrev_b32 v154, 16, v189
    v_and_b32 v155, 0xffff0000, v189
    v_lshlrev_b32 v156, 16, v190
    v_and_b32 v157, 0xffff0000, v190
    v_lshlrev_b32 v158, 16, v191
    v_and_b32 v159, 0xffff0000, v191
    v_pk_mul_f32 v[152:153], v[152:153], s[42:43]
    v_pk_mul_f32 v[154:155], v[154:155], s[42:43]
    v_pk_mul_f32 v[156:157], v[156:157], s[42:43]
    v_pk_mul_f32 v[158:159], v[158:159], s[42:43]
    v_cvt_pk_bf16_f32 v188, v152, v153
    v_cvt_pk_bf16_f32 v189, v154, v155
    v_cvt_pk_bf16_f32 v190, v156, v157
    v_cvt_pk_bf16_f32 v191, v158, v159
    buffer_load_dwordx4 v[248:251], v27, s[12:15], 0 offen offset:256
    s_waitcnt lgkmcnt(3)
    v_lshlrev_b32 v152, 16, v192
    v_and_b32 v153, 0xffff0000, v192
    v_lshlrev_b32 v154, 16, v193
    v_and_b32 v155, 0xffff0000, v193
    v_lshlrev_b32 v156, 16, v194
    v_and_b32 v157, 0xffff0000, v194
    v_lshlrev_b32 v158, 16, v195
    v_and_b32 v159, 0xffff0000, v195
    v_pk_mul_f32 v[152:153], v[152:153], s[42:43]
    v_pk_mul_f32 v[154:155], v[154:155], s[42:43]
    v_pk_mul_f32 v[156:157], v[156:157], s[42:43]
    v_pk_mul_f32 v[158:159], v[158:159], s[42:43]
    v_cvt_pk_bf16_f32 v192, v152, v153
    v_cvt_pk_bf16_f32 v193, v154, v155
    v_cvt_pk_bf16_f32 v194, v156, v157
    v_cvt_pk_bf16_f32 v195, v158, v159
    buffer_load_dwordx4 v[252:255], v27, s[12:15], 0 offen offset:320
    s_waitcnt lgkmcnt(2)
    v_lshlrev_b32 v152, 16, v196
    v_and_b32 v153, 0xffff0000, v196
    v_lshlrev_b32 v154, 16, v197
    v_and_b32 v155, 0xffff0000, v197
    v_lshlrev_b32 v156, 16, v198
    v_and_b32 v157, 0xffff0000, v198
    v_lshlrev_b32 v158, 16, v199
    v_and_b32 v159, 0xffff0000, v199
    v_pk_mul_f32 v[152:153], v[152:153], s[42:43]
    v_pk_mul_f32 v[154:155], v[154:155], s[42:43]
    v_pk_mul_f32 v[156:157], v[156:157], s[42:43]
    v_pk_mul_f32 v[158:159], v[158:159], s[42:43]
    v_cvt_pk_bf16_f32 v196, v152, v153
    v_cvt_pk_bf16_f32 v197, v154, v155
    v_cvt_pk_bf16_f32 v198, v156, v157
    v_cvt_pk_bf16_f32 v199, v158, v159
    s_add_u32 m0, s33, 24576
    s_nop 0
    buffer_load_dwordx4 v8, s[16:19], s29 offen nt lds
    s_waitcnt lgkmcnt(1)
    v_lshlrev_b32 v152, 16, v200
    v_and_b32 v153, 0xffff0000, v200
    v_lshlrev_b32 v154, 16, v201
    v_and_b32 v155, 0xffff0000, v201
    v_lshlrev_b32 v156, 16, v202
    v_and_b32 v157, 0xffff0000, v202
    v_lshlrev_b32 v158, 16, v203
    v_and_b32 v159, 0xffff0000, v203
    v_pk_mul_f32 v[152:153], v[152:153], s[42:43]
    v_pk_mul_f32 v[154:155], v[154:155], s[42:43]
    v_pk_mul_f32 v[156:157], v[156:157], s[42:43]
    v_pk_mul_f32 v[158:159], v[158:159], s[42:43]
    v_cvt_pk_bf16_f32 v200, v152, v153
    v_cvt_pk_bf16_f32 v201, v154, v155
    v_cvt_pk_bf16_f32 v202, v156, v157
    v_cvt_pk_bf16_f32 v203, v158, v159
    s_add_u32 m0, s33, 25472
    s_nop 0
    buffer_load_dwordx4 v8, s[16:19], s29 offen offset:128 nt lds
    s_waitcnt lgkmcnt(0)
    v_lshlrev_b32 v152, 16, v204
    v_and_b32 v153, 0xffff0000, v204
    v_lshlrev_b32 v154, 16, v205
    v_and_b32 v155, 0xffff0000, v205
    v_lshlrev_b32 v156, 16, v206
    v_and_b32 v157, 0xffff0000, v206
    v_lshlrev_b32 v158, 16, v207
    v_and_b32 v159, 0xffff0000, v207
    v_pk_mul_f32 v[152:153], v[152:153], s[42:43]
    v_pk_mul_f32 v[154:155], v[154:155], s[42:43]
    v_pk_mul_f32 v[156:157], v[156:157], s[42:43]
    v_pk_mul_f32 v[158:159], v[158:159], s[42:43]
    v_cvt_pk_bf16_f32 v204, v152, v153
    v_cvt_pk_bf16_f32 v205, v154, v155
    v_cvt_pk_bf16_f32 v206, v156, v157
    v_cvt_pk_bf16_f32 v207, v158, v159
    s_add_u32 m0, s33, 26368
    s_nop 0
    buffer_load_dwordx4 v8, s[16:19], s29 offen offset:256 nt lds
    s_add_u32 s29, s29, 12288
    v_mfma_f32_16x16x32_bf16 v[72:75], a[192:195], v[184:187], 0
    v_exp_f32 v67, v67
    v_mfma_f32_16x16x32_bf16 v[72:75], a[196:199], v[188:191], v[72:75]
    v_cvt_pk_bf16_f32 v112, v64, v65
    v_cvt_pk_bf16_f32 v113, v66, v67
    v_mfma_f32_16x16x32_bf16 v[72:75], a[200:203], v[192:195], v[72:75]
    v_add_f32 v16, v16, v64
    v_add_f32 v16, v16, v65
    v_mfma_f32_16x16x32_bf16 v[72:75], a[204:207], v[196:199], v[72:75]
    v_add_f32 v16, v16, v66
    v_add_f32 v16, v16, v67
    v_mfma_f32_16x16x32_bf16 v[72:75], a[208:211], v[200:203], v[72:75]
    v_exp_f32 v68, v68
    v_mfma_f32_16x16x32_bf16 v[72:75], a[212:215], v[204:207], v[72:75]
    v_exp_f32 v69, v69
    v_mfma_f32_16x16x32_bf16 v[76:79], a[216:219], v[184:187], 0
    v_exp_f32 v70, v70
    v_mfma_f32_16x16x32_bf16 v[76:79], a[220:223], v[188:191], v[76:79]
    v_exp_f32 v71, v71
    v_mfma_f32_16x16x32_bf16 v[76:79], a[224:227], v[192:195], v[76:79]
    v_cvt_pk_bf16_f32 v114, v68, v69
    v_cvt_pk_bf16_f32 v115, v70, v71
    v_mfma_f32_16x16x32_bf16 v[76:79], a[228:231], v[196:199], v[76:79]
    v_add_f32 v16, v16, v68
    v_add_f32 v16, v16, v69
    v_mfma_f32_16x16x32_bf16 v[76:79], a[232:235], v[200:203], v[76:79]
    v_add_f32 v16, v16, v70
    v_add_f32 v16, v16, v71
    v_mfma_f32_16x16x32_bf16 v[76:79], a[236:239], v[204:207], v[76:79]
    v_max3_f32 v34, v72, v73, v74
    s_nop 6
    v_max3_f32 v34, v34, v75, v76
    v_max3_f32 v34, v34, v77, v78
    v_max_f32 v34, v34, v79
    v_mov_b32 v35, v34
    s_nop 1
    v_permlane32_swap_b32 v34, v35
    v_max_f32 v34, v34, v35
    v_mov_b32 v35, v34
    s_nop 1
    v_permlane16_swap_b32 v34, v35
    v_max_f32 v34, v34, v35
    v_sub_f32 v72, v72, v34
    v_exp_f32 v72, v72
    v_sub_f32 v73, v73, v34
    v_exp_f32 v73, v73
    v_sub_f32 v74, v74, v34
    v_exp_f32 v74, v74
    v_sub_f32 v75, v75, v34
    v_exp_f32 v75, v75
    v_cvt_pk_bf16_f32 v100, v72, v73
    v_cvt_pk_bf16_f32 v101, v74, v75
    v_add_f32 v17, v72, v73
    v_add_f32 v17, v17, v74
    v_add_f32 v17, v17, v75
    v_sub_f32 v52, 0, v34
    v_sub_f32 v53, 0, v34
    v_sub_f32 v54, 0, v34
    v_sub_f32 v55, 0, v34
    v_sub_f32 v76, v76, v34
    v_sub_f32 v77, v77, v34
    v_sub_f32 v78, v78, v34
    v_sub_f32 v79, v79, v34
    v_mfma_f32_16x16x32_bf16 v[72:75], a[0:3], v[184:187], v[52:55]
    v_mfma_f32_16x16x32_bf16 v[72:75], a[4:7], v[188:191], v[72:75]
    v_mfma_f32_16x16x32_bf16 v[72:75], a[8:11], v[192:195], v[72:75]
    v_exp_f32 v76, v76
    v_exp_f32 v77, v77
    v_exp_f32 v78, v78
    v_exp_f32 v79, v79
    v_mfma_f32_16x16x32_bf16 v[72:75], a[12:15], v[196:199], v[72:75]
    v_cvt_pk_bf16_f32 v102, v76, v77
    v_cvt_pk_bf16_f32 v103, v78, v79
    v_mfma_f32_16x16x32_bf16 v[72:75], a[16:19], v[200:203], v[72:75]
    v_add_f32 v17, v17, v76
    v_add_f32 v17, v17, v77
    v_mfma_f32_16x16x32_bf16 v[72:75], a[20:23], v[204:207], v[72:75]
    v_add_f32 v17, v17, v78
    v_add_f32 v17, v17, v79
    v_mfma_f32_16x16x32_bf16 v[76:79], a[24:27], v[184:187], v[52:55]
    v_mfma_f32_16x16x32_bf16 v[76:79], a[28:31], v[188:191], v[76:79]
    v_mfma_f32_16x16x32_bf16 v[76:79], a[32:35], v[192:195], v[76:79]
    v_mfma_f32_16x16x32_bf16 v[76:79], a[36:39], v[196:199], v[76:79]
    s_nop 1
    v_exp_f32 v72, v72
    v_mfma_f32_16x16x32_bf16 v[76:79], a[40:43], v[200:203], v[76:79]
    v_exp_f32 v73, v73
    v_mfma_f32_16x16x32_bf16 v[76:79], a[44:47], v[204:207], v[76:79]
    v_exp_f32 v74, v74
    v_add_u32 v24, s47, v2
    v_add_u32 v25, s47, v3
    s_waitcnt vmcnt(9)
    ds_read_b128 v[208:211], v24
    ds_read_b128 v[212:215], v25
    ds_read_b128 v[216:219], v24 offset:1024
    ds_read_b128 v[220:223], v25 offset:1024
    ds_read_b128 v[224:227], v24 offset:2048
    ds_read_b128 v[228:231], v25 offset:2048
    s_waitcnt lgkmcnt(5)
    v_lshlrev_b32 v152, 16, v208
    v_and_b32 v153, 0xffff0000, v208
    v_lshlrev_b32 v154, 16, v209
    v_and_b32 v155, 0xffff0000, v209
    v_lshlrev_b32 v156, 16, v210
    v_and_b32 v157, 0xffff0000, v210
    v_lshlrev_b32 v158, 16, v211
    v_and_b32 v159, 0xffff0000, v211
    v_pk_mul_f32 v[152:153], v[152:153], s[42:43]
    v_pk_mul_f32 v[154:155], v[154:155], s[42:43]
    v_pk_mul_f32 v[156:157], v[156:157], s[42:43]
    v_pk_mul_f32 v[158:159], v[158:159], s[42:43]
    v_cvt_pk_bf16_f32 v208, v152, v153
    v_cvt_pk_bf16_f32 v209, v154, v155
    v_cvt_pk_bf16_f32 v210, v156, v157
    v_cvt_pk_bf16_f32 v211, v158, v159
    s_add_u32 m0, s33, 49152
    s_nop 0
    buffer_load_dwordx4 v9, s[20:23], s30 offen nt lds
    s_waitcnt lgkmcnt(4)
    v_lshlrev_b32 v152, 16, v212
    v_and_b32 v153, 0xffff0000, v212
    v_lshlrev_b32 v154, 16, v213
    v_and_b32 v155, 0xffff0000, v213
    v_lshlrev_b32 v156, 16, v214
    v_and_b32 v157, 0xffff0000, v214
    v_lshlrev_b32 v158, 16, v215
    v_and_b32 v159, 0xffff0000, v215
    v_pk_mul_f32 v[152:153], v[152:153], s[42:43]
    v_pk_mul_f32 v[154:155], v[154:155], s[42:43]
    v_pk_mul_f32 v[156:157], v[156:157], s[42:43]
    v_pk_mul_f32 v[158:159], v[158:159], s[42:43]
    v_cvt_pk_bf16_f32 v212, v152, v153
    v_cvt_pk_bf16_f32 v213, v154, v155
    v_cvt_pk_bf16_f32 v214, v156, v157
    v_cvt_pk_bf16_f32 v215, v158, v159
    s_add_u32 m0, s33, 50048
    s_nop 0
    buffer_load_dwordx4 v9, s[20:23], s30 offen offset:128 nt lds
    s_waitcnt lgkmcnt(3)
    v_lshlrev_b32 v152, 16, v216
    v_and_b32 v153, 0xffff0000, v216
    v_lshlrev_b32 v154, 16, v217
    v_and_b32 v155, 0xffff0000, v217
    v_lshlrev_b32 v156, 16, v218
    v_and_b32 v157, 0xffff0000, v218
    v_lshlrev_b32 v158, 16, v219
    v_and_b32 v159, 0xffff0000, v219
    v_pk_mul_f32 v[152:153], v[152:153], s[42:43]
    v_pk_mul_f32 v[154:155], v[154:155], s[42:43]
    v_pk_mul_f32 v[156:157], v[156:157], s[42:43]
    v_pk_mul_f32 v[158:159], v[158:159], s[42:43]
    v_cvt_pk_bf16_f32 v216, v152, v153
    v_cvt_pk_bf16_f32 v217, v154, v155
    v_cvt_pk_bf16_f32 v218, v156, v157
    v_cvt_pk_bf16_f32 v219, v158, v159
    s_add_u32 m0, s33, 50944
    s_nop 0
    buffer_load_dwordx4 v9, s[20:23], s30 offen offset:256 nt lds
    s_waitcnt lgkmcnt(2)
    v_lshlrev_b32 v152, 16, v220
    v_and_b32 v153, 0xffff0000, v220
    v_lshlrev_b32 v154, 16, v221
    v_and_b32 v155, 0xffff0000, v221
    v_lshlrev_b32 v156, 16, v222
    v_and_b32 v157, 0xffff0000, v222
    v_lshlrev_b32 v158, 16, v223
    v_and_b32 v159, 0xffff0000, v223
    v_pk_mul_f32 v[152:153], v[152:153], s[42:43]
    v_pk_mul_f32 v[154:155], v[154:155], s[42:43]
    v_pk_mul_f32 v[156:157], v[156:157], s[42:43]
    v_pk_mul_f32 v[158:159], v[158:159], s[42:43]
    v_cvt_pk_bf16_f32 v220, v152, v153
    v_cvt_pk_bf16_f32 v221, v154, v155
    v_cvt_pk_bf16_f32 v222, v156, v157
    v_cvt_pk_bf16_f32 v223, v158, v159
    s_add_u32 m0, s33, 61440
    s_nop 0
    buffer_load_dwordx4 v9, s[20:23], s32 offen nt lds
    s_waitcnt lgkmcnt(1)
    v_lshlrev_b32 v152, 16, v224
    v_and_b32 v153, 0xffff0000, v224
    v_lshlrev_b32 v154, 16, v225
    v_and_b32 v155, 0xffff0000, v225
    v_lshlrev_b32 v156, 16, v226
    v_and_b32 v157, 0xffff0000, v226
    v_lshlrev_b32 v158, 16, v227
    v_and_b32 v159, 0xffff0000, v227
    v_pk_mul_f32 v[152:153], v[152:153], s[42:43]
    v_pk_mul_f32 v[154:155], v[154:155], s[42:43]
    v_pk_mul_f32 v[156:157], v[156:157], s[42:43]
    v_pk_mul_f32 v[158:159], v[158:159], s[42:43]
    v_cvt_pk_bf16_f32 v224, v152, v153
    v_cvt_pk_bf16_f32 v225, v154, v155
    v_cvt_pk_bf16_f32 v226, v156, v157
    v_cvt_pk_bf16_f32 v227, v158, v159
    s_add_u32 m0, s33, 62336
    s_nop 0
    buffer_load_dwordx4 v9, s[20:23], s32 offen offset:128 nt lds
    s_waitcnt lgkmcnt(0)
    v_lshlrev_b32 v152, 16, v228
    v_and_b32 v153, 0xffff0000, v228
    v_lshlrev_b32 v154, 16, v229
    v_and_b32 v155, 0xffff0000, v229
    v_lshlrev_b32 v156, 16, v230
    v_and_b32 v157, 0xffff0000, v230
    v_lshlrev_b32 v158, 16, v231
    v_and_b32 v159, 0xffff0000, v231
    v_pk_mul_f32 v[152:153], v[152:153], s[42:43]
    v_pk_mul_f32 v[154:155], v[154:155], s[42:43]
    v_pk_mul_f32 v[156:157], v[156:157], s[42:43]
    v_pk_mul_f32 v[158:159], v[158:159], s[42:43]
    v_cvt_pk_bf16_f32 v228, v152, v153
    v_cvt_pk_bf16_f32 v229, v154, v155
    v_cvt_pk_bf16_f32 v230, v156, v157
    v_cvt_pk_bf16_f32 v231, v158, v159
    s_add_u32 m0, s33, 63232
    s_nop 0
    buffer_load_dwordx4 v9, s[20:23], s32 offen offset:256 nt lds
    s_add_u32 s30, s30, 24576
    s_add_u32 s32, s32, 24576
    v_mfma_f32_16x16x32_bf16 v[80:83], a[192:195], v[208:211], 0
    v_exp_f32 v75, v75
    v_mfma_f32_16x16x32_bf16 v[80:83], a[196:199], v[212:215], v[80:83]
    v_cvt_pk_bf16_f32 v116, v72, v73
    v_cvt_pk_bf16_f32 v117, v74, v75
    v_mfma_f32_16x16x32_bf16 v[80:83], a[200:203], v[216:219], v[80:83]
    v_add_f32 v17, v17, v72
    v_add_f32 v17, v17, v73
    v_mfma_f32_16x16x32_bf16 v[80:83], a[204:207], v[220:223], v[80:83]
    v_add_f32 v17, v17, v74
    v_add_f32 v17, v17, v75
    v_mfma_f32_16x16x32_bf16 v[80:83], a[208:211], v[224:227], v[80:83]
    v_exp_f32 v76, v76
    v_mfma_f32_16x16x32_bf16 v[80:83], a[212:215], v[228:231], v[80:83]
    v_exp_f32 v77, v77
    v_mfma_f32_16x16x32_bf16 v[84:87], a[216:219], v[208:211], 0
    v_exp_f32 v78, v78
    v_mfma_f32_16x16x32_bf16 v[84:87], a[220:223], v[212:215], v[84:87]
    v_exp_f32 v79, v79
    v_mfma_f32_16x16x32_bf16 v[84:87], a[224:227], v[216:219], v[84:87]
    v_cvt_pk_bf16_f32 v118, v76, v77
    v_cvt_pk_bf16_f32 v119, v78, v79
    v_mfma_f32_16x16x32_bf16 v[84:87], a[228:231], v[220:223], v[84:87]
    v_add_f32 v17, v17, v76
    v_add_f32 v17, v17, v77
    v_mfma_f32_16x16x32_bf16 v[84:87], a[232:235], v[224:227], v[84:87]
    v_add_f32 v17, v17, v78
    v_add_f32 v17, v17, v79
    v_mfma_f32_16x16x32_bf16 v[84:87], a[236:239], v[228:231], v[84:87]
    v_max3_f32 v36, v80, v81, v82
    s_nop 6
    v_max3_f32 v36, v36, v83, v84
    v_max3_f32 v36, v36, v85, v86
    v_max_f32 v36, v36, v87
    v_mov_b32 v37, v36
    s_nop 1
    v_permlane32_swap_b32 v36, v37
    v_max_f32 v36, v36, v37
    v_mov_b32 v37, v36
    s_nop 1
    v_permlane16_swap_b32 v36, v37
    v_max_f32 v36, v36, v37
    v_sub_f32 v80, v80, v36
    v_exp_f32 v80, v80
    v_sub_f32 v81, v81, v36
    v_exp_f32 v81, v81
    v_sub_f32 v82, v82, v36
    v_exp_f32 v82, v82
    v_sub_f32 v83, v83, v36
    v_exp_f32 v83, v83
    v_cvt_pk_bf16_f32 v104, v80, v81
    v_cvt_pk_bf16_f32 v105, v82, v83
    v_add_f32 v18, v80, v81
    v_add_f32 v18, v18, v82
    v_add_f32 v18, v18, v83
    v_sub_f32 v56, 0, v36
    v_sub_f32 v57, 0, v36
    v_sub_f32 v58, 0, v36
    v_sub_f32 v59, 0, v36
    v_sub_f32 v84, v84, v36
    v_sub_f32 v85, v85, v36
    v_sub_f32 v86, v86, v36
    v_sub_f32 v87, v87, v36
    v_mfma_f32_16x16x32_bf16 v[80:83], a[0:3], v[208:211], v[56:59]
    v_mfma_f32_16x16x32_bf16 v[80:83], a[4:7], v[212:215], v[80:83]
    v_mfma_f32_16x16x32_bf16 v[80:83], a[8:11], v[216:219], v[80:83]
    v_exp_f32 v84, v84
    v_exp_f32 v85, v85
    v_exp_f32 v86, v86
    v_exp_f32 v87, v87
    v_mfma_f32_16x16x32_bf16 v[80:83], a[12:15], v[220:223], v[80:83]
    v_cvt_pk_bf16_f32 v106, v84, v85
    v_cvt_pk_bf16_f32 v107, v86, v87
    v_mfma_f32_16x16x32_bf16 v[80:83], a[16:19], v[224:227], v[80:83]
    v_add_f32 v18, v18, v84
    v_add_f32 v18, v18, v85
    v_mfma_f32_16x16x32_bf16 v[80:83], a[20:23], v[228:231], v[80:83]
    v_add_f32 v18, v18, v86
    v_add_f32 v18, v18, v87
    v_mfma_f32_16x16x32_bf16 v[84:87], a[24:27], v[208:211], v[56:59]
    v_mfma_f32_16x16x32_bf16 v[84:87], a[28:31], v[212:215], v[84:87]
    v_mfma_f32_16x16x32_bf16 v[84:87], a[32:35], v[216:219], v[84:87]
    v_mfma_f32_16x16x32_bf16 v[84:87], a[36:39], v[220:223], v[84:87]
    s_nop 1
    v_exp_f32 v80, v80
    v_mfma_f32_16x16x32_bf16 v[84:87], a[40:43], v[224:227], v[84:87]
    v_exp_f32 v81, v81
    v_mfma_f32_16x16x32_bf16 v[84:87], a[44:47], v[228:231], v[84:87]
    v_exp_f32 v82, v82
    s_waitcnt vmcnt(14)
    v_lshlrev_b32 v152, 16, v232
    v_and_b32 v153, 0xffff0000, v232
    v_lshlrev_b32 v154, 16, v233
    v_and_b32 v155, 0xffff0000, v233
    v_lshlrev_b32 v156, 16, v234
    v_and_b32 v157, 0xffff0000, v234
    v_lshlrev_b32 v158, 16, v235
    v_and_b32 v159, 0xffff0000, v235
    v_pk_mul_f32 v[152:153], v[152:153], s[42:43]
    v_pk_mul_f32 v[154:155], v[154:155], s[42:43]
    v_pk_mul_f32 v[156:157], v[156:157], s[42:43]
    v_pk_mul_f32 v[158:159], v[158:159], s[42:43]
    v_cvt_pk_bf16_f32 v232, v152, v153
    v_cvt_pk_bf16_f32 v233, v154, v155
    v_cvt_pk_bf16_f32 v234, v156, v157
    v_cvt_pk_bf16_f32 v235, v158, v159
    s_add_u32 m0, s33, 36864
    s_nop 0
    buffer_load_dwordx4 v8, s[16:19], s29 offen nt lds
    s_waitcnt vmcnt(14)
    v_lshlrev_b32 v152, 16, v236
    v_and_b32 v153, 0xffff0000, v236
    v_lshlrev_b32 v154, 16, v237
    v_and_b32 v155, 0xffff0000, v237
    v_lshlrev_b32 v156, 16, v238
    v_and_b32 v157, 0xffff0000, v238
    v_lshlrev_b32 v158, 16, v239
    v_and_b32 v159, 0xffff0000, v239
    v_pk_mul_f32 v[152:153], v[152:153], s[42:43]
    v_pk_mul_f32 v[154:155], v[154:155], s[42:43]
    v_pk_mul_f32 v[156:157], v[156:157], s[42:43]
    v_pk_mul_f32 v[158:159], v[158:159], s[42:43]
    v_cvt_pk_bf16_f32 v236, v152, v153
    v_cvt_pk_bf16_f32 v237, v154, v155
    v_cvt_pk_bf16_f32 v238, v156, v157
    v_cvt_pk_bf16_f32 v239, v158, v159
    s_add_u32 m0, s33, 37760
    s_nop 0
    buffer_load_dwordx4 v8, s[16:19], s29 offen offset:128 nt lds
    s_waitcnt vmcnt(14)
    v_lshlrev_b32 v152, 16, v240
    v_and_b32 v153, 0xffff0000, v240
    v_lshlrev_b32 v154, 16, v241
    v_and_b32 v155, 0xffff0000, v241
    v_lshlrev_b32 v156, 16, v242
    v_and_b32 v157, 0xffff0000, v242
    v_lshlrev_b32 v158, 16, v243
    v_and_b32 v159, 0xffff0000, v243
    v_pk_mul_f32 v[152:153], v[152:153], s[42:43]
    v_pk_mul_f32 v[154:155], v[154:155], s[42:43]
    v_pk_mul_f32 v[156:157], v[156:157], s[42:43]
    v_pk_mul_f32 v[158:159], v[158:159], s[42:43]
    v_cvt_pk_bf16_f32 v240, v152, v153
    v_cvt_pk_bf16_f32 v241, v154, v155
    v_cvt_pk_bf16_f32 v242, v156, v157
    v_cvt_pk_bf16_f32 v243, v158, v159
    s_add_u32 m0, s33, 38656
    s_nop 0
    buffer_load_dwordx4 v8, s[16:19], s29 offen offset:256 nt lds
    s_add_u32 s29, s29, 12288
    s_waitcnt vmcnt(14)
    v_lshlrev_b32 v152, 16, v244
    v_and_b32 v153, 0xffff0000, v244
    v_lshlrev_b32 v154, 16, v245
    v_and_b32 v155, 0xffff0000, v245
    v_lshlrev_b32 v156, 16, v246
    v_and_b32 v157, 0xffff0000, v246
    v_lshlrev_b32 v158, 16, v247
    v_and_b32 v159, 0xffff0000, v247
    v_pk_mul_f32 v[152:153], v[152:153], s[42:43]
    v_pk_mul_f32 v[154:155], v[154:155], s[42:43]
    v_pk_mul_f32 v[156:157], v[156:157], s[42:43]
    v_pk_mul_f32 v[158:159], v[158:159], s[42:43]
    v_cvt_pk_bf16_f32 v244, v152, v153
    v_cvt_pk_bf16_f32 v245, v154, v155
    v_cvt_pk_bf16_f32 v246, v156, v157
    v_cvt_pk_bf16_f32 v247, v158, v159
    s_waitcnt vmcnt(13)
    v_lshlrev_b32 v152, 16, v248
    v_and_b32 v153, 0xffff0000, v248
    v_lshlrev_b32 v154, 16, v249
    v_and_b32 v155, 0xffff0000, v249
    v_lshlrev_b32 v156, 16, v250
    v_and_b32 v157, 0xffff0000, v250
    v_lshlrev_b32 v158, 16, v251
    v_and_b32 v159, 0xffff0000, v251
    v_pk_mul_f32 v[152:153], v[152:153], s[42:43]
    v_pk_mul_f32 v[154:155], v[154:155], s[42:43]
    v_pk_mul_f32 v[156:157], v[156:157], s[42:43]
    v_pk_mul_f32 v[158:159], v[158:159], s[42:43]
    v_cvt_pk_bf16_f32 v248, v152, v153
    v_cvt_pk_bf16_f32 v249, v154, v155
    v_cvt_pk_bf16_f32 v250, v156, v157
    v_cvt_pk_bf16_f32 v251, v158, v159
    s_waitcnt vmcnt(12)
    v_lshlrev_b32 v152, 16, v252
    v_and_b32 v153, 0xffff0000, v252
    v_lshlrev_b32 v154, 16, v253
    v_and_b32 v155, 0xffff0000, v253
    v_lshlrev_b32 v156, 16, v254
    v_and_b32 v157, 0xffff0000, v254
    v_lshlrev_b32 v158, 16, v255
    v_and_b32 v159, 0xffff0000, v255
    v_pk_mul_f32 v[152:153], v[152:153], s[42:43]
    v_pk_mul_f32 v[154:155], v[154:155], s[42:43]
    v_pk_mul_f32 v[156:157], v[156:157], s[42:43]
    v_pk_mul_f32 v[158:159], v[158:159], s[42:43]
    v_cvt_pk_bf16_f32 v252, v152, v153
    v_cvt_pk_bf16_f32 v253, v154, v155
    v_cvt_pk_bf16_f32 v254, v156, v157
    v_cvt_pk_bf16_f32 v255, v158, v159
    s_add_u32 s48, s52, 0
    s_mul_i32 s49, s48, 165888
    s_add_u32 s24, s10, s49
    s_addc_u32 s25, s11, 0
    s_mov_b32 s37, s39
    s_mov_b32 s38, s40
    s_mov_b32 s48, 0x7149f2ca
    s_cmp_ge_u32 s38, 165888
    s_cselect_b32 s86, s48, 0xff800000
    s_xor_b32 s49, s53, 1
    s_mul_i32 s49, s49, 86016
    s_mul_i32 s50, s28, 18432
    s_add_u32 s39, s49, s50
    s_lshr_b32 s50, s28, 1
    s_mul_i32 s50, s50, 6144
    s_add_u32 s50, s50, 73728
    s_add_u32 s40, s49, s50
    s_mov_b32 s44, s39
    s_add_u32 s45, s39, 6144
    s_add_u32 s46, s39, 12288
    s_add_u32 s48, s52, 1
    s_mul_i32 s49, s48, 165888
    s_add_u32 s12, s4, s49
    s_addc_u32 s13, s5, 0
    s_mov_b32 s80, s12
    s_mov_b32 s81, s13
    s_mov_b32 s82, 0
    s_mov_b32 s84, s39
    s_mov_b32 s89, s90
    s_add_u32 s96, s39, 24576
    s_and_b32 s48, s28, 1
    s_mul_i32 s48, s48, 3072
    s_add_u32 s97, s40, s48
    s_min_u32 s97, s97, 162816
    s_mov_b32 s85, -13056
    s_add_u32 s48, s90, 13056
    v_lshl_add_u32 v44, v1, 4, s48
    v_mfma_f32_16x16x32_bf16 v[88:91], a[192:195], v[232:235], 0
    v_exp_f32 v83, v83
    v_mfma_f32_16x16x32_bf16 v[88:91], a[196:199], v[236:239], v[88:91]
    v_cvt_pk_bf16_f32 v120, v80, v81
    v_cvt_pk_bf16_f32 v121, v82, v83
    v_mfma_f32_16x16x32_bf16 v[88:91], a[200:203], v[240:243], v[88:91]
    v_add_f32 v18, v18, v80
    v_add_f32 v18, v18, v81
    v_mfma_f32_16x16x32_bf16 v[88:91], a[204:207], v[244:247], v[88:91]
    v_add_f32 v18, v18, v82
    v_add_f32 v18, v18, v83
    v_mfma_f32_16x16x32_bf16 v[88:91], a[208:211], v[248:251], v[88:91]
    v_exp_f32 v84, v84
    v_mfma_f32_16x16x32_bf16 v[88:91], a[212:215], v[252:255], v[88:91]
    v_exp_f32 v85, v85
    v_mfma_f32_16x16x32_bf16 v[92:95], a[216:219], v[232:235], 0
    v_exp_f32 v86, v86
    v_mfma_f32_16x16x32_bf16 v[92:95], a[220:223], v[236:239], v[92:95]
    v_exp_f32 v87, v87
    v_mfma_f32_16x16x32_bf16 v[92:95], a[224:227], v[240:243], v[92:95]
    v_cvt_pk_bf16_f32 v122, v84, v85
    v_cvt_pk_bf16_f32 v123, v86, v87
    v_mfma_f32_16x16x32_bf16 v[92:95], a[228:231], v[244:247], v[92:95]
    v_add_f32 v18, v18, v84
    v_add_f32 v18, v18, v85
    v_mfma_f32_16x16x32_bf16 v[92:95], a[232:235], v[248:251], v[92:95]
    v_add_f32 v18, v18, v86
    v_add_f32 v18, v18, v87
    v_mfma_f32_16x16x32_bf16 v[92:95], a[236:239], v[252:255], v[92:95]
    v_max3_f32 v28, v16, v17, v18
    s_waitcnt vmcnt(9)
    s_barrier
    ds_read_b128 a[192:195], v2 offset:24576
    ds_read_b128 a[196:199], v3 offset:24576
    ds_read_b128 a[200:203], v2 offset:25600
    ds_read_b128 a[204:207], v3 offset:25600
    ds_read_b128 a[208:211], v2 offset:26624
    ds_read_b128 a[212:215], v3 offset:26624
    ds_read_b128 a[216:219], v2 offset:30720
    ds_read_b128 a[220:223], v3 offset:30720
    ds_read_b128 a[224:227], v2 offset:31744
    ds_read_b128 a[228:231], v3 offset:31744
    ds_read_b128 a[232:235], v2 offset:32768
    ds_read_b128 a[236:239], v3 offset:32768
    s_add_u32 m0, s33, 0
    s_nop 0
    buffer_load_dwordx4 v8, s[16:19], s29 offen nt lds
    s_add_u32 m0, s33, 896
    s_nop 0
    buffer_load_dwordx4 v8, s[16:19], s29 offen offset:128 nt lds
    s_add_u32 m0, s33, 1792
    s_nop 0
    buffer_load_dwordx4 v8, s[16:19], s29 offen offset:256 nt lds
    s_add_u32 s29, s29, 12288
    s_add_u32 m0, s33, 73728
    s_nop 0
    buffer_load_dwordx4 v9, s[20:23], s30 offen nt lds
    s_add_u32 m0, s33, 86016
    s_nop 0
    buffer_load_dwordx4 v9, s[20:23], s32 offen nt lds
    s_waitcnt vmcnt(5) lgkmcnt(0)
    s_barrier
    v_mfma_f32_16x16x32_bf16 v[64:67], a[192:195], v[160:163], v[48:51]
    s_add_u32 m0, s33, 12288
    ds_read_b64_tr_b16 v[152:153], v4
    ds_read_b64_tr_b16 v[154:155], v4 offset:6144
    v_mfma_f32_16x16x32_bf16 v[64:67], a[196:199], v[164:167], v[64:67]
    buffer_load_dwordx4 v8, s[16:19], s29 offen nt lds
    v_mfma_f32_16x16x32_bf16 v[64:67], a[200:203], v[168:171], v[64:67]
    ds_read_b64_tr_b16 v[156:157], v4 offset:12288
    v_max3_f32 v38, v88, v89, v90
    v_mfma_f32_16x16x32_bf16 v[64:67], a[204:207], v[172:175], v[64:67]
    ds_read_b64_tr_b16 v[158:159], v4 offset:18432
    v_max3_f32 v38, v38, v91, v92
    v_mfma_f32_16x16x32_bf16 v[64:67], a[208:211], v[176:179], v[64:67]
    ds_read_b64_tr_b16 a[240:241], v5
    v_max3_f32 v38, v38, v93, v94
    v_mfma_f32_16x16x32_bf16 v[64:67], a[212:215], v[180:183], v[64:67]
    ds_read_b64_tr_b16 a[242:243], v5 offset:6144
    v_max3_f32 v38, v38, v95, s86
    v_mfma_f32_16x16x32_bf16 v[72:75], a[192:195], v[184:187], v[52:55]
    ds_read_b64_tr_b16 a[244:245], v5 offset:12288
    v_mov_b32 v39, v38
    v_mfma_f32_16x16x32_bf16 v[72:75], a[196:199], v[188:191], v[72:75]
    ds_read_b64_tr_b16 a[246:247], v5 offset:18432
    ds_read_b64_tr_b16 a[248:249], v6
    v_mfma_f32_16x16x32_bf16 v[72:75], a[200:203], v[192:195], v[72:75]
    v_permlane32_swap_b32 v38, v39
    v_mfma_f32_16x16x32_bf16 v[72:75], a[204:207], v[196:199], v[72:75]
    v_max_f32 v38, v38, v39
    v_mov_b32 v39, v38
    s_nop 1
    v_permlane16_swap_b32 v38, v39
    v_max_f32 v38, v38, v39
    v_mfma_f32_16x16x32_bf16 v[72:75], a[208:211], v[200:203], v[72:75]
    s_add_u32 m0, s33, 13184
    ds_read_b64_tr_b16 a[250:251], v6 offset:6144
    v_sub_f32 v88, v88, v38
    v_mfma_f32_16x16x32_bf16 v[72:75], a[212:215], v[204:207], v[72:75]
    buffer_load_dwordx4 v8, s[16:19], s29 offen offset:128 nt lds
    v_sub_f32 v89, v89, v38
    v_sub_f32 v90, v90, v38
    v_sub_f32 v91, v91, v38
    v_sub_f32 v92, v92, v38
    v_sub_f32 v93, v93, v38
    v_sub_f32 v94, v94, v38
    v_sub_f32 v95, v95, v38
    v_mfma_f32_16x16x32_bf16 v[80:83], a[192:195], v[208:211], v[56:59]
    v_exp_f32 v88, v88
    v_mfma_f32_16x16x32_bf16 v[80:83], a[196:199], v[212:215], v[80:83]
    v_exp_f32 v89, v89
    v_mfma_f32_16x16x32_bf16 v[80:83], a[200:203], v[216:219], v[80:83]
    v_exp_f32 v90, v90
    v_exp_f32 v91, v91
    v_mfma_f32_16x16x32_bf16 v[80:83], a[204:207], v[220:223], v[80:83]
    ds_read_b64_tr_b16 a[252:253], v6 offset:12288
    v_sub_f32 v60, 0, v38
    v_mfma_f32_16x16x32_bf16 v[80:83], a[208:211], v[224:227], v[80:83]
    v_sub_f32 v61, 0, v38
    v_sub_f32 v62, 0, v38
    v_sub_f32 v63, 0, v38
    v_mfma_f32_16x16x32_bf16 v[80:83], a[212:215], v[228:231], v[80:83]
    s_add_u32 m0, s33, 14080
    v_cvt_pk_bf16_f32 v108, v88, v89
    v_cvt_pk_bf16_f32 v109, v90, v91
    v_add_f32 v22, v88, v89
    v_add_f32 v22, v22, v90
    v_add_f32 v22, v22, v91
    v_mfma_f32_16x16x32_bf16 v[88:91], a[192:195], v[232:235], v[60:63]
    buffer_load_dwordx4 v8, s[16:19], s29 offen offset:256 nt lds
    v_mfma_f32_16x16x32_bf16 v[88:91], a[196:199], v[236:239], v[88:91]
    s_add_u32 s29, s29, 12288
    v_exp_f32 v92, v92
    v_mfma_f32_16x16x32_bf16 v[88:91], a[200:203], v[240:243], v[88:91]
    ds_read_b128 a[192:195], v2 offset:36864
    v_add_f32 v22, v22, v92
    v_mfma_f32_16x16x32_bf16 v[88:91], a[204:207], v[244:247], v[88:91]
    s_add_u32 m0, s33, 74624
    v_exp_f32 v93, v93
    v_mfma_f32_16x16x32_bf16 v[88:91], a[208:211], v[248:251], v[88:91]
    buffer_load_dwordx4 v9, s[20:23], s30 offen offset:128 nt lds
    v_mfma_f32_16x16x32_bf16 v[88:91], a[212:215], v[252:255], v[88:91]
    ds_read_b128 a[196:199], v3 offset:36864
    v_cvt_pk_bf16_f32 v110, v92, v93
    v_mfma_f32_16x16x32_bf16 v[68:71], a[216:219], v[160:163], v[48:51]
    v_exp_f32 v94, v94
    v_mfma_f32_16x16x32_bf16 v[68:71], a[220:223], v[164:167], v[68:71]
    ds_read_b128 a[200:203], v2 offset:37888
    v_add_f32 v22, v22, v93
    v_mfma_f32_16x16x32_bf16 v[68:71], a[224:227], v[168:171], v[68:71]
    v_exp_f32 v95, v95
    v_mfma_f32_16x16x32_bf16 v[68:71], a[228:231], v[172:175], v[68:71]
    ds_read_b128 a[204:207], v3 offset:37888
    v_cvt_pk_bf16_f32 v111, v94, v95
    v_mfma_f32_16x16x32_bf16 v[68:71], a[232:235], v[176:179], v[68:71]
    s_add_u32 m0, s33, 75520
    ds_read_b64_tr_b16 a[254:255], v6 offset:18432
    v_add_f32 v22, v22, v94
    v_mfma_f32_16x16x32_bf16 v[68:71], a[236:239], v[180:183], v[68:71]
    buffer_load_dwordx4 v9, s[20:23], s30 offen offset:256 nt lds
    v_mfma_f32_16x16x32_bf16 v[76:79], a[216:219], v[184:187], v[52:55]
    ds_read_b128 a[208:211], v2 offset:38912
    v_add_f32 v22, v22, v95
    v_mfma_f32_16x16x32_bf16 v[76:79], a[220:223], v[188:191], v[76:79]
    v_max_f32 v28, v28, v22
    v_mfma_f32_16x16x32_bf16 v[76:79], a[224:227], v[192:195], v[76:79]
    v_exp_f32 v64, v64
    v_mfma_f32_16x16x32_bf16 v[76:79], a[228:231], v[196:199], v[76:79]
    v_exp_f32 v65, v65
    v_mfma_f32_16x16x32_bf16 v[76:79], a[232:235], v[200:203], v[76:79]
    ds_read_b128 a[212:215], v3 offset:38912
    v_cvt_pk_bf16_f32 v124, v64, v65
    v_mfma_f32_16x16x32_bf16 v[76:79], a[236:239], v[204:207], v[76:79]
    s_add_u32 m0, s33, 86912
    v_exp_f32 v66, v66
    v_mfma_f32_16x16x32_bf16 v[84:87], a[216:219], v[208:211], v[56:59]
    buffer_load_dwordx4 v9, s[20:23], s32 offen offset:128 nt lds
    v_mfma_f32_16x16x32_bf16 v[84:87], a[220:223], v[212:215], v[84:87]
    v_exp_f32 v67, v67
    v_mfma_f32_16x16x32_bf16 v[84:87], a[224:227], v[216:219], v[84:87]
    v_cvt_pk_bf16_f32 v125, v66, v67
    v_add_f32 v19, v64, v65
    v_mfma_f32_16x16x32_bf16 v[84:87], a[228:231], v[220:223], v[84:87]
    v_add_f32 v19, v19, v66
    v_add_f32 v19, v19, v67
    v_mfma_f32_16x16x32_bf16 v[84:87], a[232:235], v[224:227], v[84:87]
    v_exp_f32 v72, v72
    v_mfma_f32_16x16x32_bf16 v[84:87], a[236:239], v[228:231], v[84:87]
    v_exp_f32 v73, v73
    v_mfma_f32_16x16x32_bf16 v[92:95], a[216:219], v[232:235], v[60:63]
    ds_read_b128 a[216:219], v2 offset:43008
    v_cvt_pk_bf16_f32 v128, v72, v73
    v_mfma_f32_16x16x32_bf16 v[92:95], a[220:223], v[236:239], v[92:95]
    s_add_u32 m0, s33, 87808
    v_cmp_lt_f32 vcc, s35, v28
    v_add_f32 v20, v72, v73
    v_mfma_f32_16x16x32_bf16 v[92:95], a[224:227], v[240:243], v[92:95]
    buffer_load_dwordx4 v9, s[20:23], s32 offen offset:256 nt lds
    v_mfma_f32_16x16x32_bf16 v[92:95], a[228:231], v[244:247], v[92:95]
    s_add_u32 s30, s30, 24576
    v_exp_f32 v74, v74
    v_mfma_f32_16x16x32_bf16 v[92:95], a[232:235], v[248:251], v[92:95]
    s_add_u32 s32, s32, 24576
    ds_read_b128 a[220:223], v3 offset:43008
    v_add_f32 v20, v20, v74
    v_mfma_f32_16x16x32_bf16 v[92:95], a[236:239], v[252:255], v[92:95]
    s_waitcnt lgkmcnt(2)
    s_cbranch_vccnz L_s0_2c_rare
L_s0_2c_back:
    v_exp_f32 v75, v75
    v_mfma_f32_16x16x32_bf16 a[144:147], v[152:155], v[108:111], 0
    ds_read_b128 a[224:227], v2 offset:44032
    v_mov_b32 v12, v16
    v_mfma_f32_16x16x32_bf16 a[0:3], v[152:155], v[96:99], 0
    s_add_u32 m0, s33, 24576
    v_mov_b32 v13, v17
    v_mov_b32 v14, v18
    v_mfma_f32_16x16x32_bf16 a[0:3], v[156:159], v[112:115], a[0:3]
    buffer_load_dwordx4 v8, s[16:19], s29 offen nt lds
    v_mfma_f32_16x16x32_bf16 a[48:51], v[152:155], v[100:103], 0
    ds_read_b128 a[228:231], v3 offset:44032
    v_mov_b32 v15, v22
    v_mfma_f32_16x16x32_bf16 a[48:51], v[156:159], v[116:119], a[48:51]
    v_cvt_pk_bf16_f32 v129, v74, v75
    v_add_f32 v20, v20, v75
    v_mfma_f32_16x16x32_bf16 a[96:99], v[152:155], v[104:107], 0
    v_exp_f32 v80, v80
    v_mfma_f32_16x16x32_bf16 a[96:99], v[156:159], v[120:123], a[96:99]
    v_exp_f32 v81, v81
    v_mfma_f32_16x16x32_bf16 a[148:151], a[240:243], v[108:111], 0
    ds_read_b64_tr_b16 v[152:153], v7
    v_cvt_pk_bf16_f32 v132, v80, v81
    v_mfma_f32_16x16x32_bf16 a[4:7], a[240:243], v[96:99], 0
    s_add_u32 m0, s33, 25472
    ds_read_b64_tr_b16 v[154:155], v7 offset:6144
    v_add_f32 v21, v80, v81
    v_mfma_f32_16x16x32_bf16 a[4:7], a[244:247], v[112:115], a[4:7]
    buffer_load_dwordx4 v8, s[16:19], s29 offen offset:128 nt lds
    v_mfma_f32_16x16x32_bf16 a[52:55], a[240:243], v[100:103], 0
    ds_read_b128 a[232:235], v2 offset:45056
    v_mfma_f32_16x16x32_bf16 a[52:55], a[244:247], v[116:119], a[52:55]
    ds_read_b64_tr_b16 v[156:157], v7 offset:12288
    ds_read_b64_tr_b16 v[158:159], v7 offset:18432
    v_mfma_f32_16x16x32_bf16 a[100:103], a[240:243], v[104:107], 0
    v_exp_f32 v82, v82
    v_mfma_f32_16x16x32_bf16 a[100:103], a[244:247], v[120:123], a[100:103]
    ds_read_b128 a[236:239], v3 offset:45056
    v_add_f32 v21, v21, v82
    v_mfma_f32_16x16x32_bf16 a[152:155], a[248:251], v[108:111], 0
    s_add_u32 m0, s33, 26368
    v_exp_f32 v83, v83
    v_mfma_f32_16x16x32_bf16 a[8:11], a[248:251], v[96:99], 0
    s_waitcnt vmcnt(11)
    ds_inc_u32 v46, v46
    v_cvt_pk_bf16_f32 v133, v82, v83
    v_mfma_f32_16x16x32_bf16 a[8:11], a[252:255], v[112:115], a[8:11]
    buffer_load_dwordx4 v8, s[16:19], s29 offen offset:256 nt lds
    v_mfma_f32_16x16x32_bf16 a[56:59], a[248:251], v[100:103], 0
    s_add_u32 s29, s29, 12288
    v_exp_f32 v68, v68
    v_mfma_f32_16x16x32_bf16 a[56:59], a[252:255], v[116:119], a[56:59]
    v_add_f32 v21, v21, v83
    v_add_f32 v19, v19, v68
    v_mfma_f32_16x16x32_bf16 a[104:107], a[248:251], v[104:107], 0
    v_exp_f32 v69, v69
    v_mfma_f32_16x16x32_bf16 a[104:107], a[252:255], v[120:123], a[104:107]
    s_waitcnt lgkmcnt(1)
    v_exp_f32 v70, v70
    v_mfma_f32_16x16x32_bf16 a[156:159], v[152:155], v[108:111], 0
    v_exp_f32 v71, v71
    v_mfma_f32_16x16x32_bf16 a[12:15], v[152:155], v[96:99], 0
    v_cvt_pk_bf16_f32 v126, v68, v69
    v_cvt_pk_bf16_f32 v127, v70, v71
    v_mfma_f32_16x16x32_bf16 a[12:15], v[156:159], v[112:115], a[12:15]
    v_add_f32 v19, v19, v69
    v_add_f32 v19, v19, v70
    v_mfma_f32_16x16x32_bf16 a[60:63], v[152:155], v[100:103], 0
    v_exp_f32 v76, v76
    v_mfma_f32_16x16x32_bf16 a[60:63], v[156:159], v[116:119], a[60:63]
    v_add_f32 v19, v19, v71
    v_add_f32 v20, v20, v76
    v_mfma_f32_16x16x32_bf16 a[108:111], v[152:155], v[104:107], 0
    v_exp_f32 v77, v77
    v_mfma_f32_16x16x32_bf16 a[108:111], v[156:159], v[120:123], a[108:111]
    v_exp_f32 v78, v78
    v_mfma_f32_16x16x32_bf16 v[64:67], a[192:195], v[160:163], v[48:51]
    v_exp_f32 v79, v79
    v_mfma_f32_16x16x32_bf16 v[64:67], a[196:199], v[164:167], v[64:67]
    ds_read_b32 v30, v46
    v_cvt_pk_bf16_f32 v130, v76, v77
    v_mfma_f32_16x16x32_bf16 v[64:67], a[200:203], v[168:171], v[64:67]
    v_cvt_pk_bf16_f32 v131, v78, v79
    v_add_f32 v20, v20, v77
    v_mfma_f32_16x16x32_bf16 v[64:67], a[204:207], v[172:175], v[64:67]
    v_add_f32 v20, v20, v78
    v_add_f32 v20, v20, v79
    v_mfma_f32_16x16x32_bf16 v[64:67], a[208:211], v[176:179], v[64:67]
    v_exp_f32 v84, v84
    v_mfma_f32_16x16x32_bf16 v[64:67], a[212:215], v[180:183], v[64:67]
    v_exp_f32 v85, v85
    v_mfma_f32_16x16x32_bf16 v[72:75], a[192:195], v[184:187], v[52:55]
    v_exp_f32 v86, v86
    v_mfma_f32_16x16x32_bf16 v[72:75], a[196:199], v[188:191], v[72:75]
    v_exp_f32 v87, v87
    v_mfma_f32_16x16x32_bf16 v[72:75], a[200:203], v[192:195], v[72:75]
    s_waitcnt lgkmcnt(0)
    v_cmp_gt_u32 vcc, s93, v30
    v_cvt_pk_bf16_f32 v134, v84, v85
    v_mfma_f32_16x16x32_bf16 v[72:75], a[204:207], v[196:199], v[72:75]
    v_cvt_pk_bf16_f32 v135, v86, v87
    v_add_f32 v21, v21, v84
    v_mfma_f32_16x16x32_bf16 v[72:75], a[208:211], v[200:203], v[72:75]
    s_add_u32 m0, s33, 49152
    v_add_f32 v21, v21, v85
    v_add_f32 v21, v21, v86
    v_mfma_f32_16x16x32_bf16 v[72:75], a[212:215], v[204:207], v[72:75]
    s_cbranch_vccnz L_s0_3s_rare
L_s0_3s_back:
    ds_read_b64_tr_b16 a[240:241], v4 offset:1024
    v_add_f32 v21, v21, v87
    v_mfma_f32_16x16x32_bf16 v[80:83], a[192:195], v[208:211], v[56:59]
    s_add_u32 s93, s93, 4
    buffer_load_dwordx4 v9, s[20:23], s30 offen nt lds
    v_mfma_f32_16x16x32_bf16 v[80:83], a[196:199], v[212:215], v[80:83]
    v_exp_f32 v88, v88
    v_mfma_f32_16x16x32_bf16 v[80:83], a[200:203], v[216:219], v[80:83]
    v_exp_f32 v89, v89
    v_mfma_f32_16x16x32_bf16 v[80:83], a[204:207], v[220:223], v[80:83]
    ds_read_b64_tr_b16 a[242:243], v4 offset:7168
    v_cvt_pk_bf16_f32 v136, v88, v89
    v_mfma_f32_16x16x32_bf16 v[80:83], a[208:211], v[224:227], v[80:83]
    ds_read_b64_tr_b16 a[244:245], v4 offset:13312
    v_add_f32 v22, v88, v89
    v_mfma_f32_16x16x32_bf16 v[80:83], a[212:215], v[228:231], v[80:83]
    v_exp_f32 v90, v90
    v_mfma_f32_16x16x32_bf16 v[68:71], a[216:219], v[160:163], v[48:51]
    ds_read_b64_tr_b16 a[246:247], v4 offset:19456
    v_add_f32 v22, v22, v90
    v_mfma_f32_16x16x32_bf16 v[68:71], a[220:223], v[164:167], v[68:71]
    v_exp_f32 v91, v91
    v_mfma_f32_16x16x32_bf16 v[68:71], a[224:227], v[168:171], v[68:71]
    ds_read_b64_tr_b16 a[248:249], v5 offset:1024
    v_cvt_pk_bf16_f32 v137, v90, v91
    v_mfma_f32_16x16x32_bf16 v[68:71], a[228:231], v[172:175], v[68:71]
    s_add_u32 m0, s33, 61440
    ds_read_b64_tr_b16 a[250:251], v5 offset:7168
    v_add_f32 v22, v22, v91
    v_mfma_f32_16x16x32_bf16 v[68:71], a[232:235], v[176:179], v[68:71]
    buffer_load_dwordx4 v9, s[20:23], s32 offen nt lds
    v_mfma_f32_16x16x32_bf16 v[68:71], a[236:239], v[180:183], v[68:71]
    v_exp_f32 v92, v92
    v_mfma_f32_16x16x32_bf16 v[76:79], a[216:219], v[184:187], v[52:55]
    ds_read_b64_tr_b16 a[252:253], v5 offset:13312
    v_add_f32 v22, v22, v92
    v_mfma_f32_16x16x32_bf16 v[76:79], a[220:223], v[188:191], v[76:79]
    v_exp_f32 v93, v93
    v_mfma_f32_16x16x32_bf16 v[76:79], a[224:227], v[192:195], v[76:79]
    ds_read_b64_tr_b16 a[254:255], v5 offset:19456
    v_cvt_pk_bf16_f32 v138, v92, v93
    v_mfma_f32_16x16x32_bf16 v[76:79], a[228:231], v[196:199], v[76:79]
    ds_read_b64_tr_b16 v[152:153], v6 offset:1024
    v_add_f32 v22, v22, v93
    v_mfma_f32_16x16x32_bf16 v[76:79], a[232:235], v[200:203], v[76:79]
    v_exp_f32 v94, v94
    v_mfma_f32_16x16x32_bf16 v[76:79], a[236:239], v[204:207], v[76:79]
    ds_read_b64_tr_b16 v[154:155], v6 offset:7168
    v_add_f32 v22, v22, v94
    v_mfma_f32_16x16x32_bf16 v[84:87], a[216:219], v[208:211], v[56:59]
    v_exp_f32 v95, v95
    v_mfma_f32_16x16x32_bf16 v[84:87], a[220:223], v[212:215], v[84:87]
    s_add_u32 m0, s33, 36864
    ds_read_b64_tr_b16 v[156:157], v6 offset:13312
    v_cvt_pk_bf16_f32 v139, v94, v95
    v_mfma_f32_16x16x32_bf16 v[84:87], a[224:227], v[216:219], v[84:87]
    buffer_load_dwordx4 v8, s[16:19], s29 offen nt lds
    v_mfma_f32_16x16x32_bf16 v[84:87], a[228:231], v[220:223], v[84:87]
    ds_read_b64_tr_b16 v[158:159], v6 offset:19456
    v_add_f32 v22, v22, v95
    v_mfma_f32_16x16x32_bf16 v[84:87], a[232:235], v[224:227], v[84:87]
    v_exp_f32 v64, v64
    v_mfma_f32_16x16x32_bf16 v[84:87], a[236:239], v[228:231], v[84:87]
    s_waitcnt lgkmcnt(3)
    ds_read_b128 a[192:195], v2
    v_add_f32 v19, v19, v64
    v_mfma_f32_16x16x32_bf16 a[160:163], a[240:243], v[108:111], 0
    v_exp_f32 v65, v65
    v_mfma_f32_16x16x32_bf16 a[16:19], a[240:243], v[96:99], 0
    ds_read_b128 a[196:199], v3
    v_cvt_pk_bf16_f32 v140, v64, v65
    v_mfma_f32_16x16x32_bf16 a[16:19], a[244:247], v[112:115], a[16:19]
    v_exp_f32 v66, v66
    v_mfma_f32_16x16x32_bf16 a[64:67], a[240:243], v[100:103], 0
    ds_read_b128 a[200:203], v2 offset:1024
    v_add_f32 v19, v19, v65
    v_mfma_f32_16x16x32_bf16 a[64:67], a[244:247], v[116:119], a[64:67]
    v_exp_f32 v67, v67
    v_mfma_f32_16x16x32_bf16 a[112:115], a[240:243], v[104:107], 0
    s_add_u32 m0, s33, 37760
    ds_read_b64_tr_b16 a[240:241], v7 offset:1024
    v_cvt_pk_bf16_f32 v141, v66, v67
    v_mfma_f32_16x16x32_bf16 a[112:115], a[244:247], v[120:123], a[112:115]
    buffer_load_dwordx4 v8, s[16:19], s29 offen offset:128 nt lds
    v_mfma_f32_16x16x32_bf16 a[164:167], a[248:251], v[108:111], 0
    ds_read_b64_tr_b16 a[242:243], v7 offset:7168
    v_add_f32 v19, v19, v66
    v_mfma_f32_16x16x32_bf16 a[20:23], a[248:251], v[96:99], 0
    ds_read_b64_tr_b16 a[244:245], v7 offset:13312
    v_add_f32 v19, v19, v67
    v_mfma_f32_16x16x32_bf16 a[20:23], a[252:255], v[112:115], a[20:23]
    v_exp_f32 v68, v68
    v_mfma_f32_16x16x32_bf16 a[68:71], a[248:251], v[100:103], 0
    ds_read_b64_tr_b16 a[246:247], v7 offset:19456
    v_add_f32 v19, v19, v68
    v_mfma_f32_16x16x32_bf16 a[68:71], a[252:255], v[116:119], a[68:71]
    v_exp_f32 v69, v69
    v_mfma_f32_16x16x32_bf16 a[116:119], a[248:251], v[104:107], 0
    ds_read_b64_tr_b16 a[248:249], v4 offset:2048
    v_cvt_pk_bf16_f32 v142, v68, v69
    v_mfma_f32_16x16x32_bf16 a[116:119], a[252:255], v[120:123], a[116:119]
    s_waitcnt lgkmcnt(4)
    ds_read_b64_tr_b16 a[250:251], v4 offset:8192
    v_add_f32 v19, v19, v69
    v_mfma_f32_16x16x32_bf16 a[168:171], v[152:155], v[108:111], 0
    v_exp_f32 v70, v70
    v_mfma_f32_16x16x32_bf16 a[24:27], v[152:155], v[96:99], 0
    s_add_u32 m0, s33, 38656
    ds_read_b128 a[204:207], v3 offset:1024
    v_add_f32 v19, v19, v70
    v_mfma_f32_16x16x32_bf16 a[24:27], v[156:159], v[112:115], a[24:27]
    buffer_load_dwordx4 v8, s[16:19], s29 offen offset:256 nt lds
    v_mfma_f32_16x16x32_bf16 a[72:75], v[152:155], v[100:103], 0
    s_add_u32 s29, s29, 12288
    v_exp_f32 v71, v71
    v_mfma_f32_16x16x32_bf16 a[72:75], v[156:159], v[116:119], a[72:75]
    ds_read_b64_tr_b16 a[252:253], v4 offset:14336
    v_cvt_pk_bf16_f32 v143, v70, v71
    v_mfma_f32_16x16x32_bf16 a[120:123], v[152:155], v[104:107], 0
    ds_read_b64_tr_b16 a[254:255], v4 offset:20480
    v_add_f32 v19, v19, v71
    v_mfma_f32_16x16x32_bf16 a[120:123], v[156:159], v[120:123], a[120:123]
    s_waitcnt lgkmcnt(3)
    ds_read_b128 a[208:211], v2 offset:2048
    v_mfma_f32_16x16x32_bf16 a[172:175], a[240:243], v[108:111], 0
    v_exp_f32 v72, v72
    v_mfma_f32_16x16x32_bf16 a[28:31], a[240:243], v[96:99], 0
    ds_read_b64_tr_b16 v[152:153], v5 offset:2048
    v_add_f32 v20, v20, v72
    v_mfma_f32_16x16x32_bf16 a[28:31], a[244:247], v[112:115], a[28:31]
    ds_read_b64_tr_b16 v[154:155], v5 offset:8192
    ds_read_b64_tr_b16 v[156:157], v5 offset:14336
    v_mfma_f32_16x16x32_bf16 a[76:79], a[240:243], v[100:103], 0
    ds_read_b128 a[212:215], v3 offset:2048
    v_mfma_f32_16x16x32_bf16 a[76:79], a[244:247], v[116:119], a[76:79]
    ds_read_b64_tr_b16 v[158:159], v5 offset:20480
    v_mfma_f32_16x16x32_bf16 a[124:127], a[240:243], v[104:107], 0
    ds_read_b128 a[216:219], v2 offset:6144
    v_mfma_f32_16x16x32_bf16 a[124:127], a[244:247], v[120:123], a[124:127]
    v_exp_f32 v73, v73
    v_mfma_f32_16x16x32_bf16 a[176:179], a[248:251], v[108:111], 0
    ds_read_b128 a[220:223], v3 offset:6144
    v_cvt_pk_bf16_f32 v144, v72, v73
    v_mfma_f32_16x16x32_bf16 a[32:35], a[248:251], v[96:99], 0
    s_waitcnt lgkmcnt(6)
    ds_read_b64_tr_b16 a[240:241], v6 offset:2048
    v_add_f32 v20, v20, v73
    v_mfma_f32_16x16x32_bf16 a[32:35], a[252:255], v[112:115], a[32:35]
    ds_read_b64_tr_b16 a[242:243], v6 offset:8192
    ds_read_b64_tr_b16 a[244:245], v6 offset:14336
    v_mfma_f32_16x16x32_bf16 a[80:83], a[248:251], v[100:103], 0
    v_exp_f32 v74, v74
    v_mfma_f32_16x16x32_bf16 a[80:83], a[252:255], v[116:119], a[80:83]
    ds_read_b64_tr_b16 a[246:247], v6 offset:20480
    v_add_f32 v20, v20, v74
    v_mfma_f32_16x16x32_bf16 a[128:131], a[248:251], v[104:107], 0
    ds_read_b128 a[224:227], v2 offset:7168
    v_mfma_f32_16x16x32_bf16 a[128:131], a[252:255], v[120:123], a[128:131]
    s_waitcnt lgkmcnt(6)
    v_exp_f32 v75, v75
    v_mfma_f32_16x16x32_bf16 a[180:183], v[152:155], v[108:111], 0
    ds_read_b128 a[228:231], v3 offset:7168
    v_cvt_pk_bf16_f32 v145, v74, v75
    v_mfma_f32_16x16x32_bf16 a[36:39], v[152:155], v[96:99], 0
    ds_read_b64_tr_b16 a[248:249], v7 offset:2048
    v_add_f32 v20, v20, v75
    v_mfma_f32_16x16x32_bf16 a[36:39], v[156:159], v[112:115], a[36:39]
    ds_read_b64_tr_b16 a[250:251], v7 offset:8192
    ds_read_b64_tr_b16 a[252:253], v7 offset:14336
    v_mfma_f32_16x16x32_bf16 a[84:87], v[152:155], v[100:103], 0
    ds_read_b128 a[232:235], v2 offset:8192
    v_mfma_f32_16x16x32_bf16 a[84:87], v[156:159], v[116:119], a[84:87]
    ds_read_b64_tr_b16 a[254:255], v7 offset:20480
    v_mfma_f32_16x16x32_bf16 a[132:135], v[152:155], v[104:107], 0
    v_exp_f32 v76, v76
    v_mfma_f32_16x16x32_bf16 a[132:135], v[156:159], v[120:123], a[132:135]
    s_waitcnt lgkmcnt(6)
    ds_read_b128 a[236:239], v3 offset:8192
    v_add_f32 v20, v20, v76
    v_mfma_f32_16x16x32_bf16 a[184:187], a[240:243], v[108:111], 0
    v_exp_f32 v77, v77
    v_mfma_f32_16x16x32_bf16 a[40:43], a[240:243], v[96:99], 0
    s_waitcnt vmcnt(12)
    ds_inc_u32 v46, v46
    v_cvt_pk_bf16_f32 v146, v76, v77
    v_mfma_f32_16x16x32_bf16 a[40:43], a[244:247], v[112:115], a[40:43]
    v_exp_f32 v78, v78
    v_mfma_f32_16x16x32_bf16 a[88:91], a[240:243], v[100:103], 0
    v_exp_f32 v79, v79
    v_mfma_f32_16x16x32_bf16 a[88:91], a[244:247], v[116:119], a[88:91]
    v_cvt_pk_bf16_f32 v147, v78, v79
    v_add_f32 v20, v20, v77
    v_mfma_f32_16x16x32_bf16 a[136:139], a[240:243], v[104:107], 0
    v_add_f32 v20, v20, v78
    v_add_f32 v20, v20, v79
    v_mfma_f32_16x16x32_bf16 a[136:139], a[244:247], v[120:123], a[136:139]
    s_waitcnt lgkmcnt(1)
    v_exp_f32 v80, v80
    v_mfma_f32_16x16x32_bf16 a[188:191], a[248:251], v[108:111], 0
    v_exp_f32 v81, v81
    v_mfma_f32_16x16x32_bf16 a[44:47], a[248:251], v[96:99], 0
    v_exp_f32 v82, v82
    v_mfma_f32_16x16x32_bf16 a[44:47], a[252:255], v[112:115], a[44:47]
    v_exp_f32 v83, v83
    v_mfma_f32_16x16x32_bf16 a[92:95], a[248:251], v[100:103], 0
    v_cvt_pk_bf16_f32 v148, v80, v81
    v_cvt_pk_bf16_f32 v149, v82, v83
    v_mfma_f32_16x16x32_bf16 a[92:95], a[252:255], v[116:119], a[92:95]
    v_exp_f32 v84, v84
    v_mfma_f32_16x16x32_bf16 a[140:143], a[248:251], v[104:107], 0
    v_exp_f32 v85, v85
    v_mfma_f32_16x16x32_bf16 a[140:143], a[252:255], v[120:123], a[140:143]
    v_exp_f32 v86, v86
    v_exp_f32 v87, v87
    v_cvt_pk_bf16_f32 v150, v84, v85
    v_cvt_pk_bf16_f32 v151, v86, v87
    v_add_f32 v21, v21, v80
    v_add_f32 v21, v21, v81
    v_add_f32 v21, v21, v82
    v_add_f32 v21, v21, v83
    v_add_f32 v21, v21, v84
    v_add_f32 v21, v21, v85
    v_add_f32 v21, v21, v86
    v_add_f32 v21, v21, v87
    v_max3_f32 v28, v19, v20, v21
    v_max_f32 v28, v28, v22
    s_mov_b32 s31, 6
.p2align 6
L_loop_00:
    v_mfma_f32_16x16x32_bf16 v[64:67], a[192:195], v[160:163], v[48:51]
    s_add_u32 s57, s31, 1
    s_and_b32 s57, s57, 4
    s_lshl_b32 s87, s57, 4
    v_mfma_f32_16x16x32_bf16 v[64:67], a[196:199], v[164:167], v[64:67]
    s_mul_i32 s91, s87, 48
    s_mul_i32 s82, s87, 2592
    ds_read_b32 v30, v46
    v_mfma_f32_16x16x32_bf16 v[64:67], a[200:203], v[168:171], v[64:67]
    s_sub_i32 s57, 1, s31
    s_max_i32 s57, s57, 0
    s_mul_i32 s57, s57, 768
    v_mfma_f32_16x16x32_bf16 v[64:67], a[204:207], v[172:175], v[64:67]
    s_add_u32 s89, s89, s57
    s_mul_i32 s57, s31, 3072
    s_sub_u32 s57, s96, s57
    s_cmp_ge_u32 s31, 3
    s_cselect_b32 s92, s57, s97
    v_mfma_f32_16x16x32_bf16 v[64:67], a[208:211], v[176:179], v[64:67]
    s_waitcnt lgkmcnt(1)
    v_lshlrev_b32 v40, 16, v32
    v_and_b32 v41, 0xffff0000, v32
    v_mfma_f32_16x16x32_bf16 v[64:67], a[212:215], v[180:183], v[64:67]
    s_add_u32 s57, s31, 3
    v_mul_f32 v40, s42, v40
    v_mul_f32 v41, s42, v41
    v_mfma_f32_16x16x32_bf16 v[72:75], a[192:195], v[184:187], v[52:55]
    s_and_b32 s57, s57, 4
    v_cvt_pk_bf16_f32 v32, v40, v41
    v_lshlrev_b32 v42, 16, v33
    v_mfma_f32_16x16x32_bf16 v[72:75], a[196:199], v[188:191], v[72:75]
    s_xor_b32 s57, s57, 4
    v_cmp_lt_f32 vcc, s35, v28
    v_and_b32 v43, 0xffff0000, v33
    v_mfma_f32_16x16x32_bf16 v[72:75], a[200:203], v[192:195], v[72:75]
    s_waitcnt lgkmcnt(0)
    v_cmp_gt_u32 s[94:95], s93, v30
    v_mul_f32 v42, s42, v42
    v_mfma_f32_16x16x32_bf16 v[72:75], a[204:207], v[196:199], v[72:75]
    s_add_u32 m0, s33, 50048
    v_exp_f32 v64, v64
    v_mfma_f32_16x16x32_bf16 v[72:75], a[208:211], v[200:203], v[72:75]
    s_or_b64 vcc, vcc, s[94:95]
    v_exp_f32 v65, v65
    v_mfma_f32_16x16x32_bf16 v[72:75], a[212:215], v[204:207], v[72:75]
    s_cbranch_vccnz L_b00_3cs_rare
L_b00_3cs_back:
    ds_read_b64_tr_b16 v[152:153], v4 offset:24576
    v_cvt_pk_bf16_f32 v96, v64, v65
    v_mfma_f32_16x16x32_bf16 v[80:83], a[192:195], v[208:211], v[56:59]
    s_add_u32 s93, s93, 4
    buffer_load_dwordx4 v9, s[20:23], s30 offen offset:128 nt lds
    v_mfma_f32_16x16x32_bf16 v[80:83], a[196:199], v[212:215], v[80:83]
    s_lshl_b32 s57, s57, 24
    ds_read_b64_tr_b16 v[154:155], v4 offset:30720
    v_add_f32 v12, v12, v19
    v_mfma_f32_16x16x32_bf16 v[80:83], a[200:203], v[216:219], v[80:83]
    s_add_u32 s92, s92, s57
    ds_read_b64_tr_b16 v[156:157], v4 offset:36864
    v_add_f32 v13, v13, v20
    v_mfma_f32_16x16x32_bf16 v[80:83], a[204:207], v[220:223], v[80:83]
    ds_read_b64_tr_b16 v[158:159], v4 offset:43008
    v_add_f32 v14, v14, v21
    v_mfma_f32_16x16x32_bf16 v[80:83], a[208:211], v[224:227], v[80:83]
    ds_read_b64_tr_b16 a[240:241], v5 offset:24576
    v_add_f32 v15, v15, v22
    v_mfma_f32_16x16x32_bf16 v[80:83], a[212:215], v[228:231], v[80:83]
    ds_read_b64_tr_b16 a[242:243], v5 offset:30720
    v_add_f32 v16, v64, v65
    v_mfma_f32_16x16x32_bf16 v[88:91], a[192:195], v[232:235], v[60:63]
    v_exp_f32 v66, v66
    v_mfma_f32_16x16x32_bf16 v[88:91], a[196:199], v[236:239], v[88:91]
    s_add_u32 m0, s33, 50944
    ds_read_b128 a[192:195], v2 offset:12288
    v_add_f32 v16, v16, v66
    v_mfma_f32_16x16x32_bf16 v[88:91], a[200:203], v[240:243], v[88:91]
    buffer_load_dwordx4 v9, s[20:23], s30 offen offset:256 nt lds
    v_mfma_f32_16x16x32_bf16 v[88:91], a[204:207], v[244:247], v[88:91]
    v_exp_f32 v67, v67
    v_mfma_f32_16x16x32_bf16 v[88:91], a[208:211], v[248:251], v[88:91]
    ds_read_b128 a[196:199], v3 offset:12288
    v_cvt_pk_bf16_f32 v97, v66, v67
    v_mfma_f32_16x16x32_bf16 v[88:91], a[212:215], v[252:255], v[88:91]
    ds_read_b64_tr_b16 a[244:245], v5 offset:36864
    v_add_f32 v16, v16, v67
    v_mfma_f32_16x16x32_bf16 v[68:71], a[216:219], v[160:163], v[48:51]
    v_exp_f32 v72, v72
    v_mfma_f32_16x16x32_bf16 v[68:71], a[220:223], v[164:167], v[68:71]
    v_exp_f32 v73, v73
    v_mfma_f32_16x16x32_bf16 v[68:71], a[224:227], v[168:171], v[68:71]
    ds_read_b128 a[200:203], v2 offset:13312
    v_cvt_pk_bf16_f32 v100, v72, v73
    v_mfma_f32_16x16x32_bf16 v[68:71], a[228:231], v[172:175], v[68:71]
    s_add_u32 m0, s33, 62336
    ds_read_b64_tr_b16 a[246:247], v5 offset:43008
    v_add_f32 v17, v72, v73
    v_mfma_f32_16x16x32_bf16 v[68:71], a[232:235], v[176:179], v[68:71]
    buffer_load_dwordx4 v9, s[20:23], s32 offen offset:128 nt lds
    v_mfma_f32_16x16x32_bf16 v[68:71], a[236:239], v[180:183], v[68:71]
    v_exp_f32 v74, v74
    v_mfma_f32_16x16x32_bf16 v[76:79], a[216:219], v[184:187], v[52:55]
    ds_read_b128 a[204:207], v3 offset:13312
    v_add_f32 v17, v17, v74
    v_mfma_f32_16x16x32_bf16 v[76:79], a[220:223], v[188:191], v[76:79]
    v_exp_f32 v75, v75
    v_mfma_f32_16x16x32_bf16 v[76:79], a[224:227], v[192:195], v[76:79]
    ds_read_b128 a[208:211], v2 offset:14336
    v_cvt_pk_bf16_f32 v101, v74, v75
    v_mfma_f32_16x16x32_bf16 v[76:79], a[228:231], v[196:199], v[76:79]
    ds_read_b64_tr_b16 a[248:249], v6 offset:24576
    v_add_f32 v17, v17, v75
    v_mfma_f32_16x16x32_bf16 v[76:79], a[232:235], v[200:203], v[76:79]
    v_exp_f32 v80, v80
    v_mfma_f32_16x16x32_bf16 v[76:79], a[236:239], v[204:207], v[76:79]
    s_add_u32 m0, s33, 63232
    v_exp_f32 v81, v81
    v_mfma_f32_16x16x32_bf16 v[84:87], a[216:219], v[208:211], v[56:59]
    buffer_load_dwordx4 v9, s[20:23], s32 offen offset:256 nt lds
    v_mfma_f32_16x16x32_bf16 v[84:87], a[220:223], v[212:215], v[84:87]
    s_add_u32 s30, s30, 24576
    ds_read_b128 a[212:215], v3 offset:14336
    v_cvt_pk_bf16_f32 v104, v80, v81
    v_mfma_f32_16x16x32_bf16 v[84:87], a[224:227], v[216:219], v[84:87]
    s_add_u32 s32, s32, 24576
    ds_read_b64_tr_b16 a[250:251], v6 offset:30720
    v_add_f32 v18, v80, v81
    v_mfma_f32_16x16x32_bf16 v[84:87], a[228:231], v[220:223], v[84:87]
    v_exp_f32 v82, v82
    v_mfma_f32_16x16x32_bf16 v[84:87], a[232:235], v[224:227], v[84:87]
    ds_read_b64_tr_b16 a[252:253], v6 offset:36864
    v_add_f32 v18, v18, v82
    v_mfma_f32_16x16x32_bf16 v[84:87], a[236:239], v[228:231], v[84:87]
    v_exp_f32 v83, v83
    v_mfma_f32_16x16x32_bf16 v[92:95], a[216:219], v[232:235], v[60:63]
    ds_read_b128 a[216:219], v2 offset:18432
    v_cvt_pk_bf16_f32 v105, v82, v83
    v_mfma_f32_16x16x32_bf16 v[92:95], a[220:223], v[236:239], v[92:95]
    s_add_u32 m0, s33, 0
    ds_read_b64_tr_b16 a[254:255], v6 offset:43008
    v_add_f32 v18, v18, v83
    v_mfma_f32_16x16x32_bf16 v[92:95], a[224:227], v[240:243], v[92:95]
    buffer_load_dwordx4 v8, s[16:19], s29 offen nt lds
    v_mfma_f32_16x16x32_bf16 v[92:95], a[228:231], v[244:247], v[92:95]
    v_exp_f32 v68, v68
    v_mfma_f32_16x16x32_bf16 v[92:95], a[232:235], v[248:251], v[92:95]
    ds_read_b128 a[220:223], v3 offset:18432
    v_add_f32 v16, v16, v68
    v_mfma_f32_16x16x32_bf16 v[92:95], a[236:239], v[252:255], v[92:95]
    s_waitcnt lgkmcnt(3)
    v_exp_f32 v69, v69
    v_mfma_f32_16x16x32_bf16 a[144:147], v[152:155], v[136:139], a[144:147]
    ds_read_b128 a[224:227], v2 offset:19456
    v_cvt_pk_bf16_f32 v98, v68, v69
    v_mfma_f32_16x16x32_bf16 a[0:3], v[152:155], v[124:127], a[0:3]
    v_exp_f32 v70, v70
    v_mfma_f32_16x16x32_bf16 a[0:3], v[156:159], v[140:143], a[0:3]
    ds_read_b128 a[228:231], v3 offset:19456
    v_add_f32 v16, v16, v69
    v_mfma_f32_16x16x32_bf16 a[48:51], v[152:155], v[128:131], a[48:51]
    s_add_u32 m0, s33, 896
    v_exp_f32 v71, v71
    v_mfma_f32_16x16x32_bf16 a[48:51], v[156:159], v[144:147], a[48:51]
    buffer_load_dwordx4 v8, s[16:19], s29 offen offset:128 nt lds
    v_mfma_f32_16x16x32_bf16 a[96:99], v[152:155], v[132:135], a[96:99]
    ds_read_b64_tr_b16 v[152:153], v7 offset:24576
    v_cvt_pk_bf16_f32 v99, v70, v71
    v_mfma_f32_16x16x32_bf16 a[96:99], v[156:159], v[148:151], a[96:99]
    ds_read_b64_tr_b16 v[154:155], v7 offset:30720
    v_add_f32 v16, v16, v70
    v_mfma_f32_16x16x32_bf16 a[148:151], a[240:243], v[136:139], a[148:151]
    ds_read_b128 a[232:235], v2 offset:20480
    v_add_f32 v16, v16, v71
    v_mfma_f32_16x16x32_bf16 a[4:7], a[240:243], v[124:127], a[4:7]
    v_exp_f32 v76, v76
    v_mfma_f32_16x16x32_bf16 a[4:7], a[244:247], v[140:143], a[4:7]
    ds_read_b64_tr_b16 v[156:157], v7 offset:36864
    v_add_f32 v17, v17, v76
    v_mfma_f32_16x16x32_bf16 a[52:55], a[240:243], v[128:131], a[52:55]
    v_exp_f32 v77, v77
    v_mfma_f32_16x16x32_bf16 a[52:55], a[244:247], v[144:147], a[52:55]
    s_add_u32 m0, s33, 1792
    ds_read_b64_tr_b16 v[158:159], v7 offset:43008
    v_cvt_pk_bf16_f32 v102, v76, v77
    v_mfma_f32_16x16x32_bf16 a[100:103], a[240:243], v[132:135], a[100:103]
    buffer_load_dwordx4 v8, s[16:19], s29 offen offset:256 nt lds
    v_mfma_f32_16x16x32_bf16 a[100:103], a[244:247], v[148:151], a[100:103]
    s_add_u32 s29, s29, 12288
    ds_read_b128 a[236:239], v3 offset:20480
    v_add_f32 v17, v17, v77
    v_mfma_f32_16x16x32_bf16 a[152:155], a[248:251], v[136:139], a[152:155]
    v_exp_f32 v78, v78
    v_mfma_f32_16x16x32_bf16 a[8:11], a[248:251], v[124:127], a[8:11]
    s_waitcnt vmcnt(12) lgkmcnt(3)
    ds_inc_u32 v46, v46
    v_add_f32 v17, v17, v78
    v_mfma_f32_16x16x32_bf16 a[8:11], a[252:255], v[140:143], a[8:11]
    v_exp_f32 v79, v79
    v_mfma_f32_16x16x32_bf16 a[56:59], a[248:251], v[128:131], a[56:59]
    v_cvt_pk_bf16_f32 v103, v78, v79
    v_add_f32 v17, v17, v79
    v_mfma_f32_16x16x32_bf16 a[56:59], a[252:255], v[144:147], a[56:59]
    v_exp_f32 v84, v84
    v_mfma_f32_16x16x32_bf16 a[104:107], a[248:251], v[132:135], a[104:107]
    v_exp_f32 v85, v85
    v_mfma_f32_16x16x32_bf16 a[104:107], a[252:255], v[148:151], a[104:107]
    v_exp_f32 v86, v86
    v_mfma_f32_16x16x32_bf16 a[156:159], v[152:155], v[136:139], a[156:159]
    v_exp_f32 v87, v87
    v_mfma_f32_16x16x32_bf16 a[12:15], v[152:155], v[124:127], a[12:15]
    s_waitcnt lgkmcnt(0)
    v_cvt_pk_bf16_f32 v106, v84, v85
    v_cvt_pk_bf16_f32 v107, v86, v87
    v_mfma_f32_16x16x32_bf16 a[12:15], v[156:159], v[140:143], a[12:15]
    v_add_f32 v18, v18, v84
    v_add_f32 v18, v18, v85
    v_mfma_f32_16x16x32_bf16 a[60:63], v[152:155], v[128:131], a[60:63]
    v_add_f32 v18, v18, v86
    v_add_f32 v18, v18, v87
    v_mfma_f32_16x16x32_bf16 a[60:63], v[156:159], v[144:147], a[60:63]
    v_exp_f32 v88, v88
    v_mfma_f32_16x16x32_bf16 a[108:111], v[152:155], v[132:135], a[108:111]
    v_exp_f32 v89, v89
    v_mfma_f32_16x16x32_bf16 a[108:111], v[156:159], v[148:151], a[108:111]
    v_exp_f32 v90, v90
    v_mfma_f32_16x16x32_bf16 v[64:67], a[192:195], v[160:163], v[48:51]
    v_exp_f32 v91, v91
    v_mfma_f32_16x16x32_bf16 v[64:67], a[196:199], v[164:167], v[64:67]
    ds_read_b32 v30, v46
    v_cvt_pk_bf16_f32 v108, v88, v89
    v_mfma_f32_16x16x32_bf16 v[64:67], a[200:203], v[168:171], v[64:67]
    v_exp_f32 v92, v92
    v_mfma_f32_16x16x32_bf16 v[64:67], a[204:207], v[172:175], v[64:67]
    v_exp_f32 v93, v93
    v_mfma_f32_16x16x32_bf16 v[64:67], a[208:211], v[176:179], v[64:67]
    v_exp_f32 v94, v94
    v_mfma_f32_16x16x32_bf16 v[64:67], a[212:215], v[180:183], v[64:67]
    v_exp_f32 v95, v95
    v_mfma_f32_16x16x32_bf16 v[72:75], a[192:195], v[184:187], v[52:55]
    v_cvt_pk_bf16_f32 v109, v90, v91
    v_cvt_pk_bf16_f32 v110, v92, v93
    v_mfma_f32_16x16x32_bf16 v[72:75], a[196:199], v[188:191], v[72:75]
    v_cvt_pk_bf16_f32 v111, v94, v95
    v_add_f32 v22, v88, v89
    v_mfma_f32_16x16x32_bf16 v[72:75], a[200:203], v[192:195], v[72:75]
    s_waitcnt lgkmcnt(0)
    v_cmp_gt_u32 vcc, s93, v30
    v_add_f32 v22, v22, v90
    v_mfma_f32_16x16x32_bf16 v[72:75], a[204:207], v[196:199], v[72:75]
    v_exp_f32 v64, v64
    v_mfma_f32_16x16x32_bf16 v[72:75], a[208:211], v[200:203], v[72:75]
    s_add_u32 m0, s33, 73728
    v_exp_f32 v65, v65
    v_mfma_f32_16x16x32_bf16 v[72:75], a[212:215], v[204:207], v[72:75]
    s_cbranch_vccnz L_b00_4s_rare
L_b00_4s_back:
    ds_read_b64_tr_b16 a[240:241], v4 offset:25600
    v_cvt_pk_bf16_f32 v112, v64, v65
    v_mfma_f32_16x16x32_bf16 v[80:83], a[192:195], v[208:211], v[56:59]
    s_add_u32 s93, s93, 4
    buffer_load_dwordx4 v9, s[20:23], s30 offen nt lds
    v_mfma_f32_16x16x32_bf16 v[80:83], a[196:199], v[212:215], v[80:83]
    ds_read_b64_tr_b16 a[242:243], v4 offset:31744
    v_add_f32 v16, v16, v64
    v_mfma_f32_16x16x32_bf16 v[80:83], a[200:203], v[216:219], v[80:83]
    ds_read_b64_tr_b16 a[244:245], v4 offset:37888
    v_add_f32 v16, v16, v65
    v_mfma_f32_16x16x32_bf16 v[80:83], a[204:207], v[220:223], v[80:83]
    ds_read_b64_tr_b16 a[246:247], v4 offset:44032
    v_add_f32 v22, v22, v91
    v_mfma_f32_16x16x32_bf16 v[80:83], a[208:211], v[224:227], v[80:83]
    ds_read_b64_tr_b16 a[248:249], v5 offset:25600
    v_add_f32 v22, v22, v92
    v_mfma_f32_16x16x32_bf16 v[80:83], a[212:215], v[228:231], v[80:83]
    ds_read_b64_tr_b16 a[250:251], v5 offset:31744
    v_add_f32 v22, v22, v93
    v_mfma_f32_16x16x32_bf16 v[68:71], a[216:219], v[160:163], v[48:51]
    ds_read_b64_tr_b16 a[252:253], v5 offset:37888
    v_add_f32 v22, v22, v94
    v_mfma_f32_16x16x32_bf16 v[68:71], a[220:223], v[164:167], v[68:71]
    ds_read_b64_tr_b16 a[254:255], v5 offset:44032
    v_add_f32 v22, v22, v95
    v_mfma_f32_16x16x32_bf16 v[68:71], a[224:227], v[168:171], v[68:71]
    v_exp_f32 v66, v66
    v_mfma_f32_16x16x32_bf16 v[68:71], a[228:231], v[172:175], v[68:71]
    s_add_u32 m0, s33, 86016
    ds_read_b64_tr_b16 v[152:153], v6 offset:25600
    v_add_f32 v16, v16, v66
    v_mfma_f32_16x16x32_bf16 v[68:71], a[232:235], v[176:179], v[68:71]
    buffer_load_dwordx4 v9, s[20:23], s32 offen nt lds
    v_mfma_f32_16x16x32_bf16 v[68:71], a[236:239], v[180:183], v[68:71]
    v_exp_f32 v67, v67
    v_mfma_f32_16x16x32_bf16 v[76:79], a[216:219], v[184:187], v[52:55]
    ds_read_b64_tr_b16 v[154:155], v6 offset:31744
    v_cvt_pk_bf16_f32 v113, v66, v67
    v_mfma_f32_16x16x32_bf16 v[76:79], a[220:223], v[188:191], v[76:79]
    ds_read_b64_tr_b16 v[156:157], v6 offset:37888
    v_add_f32 v16, v16, v67
    v_mfma_f32_16x16x32_bf16 v[76:79], a[224:227], v[192:195], v[76:79]
    v_exp_f32 v72, v72
    v_mfma_f32_16x16x32_bf16 v[76:79], a[228:231], v[196:199], v[76:79]
    ds_read_b64_tr_b16 v[158:159], v6 offset:44032
    v_add_f32 v17, v17, v72
    v_mfma_f32_16x16x32_bf16 v[76:79], a[232:235], v[200:203], v[76:79]
    v_exp_f32 v73, v73
    v_mfma_f32_16x16x32_bf16 v[76:79], a[236:239], v[204:207], v[76:79]
    ds_read_b128 a[192:195], v2 offset:24576
    v_cvt_pk_bf16_f32 v116, v72, v73
    v_mfma_f32_16x16x32_bf16 v[84:87], a[216:219], v[208:211], v[56:59]
    v_exp_f32 v74, v74
    v_mfma_f32_16x16x32_bf16 v[84:87], a[220:223], v[212:215], v[84:87]
    s_add_u32 m0, s33, 12288
    ds_read_b128 a[196:199], v3 offset:24576
    v_add_f32 v17, v17, v73
    v_mfma_f32_16x16x32_bf16 v[84:87], a[224:227], v[216:219], v[84:87]
    buffer_load_dwordx4 v8, s[16:19], s29 offen nt lds
    v_mfma_f32_16x16x32_bf16 v[84:87], a[228:231], v[220:223], v[84:87]
    ds_read_b128 a[200:203], v2 offset:25600
    v_add_f32 v17, v17, v74
    v_mfma_f32_16x16x32_bf16 v[84:87], a[232:235], v[224:227], v[84:87]
    v_exp_f32 v75, v75
    v_mfma_f32_16x16x32_bf16 v[84:87], a[236:239], v[228:231], v[84:87]
    s_waitcnt lgkmcnt(3)
    ds_read_b128 a[204:207], v3 offset:25600
    v_cvt_pk_bf16_f32 v117, v74, v75
    v_mfma_f32_16x16x32_bf16 a[160:163], a[240:243], v[136:139], a[160:163]
    v_exp_f32 v68, v68
    v_mfma_f32_16x16x32_bf16 a[16:19], a[240:243], v[124:127], a[16:19]
    ds_read_b128 a[208:211], v2 offset:26624
    v_add_f32 v17, v17, v75
    v_mfma_f32_16x16x32_bf16 a[16:19], a[244:247], v[140:143], a[16:19]
    v_exp_f32 v69, v69
    v_mfma_f32_16x16x32_bf16 a[64:67], a[240:243], v[128:131], a[64:67]
    ds_read_b128 a[212:215], v3 offset:26624
    v_cvt_pk_bf16_f32 v114, v68, v69
    v_mfma_f32_16x16x32_bf16 a[64:67], a[244:247], v[144:147], a[64:67]
    v_exp_f32 v70, v70
    v_mfma_f32_16x16x32_bf16 a[112:115], a[240:243], v[132:135], a[112:115]
    s_add_u32 m0, s33, 13184
    ds_read_b64_tr_b16 a[240:241], v7 offset:25600
    v_add_f32 v16, v16, v68
    v_mfma_f32_16x16x32_bf16 a[112:115], a[244:247], v[148:151], a[112:115]
    buffer_load_dwordx4 v8, s[16:19], s29 offen offset:128 nt lds
    v_mfma_f32_16x16x32_bf16 a[164:167], a[248:251], v[136:139], a[164:167]
    ds_read_b64_tr_b16 a[242:243], v7 offset:31744
    v_add_f32 v16, v16, v69
    v_mfma_f32_16x16x32_bf16 a[20:23], a[248:251], v[124:127], a[20:23]
    ds_read_b64_tr_b16 a[244:245], v7 offset:37888
    v_add_f32 v16, v16, v70
    v_mfma_f32_16x16x32_bf16 a[20:23], a[252:255], v[140:143], a[20:23]
    v_exp_f32 v71, v71
    v_mfma_f32_16x16x32_bf16 a[68:71], a[248:251], v[128:131], a[68:71]
    ds_read_b64_tr_b16 a[246:247], v7 offset:44032
    v_cvt_pk_bf16_f32 v115, v70, v71
    v_mfma_f32_16x16x32_bf16 a[68:71], a[252:255], v[144:147], a[68:71]
    ds_read_b128 a[216:219], v2 offset:30720
    v_add_f32 v16, v16, v71
    v_mfma_f32_16x16x32_bf16 a[116:119], a[248:251], v[132:135], a[116:119]
    v_exp_f32 v76, v76
    v_mfma_f32_16x16x32_bf16 a[116:119], a[252:255], v[148:151], a[116:119]
    ds_read_b64_tr_b16 a[248:249], v4 offset:26624
    v_add_f32 v17, v17, v76
    v_mfma_f32_16x16x32_bf16 a[168:171], v[152:155], v[136:139], a[168:171]
    v_exp_f32 v77, v77
    v_mfma_f32_16x16x32_bf16 a[24:27], v[152:155], v[124:127], a[24:27]
    s_add_u32 m0, s33, 14080
    ds_read_b64_tr_b16 a[250:251], v4 offset:32768
    v_cvt_pk_bf16_f32 v118, v76, v77
    v_mfma_f32_16x16x32_bf16 a[24:27], v[156:159], v[140:143], a[24:27]
    buffer_load_dwordx4 v8, s[16:19], s29 offen offset:256 nt lds
    v_mfma_f32_16x16x32_bf16 a[72:75], v[152:155], v[128:131], a[72:75]
    s_add_u32 s29, s29, 12288
    ds_read_b64_tr_b16 a[252:253], v4 offset:38912
    v_add_f32 v17, v17, v77
    v_mfma_f32_16x16x32_bf16 a[72:75], v[156:159], v[144:147], a[72:75]
    ds_read_b64_tr_b16 a[254:255], v4 offset:45056
    v_mul_f32 v43, s42, v43
    v_mfma_f32_16x16x32_bf16 a[120:123], v[152:155], v[132:135], a[120:123]
    v_exp_f32 v78, v78
    v_mfma_f32_16x16x32_bf16 a[120:123], v[156:159], v[148:151], a[120:123]
    s_waitcnt lgkmcnt(3)
    ds_read_b64_tr_b16 v[152:153], v5 offset:26624
    v_add_f32 v17, v17, v78
    v_mfma_f32_16x16x32_bf16 a[172:175], a[240:243], v[136:139], a[172:175]
    v_exp_f32 v79, v79
    v_mfma_f32_16x16x32_bf16 a[28:31], a[240:243], v[124:127], a[28:31]
    ds_read_b64_tr_b16 v[154:155], v5 offset:32768
    v_cvt_pk_bf16_f32 v119, v78, v79
    v_mfma_f32_16x16x32_bf16 a[28:31], a[244:247], v[140:143], a[28:31]
    ds_read_b64_tr_b16 v[156:157], v5 offset:38912
    v_add_f32 v17, v17, v79
    v_mfma_f32_16x16x32_bf16 a[76:79], a[240:243], v[128:131], a[76:79]
    v_exp_f32 v80, v80
    v_mfma_f32_16x16x32_bf16 a[76:79], a[244:247], v[144:147], a[76:79]
    ds_read_b64_tr_b16 v[158:159], v5 offset:45056
    v_add_f32 v18, v18, v80
    v_mfma_f32_16x16x32_bf16 a[124:127], a[240:243], v[132:135], a[124:127]
    v_exp_f32 v81, v81
    v_mfma_f32_16x16x32_bf16 a[124:127], a[244:247], v[148:151], a[124:127]
    s_waitcnt lgkmcnt(3)
    ds_read_b128 a[220:223], v3 offset:30720
    v_cvt_pk_bf16_f32 v120, v80, v81
    v_mfma_f32_16x16x32_bf16 a[176:179], a[248:251], v[136:139], a[176:179]
    ds_read_b64_tr_b16 a[240:241], v6 offset:26624
    v_add_f32 v18, v18, v81
    v_mfma_f32_16x16x32_bf16 a[32:35], a[248:251], v[124:127], a[32:35]
    v_exp_f32 v82, v82
    v_mfma_f32_16x16x32_bf16 a[32:35], a[252:255], v[140:143], a[32:35]
    ds_read_b64_tr_b16 a[242:243], v6 offset:32768
    v_add_f32 v18, v18, v82
    v_mfma_f32_16x16x32_bf16 a[80:83], a[248:251], v[128:131], a[80:83]
    v_exp_f32 v83, v83
    v_mfma_f32_16x16x32_bf16 a[80:83], a[252:255], v[144:147], a[80:83]
    ds_read_b64_tr_b16 a[244:245], v6 offset:38912
    v_cvt_pk_bf16_f32 v121, v82, v83
    v_mfma_f32_16x16x32_bf16 a[128:131], a[248:251], v[132:135], a[128:131]
    ds_read_b64_tr_b16 a[246:247], v6 offset:45056
    v_add_f32 v18, v18, v83
    v_mfma_f32_16x16x32_bf16 a[128:131], a[252:255], v[148:151], a[128:131]
    s_waitcnt lgkmcnt(4)
    ds_read_b128 a[224:227], v2 offset:31744
    v_cvt_pk_bf16_f32 v33, v42, v43
    v_mfma_f32_16x16x32_bf16 a[180:183], v[152:155], v[136:139], a[180:183]
    v_exp_f32 v84, v84
    v_mfma_f32_16x16x32_bf16 a[36:39], v[152:155], v[124:127], a[36:39]
    ds_read_b128 a[228:231], v3 offset:31744
    v_add_f32 v18, v18, v84
    v_mfma_f32_16x16x32_bf16 a[36:39], v[156:159], v[140:143], a[36:39]
    s_add_u32 m0, s89, 0
    ds_read_b64_tr_b16 a[248:249], v7 offset:26624
    ds_read_b64_tr_b16 a[250:251], v7 offset:32768
    v_mfma_f32_16x16x32_bf16 a[84:87], v[152:155], v[128:131], a[84:87]
    ds_read_b128 a[232:235], v2 offset:32768
    buffer_load_dwordx4 v23, s[80:83], s84 offen nt lds
    v_mfma_f32_16x16x32_bf16 a[84:87], v[156:159], v[144:147], a[84:87]
    ds_read_b64_tr_b16 a[252:253], v7 offset:38912
    ds_read_b64_tr_b16 a[254:255], v7 offset:45056
    v_mfma_f32_16x16x32_bf16 a[132:135], v[152:155], v[132:135], a[132:135]
    v_exp_f32 v85, v85
    v_mfma_f32_16x16x32_bf16 a[132:135], v[156:159], v[148:151], a[132:135]
    s_waitcnt lgkmcnt(6)
    ds_read_b128 a[236:239], v3 offset:32768
    v_cvt_pk_bf16_f32 v122, v84, v85
    v_mfma_f32_16x16x32_bf16 a[184:187], a[240:243], v[136:139], a[184:187]
    v_exp_f32 v86, v86
    v_mfma_f32_16x16x32_bf16 a[40:43], a[240:243], v[124:127], a[40:43]
    s_waitcnt vmcnt(13)
    ds_inc_u32 v46, v46
    v_add_f32 v18, v18, v85
    v_mfma_f32_16x16x32_bf16 a[40:43], a[244:247], v[140:143], a[40:43]
    v_exp_f32 v87, v87
    v_mfma_f32_16x16x32_bf16 a[88:91], a[240:243], v[128:131], a[88:91]
    v_cvt_pk_bf16_f32 v123, v86, v87
    v_add_f32 v18, v18, v86
    v_mfma_f32_16x16x32_bf16 a[88:91], a[244:247], v[144:147], a[88:91]
    v_add_f32 v18, v18, v87
    v_max3_f32 v28, v16, v17, v18
    v_mfma_f32_16x16x32_bf16 a[136:139], a[240:243], v[132:135], a[136:139]
    s_add_u32 m0, s89, 896
    v_max_f32 v28, v28, v22
    v_lshlrev_b32 v40, 16, v34
    v_mfma_f32_16x16x32_bf16 a[136:139], a[244:247], v[148:151], a[136:139]
    s_waitcnt lgkmcnt(1)
    buffer_load_dwordx4 v23, s[80:83], s84 offen offset:128 nt lds
    v_mfma_f32_16x16x32_bf16 a[188:191], a[248:251], v[136:139], a[188:191]
    s_add_u32 m0, s89, 1792
    v_and_b32 v41, 0xffff0000, v34
    v_mul_f32 v40, s42, v40
    v_mfma_f32_16x16x32_bf16 a[44:47], a[248:251], v[124:127], a[44:47]
    buffer_load_dwordx4 v23, s[80:83], s84 offen offset:256 nt lds
    v_mfma_f32_16x16x32_bf16 a[44:47], a[252:255], v[140:143], a[44:47]
    s_add_u32 s84, s84, s91
    v_mul_f32 v41, s42, v41
    v_cvt_pk_bf16_f32 v34, v40, v41
    v_mfma_f32_16x16x32_bf16 a[92:95], a[248:251], v[128:131], a[92:95]
    s_add_u32 s89, s89, s91
    buffer_load_dword v25, v47, s[12:15], s92 offen
    v_mfma_f32_16x16x32_bf16 a[92:95], a[252:255], v[144:147], a[92:95]
    v_lshlrev_b32 v42, 16, v35
    v_and_b32 v43, 0xffff0000, v35
    v_mfma_f32_16x16x32_bf16 a[140:143], a[248:251], v[132:135], a[140:143]
    v_mul_f32 v42, s42, v42
    v_mul_f32 v43, s42, v43
    v_mfma_f32_16x16x32_bf16 a[140:143], a[252:255], v[148:151], a[140:143]
    v_cvt_pk_bf16_f32 v35, v42, v43
    v_lshlrev_b32 v40, 16, v36
    v_mfma_f32_16x16x32_bf16 v[64:67], a[192:195], v[160:163], v[48:51]
    v_and_b32 v41, 0xffff0000, v36
    v_mul_f32 v40, s42, v40
    v_mfma_f32_16x16x32_bf16 v[64:67], a[196:199], v[164:167], v[64:67]
    ds_read_b32 v30, v46
    v_mul_f32 v41, s42, v41
    v_mfma_f32_16x16x32_bf16 v[64:67], a[200:203], v[168:171], v[64:67]
    v_cvt_pk_bf16_f32 v36, v40, v41
    v_lshlrev_b32 v42, 16, v37
    v_mfma_f32_16x16x32_bf16 v[64:67], a[204:207], v[172:175], v[64:67]
    v_and_b32 v43, 0xffff0000, v37
    v_mul_f32 v42, s42, v42
    v_mfma_f32_16x16x32_bf16 v[64:67], a[208:211], v[176:179], v[64:67]
    v_mul_f32 v43, s42, v43
    v_cvt_pk_bf16_f32 v37, v42, v43
    v_mfma_f32_16x16x32_bf16 v[64:67], a[212:215], v[180:183], v[64:67]
    v_lshlrev_b32 v40, 16, v38
    v_and_b32 v41, 0xffff0000, v38
    v_mfma_f32_16x16x32_bf16 v[72:75], a[192:195], v[184:187], v[52:55]
    v_mul_f32 v40, s42, v40
    v_mul_f32 v41, s42, v41
    v_mfma_f32_16x16x32_bf16 v[72:75], a[196:199], v[188:191], v[72:75]
    v_cmp_lt_f32 vcc, s35, v28
    v_cvt_pk_bf16_f32 v38, v40, v41
    v_mfma_f32_16x16x32_bf16 v[72:75], a[200:203], v[192:195], v[72:75]
    s_waitcnt lgkmcnt(0)
    v_cmp_gt_u32 s[94:95], s93, v30
    v_lshlrev_b32 v42, 16, v39
    v_mfma_f32_16x16x32_bf16 v[72:75], a[204:207], v[196:199], v[72:75]
    s_add_u32 m0, s33, 74624
    v_exp_f32 v64, v64
    v_mfma_f32_16x16x32_bf16 v[72:75], a[208:211], v[200:203], v[72:75]
    s_or_b64 vcc, vcc, s[94:95]
    v_exp_f32 v65, v65
    v_mfma_f32_16x16x32_bf16 v[72:75], a[212:215], v[204:207], v[72:75]
    s_cbranch_vccnz L_b00_5cs_rare
L_b00_5cs_back:
    ds_read_b64_tr_b16 v[152:153], v4
    v_cvt_pk_bf16_f32 v124, v64, v65
    v_mfma_f32_16x16x32_bf16 v[80:83], a[192:195], v[208:211], v[56:59]
    s_add_u32 s93, s93, 4
    buffer_load_dwordx4 v9, s[20:23], s30 offen offset:128 nt lds
    v_mfma_f32_16x16x32_bf16 v[80:83], a[196:199], v[212:215], v[80:83]
    ds_read_b64_tr_b16 v[154:155], v4 offset:6144
    v_add_f32 v12, v12, v16
    v_mfma_f32_16x16x32_bf16 v[80:83], a[200:203], v[216:219], v[80:83]
    ds_read_b64_tr_b16 v[156:157], v4 offset:12288
    v_add_f32 v13, v13, v17
    v_mfma_f32_16x16x32_bf16 v[80:83], a[204:207], v[220:223], v[80:83]
    ds_read_b64_tr_b16 v[158:159], v4 offset:18432
    v_add_f32 v14, v14, v18
    v_mfma_f32_16x16x32_bf16 v[80:83], a[208:211], v[224:227], v[80:83]
    ds_read_b64_tr_b16 a[240:241], v5
    v_add_f32 v15, v15, v22
    v_mfma_f32_16x16x32_bf16 v[80:83], a[212:215], v[228:231], v[80:83]
    ds_read_b64_tr_b16 a[242:243], v5 offset:6144
    v_add_f32 v19, v64, v65
    v_mfma_f32_16x16x32_bf16 v[88:91], a[192:195], v[232:235], v[60:63]
    v_exp_f32 v66, v66
    v_mfma_f32_16x16x32_bf16 v[88:91], a[196:199], v[236:239], v[88:91]
    s_add_u32 m0, s33, 75520
    ds_read_b128 a[192:195], v2 offset:36864
    v_add_f32 v19, v19, v66
    v_mfma_f32_16x16x32_bf16 v[88:91], a[200:203], v[240:243], v[88:91]
    buffer_load_dwordx4 v9, s[20:23], s30 offen offset:256 nt lds
    v_mfma_f32_16x16x32_bf16 v[88:91], a[204:207], v[244:247], v[88:91]
    v_exp_f32 v67, v67
    v_mfma_f32_16x16x32_bf16 v[88:91], a[208:211], v[248:251], v[88:91]
    ds_read_b128 a[196:199], v3 offset:36864
    v_cvt_pk_bf16_f32 v125, v66, v67
    v_mfma_f32_16x16x32_bf16 v[88:91], a[212:215], v[252:255], v[88:91]
    ds_read_b64_tr_b16 a[244:245], v5 offset:12288
    v_add_f32 v19, v19, v67
    v_mfma_f32_16x16x32_bf16 v[68:71], a[216:219], v[160:163], v[48:51]
    v_exp_f32 v72, v72
    v_mfma_f32_16x16x32_bf16 v[68:71], a[220:223], v[164:167], v[68:71]
    v_exp_f32 v73, v73
    v_mfma_f32_16x16x32_bf16 v[68:71], a[224:227], v[168:171], v[68:71]
    ds_read_b128 a[200:203], v2 offset:37888
    v_cvt_pk_bf16_f32 v128, v72, v73
    v_mfma_f32_16x16x32_bf16 v[68:71], a[228:231], v[172:175], v[68:71]
    s_add_u32 m0, s33, 86912
    ds_read_b64_tr_b16 a[246:247], v5 offset:18432
    v_add_f32 v20, v72, v73
    v_mfma_f32_16x16x32_bf16 v[68:71], a[232:235], v[176:179], v[68:71]
    buffer_load_dwordx4 v9, s[20:23], s32 offen offset:128 nt lds
    v_mfma_f32_16x16x32_bf16 v[68:71], a[236:239], v[180:183], v[68:71]
    v_exp_f32 v74, v74
    v_mfma_f32_16x16x32_bf16 v[76:79], a[216:219], v[184:187], v[52:55]
    ds_read_b128 a[204:207], v3 offset:37888
    v_add_f32 v20, v20, v74
    v_mfma_f32_16x16x32_bf16 v[76:79], a[220:223], v[188:191], v[76:79]
    v_exp_f32 v75, v75
    v_mfma_f32_16x16x32_bf16 v[76:79], a[224:227], v[192:195], v[76:79]
    ds_read_b128 a[208:211], v2 offset:38912
    v_cvt_pk_bf16_f32 v129, v74, v75
    v_mfma_f32_16x16x32_bf16 v[76:79], a[228:231], v[196:199], v[76:79]
    ds_read_b64_tr_b16 a[248:249], v6
    v_add_f32 v20, v20, v75
    v_mfma_f32_16x16x32_bf16 v[76:79], a[232:235], v[200:203], v[76:79]
    v_exp_f32 v80, v80
    v_mfma_f32_16x16x32_bf16 v[76:79], a[236:239], v[204:207], v[76:79]
    s_add_u32 m0, s33, 87808
    v_exp_f32 v81, v81
    v_mfma_f32_16x16x32_bf16 v[84:87], a[216:219], v[208:211], v[56:59]
    buffer_load_dwordx4 v9, s[20:23], s32 offen offset:256 nt lds
    v_mfma_f32_16x16x32_bf16 v[84:87], a[220:223], v[212:215], v[84:87]
    s_add_u32 s30, s30, 24576
    ds_read_b128 a[212:215], v3 offset:38912
    v_cvt_pk_bf16_f32 v132, v80, v81
    v_mfma_f32_16x16x32_bf16 v[84:87], a[224:227], v[216:219], v[84:87]
    s_add_u32 s32, s32, 24576
    ds_read_b64_tr_b16 a[250:251], v6 offset:6144
    v_add_f32 v21, v80, v81
    v_mfma_f32_16x16x32_bf16 v[84:87], a[228:231], v[220:223], v[84:87]
    v_exp_f32 v82, v82
    v_mfma_f32_16x16x32_bf16 v[84:87], a[232:235], v[224:227], v[84:87]
    ds_read_b64_tr_b16 a[252:253], v6 offset:12288
    v_add_f32 v21, v21, v82
    v_mfma_f32_16x16x32_bf16 v[84:87], a[236:239], v[228:231], v[84:87]
    v_exp_f32 v83, v83
    v_mfma_f32_16x16x32_bf16 v[92:95], a[216:219], v[232:235], v[60:63]
    ds_read_b128 a[216:219], v2 offset:43008
    v_cvt_pk_bf16_f32 v133, v82, v83
    v_mfma_f32_16x16x32_bf16 v[92:95], a[220:223], v[236:239], v[92:95]
    s_add_u32 m0, s33, 24576
    ds_read_b64_tr_b16 a[254:255], v6 offset:18432
    v_add_f32 v21, v21, v83
    v_mfma_f32_16x16x32_bf16 v[92:95], a[224:227], v[240:243], v[92:95]
    buffer_load_dwordx4 v8, s[16:19], s29 offen nt lds
    v_mfma_f32_16x16x32_bf16 v[92:95], a[228:231], v[244:247], v[92:95]
    v_exp_f32 v68, v68
    v_mfma_f32_16x16x32_bf16 v[92:95], a[232:235], v[248:251], v[92:95]
    ds_read_b128 a[220:223], v3 offset:43008
    v_add_f32 v19, v19, v68
    v_mfma_f32_16x16x32_bf16 v[92:95], a[236:239], v[252:255], v[92:95]
    s_waitcnt lgkmcnt(3)
    v_exp_f32 v69, v69
    v_mfma_f32_16x16x32_bf16 a[144:147], v[152:155], v[108:111], a[144:147]
    ds_read_b128 a[224:227], v2 offset:44032
    v_cvt_pk_bf16_f32 v126, v68, v69
    v_mfma_f32_16x16x32_bf16 a[0:3], v[152:155], v[96:99], a[0:3]
    v_exp_f32 v70, v70
    v_mfma_f32_16x16x32_bf16 a[0:3], v[156:159], v[112:115], a[0:3]
    ds_read_b128 a[228:231], v3 offset:44032
    v_add_f32 v19, v19, v69
    v_mfma_f32_16x16x32_bf16 a[48:51], v[152:155], v[100:103], a[48:51]
    s_add_u32 m0, s33, 25472
    v_exp_f32 v71, v71
    v_mfma_f32_16x16x32_bf16 a[48:51], v[156:159], v[116:119], a[48:51]
    buffer_load_dwordx4 v8, s[16:19], s29 offen offset:128 nt lds
    v_mfma_f32_16x16x32_bf16 a[96:99], v[152:155], v[104:107], a[96:99]
    ds_read_b64_tr_b16 v[152:153], v7
    v_cvt_pk_bf16_f32 v127, v70, v71
    v_mfma_f32_16x16x32_bf16 a[96:99], v[156:159], v[120:123], a[96:99]
    ds_read_b64_tr_b16 v[154:155], v7 offset:6144
    v_add_f32 v19, v19, v70
    v_mfma_f32_16x16x32_bf16 a[148:151], a[240:243], v[108:111], a[148:151]
    ds_read_b128 a[232:235], v2 offset:45056
    v_add_f32 v19, v19, v71
    v_mfma_f32_16x16x32_bf16 a[4:7], a[240:243], v[96:99], a[4:7]
    v_exp_f32 v76, v76
    v_mfma_f32_16x16x32_bf16 a[4:7], a[244:247], v[112:115], a[4:7]
    ds_read_b64_tr_b16 v[156:157], v7 offset:12288
    v_add_f32 v20, v20, v76
    v_mfma_f32_16x16x32_bf16 a[52:55], a[240:243], v[100:103], a[52:55]
    v_exp_f32 v77, v77
    v_mfma_f32_16x16x32_bf16 a[52:55], a[244:247], v[116:119], a[52:55]
    s_add_u32 m0, s33, 26368
    ds_read_b64_tr_b16 v[158:159], v7 offset:18432
    v_cvt_pk_bf16_f32 v130, v76, v77
    v_mfma_f32_16x16x32_bf16 a[100:103], a[240:243], v[104:107], a[100:103]
    buffer_load_dwordx4 v8, s[16:19], s29 offen offset:256 nt lds
    v_mfma_f32_16x16x32_bf16 a[100:103], a[244:247], v[120:123], a[100:103]
    s_add_u32 s29, s29, 12288
    ds_read_b128 a[236:239], v3 offset:45056
    v_add_f32 v20, v20, v77
    v_mfma_f32_16x16x32_bf16 a[152:155], a[248:251], v[108:111], a[152:155]
    v_exp_f32 v78, v78
    v_mfma_f32_16x16x32_bf16 a[8:11], a[248:251], v[96:99], a[8:11]
    s_waitcnt vmcnt(16) lgkmcnt(3)
    ds_inc_u32 v46, v46
    v_add_f32 v20, v20, v78
    v_mfma_f32_16x16x32_bf16 a[8:11], a[252:255], v[112:115], a[8:11]
    v_exp_f32 v79, v79
    v_mfma_f32_16x16x32_bf16 a[56:59], a[248:251], v[100:103], a[56:59]
    v_cvt_pk_bf16_f32 v131, v78, v79
    v_add_f32 v20, v20, v79
    v_mfma_f32_16x16x32_bf16 a[56:59], a[252:255], v[116:119], a[56:59]
    v_exp_f32 v84, v84
    v_mfma_f32_16x16x32_bf16 a[104:107], a[248:251], v[104:107], a[104:107]
    v_exp_f32 v85, v85
    v_mfma_f32_16x16x32_bf16 a[104:107], a[252:255], v[120:123], a[104:107]
    v_exp_f32 v86, v86
    v_mfma_f32_16x16x32_bf16 a[156:159], v[152:155], v[108:111], a[156:159]
    v_exp_f32 v87, v87
    v_mfma_f32_16x16x32_bf16 a[12:15], v[152:155], v[96:99], a[12:15]
    s_waitcnt lgkmcnt(0)
    v_cvt_pk_bf16_f32 v134, v84, v85
    v_cvt_pk_bf16_f32 v135, v86, v87
    v_mfma_f32_16x16x32_bf16 a[12:15], v[156:159], v[112:115], a[12:15]
    v_add_f32 v21, v21, v84
    v_add_f32 v21, v21, v85
    v_mfma_f32_16x16x32_bf16 a[60:63], v[152:155], v[100:103], a[60:63]
    v_add_f32 v21, v21, v86
    v_add_f32 v21, v21, v87
    v_mfma_f32_16x16x32_bf16 a[60:63], v[156:159], v[116:119], a[60:63]
    v_exp_f32 v88, v88
    v_mfma_f32_16x16x32_bf16 a[108:111], v[152:155], v[104:107], a[108:111]
    v_exp_f32 v89, v89
    v_mfma_f32_16x16x32_bf16 a[108:111], v[156:159], v[120:123], a[108:111]
    v_exp_f32 v90, v90
    v_mfma_f32_16x16x32_bf16 v[64:67], a[192:195], v[160:163], v[48:51]
    v_exp_f32 v91, v91
    v_mfma_f32_16x16x32_bf16 v[64:67], a[196:199], v[164:167], v[64:67]
    ds_read_b32 v30, v46
    v_cvt_pk_bf16_f32 v136, v88, v89
    v_mfma_f32_16x16x32_bf16 v[64:67], a[200:203], v[168:171], v[64:67]
    v_exp_f32 v92, v92
    v_mfma_f32_16x16x32_bf16 v[64:67], a[204:207], v[172:175], v[64:67]
    v_exp_f32 v93, v93
    v_mfma_f32_16x16x32_bf16 v[64:67], a[208:211], v[176:179], v[64:67]
    v_exp_f32 v94, v94
    v_mfma_f32_16x16x32_bf16 v[64:67], a[212:215], v[180:183], v[64:67]
    v_exp_f32 v95, v95
    v_mfma_f32_16x16x32_bf16 v[72:75], a[192:195], v[184:187], v[52:55]
    v_cvt_pk_bf16_f32 v137, v90, v91
    v_cvt_pk_bf16_f32 v138, v92, v93
    v_mfma_f32_16x16x32_bf16 v[72:75], a[196:199], v[188:191], v[72:75]
    v_cvt_pk_bf16_f32 v139, v94, v95
    v_add_f32 v22, v88, v89
    v_mfma_f32_16x16x32_bf16 v[72:75], a[200:203], v[192:195], v[72:75]
    s_waitcnt lgkmcnt(0)
    v_cmp_gt_u32 vcc, s93, v30
    v_add_f32 v22, v22, v90
    v_mfma_f32_16x16x32_bf16 v[72:75], a[204:207], v[196:199], v[72:75]
    v_exp_f32 v64, v64
    v_mfma_f32_16x16x32_bf16 v[72:75], a[208:211], v[200:203], v[72:75]
    s_add_u32 m0, s33, 49152
    v_exp_f32 v65, v65
    v_mfma_f32_16x16x32_bf16 v[72:75], a[212:215], v[204:207], v[72:75]
    s_cbranch_vccnz L_b00_6s_rare
L_b00_6s_back:
    ds_read_b64_tr_b16 a[240:241], v4 offset:1024
    v_cvt_pk_bf16_f32 v140, v64, v65
    v_mfma_f32_16x16x32_bf16 v[80:83], a[192:195], v[208:211], v[56:59]
    s_add_u32 s93, s93, 4
    buffer_load_dwordx4 v9, s[20:23], s30 offen nt lds
    v_mfma_f32_16x16x32_bf16 v[80:83], a[196:199], v[212:215], v[80:83]
    ds_read_b64_tr_b16 a[242:243], v4 offset:7168
    v_add_f32 v19, v19, v64
    v_mfma_f32_16x16x32_bf16 v[80:83], a[200:203], v[216:219], v[80:83]
    ds_read_b64_tr_b16 a[244:245], v4 offset:13312
    v_add_f32 v19, v19, v65
    v_mfma_f32_16x16x32_bf16 v[80:83], a[204:207], v[220:223], v[80:83]
    ds_read_b64_tr_b16 a[246:247], v4 offset:19456
    v_add_f32 v22, v22, v91
    v_mfma_f32_16x16x32_bf16 v[80:83], a[208:211], v[224:227], v[80:83]
    ds_read_b64_tr_b16 a[248:249], v5 offset:1024
    v_add_f32 v22, v22, v92
    v_mfma_f32_16x16x32_bf16 v[80:83], a[212:215], v[228:231], v[80:83]
    ds_read_b64_tr_b16 a[250:251], v5 offset:7168
    v_add_f32 v22, v22, v93
    v_mfma_f32_16x16x32_bf16 v[68:71], a[216:219], v[160:163], v[48:51]
    ds_read_b64_tr_b16 a[252:253], v5 offset:13312
    v_add_f32 v22, v22, v94
    v_mfma_f32_16x16x32_bf16 v[68:71], a[220:223], v[164:167], v[68:71]
    ds_read_b64_tr_b16 a[254:255], v5 offset:19456
    v_add_f32 v22, v22, v95
    v_mfma_f32_16x16x32_bf16 v[68:71], a[224:227], v[168:171], v[68:71]
    v_exp_f32 v66, v66
    v_mfma_f32_16x16x32_bf16 v[68:71], a[228:231], v[172:175], v[68:71]
    s_add_u32 m0, s33, 61440
    ds_read_b64_tr_b16 v[152:153], v6 offset:1024
    v_add_f32 v19, v19, v66
    v_mfma_f32_16x16x32_bf16 v[68:71], a[232:235], v[176:179], v[68:71]
    buffer_load_dwordx4 v9, s[20:23], s32 offen nt lds
    v_mfma_f32_16x16x32_bf16 v[68:71], a[236:239], v[180:183], v[68:71]
    v_exp_f32 v67, v67
    v_mfma_f32_16x16x32_bf16 v[76:79], a[216:219], v[184:187], v[52:55]
    ds_read_b64_tr_b16 v[154:155], v6 offset:7168
    v_cvt_pk_bf16_f32 v141, v66, v67
    v_mfma_f32_16x16x32_bf16 v[76:79], a[220:223], v[188:191], v[76:79]
    ds_read_b64_tr_b16 v[156:157], v6 offset:13312
    v_add_f32 v19, v19, v67
    v_mfma_f32_16x16x32_bf16 v[76:79], a[224:227], v[192:195], v[76:79]
    v_exp_f32 v72, v72
    v_mfma_f32_16x16x32_bf16 v[76:79], a[228:231], v[196:199], v[76:79]
    ds_read_b64_tr_b16 v[158:159], v6 offset:19456
    v_add_f32 v20, v20, v72
    v_mfma_f32_16x16x32_bf16 v[76:79], a[232:235], v[200:203], v[76:79]
    v_exp_f32 v73, v73
    v_mfma_f32_16x16x32_bf16 v[76:79], a[236:239], v[204:207], v[76:79]
    ds_read_b128 a[192:195], v2
    v_cvt_pk_bf16_f32 v144, v72, v73
    v_mfma_f32_16x16x32_bf16 v[84:87], a[216:219], v[208:211], v[56:59]
    v_exp_f32 v74, v74
    v_mfma_f32_16x16x32_bf16 v[84:87], a[220:223], v[212:215], v[84:87]
    s_add_u32 m0, s33, 36864
    ds_read_b128 a[196:199], v3
    v_add_f32 v20, v20, v73
    v_mfma_f32_16x16x32_bf16 v[84:87], a[224:227], v[216:219], v[84:87]
    buffer_load_dwordx4 v8, s[16:19], s29 offen nt lds
    v_mfma_f32_16x16x32_bf16 v[84:87], a[228:231], v[220:223], v[84:87]
    ds_read_b128 a[200:203], v2 offset:1024
    v_add_f32 v20, v20, v74
    v_mfma_f32_16x16x32_bf16 v[84:87], a[232:235], v[224:227], v[84:87]
    v_exp_f32 v75, v75
    v_mfma_f32_16x16x32_bf16 v[84:87], a[236:239], v[228:231], v[84:87]
    s_waitcnt lgkmcnt(3)
    ds_read_b128 a[204:207], v3 offset:1024
    v_cvt_pk_bf16_f32 v145, v74, v75
    v_mfma_f32_16x16x32_bf16 a[160:163], a[240:243], v[108:111], a[160:163]
    v_exp_f32 v68, v68
    v_mfma_f32_16x16x32_bf16 a[16:19], a[240:243], v[96:99], a[16:19]
    ds_read_b128 a[208:211], v2 offset:2048
    v_add_f32 v20, v20, v75
    v_mfma_f32_16x16x32_bf16 a[16:19], a[244:247], v[112:115], a[16:19]
    v_exp_f32 v69, v69
    v_mfma_f32_16x16x32_bf16 a[64:67], a[240:243], v[100:103], a[64:67]
    ds_read_b128 a[212:215], v3 offset:2048
    v_cvt_pk_bf16_f32 v142, v68, v69
    v_mfma_f32_16x16x32_bf16 a[64:67], a[244:247], v[116:119], a[64:67]
    v_exp_f32 v70, v70
    v_mfma_f32_16x16x32_bf16 a[112:115], a[240:243], v[104:107], a[112:115]
    s_add_u32 m0, s33, 37760
    ds_read_b64_tr_b16 a[240:241], v7 offset:1024
    v_add_f32 v19, v19, v68
    v_mfma_f32_16x16x32_bf16 a[112:115], a[244:247], v[120:123], a[112:115]
    buffer_load_dwordx4 v8, s[16:19], s29 offen offset:128 nt lds
    v_mfma_f32_16x16x32_bf16 a[164:167], a[248:251], v[108:111], a[164:167]
    ds_read_b64_tr_b16 a[242:243], v7 offset:7168
    v_add_f32 v19, v19, v69
    v_mfma_f32_16x16x32_bf16 a[20:23], a[248:251], v[96:99], a[20:23]
    ds_read_b64_tr_b16 a[244:245], v7 offset:13312
    v_add_f32 v19, v19, v70
    v_mfma_f32_16x16x32_bf16 a[20:23], a[252:255], v[112:115], a[20:23]
    v_exp_f32 v71, v71
    v_mfma_f32_16x16x32_bf16 a[68:71], a[248:251], v[100:103], a[68:71]
    ds_read_b64_tr_b16 a[246:247], v7 offset:19456
    v_cvt_pk_bf16_f32 v143, v70, v71
    v_mfma_f32_16x16x32_bf16 a[68:71], a[252:255], v[116:119], a[68:71]
    ds_read_b128 a[216:219], v2 offset:6144
    v_add_f32 v19, v19, v71
    v_mfma_f32_16x16x32_bf16 a[116:119], a[248:251], v[104:107], a[116:119]
    v_exp_f32 v76, v76
    v_mfma_f32_16x16x32_bf16 a[116:119], a[252:255], v[120:123], a[116:119]
    ds_read_b64_tr_b16 a[248:249], v4 offset:2048
    v_add_f32 v20, v20, v76
    v_mfma_f32_16x16x32_bf16 a[168:171], v[152:155], v[108:111], a[168:171]
    v_exp_f32 v77, v77
    v_mfma_f32_16x16x32_bf16 a[24:27], v[152:155], v[96:99], a[24:27]
    s_add_u32 m0, s33, 38656
    ds_read_b64_tr_b16 a[250:251], v4 offset:8192
    v_cvt_pk_bf16_f32 v146, v76, v77
    v_mfma_f32_16x16x32_bf16 a[24:27], v[156:159], v[112:115], a[24:27]
    buffer_load_dwordx4 v8, s[16:19], s29 offen offset:256 nt lds
    v_mfma_f32_16x16x32_bf16 a[72:75], v[152:155], v[100:103], a[72:75]
    s_add_u32 s29, s29, 12288
    ds_read_b64_tr_b16 a[252:253], v4 offset:14336
    v_add_f32 v20, v20, v77
    v_mfma_f32_16x16x32_bf16 a[72:75], v[156:159], v[116:119], a[72:75]
    ds_read_b64_tr_b16 a[254:255], v4 offset:20480
    v_and_b32 v43, 0xffff0000, v39
    v_mfma_f32_16x16x32_bf16 a[120:123], v[152:155], v[104:107], a[120:123]
    v_exp_f32 v78, v78
    v_mfma_f32_16x16x32_bf16 a[120:123], v[156:159], v[120:123], a[120:123]
    s_waitcnt lgkmcnt(3)
    ds_read_b64_tr_b16 v[152:153], v5 offset:2048
    v_add_f32 v20, v20, v78
    v_mfma_f32_16x16x32_bf16 a[172:175], a[240:243], v[108:111], a[172:175]
    v_exp_f32 v79, v79
    v_mfma_f32_16x16x32_bf16 a[28:31], a[240:243], v[96:99], a[28:31]
    ds_read_b64_tr_b16 v[154:155], v5 offset:8192
    v_cvt_pk_bf16_f32 v147, v78, v79
    v_mfma_f32_16x16x32_bf16 a[28:31], a[244:247], v[112:115], a[28:31]
    ds_read_b64_tr_b16 v[156:157], v5 offset:14336
    v_add_f32 v20, v20, v79
    v_mfma_f32_16x16x32_bf16 a[76:79], a[240:243], v[100:103], a[76:79]
    v_exp_f32 v80, v80
    v_mfma_f32_16x16x32_bf16 a[76:79], a[244:247], v[116:119], a[76:79]
    ds_read_b64_tr_b16 v[158:159], v5 offset:20480
    v_add_f32 v21, v21, v80
    v_mfma_f32_16x16x32_bf16 a[124:127], a[240:243], v[104:107], a[124:127]
    v_exp_f32 v81, v81
    v_mfma_f32_16x16x32_bf16 a[124:127], a[244:247], v[120:123], a[124:127]
    s_waitcnt lgkmcnt(3)
    ds_read_b128 a[220:223], v3 offset:6144
    v_cvt_pk_bf16_f32 v148, v80, v81
    v_mfma_f32_16x16x32_bf16 a[176:179], a[248:251], v[108:111], a[176:179]
    ds_read_b64_tr_b16 a[240:241], v6 offset:2048
    v_add_f32 v21, v21, v81
    v_mfma_f32_16x16x32_bf16 a[32:35], a[248:251], v[96:99], a[32:35]
    v_exp_f32 v82, v82
    v_mfma_f32_16x16x32_bf16 a[32:35], a[252:255], v[112:115], a[32:35]
    ds_read_b64_tr_b16 a[242:243], v6 offset:8192
    v_add_f32 v21, v21, v82
    v_mfma_f32_16x16x32_bf16 a[80:83], a[248:251], v[100:103], a[80:83]
    v_exp_f32 v83, v83
    v_mfma_f32_16x16x32_bf16 a[80:83], a[252:255], v[116:119], a[80:83]
    ds_read_b64_tr_b16 a[244:245], v6 offset:14336
    v_cvt_pk_bf16_f32 v149, v82, v83
    v_mfma_f32_16x16x32_bf16 a[128:131], a[248:251], v[104:107], a[128:131]
    ds_read_b64_tr_b16 a[246:247], v6 offset:20480
    v_add_f32 v21, v21, v83
    v_mfma_f32_16x16x32_bf16 a[128:131], a[252:255], v[120:123], a[128:131]
    s_waitcnt lgkmcnt(4)
    ds_read_b128 a[224:227], v2 offset:7168
    v_mul_f32 v42, s42, v42
    v_mfma_f32_16x16x32_bf16 a[180:183], v[152:155], v[108:111], a[180:183]
    v_exp_f32 v84, v84
    v_mfma_f32_16x16x32_bf16 a[36:39], v[152:155], v[96:99], a[36:39]
    ds_read_b128 a[228:231], v3 offset:7168
    v_add_f32 v21, v21, v84
    v_mfma_f32_16x16x32_bf16 a[36:39], v[156:159], v[112:115], a[36:39]
    ds_read_b64_tr_b16 a[248:249], v7 offset:2048
    ds_read_b64_tr_b16 a[250:251], v7 offset:8192
    v_mfma_f32_16x16x32_bf16 a[84:87], v[152:155], v[100:103], a[84:87]
    ds_read_b128 a[232:235], v2 offset:8192
    v_mul_f32 v43, s42, v43
    v_mfma_f32_16x16x32_bf16 a[84:87], v[156:159], v[116:119], a[84:87]
    ds_read_b64_tr_b16 a[252:253], v7 offset:14336
    ds_read_b64_tr_b16 a[254:255], v7 offset:20480
    v_mfma_f32_16x16x32_bf16 a[132:135], v[152:155], v[104:107], a[132:135]
    v_exp_f32 v85, v85
    v_mfma_f32_16x16x32_bf16 a[132:135], v[156:159], v[120:123], a[132:135]
    s_waitcnt lgkmcnt(6)
    ds_read_b128 a[236:239], v3 offset:8192
    v_cvt_pk_bf16_f32 v150, v84, v85
    v_mfma_f32_16x16x32_bf16 a[184:187], a[240:243], v[108:111], a[184:187]
    v_exp_f32 v86, v86
    v_mfma_f32_16x16x32_bf16 a[40:43], a[240:243], v[96:99], a[40:43]
    s_waitcnt vmcnt(16)
    ds_inc_u32 v46, v46
    v_add_f32 v21, v21, v85
    v_mfma_f32_16x16x32_bf16 a[40:43], a[244:247], v[112:115], a[40:43]
    v_exp_f32 v87, v87
    v_mfma_f32_16x16x32_bf16 a[88:91], a[240:243], v[100:103], a[88:91]
    ds_write_b128 v44, v[32:35]
    v_cvt_pk_bf16_f32 v151, v86, v87
    v_add_f32 v21, v21, v86
    v_mfma_f32_16x16x32_bf16 a[88:91], a[244:247], v[116:119], a[88:91]
    v_add_f32 v21, v21, v87
    v_max3_f32 v28, v19, v20, v21
    v_mfma_f32_16x16x32_bf16 a[136:139], a[240:243], v[104:107], a[136:139]
    v_max_f32 v28, v28, v22
    v_cvt_pk_bf16_f32 v39, v42, v43
    v_mfma_f32_16x16x32_bf16 a[136:139], a[244:247], v[120:123], a[136:139]
    s_waitcnt lgkmcnt(2)
    ds_write_b128 v44, v[36:39] offset:1024
    v_mfma_f32_16x16x32_bf16 a[188:191], a[248:251], v[108:111], a[188:191]
    v_add_u32 v44, s85, v44
    v_xor_b32 v23, s87, v23
    v_mfma_f32_16x16x32_bf16 a[44:47], a[248:251], v[96:99], a[44:47]
    s_waitcnt vmcnt(14)
    ds_read_b128 v[32:35], v44
    v_mfma_f32_16x16x32_bf16 a[44:47], a[252:255], v[112:115], a[44:47]
    ds_read_b128 v[36:39], v44 offset:1024
    v_mfma_f32_16x16x32_bf16 a[92:95], a[248:251], v[100:103], a[92:95]
    v_mfma_f32_16x16x32_bf16 a[92:95], a[252:255], v[116:119], a[92:95]
    v_mfma_f32_16x16x32_bf16 a[140:143], a[248:251], v[104:107], a[140:143]
    v_mfma_f32_16x16x32_bf16 a[140:143], a[252:255], v[120:123], a[140:143]
    s_mov_b32 s85, 2048
    s_sub_u32 s31, s31, 1
    s_cbranch_scc0 L_loop_00
L_after_00:
    s_waitcnt vmcnt(8) lgkmcnt(0)
    s_barrier
    s_add_u32 s93, s93, 4
    s_mov_b32 s48, s90
    s_xor_b32 s49, s90, 16384
    s_add_u32 s50, s90, 256
    s_add_u32 s51, s90, 6656
    ds_read_b64_tr_b16 v[152:153], v6 offset:25600
    ds_read_b64_tr_b16 v[154:155], v6 offset:31744
    ds_read_b64_tr_b16 v[156:157], v6 offset:37888
    ds_read_b64_tr_b16 v[158:159], v6 offset:44032
    ds_read_b64_tr_b16 a[240:241], v7 offset:25600
    ds_read_b64_tr_b16 a[242:243], v7 offset:31744
    ds_read_b64_tr_b16 a[244:245], v7 offset:37888
    ds_read_b64_tr_b16 a[246:247], v7 offset:44032
    v_cmp_lt_f32 vcc, s35, v28
    s_nop 3
    s_cbranch_vccnz L_t00_31c_rare
L_t00_31c_back:
    s_add_u32 m0, s33, 50048
    s_mov_b32 s54, 6144
    s_mov_b32 s55, 12288
    v_add_u32 v24, s90, v2
    v_add_u32 v25, s90, v3
    v_lshl_add_u32 v36, v1, 4, s48
    v_add_u32 v26, s46, v10
    v_add_u32 v27, s40, v10
    v_add_f32 v12, v12, v19
    v_add_f32 v13, v13, v20
    v_add_f32 v14, v14, v21
    v_add_f32 v15, v15, v22
    v_mov_b32 v32, v12
    s_nop 1
    v_permlane32_swap_b32 v12, v32
    v_add_f32 v12, v12, v32
    v_mov_b32 v32, v12
    s_nop 1
    v_permlane16_swap_b32 v12, v32
    v_add_f32 v12, v12, v32
    v_rcp_f32 v40, v12
    v_mov_b32 v35, v15
    s_nop 1
    v_permlane32_swap_b32 v15, v35
    v_add_f32 v15, v15, v35
    v_mov_b32 v35, v15
    s_nop 1
    v_permlane16_swap_b32 v15, v35
    v_add_f32 v15, v15, v35
    v_mov_b32 v39, v15
    v_mov_b32 v33, v13
    v_mov_b32 v34, v14
    s_waitcnt lgkmcnt(6)
    v_mfma_f32_16x16x32_bf16 a[168:171], v[152:155], v[136:139], a[168:171]
    buffer_load_dwordx4 v9, s[20:23], s30 offen offset:128 nt lds
    v_mfma_f32_16x16x32_bf16 a[24:27], v[152:155], v[124:127], a[24:27]
    s_waitcnt lgkmcnt(4)
    ds_read_b64_tr_b16 a[248:249], v4 offset:26624
    v_mov_b32 v38, v60
    v_mfma_f32_16x16x32_bf16 a[24:27], v[156:159], v[140:143], a[24:27]
    ds_read_b64_tr_b16 a[250:251], v4 offset:32768
    v_lshl_add_u32 v37, v1, 4, s49
    v_mfma_f32_16x16x32_bf16 a[72:75], v[152:155], v[128:131], a[72:75]
    ds_read_b64_tr_b16 a[252:253], v4 offset:38912
    v_lshl_add_u32 v41, v1, 3, s48
    v_mfma_f32_16x16x32_bf16 a[72:75], v[156:159], v[144:147], a[72:75]
    ds_read_b64_tr_b16 a[254:255], v4 offset:45056
    v_lshl_add_u32 v43, v1, 3, s49
    v_mfma_f32_16x16x32_bf16 a[120:123], v[152:155], v[132:135], a[120:123]
    ds_read_b64_tr_b16 v[152:153], v5 offset:26624
    v_and_b32 v45, 15, v1
    v_mfma_f32_16x16x32_bf16 a[120:123], v[156:159], v[148:151], a[120:123]
    s_waitcnt lgkmcnt(5)
    buffer_load_dwordx4 v[208:211], v26, s[12:15], 0 offen
    v_mfma_f32_16x16x32_bf16 a[172:175], a[240:243], v[136:139], a[172:175]
    ds_read_b64_tr_b16 v[154:155], v5 offset:32768
    v_mul_u32_u24 v45, 400, v45
    v_mfma_f32_16x16x32_bf16 a[28:31], a[240:243], v[124:127], a[28:31]
    ds_read_b128 v[160:163], v24
    v_lshrrev_b32 v29, 4, v1
    v_mfma_f32_16x16x32_bf16 a[28:31], a[244:247], v[140:143], a[28:31]
    s_add_u32 m0, s33, 50944
    ds_read_b64_tr_b16 v[156:157], v5 offset:38912
    v_lshl_add_u32 v45, v29, 3, v45
    v_mfma_f32_16x16x32_bf16 a[76:79], a[240:243], v[128:131], a[76:79]
    buffer_load_dwordx4 v9, s[20:23], s30 offen offset:256 nt lds
    v_mfma_f32_16x16x32_bf16 a[76:79], a[244:247], v[144:147], a[76:79]
    ds_read_b64_tr_b16 v[158:159], v5 offset:45056
    v_add_u32 v28, s51, v45
    v_mfma_f32_16x16x32_bf16 a[124:127], a[240:243], v[132:135], a[124:127]
    ds_read_b128 v[164:167], v25
    v_lshrrev_b32 v45, 3, v1
    v_mfma_f32_16x16x32_bf16 a[124:127], a[244:247], v[148:151], a[124:127]
    s_waitcnt lgkmcnt(5)
    ds_read_b64_tr_b16 a[240:241], v6 offset:26624
    v_and_b32 v29, 7, v1
    v_mfma_f32_16x16x32_bf16 a[176:179], a[248:251], v[136:139], a[176:179]
    ds_read_b128 v[168:171], v24 offset:1024
    v_lshlrev_b32 v29, 4, v29
    v_mfma_f32_16x16x32_bf16 a[32:35], a[248:251], v[124:127], a[32:35]
    ds_read_b64_tr_b16 a[242:243], v6 offset:32768
    v_mul_u32_u24 v30, 400, v45
    v_mfma_f32_16x16x32_bf16 a[32:35], a[252:255], v[140:143], a[32:35]
    ds_read_b128 v[172:175], v25 offset:1024
    v_add3_u32 v30, v30, v29, s50
    v_mfma_f32_16x16x32_bf16 a[80:83], a[248:251], v[128:131], a[80:83]
    ds_read_b64_tr_b16 a[244:245], v6 offset:38912
    v_mul_u32_u24 v31, 384, v45
    v_mfma_f32_16x16x32_bf16 a[80:83], a[252:255], v[144:147], a[80:83]
    ds_read_b128 v[176:179], v24 offset:2048
    v_add3_u32 v31, v31, v29, s37
    v_mfma_f32_16x16x32_bf16 a[128:131], a[248:251], v[132:135], a[128:131]
    ds_read_b64_tr_b16 a[246:247], v6 offset:45056
    v_add_u32 v29, s38, v11
    v_mfma_f32_16x16x32_bf16 a[128:131], a[252:255], v[148:151], a[128:131]
    s_waitcnt lgkmcnt(6)
    ds_read_b128 v[180:183], v25 offset:2048
    v_accvgpr_read_b32 v64, a24
    v_mfma_f32_16x16x32_bf16 a[180:183], v[152:155], v[136:139], a[180:183]
    s_add_u32 m0, s33, 62336
    buffer_load_dwordx4 v[212:215], v26, s[12:15], 0 offen offset:64
    v_mfma_f32_16x16x32_bf16 a[36:39], v[152:155], v[124:127], a[36:39]
    buffer_load_dwordx4 v9, s[20:23], s32 offen offset:128 nt lds
    v_mfma_f32_16x16x32_bf16 a[36:39], v[156:159], v[140:143], a[36:39]
    ds_read_b128 v[184:187], v24 offset:6144
    v_mul_f32 v64, v64, v40
    v_mfma_f32_16x16x32_bf16 a[84:87], v[152:155], v[128:131], a[84:87]
    ds_read_b64_tr_b16 a[248:249], v7 offset:26624
    v_accvgpr_read_b32 v65, a25
    v_mfma_f32_16x16x32_bf16 a[84:87], v[156:159], v[144:147], a[84:87]
    ds_read_b64_tr_b16 a[250:251], v7 offset:32768
    v_mul_f32 v65, v65, v40
    v_mfma_f32_16x16x32_bf16 a[132:135], v[152:155], v[132:135], a[132:135]
    ds_read_b128 v[188:191], v25 offset:6144
    v_cvt_pk_bf16_f32 v96, v64, v65
    v_mfma_f32_16x16x32_bf16 a[132:135], v[156:159], v[148:151], a[132:135]
    s_waitcnt lgkmcnt(4)
    ds_read_b64_tr_b16 a[252:253], v7 offset:38912
    v_accvgpr_read_b32 v66, a26
    v_mfma_f32_16x16x32_bf16 a[184:187], a[240:243], v[136:139], a[184:187]
    ds_read_b64_tr_b16 a[254:255], v7 offset:45056
    ds_read_b128 v[192:195], v24 offset:7168
    v_mfma_f32_16x16x32_bf16 a[40:43], a[240:243], v[124:127], a[40:43]
    ds_read_b64_tr_b16 v[152:153], v4 offset:24576
    v_mul_f32 v66, v66, v40
    v_mfma_f32_16x16x32_bf16 a[40:43], a[244:247], v[140:143], a[40:43]
    ds_read_b128 v[196:199], v25 offset:7168
    v_accvgpr_read_b32 v67, a27
    v_mfma_f32_16x16x32_bf16 a[88:91], a[240:243], v[128:131], a[88:91]
    ds_read_b64_tr_b16 v[154:155], v4 offset:30720
    v_mul_f32 v67, v67, v40
    v_mfma_f32_16x16x32_bf16 a[88:91], a[244:247], v[144:147], a[88:91]
    s_add_u32 m0, s33, 63232
    ds_read_b128 v[200:203], v24 offset:8192
    v_cvt_pk_bf16_f32 v97, v66, v67
    v_mfma_f32_16x16x32_bf16 a[136:139], a[240:243], v[132:135], a[136:139]
    buffer_load_dwordx4 v9, s[20:23], s32 offen offset:256 nt lds
    v_mfma_f32_16x16x32_bf16 a[136:139], a[244:247], v[148:151], a[136:139]
    s_waitcnt lgkmcnt(6)
    ds_read_b128 v[204:207], v25 offset:8192
    v_accvgpr_read_b32 v68, a28
    v_mfma_f32_16x16x32_bf16 a[188:191], a[248:251], v[136:139], a[188:191]
    s_add_u32 s30, s30, 24576
    ds_read_b64_tr_b16 v[156:157], v4 offset:36864
    ds_read_b64_tr_b16 v[158:159], v4 offset:43008
    v_mfma_f32_16x16x32_bf16 a[44:47], a[248:251], v[124:127], a[44:47]
    s_waitcnt lgkmcnt(6)
    buffer_load_dwordx4 v[216:219], v26, s[12:15], 0 offen offset:128
    v_mfma_f32_16x16x32_bf16 a[44:47], a[252:255], v[140:143], a[44:47]
    s_add_u32 s32, s32, 24576
    ds_read_b64_tr_b16 a[240:241], v5 offset:24576
    v_mul_f32 v68, v68, v40
    v_mfma_f32_16x16x32_bf16 a[92:95], a[248:251], v[128:131], a[92:95]
    ds_read_b64_tr_b16 a[242:243], v5 offset:30720
    v_accvgpr_read_b32 v69, a29
    v_mfma_f32_16x16x32_bf16 a[92:95], a[252:255], v[144:147], a[92:95]
    ds_read_b64_tr_b16 a[244:245], v5 offset:36864
    v_mul_f32 v69, v69, v40
    v_mfma_f32_16x16x32_bf16 a[140:143], a[248:251], v[132:135], a[140:143]
    s_add_u32 m0, s33, 0
    ds_read_b64_tr_b16 a[246:247], v5 offset:43008
    v_cvt_pk_bf16_f32 v98, v68, v69
    v_mfma_f32_16x16x32_bf16 a[140:143], a[252:255], v[148:151], a[140:143]
    s_waitcnt lgkmcnt(6)
    buffer_load_dwordx4 v8, s[16:19], s29 offen nt lds
    v_mfma_f32_16x16x32_bf16 a[144:147], v[152:155], v[136:139], a[144:147]
    ds_read_b64_tr_b16 a[248:249], v6 offset:24576
    v_accvgpr_read_b32 v70, a30
    v_mfma_f32_16x16x32_bf16 a[0:3], v[152:155], v[124:127], a[0:3]
    s_waitcnt lgkmcnt(5)
    ds_read_b64_tr_b16 a[250:251], v6 offset:30720
    v_mul_f32 v70, v70, v40
    v_mfma_f32_16x16x32_bf16 a[0:3], v[156:159], v[140:143], a[0:3]
    ds_read_b64_tr_b16 a[252:253], v6 offset:36864
    v_accvgpr_read_b32 v71, a31
    v_mfma_f32_16x16x32_bf16 a[48:51], v[152:155], v[128:131], a[48:51]
    ds_read_b64_tr_b16 a[254:255], v6 offset:43008
    v_mul_f32 v71, v71, v40
    v_mfma_f32_16x16x32_bf16 a[48:51], v[156:159], v[144:147], a[48:51]
    ds_write_b128 v36, a[168:171]
    v_mfma_f32_16x16x32_bf16 a[96:99], v[152:155], v[132:135], a[96:99]
    ds_read_b64_tr_b16 v[152:153], v7 offset:24576
    v_cvt_pk_bf16_f32 v99, v70, v71
    v_mfma_f32_16x16x32_bf16 a[96:99], v[156:159], v[148:151], a[96:99]
    s_waitcnt lgkmcnt(6)
    buffer_load_dwordx4 v[220:223], v26, s[12:15], 0 offen offset:192
    v_mfma_f32_16x16x32_bf16 a[148:151], a[240:243], v[136:139], a[148:151]
    s_add_u32 m0, s33, 896
    ds_read_b64_tr_b16 v[154:155], v7 offset:30720
    v_accvgpr_read_b32 v72, a32
    v_mfma_f32_16x16x32_bf16 a[4:7], a[240:243], v[124:127], a[4:7]
    buffer_load_dwordx4 v8, s[16:19], s29 offen offset:128 nt lds
    v_mfma_f32_16x16x32_bf16 a[4:7], a[244:247], v[140:143], a[4:7]
    ds_read_b64_tr_b16 v[156:157], v7 offset:36864
    v_mul_f32 v72, v72, v40
    v_mfma_f32_16x16x32_bf16 a[52:55], a[240:243], v[128:131], a[52:55]
    ds_read_b64_tr_b16 v[158:159], v7 offset:43008
    v_accvgpr_read_b32 v73, a33
    v_mfma_f32_16x16x32_bf16 a[52:55], a[244:247], v[144:147], a[52:55]
    ds_write_b128 v36, a[172:175] offset:1024
    v_mfma_f32_16x16x32_bf16 a[100:103], a[240:243], v[132:135], a[100:103]
    ds_read_b64_tr_b16 a[240:241], v4 offset:25600
    v_mul_f32 v73, v73, v40
    v_mfma_f32_16x16x32_bf16 a[100:103], a[244:247], v[148:151], a[100:103]
    s_waitcnt lgkmcnt(5)
    ds_read_b64_tr_b16 a[242:243], v4 offset:31744
    v_cvt_pk_bf16_f32 v100, v72, v73
    v_mfma_f32_16x16x32_bf16 a[152:155], a[248:251], v[136:139], a[152:155]
    ds_read_b64_tr_b16 a[244:245], v4 offset:37888
    v_accvgpr_read_b32 v74, a34
    v_mfma_f32_16x16x32_bf16 a[8:11], a[248:251], v[124:127], a[8:11]
    ds_write_b128 v36, a[176:179] offset:2048
    v_mfma_f32_16x16x32_bf16 a[8:11], a[252:255], v[140:143], a[8:11]
    ds_read_b64_tr_b16 a[246:247], v4 offset:44032
    v_mul_f32 v74, v74, v40
    v_mfma_f32_16x16x32_bf16 a[56:59], a[248:251], v[128:131], a[56:59]
    s_add_u32 m0, s33, 1792
    v_permlane32_swap_b32 v13, v33
    v_mfma_f32_16x16x32_bf16 a[56:59], a[252:255], v[144:147], a[56:59]
    buffer_load_dwordx4 v8, s[16:19], s29 offen offset:256 nt lds
    v_mfma_f32_16x16x32_bf16 a[104:107], a[248:251], v[132:135], a[104:107]
    s_add_u32 s29, s29, 12288
    ds_write_b128 v36, a[180:183] offset:3072
    v_mfma_f32_16x16x32_bf16 a[104:107], a[252:255], v[148:151], a[104:107]
    s_waitcnt lgkmcnt(4)
    buffer_load_dwordx4 v[224:227], v26, s[12:15], 0 offen offset:256
    v_mfma_f32_16x16x32_bf16 a[156:159], v[152:155], v[136:139], a[156:159]
    ds_read_b64_tr_b16 a[248:249], v5 offset:25600
    v_add_f32 v13, v13, v33
    v_mfma_f32_16x16x32_bf16 a[12:15], v[152:155], v[124:127], a[12:15]
    ds_read_b64_tr_b16 a[250:251], v5 offset:31744
    v_mov_b32 v33, v13
    v_mfma_f32_16x16x32_bf16 a[12:15], v[156:159], v[140:143], a[12:15]
    ds_write_b128 v36, a[184:187] offset:4096
    v_mfma_f32_16x16x32_bf16 a[60:63], v[152:155], v[128:131], a[60:63]
    ds_read_b64_tr_b16 a[252:253], v5 offset:37888
    v_accvgpr_read_b32 v75, a35
    v_mfma_f32_16x16x32_bf16 a[60:63], v[156:159], v[144:147], a[60:63]
    ds_read_b64_tr_b16 a[254:255], v5 offset:44032
    v_mul_f32 v75, v75, v40
    v_mfma_f32_16x16x32_bf16 a[108:111], v[152:155], v[132:135], a[108:111]
    v_permlane16_swap_b32 v13, v33
    v_mfma_f32_16x16x32_bf16 a[108:111], v[156:159], v[148:151], a[108:111]
    ds_write_b128 v36, a[188:191] offset:5120
    v_mfma_f32_16x16x32_bf16 a[160:163], a[240:243], v[136:139], a[160:163]
    v_add_f32 v13, v13, v33
    v_cvt_pk_bf16_f32 v101, v74, v75
    v_mfma_f32_16x16x32_bf16 a[16:19], a[240:243], v[124:127], a[16:19]
    s_waitcnt lgkmcnt(4)
    v_rcp_f32 v42, v13
    v_mfma_f32_16x16x32_bf16 a[16:19], a[244:247], v[140:143], a[16:19]
    v_permlane32_swap_b32 v14, v34
    v_mfma_f32_16x16x32_bf16 a[64:67], a[240:243], v[128:131], a[64:67]
    v_add_f32 v14, v14, v34
    v_mov_b32 v34, v14
    v_mfma_f32_16x16x32_bf16 a[64:67], a[244:247], v[144:147], a[64:67]
    ds_write_b64 v41, v[38:39] offset:6144
    v_mfma_f32_16x16x32_bf16 a[112:115], a[240:243], v[132:135], a[112:115]
    v_permlane16_swap_b32 v14, v34
    v_mfma_f32_16x16x32_bf16 a[112:115], a[244:247], v[148:151], a[112:115]
    buffer_load_dwordx4 v[228:231], v26, s[12:15], 0 offen offset:320
    v_mfma_f32_16x16x32_bf16 a[164:167], a[248:251], v[136:139], a[164:167]
    v_add_f32 v14, v14, v34
    v_accvgpr_read_b32 v76, a36
    v_mfma_f32_16x16x32_bf16 a[20:23], a[248:251], v[124:127], a[20:23]
    s_waitcnt lgkmcnt(1)
    v_rcp_f32 v44, v14
    v_mfma_f32_16x16x32_bf16 a[20:23], a[252:255], v[140:143], a[20:23]
    ds_write2_b64 v28, v[96:97], v[98:99] offset0:24 offset1:28
    v_mfma_f32_16x16x32_bf16 a[68:71], a[248:251], v[128:131], a[68:71]
    v_mul_f32 v76, v76, v40
    v_accvgpr_read_b32 v77, a37
    v_mfma_f32_16x16x32_bf16 a[68:71], a[252:255], v[144:147], a[68:71]
    v_mul_f32 v77, v77, v40
    v_cvt_pk_bf16_f32 v102, v76, v77
    v_mfma_f32_16x16x32_bf16 a[116:119], a[248:251], v[132:135], a[116:119]
    v_accvgpr_read_b32 v78, a38
    v_mul_f32 v78, v78, v40
    v_mfma_f32_16x16x32_bf16 a[116:119], a[252:255], v[148:151], a[116:119]
    v_accvgpr_read_b32 v79, a39
    v_mul_f32 v79, v79, v40
    v_cvt_pk_bf16_f32 v103, v78, v79
    ds_write2_b64 v28, v[100:101], v[102:103] offset0:32 offset1:36
    s_waitcnt vmcnt(18) lgkmcnt(0)
    s_barrier
    ds_read_b64 v[38:39], v43 offset:6144
    ds_read_b128 v[128:131], v37
    ds_read_b128 v[132:135], v37 offset:1024
    ds_read_b128 v[136:139], v37 offset:2048
    ds_read_b128 v[140:143], v37 offset:3072
    ds_read_b128 v[144:147], v37 offset:4096
    ds_read_b128 v[148:151], v37 offset:5120
    s_add_u32 m0, s33, 73728
    s_nop 0
    buffer_load_dwordx4 v9, s[20:23], s30 offen nt lds
    s_add_u32 m0, s33, 74624
    s_nop 0
    buffer_load_dwordx4 v9, s[20:23], s30 offen offset:128 nt lds
    s_add_u32 m0, s33, 75520
    s_nop 0
    buffer_load_dwordx4 v9, s[20:23], s30 offen offset:256 nt lds
    s_add_u32 m0, s33, 86016
    s_nop 0
    buffer_load_dwordx4 v9, s[20:23], s32 offen nt lds
    s_add_u32 m0, s33, 86912
    s_nop 0
    buffer_load_dwordx4 v9, s[20:23], s32 offen offset:128 nt lds
    s_add_u32 m0, s33, 87808
    s_nop 0
    buffer_load_dwordx4 v9, s[20:23], s32 offen offset:256 nt lds
    s_add_u32 s30, s30, 24576
    s_add_u32 s32, s32, 24576
    v_accvgpr_read_b32 v80, a40
    v_accvgpr_read_b32 v81, a41
    v_accvgpr_read_b32 v82, a42
    v_accvgpr_read_b32 v83, a43
    v_accvgpr_read_b32 v84, a44
    v_accvgpr_read_b32 v85, a45
    v_accvgpr_read_b32 v86, a46
    v_accvgpr_read_b32 v87, a47
    buffer_load_dwordx4 v[232:235], v27, s[12:15], 0 offen
    v_pk_mul_f32 v[80:81], v[80:81], v[40:41] op_sel_hi:[1,0]
    v_pk_mul_f32 v[82:83], v[82:83], v[40:41] op_sel_hi:[1,0]
    v_pk_mul_f32 v[84:85], v[84:85], v[40:41] op_sel_hi:[1,0]
    v_pk_mul_f32 v[86:87], v[86:87], v[40:41] op_sel_hi:[1,0]
    v_cvt_pk_bf16_f32 v96, v80, v81
    v_cvt_pk_bf16_f32 v97, v82, v83
    v_cvt_pk_bf16_f32 v98, v84, v85
    v_cvt_pk_bf16_f32 v99, v86, v87
    v_accvgpr_read_b32 v88, a0
    v_accvgpr_read_b32 v89, a1
    v_accvgpr_read_b32 v90, a2
    v_accvgpr_read_b32 v91, a3
    v_accvgpr_read_b32 v92, a4
    v_accvgpr_read_b32 v93, a5
    v_accvgpr_read_b32 v94, a6
    v_accvgpr_read_b32 v95, a7
    ds_write2_b64 v28, v[96:97], v[98:99] offset0:40 offset1:44
    ds_read_b128 v[104:107], v30 offset:6656
    ds_read_b128 v[108:111], v30 offset:9856
    buffer_load_dwordx4 v[236:239], v27, s[12:15], 0 offen offset:64
    v_pk_mul_f32 v[88:89], v[88:89], v[40:41] op_sel_hi:[1,0]
    v_pk_mul_f32 v[90:91], v[90:91], v[40:41] op_sel_hi:[1,0]
    v_pk_mul_f32 v[92:93], v[92:93], v[40:41] op_sel_hi:[1,0]
    v_pk_mul_f32 v[94:95], v[94:95], v[40:41] op_sel_hi:[1,0]
    v_cvt_pk_bf16_f32 v100, v88, v89
    v_cvt_pk_bf16_f32 v101, v90, v91
    v_cvt_pk_bf16_f32 v102, v92, v93
    v_cvt_pk_bf16_f32 v103, v94, v95
    v_accvgpr_read_b32 v64, a8
    v_accvgpr_read_b32 v65, a9
    v_accvgpr_read_b32 v66, a10
    v_accvgpr_read_b32 v67, a11
    v_accvgpr_read_b32 v68, a12
    v_accvgpr_read_b32 v69, a13
    v_accvgpr_read_b32 v70, a14
    v_accvgpr_read_b32 v71, a15
    ds_write2_b64 v28, v[100:101], v[102:103] offset0:0 offset1:4
    buffer_load_dwordx4 v[240:243], v27, s[12:15], 0 offen offset:128
    v_pk_mul_f32 v[64:65], v[64:65], v[40:41] op_sel_hi:[1,0]
    v_pk_mul_f32 v[66:67], v[66:67], v[40:41] op_sel_hi:[1,0]
    v_pk_mul_f32 v[68:69], v[68:69], v[40:41] op_sel_hi:[1,0]
    v_pk_mul_f32 v[70:71], v[70:71], v[40:41] op_sel_hi:[1,0]
    v_cvt_pk_bf16_f32 v96, v64, v65
    v_cvt_pk_bf16_f32 v97, v66, v67
    v_cvt_pk_bf16_f32 v98, v68, v69
    v_cvt_pk_bf16_f32 v99, v70, v71
    v_accvgpr_read_b32 v72, a16
    v_accvgpr_read_b32 v73, a17
    v_accvgpr_read_b32 v74, a18
    v_accvgpr_read_b32 v75, a19
    v_accvgpr_read_b32 v76, a20
    v_accvgpr_read_b32 v77, a21
    v_accvgpr_read_b32 v78, a22
    v_accvgpr_read_b32 v79, a23
    ds_write2_b64 v28, v[96:97], v[98:99] offset0:8 offset1:12
    ds_read_b128 v[112:115], v30 offset:6400
    ds_read_b128 v[116:119], v30 offset:9600
    buffer_load_dwordx4 v[244:247], v27, s[12:15], 0 offen offset:192
    v_pk_mul_f32 v[72:73], v[72:73], v[40:41] op_sel_hi:[1,0]
    v_pk_mul_f32 v[74:75], v[74:75], v[40:41] op_sel_hi:[1,0]
    v_pk_mul_f32 v[76:77], v[76:77], v[40:41] op_sel_hi:[1,0]
    v_pk_mul_f32 v[78:79], v[78:79], v[40:41] op_sel_hi:[1,0]
    v_cvt_pk_bf16_f32 v100, v72, v73
    v_cvt_pk_bf16_f32 v101, v74, v75
    v_cvt_pk_bf16_f32 v102, v76, v77
    v_cvt_pk_bf16_f32 v103, v78, v79
    v_accvgpr_read_b32 v80, a48
    v_accvgpr_read_b32 v81, a49
    v_accvgpr_read_b32 v82, a50
    v_accvgpr_read_b32 v83, a51
    v_accvgpr_read_b32 v84, a52
    v_accvgpr_read_b32 v85, a53
    v_accvgpr_read_b32 v86, a54
    v_accvgpr_read_b32 v87, a55
    ds_write2_b64 v28, v[100:101], v[102:103] offset0:16 offset1:20
    ds_read_b128 v[120:123], v30 offset:6528
    ds_read_b128 v[124:127], v30 offset:9728
    v_add_u32 v28, -6400, v28
    buffer_load_dwordx4 v[248:251], v27, s[12:15], 0 offen offset:256
    v_pk_mul_f32 v[80:81], v[80:81], v[42:43] op_sel_hi:[1,0]
    v_pk_mul_f32 v[82:83], v[82:83], v[42:43] op_sel_hi:[1,0]
    v_pk_mul_f32 v[84:85], v[84:85], v[42:43] op_sel_hi:[1,0]
    v_pk_mul_f32 v[86:87], v[86:87], v[42:43] op_sel_hi:[1,0]
    v_cvt_pk_bf16_f32 v96, v80, v81
    v_cvt_pk_bf16_f32 v97, v82, v83
    v_cvt_pk_bf16_f32 v98, v84, v85
    v_cvt_pk_bf16_f32 v99, v86, v87
    s_waitcnt lgkmcnt(0)
    s_barrier
    v_accvgpr_read_b32 v88, a56
    v_accvgpr_read_b32 v89, a57
    v_accvgpr_read_b32 v90, a58
    v_accvgpr_read_b32 v91, a59
    v_accvgpr_read_b32 v92, a60
    v_accvgpr_read_b32 v93, a61
    v_accvgpr_read_b32 v94, a62
    v_accvgpr_read_b32 v95, a63
    ds_write2_b64 v28, v[96:97], v[98:99] offset0:0 offset1:4
    buffer_load_dwordx4 v[252:255], v27, s[12:15], 0 offen offset:320
    v_pk_mul_f32 v[88:89], v[88:89], v[42:43] op_sel_hi:[1,0]
    v_pk_mul_f32 v[90:91], v[90:91], v[42:43] op_sel_hi:[1,0]
    v_pk_mul_f32 v[92:93], v[92:93], v[42:43] op_sel_hi:[1,0]
    v_pk_mul_f32 v[94:95], v[94:95], v[42:43] op_sel_hi:[1,0]
    v_cvt_pk_bf16_f32 v100, v88, v89
    v_cvt_pk_bf16_f32 v101, v90, v91
    v_cvt_pk_bf16_f32 v102, v92, v93
    v_cvt_pk_bf16_f32 v103, v94, v95
    v_accvgpr_read_b32 v64, a64
    v_accvgpr_read_b32 v65, a65
    v_accvgpr_read_b32 v66, a66
    v_accvgpr_read_b32 v67, a67
    v_accvgpr_read_b32 v68, a68
    v_accvgpr_read_b32 v69, a69
    v_accvgpr_read_b32 v70, a70
    v_accvgpr_read_b32 v71, a71
    ds_write2_b64 v28, v[100:101], v[102:103] offset0:8 offset1:12
    v_pk_mul_f32 v[64:65], v[64:65], v[42:43] op_sel_hi:[1,0]
    v_pk_mul_f32 v[66:67], v[66:67], v[42:43] op_sel_hi:[1,0]
    v_pk_mul_f32 v[68:69], v[68:69], v[42:43] op_sel_hi:[1,0]
    v_pk_mul_f32 v[70:71], v[70:71], v[42:43] op_sel_hi:[1,0]
    v_cvt_pk_bf16_f32 v96, v64, v65
    v_cvt_pk_bf16_f32 v97, v66, v67
    v_cvt_pk_bf16_f32 v98, v68, v69
    v_cvt_pk_bf16_f32 v99, v70, v71
    s_waitcnt vmcnt(23)
    v_lshlrev_b32 v152, 16, v208
    v_and_b32 v153, 0xffff0000, v208
    v_lshlrev_b32 v154, 16, v209
    v_and_b32 v155, 0xffff0000, v209
    v_lshlrev_b32 v156, 16, v210
    v_and_b32 v157, 0xffff0000, v210
    v_lshlrev_b32 v158, 16, v211
    v_and_b32 v159, 0xffff0000, v211
    v_pk_mul_f32 v[152:153], v[152:153], s[42:43]
    v_pk_mul_f32 v[154:155], v[154:155], s[42:43]
    v_pk_mul_f32 v[156:157], v[156:157], s[42:43]
    v_pk_mul_f32 v[158:159], v[158:159], s[42:43]
    v_cvt_pk_bf16_f32 v208, v152, v153
    v_cvt_pk_bf16_f32 v209, v154, v155
    v_cvt_pk_bf16_f32 v210, v156, v157
    v_cvt_pk_bf16_f32 v211, v158, v159
    v_accvgpr_read_b32 v72, a72
    v_accvgpr_read_b32 v73, a73
    v_accvgpr_read_b32 v74, a74
    v_accvgpr_read_b32 v75, a75
    v_accvgpr_read_b32 v76, a76
    v_accvgpr_read_b32 v77, a77
    v_accvgpr_read_b32 v78, a78
    v_accvgpr_read_b32 v79, a79
    ds_write2_b64 v28, v[96:97], v[98:99] offset0:16 offset1:20
    buffer_store_dwordx4 v[104:107], v31, s[24:27], 0 offen offset:256
    v_pk_mul_f32 v[72:73], v[72:73], v[42:43] op_sel_hi:[1,0]
    v_pk_mul_f32 v[74:75], v[74:75], v[42:43] op_sel_hi:[1,0]
    v_pk_mul_f32 v[76:77], v[76:77], v[42:43] op_sel_hi:[1,0]
    v_pk_mul_f32 v[78:79], v[78:79], v[42:43] op_sel_hi:[1,0]
    v_cvt_pk_bf16_f32 v100, v72, v73
    v_cvt_pk_bf16_f32 v101, v74, v75
    v_cvt_pk_bf16_f32 v102, v76, v77
    v_cvt_pk_bf16_f32 v103, v78, v79
    s_waitcnt vmcnt(22)
    v_lshlrev_b32 v152, 16, v212
    v_and_b32 v153, 0xffff0000, v212
    v_lshlrev_b32 v154, 16, v213
    v_and_b32 v155, 0xffff0000, v213
    v_lshlrev_b32 v156, 16, v214
    v_and_b32 v157, 0xffff0000, v214
    v_lshlrev_b32 v158, 16, v215
    v_and_b32 v159, 0xffff0000, v215
    v_pk_mul_f32 v[152:153], v[152:153], s[42:43]
    v_pk_mul_f32 v[154:155], v[154:155], s[42:43]
    v_pk_mul_f32 v[156:157], v[156:157], s[42:43]
    v_pk_mul_f32 v[158:159], v[158:159], s[42:43]
    v_cvt_pk_bf16_f32 v212, v152, v153
    v_cvt_pk_bf16_f32 v213, v154, v155
    v_cvt_pk_bf16_f32 v214, v156, v157
    v_cvt_pk_bf16_f32 v215, v158, v159
    v_accvgpr_read_b32 v80, a80
    v_accvgpr_read_b32 v81, a81
    v_accvgpr_read_b32 v82, a82
    v_accvgpr_read_b32 v83, a83
    v_accvgpr_read_b32 v84, a84
    v_accvgpr_read_b32 v85, a85
    v_accvgpr_read_b32 v86, a86
    v_accvgpr_read_b32 v87, a87
    ds_write2_b64 v28, v[100:101], v[102:103] offset0:24 offset1:28
    buffer_store_dwordx4 v[108:111], v31, s[24:27], 0 offen offset:3328
    v_pk_mul_f32 v[80:81], v[80:81], v[42:43] op_sel_hi:[1,0]
    v_pk_mul_f32 v[82:83], v[82:83], v[42:43] op_sel_hi:[1,0]
    v_pk_mul_f32 v[84:85], v[84:85], v[42:43] op_sel_hi:[1,0]
    v_pk_mul_f32 v[86:87], v[86:87], v[42:43] op_sel_hi:[1,0]
    v_cvt_pk_bf16_f32 v96, v80, v81
    v_cvt_pk_bf16_f32 v97, v82, v83
    v_cvt_pk_bf16_f32 v98, v84, v85
    v_cvt_pk_bf16_f32 v99, v86, v87
    s_waitcnt vmcnt(20)
    v_lshlrev_b32 v152, 16, v216
    v_and_b32 v153, 0xffff0000, v216
    v_lshlrev_b32 v154, 16, v217
    v_and_b32 v155, 0xffff0000, v217
    v_lshlrev_b32 v156, 16, v218
    v_and_b32 v157, 0xffff0000, v218
    v_lshlrev_b32 v158, 16, v219
    v_and_b32 v159, 0xffff0000, v219
    v_pk_mul_f32 v[152:153], v[152:153], s[42:43]
    v_pk_mul_f32 v[154:155], v[154:155], s[42:43]
    v_pk_mul_f32 v[156:157], v[156:157], s[42:43]
    v_pk_mul_f32 v[158:159], v[158:159], s[42:43]
    v_cvt_pk_bf16_f32 v216, v152, v153
    v_cvt_pk_bf16_f32 v217, v154, v155
    v_cvt_pk_bf16_f32 v218, v156, v157
    v_cvt_pk_bf16_f32 v219, v158, v159
    v_accvgpr_read_b32 v88, a88
    v_accvgpr_read_b32 v89, a89
    v_accvgpr_read_b32 v90, a90
    v_accvgpr_read_b32 v91, a91
    v_accvgpr_read_b32 v92, a92
    v_accvgpr_read_b32 v93, a93
    v_accvgpr_read_b32 v94, a94
    v_accvgpr_read_b32 v95, a95
    ds_write2_b64 v28, v[96:97], v[98:99] offset0:32 offset1:36
    buffer_store_dwordx4 v[112:115], v31, s[24:27], 0 offen
    v_pk_mul_f32 v[88:89], v[88:89], v[42:43] op_sel_hi:[1,0]
    v_pk_mul_f32 v[90:91], v[90:91], v[42:43] op_sel_hi:[1,0]
    v_pk_mul_f32 v[92:93], v[92:93], v[42:43] op_sel_hi:[1,0]
    v_pk_mul_f32 v[94:95], v[94:95], v[42:43] op_sel_hi:[1,0]
    v_cvt_pk_bf16_f32 v100, v88, v89
    v_cvt_pk_bf16_f32 v101, v90, v91
    v_cvt_pk_bf16_f32 v102, v92, v93
    v_cvt_pk_bf16_f32 v103, v94, v95
    s_waitcnt vmcnt(19)
    v_lshlrev_b32 v152, 16, v220
    v_and_b32 v153, 0xffff0000, v220
    v_lshlrev_b32 v154, 16, v221
    v_and_b32 v155, 0xffff0000, v221
    v_lshlrev_b32 v156, 16, v222
    v_and_b32 v157, 0xffff0000, v222
    v_lshlrev_b32 v158, 16, v223
    v_and_b32 v159, 0xffff0000, v223
    v_pk_mul_f32 v[152:153], v[152:153], s[42:43]
    v_pk_mul_f32 v[154:155], v[154:155], s[42:43]
    v_pk_mul_f32 v[156:157], v[156:157], s[42:43]
    v_pk_mul_f32 v[158:159], v[158:159], s[42:43]
    v_cvt_pk_bf16_f32 v220, v152, v153
    v_cvt_pk_bf16_f32 v221, v154, v155
    v_cvt_pk_bf16_f32 v222, v156, v157
    v_cvt_pk_bf16_f32 v223, v158, v159
    v_accvgpr_read_b32 v64, a96
    v_accvgpr_read_b32 v65, a97
    v_accvgpr_read_b32 v66, a98
    v_accvgpr_read_b32 v67, a99
    v_accvgpr_read_b32 v68, a100
    v_accvgpr_read_b32 v69, a101
    v_accvgpr_read_b32 v70, a102
    v_accvgpr_read_b32 v71, a103
    ds_write2_b64 v28, v[100:101], v[102:103] offset0:40 offset1:44
    v_add_u32 v28, 6400, v28
    buffer_store_dwordx4 v[116:119], v31, s[24:27], 0 offen offset:3072
    v_pk_mul_f32 v[64:65], v[64:65], v[44:45] op_sel_hi:[1,0]
    v_pk_mul_f32 v[66:67], v[66:67], v[44:45] op_sel_hi:[1,0]
    v_pk_mul_f32 v[68:69], v[68:69], v[44:45] op_sel_hi:[1,0]
    v_pk_mul_f32 v[70:71], v[70:71], v[44:45] op_sel_hi:[1,0]
    v_cvt_pk_bf16_f32 v96, v64, v65
    v_cvt_pk_bf16_f32 v97, v66, v67
    v_cvt_pk_bf16_f32 v98, v68, v69
    v_cvt_pk_bf16_f32 v99, v70, v71
    s_waitcnt vmcnt(17)
    v_lshlrev_b32 v152, 16, v224
    v_and_b32 v153, 0xffff0000, v224
    v_lshlrev_b32 v154, 16, v225
    v_and_b32 v155, 0xffff0000, v225
    v_lshlrev_b32 v156, 16, v226
    v_and_b32 v157, 0xffff0000, v226
    v_lshlrev_b32 v158, 16, v227
    v_and_b32 v159, 0xffff0000, v227
    v_pk_mul_f32 v[152:153], v[152:153], s[42:43]
    v_pk_mul_f32 v[154:155], v[154:155], s[42:43]
    v_pk_mul_f32 v[156:157], v[156:157], s[42:43]
    v_pk_mul_f32 v[158:159], v[158:159], s[42:43]
    v_cvt_pk_bf16_f32 v224, v152, v153
    v_cvt_pk_bf16_f32 v225, v154, v155
    v_cvt_pk_bf16_f32 v226, v156, v157
    v_cvt_pk_bf16_f32 v227, v158, v159
    v_accvgpr_read_b32 v72, a104
    v_accvgpr_read_b32 v73, a105
    v_accvgpr_read_b32 v74, a106
    v_accvgpr_read_b32 v75, a107
    v_accvgpr_read_b32 v76, a108
    v_accvgpr_read_b32 v77, a109
    v_accvgpr_read_b32 v78, a110
    v_accvgpr_read_b32 v79, a111
    ds_write2_b64 v28, v[96:97], v[98:99] offset0:0 offset1:4
    buffer_store_dwordx4 v[120:123], v31, s[24:27], 0 offen offset:128
    v_pk_mul_f32 v[72:73], v[72:73], v[44:45] op_sel_hi:[1,0]
    v_pk_mul_f32 v[74:75], v[74:75], v[44:45] op_sel_hi:[1,0]
    v_pk_mul_f32 v[76:77], v[76:77], v[44:45] op_sel_hi:[1,0]
    v_pk_mul_f32 v[78:79], v[78:79], v[44:45] op_sel_hi:[1,0]
    v_cvt_pk_bf16_f32 v100, v72, v73
    v_cvt_pk_bf16_f32 v101, v74, v75
    v_cvt_pk_bf16_f32 v102, v76, v77
    v_cvt_pk_bf16_f32 v103, v78, v79
    s_waitcnt vmcnt(17)
    v_lshlrev_b32 v152, 16, v228
    v_and_b32 v153, 0xffff0000, v228
    v_lshlrev_b32 v154, 16, v229
    v_and_b32 v155, 0xffff0000, v229
    v_lshlrev_b32 v156, 16, v230
    v_and_b32 v157, 0xffff0000, v230
    v_lshlrev_b32 v158, 16, v231
    v_and_b32 v159, 0xffff0000, v231
    v_pk_mul_f32 v[152:153], v[152:153], s[42:43]
    v_pk_mul_f32 v[154:155], v[154:155], s[42:43]
    v_pk_mul_f32 v[156:157], v[156:157], s[42:43]
    v_pk_mul_f32 v[158:159], v[158:159], s[42:43]
    v_cvt_pk_bf16_f32 v228, v152, v153
    v_cvt_pk_bf16_f32 v229, v154, v155
    v_cvt_pk_bf16_f32 v230, v156, v157
    v_cvt_pk_bf16_f32 v231, v158, v159
    v_accvgpr_read_b32 v80, a112
    v_accvgpr_read_b32 v81, a113
    v_accvgpr_read_b32 v82, a114
    v_accvgpr_read_b32 v83, a115
    v_accvgpr_read_b32 v84, a116
    v_accvgpr_read_b32 v85, a117
    v_accvgpr_read_b32 v86, a118
    v_accvgpr_read_b32 v87, a119
    ds_write2_b64 v28, v[100:101], v[102:103] offset0:8 offset1:12
    buffer_store_dwordx4 v[124:127], v31, s[24:27], 0 offen offset:3200
    v_pk_mul_f32 v[80:81], v[80:81], v[44:45] op_sel_hi:[1,0]
    v_pk_mul_f32 v[82:83], v[82:83], v[44:45] op_sel_hi:[1,0]
    v_pk_mul_f32 v[84:85], v[84:85], v[44:45] op_sel_hi:[1,0]
    v_pk_mul_f32 v[86:87], v[86:87], v[44:45] op_sel_hi:[1,0]
    v_cvt_pk_bf16_f32 v96, v80, v81
    v_cvt_pk_bf16_f32 v97, v82, v83
    v_cvt_pk_bf16_f32 v98, v84, v85
    v_cvt_pk_bf16_f32 v99, v86, v87
    s_waitcnt vmcnt(11)
    v_lshlrev_b32 v152, 16, v232
    v_and_b32 v153, 0xffff0000, v232
    v_lshlrev_b32 v154, 16, v233
    v_and_b32 v155, 0xffff0000, v233
    v_lshlrev_b32 v156, 16, v234
    v_and_b32 v157, 0xffff0000, v234
    v_lshlrev_b32 v158, 16, v235
    v_and_b32 v159, 0xffff0000, v235
    v_pk_mul_f32 v[152:153], v[152:153], s[42:43]
    v_pk_mul_f32 v[154:155], v[154:155], s[42:43]
    v_pk_mul_f32 v[156:157], v[156:157], s[42:43]
    v_pk_mul_f32 v[158:159], v[158:159], s[42:43]
    v_cvt_pk_bf16_f32 v232, v152, v153
    v_cvt_pk_bf16_f32 v233, v154, v155
    v_cvt_pk_bf16_f32 v234, v156, v157
    v_cvt_pk_bf16_f32 v235, v158, v159
    v_accvgpr_read_b32 v88, a120
    v_accvgpr_read_b32 v89, a121
    v_accvgpr_read_b32 v90, a122
    v_accvgpr_read_b32 v91, a123
    v_accvgpr_read_b32 v92, a124
    v_accvgpr_read_b32 v93, a125
    v_accvgpr_read_b32 v94, a126
    v_accvgpr_read_b32 v95, a127
    ds_write2_b64 v28, v[96:97], v[98:99] offset0:16 offset1:20
    v_pk_mul_f32 v[88:89], v[88:89], v[44:45] op_sel_hi:[1,0]
    v_pk_mul_f32 v[90:91], v[90:91], v[44:45] op_sel_hi:[1,0]
    v_pk_mul_f32 v[92:93], v[92:93], v[44:45] op_sel_hi:[1,0]
    v_pk_mul_f32 v[94:95], v[94:95], v[44:45] op_sel_hi:[1,0]
    v_cvt_pk_bf16_f32 v100, v88, v89
    v_cvt_pk_bf16_f32 v101, v90, v91
    v_cvt_pk_bf16_f32 v102, v92, v93
    v_cvt_pk_bf16_f32 v103, v94, v95
    s_waitcnt vmcnt(10)
    v_lshlrev_b32 v152, 16, v236
    v_and_b32 v153, 0xffff0000, v236
    v_lshlrev_b32 v154, 16, v237
    v_and_b32 v155, 0xffff0000, v237
    v_lshlrev_b32 v156, 16, v238
    v_and_b32 v157, 0xffff0000, v238
    v_lshlrev_b32 v158, 16, v239
    v_and_b32 v159, 0xffff0000, v239
    v_pk_mul_f32 v[152:153], v[152:153], s[42:43]
    v_pk_mul_f32 v[154:155], v[154:155], s[42:43]
    v_pk_mul_f32 v[156:157], v[156:157], s[42:43]
    v_pk_mul_f32 v[158:159], v[158:159], s[42:43]
    v_cvt_pk_bf16_f32 v236, v152, v153
    v_cvt_pk_bf16_f32 v237, v154, v155
    v_cvt_pk_bf16_f32 v238, v156, v157
    v_cvt_pk_bf16_f32 v239, v158, v159
    v_accvgpr_read_b32 v64, a128
    v_accvgpr_read_b32 v65, a129
    v_accvgpr_read_b32 v66, a130
    v_accvgpr_read_b32 v67, a131
    v_accvgpr_read_b32 v68, a132
    v_accvgpr_read_b32 v69, a133
    v_accvgpr_read_b32 v70, a134
    v_accvgpr_read_b32 v71, a135
    ds_write2_b64 v28, v[100:101], v[102:103] offset0:24 offset1:28
    v_pk_mul_f32 v[64:65], v[64:65], v[44:45] op_sel_hi:[1,0]
    v_pk_mul_f32 v[66:67], v[66:67], v[44:45] op_sel_hi:[1,0]
    v_pk_mul_f32 v[68:69], v[68:69], v[44:45] op_sel_hi:[1,0]
    v_pk_mul_f32 v[70:71], v[70:71], v[44:45] op_sel_hi:[1,0]
    v_cvt_pk_bf16_f32 v96, v64, v65
    v_cvt_pk_bf16_f32 v97, v66, v67
    v_cvt_pk_bf16_f32 v98, v68, v69
    v_cvt_pk_bf16_f32 v99, v70, v71
    s_waitcnt vmcnt(9)
    v_lshlrev_b32 v152, 16, v240
    v_and_b32 v153, 0xffff0000, v240
    v_lshlrev_b32 v154, 16, v241
    v_and_b32 v155, 0xffff0000, v241
    v_lshlrev_b32 v156, 16, v242
    v_and_b32 v157, 0xffff0000, v242
    v_lshlrev_b32 v158, 16, v243
    v_and_b32 v159, 0xffff0000, v243
    v_pk_mul_f32 v[152:153], v[152:153], s[42:43]
    v_pk_mul_f32 v[154:155], v[154:155], s[42:43]
    v_pk_mul_f32 v[156:157], v[156:157], s[42:43]
    v_pk_mul_f32 v[158:159], v[158:159], s[42:43]
    v_cvt_pk_bf16_f32 v240, v152, v153
    v_cvt_pk_bf16_f32 v241, v154, v155
    v_cvt_pk_bf16_f32 v242, v156, v157
    v_cvt_pk_bf16_f32 v243, v158, v159
    v_accvgpr_read_b32 v72, a136
    v_accvgpr_read_b32 v73, a137
    v_accvgpr_read_b32 v74, a138
    v_accvgpr_read_b32 v75, a139
    v_accvgpr_read_b32 v76, a140
    v_accvgpr_read_b32 v77, a141
    v_accvgpr_read_b32 v78, a142
    v_accvgpr_read_b32 v79, a143
    ds_write2_b64 v28, v[96:97], v[98:99] offset0:32 offset1:36
    v_pk_mul_f32 v[72:73], v[72:73], v[44:45] op_sel_hi:[1,0]
    v_pk_mul_f32 v[74:75], v[74:75], v[44:45] op_sel_hi:[1,0]
    v_pk_mul_f32 v[76:77], v[76:77], v[44:45] op_sel_hi:[1,0]
    v_pk_mul_f32 v[78:79], v[78:79], v[44:45] op_sel_hi:[1,0]
    v_cvt_pk_bf16_f32 v100, v72, v73
    v_cvt_pk_bf16_f32 v101, v74, v75
    v_cvt_pk_bf16_f32 v102, v76, v77
    v_cvt_pk_bf16_f32 v103, v78, v79
    s_waitcnt vmcnt(8)
    v_lshlrev_b32 v152, 16, v244
    v_and_b32 v153, 0xffff0000, v244
    v_lshlrev_b32 v154, 16, v245
    v_and_b32 v155, 0xffff0000, v245
    v_lshlrev_b32 v156, 16, v246
    v_and_b32 v157, 0xffff0000, v246
    v_lshlrev_b32 v158, 16, v247
    v_and_b32 v159, 0xffff0000, v247
    v_pk_mul_f32 v[152:153], v[152:153], s[42:43]
    v_pk_mul_f32 v[154:155], v[154:155], s[42:43]
    v_pk_mul_f32 v[156:157], v[156:157], s[42:43]
    v_pk_mul_f32 v[158:159], v[158:159], s[42:43]
    v_cvt_pk_bf16_f32 v244, v152, v153
    v_cvt_pk_bf16_f32 v245, v154, v155
    v_cvt_pk_bf16_f32 v246, v156, v157
    v_cvt_pk_bf16_f32 v247, v158, v159
    v_min_f32 v33, v60, v38
    v_sub_f32 v32, v33, v60
    v_sub_f32 v34, v33, v38
    v_exp_f32 v32, v32
    v_exp_f32 v34, v34
    v_accvgpr_read_b32 v80, a144
    v_accvgpr_read_b32 v81, a145
    v_accvgpr_read_b32 v82, a146
    v_accvgpr_read_b32 v83, a147
    v_accvgpr_read_b32 v84, a148
    v_accvgpr_read_b32 v85, a149
    v_accvgpr_read_b32 v86, a150
    v_accvgpr_read_b32 v87, a151
    v_mul_f32 v35, v15, v32
    v_fma_f32 v35, v39, v34, v35
    v_rcp_f32 v35, v35
    ds_write2_b64 v28, v[100:101], v[102:103] offset0:40 offset1:44
    v_mul_f32 v32, v32, v35
    v_mul_f32 v34, v34, v35
    v_pk_mul_f32 v[80:81], v[80:81], v[32:33] op_sel_hi:[1,0]
    v_pk_mul_f32 v[82:83], v[82:83], v[32:33] op_sel_hi:[1,0]
    v_pk_mul_f32 v[84:85], v[84:85], v[32:33] op_sel_hi:[1,0]
    v_pk_mul_f32 v[86:87], v[86:87], v[32:33] op_sel_hi:[1,0]
    v_pk_fma_f32 v[80:81], v[128:129], v[34:35], v[80:81] op_sel_hi:[1,0,1]
    v_pk_fma_f32 v[82:83], v[130:131], v[34:35], v[82:83] op_sel_hi:[1,0,1]
    v_pk_fma_f32 v[84:85], v[132:133], v[34:35], v[84:85] op_sel_hi:[1,0,1]
    v_pk_fma_f32 v[86:87], v[134:135], v[34:35], v[86:87] op_sel_hi:[1,0,1]
    v_cvt_pk_bf16_f32 v96, v80, v81
    v_cvt_pk_bf16_f32 v97, v82, v83
    v_cvt_pk_bf16_f32 v98, v84, v85
    v_cvt_pk_bf16_f32 v99, v86, v87
    s_waitcnt vmcnt(7)
    v_lshlrev_b32 v152, 16, v248
    v_and_b32 v153, 0xffff0000, v248
    v_lshlrev_b32 v154, 16, v249
    v_and_b32 v155, 0xffff0000, v249
    v_lshlrev_b32 v156, 16, v250
    v_and_b32 v157, 0xffff0000, v250
    v_lshlrev_b32 v158, 16, v251
    v_and_b32 v159, 0xffff0000, v251
    v_pk_mul_f32 v[152:153], v[152:153], s[42:43]
    v_pk_mul_f32 v[154:155], v[154:155], s[42:43]
    v_pk_mul_f32 v[156:157], v[156:157], s[42:43]
    v_pk_mul_f32 v[158:159], v[158:159], s[42:43]
    v_cvt_pk_bf16_f32 v248, v152, v153
    v_cvt_pk_bf16_f32 v249, v154, v155
    v_cvt_pk_bf16_f32 v250, v156, v157
    v_cvt_pk_bf16_f32 v251, v158, v159
    v_accvgpr_read_b32 v88, a152
    v_accvgpr_read_b32 v89, a153
    v_accvgpr_read_b32 v90, a154
    v_accvgpr_read_b32 v91, a155
    v_accvgpr_read_b32 v92, a156
    v_accvgpr_read_b32 v93, a157
    v_accvgpr_read_b32 v94, a158
    v_accvgpr_read_b32 v95, a159
    v_permlane16_swap_b32 v96, v98
    v_permlane16_swap_b32 v97, v99
    buffer_store_dwordx4 v[96:99], v29, s[24:27], 0 offen
    v_pk_mul_f32 v[88:89], v[88:89], v[32:33] op_sel_hi:[1,0]
    v_pk_mul_f32 v[90:91], v[90:91], v[32:33] op_sel_hi:[1,0]
    v_pk_mul_f32 v[92:93], v[92:93], v[32:33] op_sel_hi:[1,0]
    v_pk_mul_f32 v[94:95], v[94:95], v[32:33] op_sel_hi:[1,0]
    v_pk_fma_f32 v[88:89], v[136:137], v[34:35], v[88:89] op_sel_hi:[1,0,1]
    v_pk_fma_f32 v[90:91], v[138:139], v[34:35], v[90:91] op_sel_hi:[1,0,1]
    v_pk_fma_f32 v[92:93], v[140:141], v[34:35], v[92:93] op_sel_hi:[1,0,1]
    v_pk_fma_f32 v[94:95], v[142:143], v[34:35], v[94:95] op_sel_hi:[1,0,1]
    v_cvt_pk_bf16_f32 v100, v88, v89
    v_cvt_pk_bf16_f32 v101, v90, v91
    v_cvt_pk_bf16_f32 v102, v92, v93
    v_cvt_pk_bf16_f32 v103, v94, v95
    s_waitcnt vmcnt(7)
    v_lshlrev_b32 v152, 16, v252
    v_and_b32 v153, 0xffff0000, v252
    v_lshlrev_b32 v154, 16, v253
    v_and_b32 v155, 0xffff0000, v253
    v_lshlrev_b32 v156, 16, v254
    v_and_b32 v157, 0xffff0000, v254
    v_lshlrev_b32 v158, 16, v255
    v_and_b32 v159, 0xffff0000, v255
    v_pk_mul_f32 v[152:153], v[152:153], s[42:43]
    v_pk_mul_f32 v[154:155], v[154:155], s[42:43]
    v_pk_mul_f32 v[156:157], v[156:157], s[42:43]
    v_pk_mul_f32 v[158:159], v[158:159], s[42:43]
    v_cvt_pk_bf16_f32 v252, v152, v153
    v_cvt_pk_bf16_f32 v253, v154, v155
    v_cvt_pk_bf16_f32 v254, v156, v157
    v_cvt_pk_bf16_f32 v255, v158, v159
    v_accvgpr_read_b32 v64, a160
    v_accvgpr_read_b32 v65, a161
    v_accvgpr_read_b32 v66, a162
    v_accvgpr_read_b32 v67, a163
    v_accvgpr_read_b32 v68, a164
    v_accvgpr_read_b32 v69, a165
    v_accvgpr_read_b32 v70, a166
    v_accvgpr_read_b32 v71, a167
    v_permlane16_swap_b32 v100, v102
    v_permlane16_swap_b32 v101, v103
    buffer_store_dwordx4 v[100:103], v29, s[24:27], 0 offen offset:64
    v_pk_mul_f32 v[64:65], v[64:65], v[32:33] op_sel_hi:[1,0]
    v_pk_mul_f32 v[66:67], v[66:67], v[32:33] op_sel_hi:[1,0]
    v_pk_mul_f32 v[68:69], v[68:69], v[32:33] op_sel_hi:[1,0]
    v_pk_mul_f32 v[70:71], v[70:71], v[32:33] op_sel_hi:[1,0]
    v_pk_fma_f32 v[64:65], v[144:145], v[34:35], v[64:65] op_sel_hi:[1,0,1]
    v_pk_fma_f32 v[66:67], v[146:147], v[34:35], v[66:67] op_sel_hi:[1,0,1]
    v_pk_fma_f32 v[68:69], v[148:149], v[34:35], v[68:69] op_sel_hi:[1,0,1]
    v_pk_fma_f32 v[70:71], v[150:151], v[34:35], v[70:71] op_sel_hi:[1,0,1]
    v_cvt_pk_bf16_f32 v96, v64, v65
    v_cvt_pk_bf16_f32 v97, v66, v67
    v_cvt_pk_bf16_f32 v98, v68, v69
    v_cvt_pk_bf16_f32 v99, v70, v71
    s_nop 0
    v_permlane16_swap_b32 v96, v98
    v_permlane16_swap_b32 v97, v99
    buffer_store_dwordx4 v[96:99], v29, s[24:27], 0 offen offset:128
    s_mov_b32 s80, s24
    s_mov_b32 s81, s25
    s_mov_b32 s82, 0
    s_add_u32 s84, s37, 6144
    s_add_u32 s48, s90, 256
    v_lshrrev_b32 v47, 3, v1
    v_lshlrev_b32 v47, 4, v47
    v_add3_u32 v47, v47, v23, s48
    s_add_u32 s48, s52, 1
    s_mul_i32 s49, s48, 165888
    s_add_u32 s24, s10, s49
    s_addc_u32 s25, s11, 0
    s_mov_b32 s37, s39
    s_mov_b32 s38, s40
    s_mov_b32 s48, 0x7149f2ca
    s_cmp_ge_u32 s38, 165888
    s_cselect_b32 s86, s48, 0xff800000
    v_mfma_f32_16x16x32_bf16 v[64:67], a[192:195], v[160:163], 0
    v_mfma_f32_16x16x32_bf16 v[64:67], a[196:199], v[164:167], v[64:67]
    v_mfma_f32_16x16x32_bf16 v[64:67], a[200:203], v[168:171], v[64:67]
    v_mfma_f32_16x16x32_bf16 v[64:67], a[204:207], v[172:175], v[64:67]
    v_mfma_f32_16x16x32_bf16 v[64:67], a[208:211], v[176:179], v[64:67]
    v_mfma_f32_16x16x32_bf16 v[64:67], a[212:215], v[180:183], v[64:67]
    v_mfma_f32_16x16x32_bf16 v[68:71], a[216:219], v[160:163], 0
    v_mfma_f32_16x16x32_bf16 v[68:71], a[220:223], v[164:167], v[68:71]
    v_mfma_f32_16x16x32_bf16 v[68:71], a[224:227], v[168:171], v[68:71]
    v_mfma_f32_16x16x32_bf16 v[68:71], a[228:231], v[172:175], v[68:71]
    v_mfma_f32_16x16x32_bf16 v[68:71], a[232:235], v[176:179], v[68:71]
    v_mfma_f32_16x16x32_bf16 v[68:71], a[236:239], v[180:183], v[68:71]
    v_mfma_f32_16x16x32_bf16 v[72:75], a[192:195], v[184:187], 0
    v_mfma_f32_16x16x32_bf16 v[72:75], a[196:199], v[188:191], v[72:75]
    v_mfma_f32_16x16x32_bf16 v[72:75], a[200:203], v[192:195], v[72:75]
    v_mfma_f32_16x16x32_bf16 v[72:75], a[204:207], v[196:199], v[72:75]
    v_max3_f32 v32, v64, v65, v66
    s_nop 2
    v_max3_f32 v32, v32, v67, v68
    v_mfma_f32_16x16x32_bf16 v[72:75], a[208:211], v[200:203], v[72:75]
    v_max3_f32 v32, v32, v69, v70
    v_max_f32 v32, v32, v71
    v_mfma_f32_16x16x32_bf16 v[72:75], a[212:215], v[204:207], v[72:75]
    v_mov_b32 v33, v32
    v_mfma_f32_16x16x32_bf16 v[76:79], a[216:219], v[184:187], 0
    v_mfma_f32_16x16x32_bf16 v[76:79], a[220:223], v[188:191], v[76:79]
    v_permlane32_swap_b32 v32, v33
    v_mfma_f32_16x16x32_bf16 v[76:79], a[224:227], v[192:195], v[76:79]
    v_max_f32 v32, v32, v33
    v_mov_b32 v33, v32
    v_mfma_f32_16x16x32_bf16 v[76:79], a[228:231], v[196:199], v[76:79]
    v_mfma_f32_16x16x32_bf16 v[76:79], a[232:235], v[200:203], v[76:79]
    v_permlane16_swap_b32 v32, v33
    v_mfma_f32_16x16x32_bf16 v[76:79], a[236:239], v[204:207], v[76:79]
    v_max_f32 v32, v32, v33
    v_sub_f32 v64, v64, v32
    v_mfma_f32_16x16x32_bf16 v[80:83], a[192:195], v[208:211], 0
    v_sub_f32 v65, v65, v32
    v_sub_f32 v66, v66, v32
    v_mfma_f32_16x16x32_bf16 v[80:83], a[196:199], v[212:215], v[80:83]
    v_sub_f32 v67, v67, v32
    v_sub_f32 v68, v68, v32
    v_mfma_f32_16x16x32_bf16 v[80:83], a[200:203], v[216:219], v[80:83]
    v_sub_f32 v69, v69, v32
    v_sub_f32 v70, v70, v32
    v_mfma_f32_16x16x32_bf16 v[80:83], a[204:207], v[220:223], v[80:83]
    v_sub_f32 v71, v71, v32
    v_max3_f32 v34, v72, v73, v74
    v_mfma_f32_16x16x32_bf16 v[80:83], a[208:211], v[224:227], v[80:83]
    v_exp_f32 v64, v64
    v_mfma_f32_16x16x32_bf16 v[80:83], a[212:215], v[228:231], v[80:83]
    v_exp_f32 v65, v65
    v_mfma_f32_16x16x32_bf16 v[84:87], a[216:219], v[208:211], 0
    v_exp_f32 v66, v66
    v_mfma_f32_16x16x32_bf16 v[84:87], a[220:223], v[212:215], v[84:87]
    v_exp_f32 v67, v67
    v_mfma_f32_16x16x32_bf16 v[84:87], a[224:227], v[216:219], v[84:87]
    v_max3_f32 v34, v34, v75, v76
    v_max3_f32 v34, v34, v77, v78
    v_mfma_f32_16x16x32_bf16 v[84:87], a[228:231], v[220:223], v[84:87]
    v_max_f32 v34, v34, v79
    v_mov_b32 v35, v34
    v_mfma_f32_16x16x32_bf16 v[84:87], a[232:235], v[224:227], v[84:87]
    v_sub_f32 v48, 0, v32
    v_sub_f32 v49, 0, v32
    v_mfma_f32_16x16x32_bf16 v[84:87], a[236:239], v[228:231], v[84:87]
    v_permlane32_swap_b32 v34, v35
    v_mfma_f32_16x16x32_bf16 v[88:91], a[192:195], v[232:235], 0
    ds_read_b128 a[192:195], v2 offset:12288
    v_max_f32 v34, v34, v35
    v_mfma_f32_16x16x32_bf16 v[88:91], a[196:199], v[236:239], v[88:91]
    ds_read_b128 a[196:199], v3 offset:12288
    v_mov_b32 v35, v34
    v_mfma_f32_16x16x32_bf16 v[88:91], a[200:203], v[240:243], v[88:91]
    ds_read_b128 a[200:203], v2 offset:13312
    v_sub_f32 v50, 0, v32
    v_mfma_f32_16x16x32_bf16 v[88:91], a[204:207], v[244:247], v[88:91]
    ds_read_b128 a[204:207], v3 offset:13312
    v_sub_f32 v51, 0, v32
    v_mfma_f32_16x16x32_bf16 v[88:91], a[208:211], v[248:251], v[88:91]
    ds_read_b128 a[208:211], v2 offset:14336
    v_cvt_pk_bf16_f32 v96, v64, v65
    v_mfma_f32_16x16x32_bf16 v[88:91], a[212:215], v[252:255], v[88:91]
    ds_read_b128 a[212:215], v3 offset:14336
    v_cvt_pk_bf16_f32 v97, v66, v67
    v_mfma_f32_16x16x32_bf16 v[92:95], a[216:219], v[232:235], 0
    ds_read_b128 a[216:219], v2 offset:18432
    v_add_f32 v16, v64, v65
    v_mfma_f32_16x16x32_bf16 v[92:95], a[220:223], v[236:239], v[92:95]
    ds_read_b128 a[220:223], v3 offset:18432
    v_add_f32 v16, v16, v66
    v_mfma_f32_16x16x32_bf16 v[92:95], a[224:227], v[240:243], v[92:95]
    ds_read_b128 a[224:227], v2 offset:19456
    v_add_f32 v16, v16, v67
    v_mfma_f32_16x16x32_bf16 v[92:95], a[228:231], v[244:247], v[92:95]
    ds_read_b128 a[228:231], v3 offset:19456
    v_permlane16_swap_b32 v34, v35
    v_max_f32 v34, v34, v35
    v_mfma_f32_16x16x32_bf16 v[92:95], a[232:235], v[248:251], v[92:95]
    ds_read_b128 a[232:235], v2 offset:20480
    v_sub_f32 v72, v72, v34
    v_mfma_f32_16x16x32_bf16 v[92:95], a[236:239], v[252:255], v[92:95]
    s_waitcnt lgkmcnt(6)
    ds_read_b128 a[236:239], v3 offset:20480
    v_sub_f32 v73, v73, v34
    v_sub_f32 v74, v74, v34
    v_sub_f32 v75, v75, v34
    v_sub_f32 v76, v76, v34
    v_sub_f32 v77, v77, v34
    v_sub_f32 v78, v78, v34
    v_sub_f32 v79, v79, v34
    v_mfma_f32_16x16x32_bf16 v[64:67], a[192:195], v[160:163], v[48:51]
    v_exp_f32 v72, v72
    v_mfma_f32_16x16x32_bf16 v[64:67], a[196:199], v[164:167], v[64:67]
    v_exp_f32 v73, v73
    v_mfma_f32_16x16x32_bf16 v[64:67], a[200:203], v[168:171], v[64:67]
    v_exp_f32 v74, v74
    v_exp_f32 v75, v75
    v_mfma_f32_16x16x32_bf16 v[64:67], a[204:207], v[172:175], v[64:67]
    v_max3_f32 v36, v80, v81, v82
    v_max3_f32 v36, v36, v83, v84
    v_max3_f32 v36, v36, v85, v86
    v_max_f32 v36, v36, v87
    v_mov_b32 v37, v36
    s_nop 1
    v_permlane32_swap_b32 v36, v37
    v_max_f32 v36, v36, v37
    v_mov_b32 v37, v36
    s_nop 1
    v_permlane16_swap_b32 v36, v37
    v_max_f32 v36, v36, v37
    v_mfma_f32_16x16x32_bf16 v[64:67], a[208:211], v[176:179], v[64:67]
    s_waitcnt lgkmcnt(2)
    v_sub_f32 v52, 0, v34
    v_sub_f32 v53, 0, v34
    v_sub_f32 v54, 0, v34
    v_sub_f32 v55, 0, v34
    v_mfma_f32_16x16x32_bf16 v[64:67], a[212:215], v[180:183], v[64:67]
    v_cvt_pk_bf16_f32 v100, v72, v73
    v_cvt_pk_bf16_f32 v101, v74, v75
    v_add_f32 v17, v72, v73
    v_add_f32 v17, v17, v74
    v_add_f32 v17, v17, v75
    v_sub_f32 v80, v80, v36
    v_sub_f32 v81, v81, v36
    v_sub_f32 v82, v82, v36
    v_sub_f32 v83, v83, v36
    v_sub_f32 v84, v84, v36
    v_sub_f32 v85, v85, v36
    v_sub_f32 v86, v86, v36
    v_sub_f32 v87, v87, v36
    v_mfma_f32_16x16x32_bf16 v[72:75], a[192:195], v[184:187], v[52:55]
    v_exp_f32 v80, v80
    v_mfma_f32_16x16x32_bf16 v[72:75], a[196:199], v[188:191], v[72:75]
    v_exp_f32 v81, v81
    v_mfma_f32_16x16x32_bf16 v[72:75], a[200:203], v[192:195], v[72:75]
    v_exp_f32 v82, v82
    v_exp_f32 v83, v83
    v_mfma_f32_16x16x32_bf16 v[72:75], a[204:207], v[196:199], v[72:75]
    v_sub_f32 v56, 0, v36
    v_sub_f32 v57, 0, v36
    v_mfma_f32_16x16x32_bf16 v[72:75], a[208:211], v[200:203], v[72:75]
    v_sub_f32 v58, 0, v36
    v_sub_f32 v59, 0, v36
    v_mfma_f32_16x16x32_bf16 v[72:75], a[212:215], v[204:207], v[72:75]
    v_cvt_pk_bf16_f32 v104, v80, v81
    v_cvt_pk_bf16_f32 v105, v82, v83
    v_add_f32 v18, v80, v81
    v_add_f32 v18, v18, v82
    v_add_f32 v18, v18, v83
    v_mfma_f32_16x16x32_bf16 v[80:83], a[192:195], v[208:211], v[56:59]
    ds_read_b128 a[192:195], v2 offset:24576
    v_max3_f32 v38, v88, v89, v90
    v_mfma_f32_16x16x32_bf16 v[80:83], a[196:199], v[212:215], v[80:83]
    ds_read_b128 a[196:199], v3 offset:24576
    v_max3_f32 v38, v38, v91, v92
    v_mfma_f32_16x16x32_bf16 v[80:83], a[200:203], v[216:219], v[80:83]
    ds_read_b128 a[200:203], v2 offset:25600
    v_exp_f32 v68, v68
    v_exp_f32 v69, v69
    v_exp_f32 v70, v70
    v_exp_f32 v71, v71
    v_mfma_f32_16x16x32_bf16 v[80:83], a[204:207], v[220:223], v[80:83]
    ds_read_b128 a[204:207], v3 offset:25600
    v_cvt_pk_bf16_f32 v98, v68, v69
    v_mfma_f32_16x16x32_bf16 v[80:83], a[208:211], v[224:227], v[80:83]
    ds_read_b128 a[208:211], v2 offset:26624
    v_cvt_pk_bf16_f32 v99, v70, v71
    v_mfma_f32_16x16x32_bf16 v[80:83], a[212:215], v[228:231], v[80:83]
    ds_read_b128 a[212:215], v3 offset:26624
    v_add_f32 v16, v16, v68
    v_add_f32 v16, v16, v69
    v_add_f32 v16, v16, v70
    v_add_f32 v16, v16, v71
    v_mfma_f32_16x16x32_bf16 v[68:71], a[216:219], v[160:163], v[48:51]
    v_exp_f32 v76, v76
    v_mfma_f32_16x16x32_bf16 v[68:71], a[220:223], v[164:167], v[68:71]
    v_exp_f32 v77, v77
    v_mfma_f32_16x16x32_bf16 v[68:71], a[224:227], v[168:171], v[68:71]
    v_exp_f32 v78, v78
    v_exp_f32 v79, v79
    v_mfma_f32_16x16x32_bf16 v[68:71], a[228:231], v[172:175], v[68:71]
    s_waitcnt lgkmcnt(3)
    v_cvt_pk_bf16_f32 v102, v76, v77
    v_cvt_pk_bf16_f32 v103, v78, v79
    v_mfma_f32_16x16x32_bf16 v[68:71], a[232:235], v[176:179], v[68:71]
    v_add_f32 v17, v17, v76
    v_add_f32 v17, v17, v77
    v_mfma_f32_16x16x32_bf16 v[68:71], a[236:239], v[180:183], v[68:71]
    v_add_f32 v17, v17, v78
    v_add_f32 v17, v17, v79
    v_mfma_f32_16x16x32_bf16 v[76:79], a[216:219], v[184:187], v[52:55]
    v_exp_f32 v84, v84
    v_mfma_f32_16x16x32_bf16 v[76:79], a[220:223], v[188:191], v[76:79]
    v_exp_f32 v85, v85
    v_mfma_f32_16x16x32_bf16 v[76:79], a[224:227], v[192:195], v[76:79]
    v_exp_f32 v86, v86
    v_exp_f32 v87, v87
    v_mfma_f32_16x16x32_bf16 v[76:79], a[228:231], v[196:199], v[76:79]
    v_cvt_pk_bf16_f32 v106, v84, v85
    v_cvt_pk_bf16_f32 v107, v86, v87
    v_mfma_f32_16x16x32_bf16 v[76:79], a[232:235], v[200:203], v[76:79]
    v_add_f32 v18, v18, v84
    v_add_f32 v18, v18, v85
    v_mfma_f32_16x16x32_bf16 v[76:79], a[236:239], v[204:207], v[76:79]
    v_add_f32 v18, v18, v86
    v_add_f32 v18, v18, v87
    v_mfma_f32_16x16x32_bf16 v[84:87], a[216:219], v[208:211], v[56:59]
    ds_read_b128 a[216:219], v2 offset:30720
    v_max3_f32 v38, v38, v93, v94
    v_mfma_f32_16x16x32_bf16 v[84:87], a[220:223], v[212:215], v[84:87]
    ds_read_b128 a[220:223], v3 offset:30720
    v_max3_f32 v38, v38, v95, s86
    v_mfma_f32_16x16x32_bf16 v[84:87], a[224:227], v[216:219], v[84:87]
    ds_read_b128 a[224:227], v2 offset:31744
    v_exp_f32 v64, v64
    v_exp_f32 v65, v65
    v_exp_f32 v66, v66
    v_exp_f32 v67, v67
    v_mfma_f32_16x16x32_bf16 v[84:87], a[228:231], v[220:223], v[84:87]
    ds_read_b128 a[228:231], v3 offset:31744
    v_cvt_pk_bf16_f32 v112, v64, v65
    v_mfma_f32_16x16x32_bf16 v[84:87], a[232:235], v[224:227], v[84:87]
    ds_read_b128 a[232:235], v2 offset:32768
    v_cvt_pk_bf16_f32 v113, v66, v67
    v_mfma_f32_16x16x32_bf16 v[84:87], a[236:239], v[228:231], v[84:87]
    ds_read_b128 a[236:239], v3 offset:32768
    v_add_f32 v16, v16, v64
    v_add_f32 v16, v16, v65
    v_add_f32 v16, v16, v66
    v_add_f32 v16, v16, v67
    s_waitcnt lgkmcnt(0)
    s_barrier
    v_mfma_f32_16x16x32_bf16 v[64:67], a[192:195], v[160:163], v[48:51]
    v_exp_f32 v72, v72
    v_mfma_f32_16x16x32_bf16 v[64:67], a[196:199], v[164:167], v[64:67]
    v_exp_f32 v73, v73
    v_mfma_f32_16x16x32_bf16 v[64:67], a[200:203], v[168:171], v[64:67]
    s_add_u32 m0, s33, 12288
    v_exp_f32 v74, v74
    v_exp_f32 v75, v75
    v_mfma_f32_16x16x32_bf16 v[64:67], a[204:207], v[172:175], v[64:67]
    buffer_load_dwordx4 v8, s[16:19], s29 offen nt lds
    v_mfma_f32_16x16x32_bf16 v[64:67], a[208:211], v[176:179], v[64:67]
    ds_read_b64_tr_b16 v[152:153], v4
    v_cvt_pk_bf16_f32 v116, v72, v73
    v_mfma_f32_16x16x32_bf16 v[64:67], a[212:215], v[180:183], v[64:67]
    v_cvt_pk_bf16_f32 v117, v74, v75
    v_add_f32 v17, v17, v72
    v_add_f32 v17, v17, v73
    v_add_f32 v17, v17, v74
    v_add_f32 v17, v17, v75
    v_mfma_f32_16x16x32_bf16 v[72:75], a[192:195], v[184:187], v[52:55]
    v_exp_f32 v80, v80
    v_mfma_f32_16x16x32_bf16 v[72:75], a[196:199], v[188:191], v[72:75]
    v_exp_f32 v81, v81
    v_mfma_f32_16x16x32_bf16 v[72:75], a[200:203], v[192:195], v[72:75]
    v_exp_f32 v82, v82
    v_exp_f32 v83, v83
    v_mfma_f32_16x16x32_bf16 v[72:75], a[204:207], v[196:199], v[72:75]
    v_mov_b32 v39, v38
    s_nop 1
    v_permlane32_swap_b32 v38, v39
    v_max_f32 v38, v38, v39
    v_mov_b32 v39, v38
    s_nop 1
    v_permlane16_swap_b32 v38, v39
    v_max_f32 v38, v38, v39
    v_mfma_f32_16x16x32_bf16 v[72:75], a[208:211], v[200:203], v[72:75]
    ds_read_b64_tr_b16 v[154:155], v4 offset:6144
    v_cvt_pk_bf16_f32 v120, v80, v81
    v_mfma_f32_16x16x32_bf16 v[72:75], a[212:215], v[204:207], v[72:75]
    v_cvt_pk_bf16_f32 v121, v82, v83
    v_add_f32 v18, v18, v80
    v_add_f32 v18, v18, v81
    v_add_f32 v18, v18, v82
    v_add_f32 v18, v18, v83
    v_sub_f32 v88, v88, v38
    v_sub_f32 v89, v89, v38
    v_sub_f32 v90, v90, v38
    v_sub_f32 v91, v91, v38
    v_sub_f32 v92, v92, v38
    v_sub_f32 v93, v93, v38
    v_sub_f32 v94, v94, v38
    v_sub_f32 v95, v95, v38
    v_mfma_f32_16x16x32_bf16 v[80:83], a[192:195], v[208:211], v[56:59]
    v_exp_f32 v88, v88
    v_mfma_f32_16x16x32_bf16 v[80:83], a[196:199], v[212:215], v[80:83]
    s_add_u32 m0, s33, 13184
    v_exp_f32 v89, v89
    v_mfma_f32_16x16x32_bf16 v[80:83], a[200:203], v[216:219], v[80:83]
    buffer_load_dwordx4 v8, s[16:19], s29 offen offset:128 nt lds
    v_exp_f32 v90, v90
    v_exp_f32 v91, v91
    v_mfma_f32_16x16x32_bf16 v[80:83], a[204:207], v[220:223], v[80:83]
    ds_read_b64_tr_b16 v[156:157], v4 offset:12288
    v_sub_f32 v60, 0, v38
    v_mfma_f32_16x16x32_bf16 v[80:83], a[208:211], v[224:227], v[80:83]
    v_sub_f32 v61, 0, v38
    v_sub_f32 v62, 0, v38
    v_sub_f32 v63, 0, v38
    v_mfma_f32_16x16x32_bf16 v[80:83], a[212:215], v[228:231], v[80:83]
    v_cvt_pk_bf16_f32 v108, v88, v89
    v_cvt_pk_bf16_f32 v109, v90, v91
    v_add_f32 v22, v88, v89
    v_add_f32 v22, v22, v90
    v_add_f32 v22, v22, v91
    v_mfma_f32_16x16x32_bf16 v[88:91], a[192:195], v[232:235], v[60:63]
    v_exp_f32 v68, v68
    v_mfma_f32_16x16x32_bf16 v[88:91], a[196:199], v[236:239], v[88:91]
    v_exp_f32 v69, v69
    v_mfma_f32_16x16x32_bf16 v[88:91], a[200:203], v[240:243], v[88:91]
    v_exp_f32 v70, v70
    v_exp_f32 v71, v71
    v_mfma_f32_16x16x32_bf16 v[88:91], a[204:207], v[244:247], v[88:91]
    ds_read_b128 a[192:195], v2 offset:36864
    v_cvt_pk_bf16_f32 v114, v68, v69
    v_mfma_f32_16x16x32_bf16 v[88:91], a[208:211], v[248:251], v[88:91]
    ds_read_b64_tr_b16 v[158:159], v4 offset:18432
    v_cvt_pk_bf16_f32 v115, v70, v71
    v_mfma_f32_16x16x32_bf16 v[88:91], a[212:215], v[252:255], v[88:91]
    s_add_u32 m0, s33, 14080
    v_add_f32 v16, v16, v68
    v_add_f32 v16, v16, v69
    v_add_f32 v16, v16, v70
    v_add_f32 v16, v16, v71
    v_mfma_f32_16x16x32_bf16 v[68:71], a[216:219], v[160:163], v[48:51]
    buffer_load_dwordx4 v8, s[16:19], s29 offen offset:256 nt lds
    v_mfma_f32_16x16x32_bf16 v[68:71], a[220:223], v[164:167], v[68:71]
    s_add_u32 s29, s29, 12288
    v_exp_f32 v76, v76
    v_mfma_f32_16x16x32_bf16 v[68:71], a[224:227], v[168:171], v[68:71]
    v_exp_f32 v77, v77
    v_exp_f32 v78, v78
    v_exp_f32 v79, v79
    v_mfma_f32_16x16x32_bf16 v[68:71], a[228:231], v[172:175], v[68:71]
    ds_read_b128 a[196:199], v3 offset:36864
    v_cvt_pk_bf16_f32 v118, v76, v77
    v_mfma_f32_16x16x32_bf16 v[68:71], a[232:235], v[176:179], v[68:71]
    ds_read_b64_tr_b16 a[240:241], v5
    v_cvt_pk_bf16_f32 v119, v78, v79
    v_mfma_f32_16x16x32_bf16 v[68:71], a[236:239], v[180:183], v[68:71]
    v_add_f32 v17, v17, v76
    v_add_f32 v17, v17, v77
    v_add_f32 v17, v17, v78
    v_add_f32 v17, v17, v79
    v_mfma_f32_16x16x32_bf16 v[76:79], a[216:219], v[184:187], v[52:55]
    v_exp_f32 v84, v84
    v_mfma_f32_16x16x32_bf16 v[76:79], a[220:223], v[188:191], v[76:79]
    v_exp_f32 v85, v85
    v_mfma_f32_16x16x32_bf16 v[76:79], a[224:227], v[192:195], v[76:79]
    s_add_u32 m0, s33, 24576
    v_exp_f32 v86, v86
    v_exp_f32 v87, v87
    v_mfma_f32_16x16x32_bf16 v[76:79], a[228:231], v[196:199], v[76:79]
    buffer_load_dwordx4 v8, s[16:19], s29 offen nt lds
    v_mfma_f32_16x16x32_bf16 v[76:79], a[232:235], v[200:203], v[76:79]
    ds_read_b128 a[200:203], v2 offset:37888
    v_cvt_pk_bf16_f32 v122, v84, v85
    v_mfma_f32_16x16x32_bf16 v[76:79], a[236:239], v[204:207], v[76:79]
    v_cvt_pk_bf16_f32 v123, v86, v87
    v_add_f32 v18, v18, v84
    v_add_f32 v18, v18, v85
    v_add_f32 v18, v18, v86
    v_add_f32 v18, v18, v87
    v_mfma_f32_16x16x32_bf16 v[84:87], a[216:219], v[208:211], v[56:59]
    v_exp_f32 v92, v92
    v_mfma_f32_16x16x32_bf16 v[84:87], a[220:223], v[212:215], v[84:87]
    v_exp_f32 v93, v93
    v_mfma_f32_16x16x32_bf16 v[84:87], a[224:227], v[216:219], v[84:87]
    v_exp_f32 v94, v94
    v_exp_f32 v95, v95
    v_mfma_f32_16x16x32_bf16 v[84:87], a[228:231], v[220:223], v[84:87]
    ds_read_b128 a[204:207], v3 offset:37888
    v_cvt_pk_bf16_f32 v110, v92, v93
    v_mfma_f32_16x16x32_bf16 v[84:87], a[232:235], v[224:227], v[84:87]
    ds_read_b64_tr_b16 a[242:243], v5 offset:6144
    v_cvt_pk_bf16_f32 v111, v94, v95
    v_mfma_f32_16x16x32_bf16 v[84:87], a[236:239], v[228:231], v[84:87]
    v_add_f32 v22, v22, v92
    v_add_f32 v22, v22, v93
    v_add_f32 v22, v22, v94
    v_add_f32 v22, v22, v95
    v_mfma_f32_16x16x32_bf16 v[92:95], a[216:219], v[232:235], v[60:63]
    ds_read_b128 a[208:211], v2 offset:38912
    v_max3_f32 v28, v16, v17, v18
    v_mfma_f32_16x16x32_bf16 v[92:95], a[220:223], v[236:239], v[92:95]
    s_add_u32 m0, s33, 25472
    ds_read_b64_tr_b16 a[244:245], v5 offset:12288
    v_max_f32 v28, v28, v22
    v_mfma_f32_16x16x32_bf16 v[92:95], a[224:227], v[240:243], v[92:95]
    buffer_load_dwordx4 v8, s[16:19], s29 offen offset:128 nt lds
    v_mfma_f32_16x16x32_bf16 v[92:95], a[228:231], v[244:247], v[92:95]
    ds_read_b128 a[212:215], v3 offset:38912
    v_cmp_lt_f32 vcc, s35, v28
    v_mfma_f32_16x16x32_bf16 v[92:95], a[232:235], v[248:251], v[92:95]
    ds_read_b64_tr_b16 a[246:247], v5 offset:18432
    ds_read_b64_tr_b16 a[248:249], v6
    v_mfma_f32_16x16x32_bf16 v[92:95], a[236:239], v[252:255], v[92:95]
    s_waitcnt lgkmcnt(5)
    s_cbranch_vccnz L_h0_2c_rare
L_h0_2c_back:
    ds_read_b128 a[216:219], v2 offset:43008
    v_mfma_f32_16x16x32_bf16 a[144:147], v[152:155], v[108:111], 0
    ds_read_b64_tr_b16 a[250:251], v6 offset:6144
    v_mov_b32 v12, v16
    v_mfma_f32_16x16x32_bf16 a[0:3], v[152:155], v[96:99], 0
    ds_read_b128 a[220:223], v3 offset:43008
    v_mov_b32 v13, v17
    v_mfma_f32_16x16x32_bf16 a[0:3], v[156:159], v[112:115], a[0:3]
    s_add_u32 m0, s33, 26368
    ds_read_b64_tr_b16 a[252:253], v6 offset:12288
    v_mov_b32 v14, v18
    v_mfma_f32_16x16x32_bf16 a[48:51], v[152:155], v[100:103], 0
    buffer_load_dwordx4 v8, s[16:19], s29 offen offset:256 nt lds
    v_mfma_f32_16x16x32_bf16 a[48:51], v[156:159], v[116:119], a[48:51]
    s_add_u32 s29, s29, 12288
    ds_read_b64_tr_b16 a[254:255], v6 offset:18432
    v_mov_b32 v15, v22
    v_mfma_f32_16x16x32_bf16 a[96:99], v[152:155], v[104:107], 0
    ds_read_b128 a[224:227], v2 offset:44032
    v_mfma_f32_16x16x32_bf16 a[96:99], v[156:159], v[120:123], a[96:99]
    v_exp_f32 v64, v64
    v_mfma_f32_16x16x32_bf16 a[148:151], a[240:243], v[108:111], 0
    ds_read_b128 a[228:231], v3 offset:44032
    v_mfma_f32_16x16x32_bf16 a[4:7], a[240:243], v[96:99], 0
    s_waitcnt lgkmcnt(4)
    v_exp_f32 v65, v65
    v_mfma_f32_16x16x32_bf16 a[4:7], a[244:247], v[112:115], a[4:7]
    ds_read_b64_tr_b16 v[152:153], v7
    v_cvt_pk_bf16_f32 v124, v64, v65
    v_mfma_f32_16x16x32_bf16 a[52:55], a[240:243], v[100:103], 0
    ds_read_b64_tr_b16 v[154:155], v7 offset:6144
    v_add_f32 v19, v64, v65
    v_mfma_f32_16x16x32_bf16 a[52:55], a[244:247], v[116:119], a[52:55]
    ds_read_b128 a[232:235], v2 offset:45056
    v_mfma_f32_16x16x32_bf16 a[100:103], a[240:243], v[104:107], 0
    ds_read_b64_tr_b16 v[156:157], v7 offset:12288
    ds_read_b64_tr_b16 v[158:159], v7 offset:18432
    v_mfma_f32_16x16x32_bf16 a[100:103], a[244:247], v[120:123], a[100:103]
    ds_read_b128 a[236:239], v3 offset:45056
    v_mfma_f32_16x16x32_bf16 a[152:155], a[248:251], v[108:111], 0
    v_exp_f32 v66, v66
    v_mfma_f32_16x16x32_bf16 a[8:11], a[248:251], v[96:99], 0
    s_waitcnt lgkmcnt(6)
    ds_inc_u32 v46, v46
    v_add_f32 v19, v19, v66
    v_mfma_f32_16x16x32_bf16 a[8:11], a[252:255], v[112:115], a[8:11]
    v_exp_f32 v67, v67
    v_mfma_f32_16x16x32_bf16 a[56:59], a[248:251], v[100:103], 0
    v_cvt_pk_bf16_f32 v125, v66, v67
    v_add_f32 v19, v19, v67
    v_mfma_f32_16x16x32_bf16 a[56:59], a[252:255], v[116:119], a[56:59]
    v_exp_f32 v72, v72
    v_mfma_f32_16x16x32_bf16 a[104:107], a[248:251], v[104:107], 0
    v_exp_f32 v73, v73
    v_mfma_f32_16x16x32_bf16 a[104:107], a[252:255], v[120:123], a[104:107]
    s_waitcnt lgkmcnt(1)
    v_exp_f32 v74, v74
    v_mfma_f32_16x16x32_bf16 a[156:159], v[152:155], v[108:111], 0
    v_exp_f32 v75, v75
    v_mfma_f32_16x16x32_bf16 a[12:15], v[152:155], v[96:99], 0
    v_cvt_pk_bf16_f32 v128, v72, v73
    v_cvt_pk_bf16_f32 v129, v74, v75
    v_mfma_f32_16x16x32_bf16 a[12:15], v[156:159], v[112:115], a[12:15]
    v_add_f32 v20, v72, v73
    v_add_f32 v20, v20, v74
    v_mfma_f32_16x16x32_bf16 a[60:63], v[152:155], v[100:103], 0
    v_exp_f32 v80, v80
    v_mfma_f32_16x16x32_bf16 a[60:63], v[156:159], v[116:119], a[60:63]
    v_exp_f32 v81, v81
    v_mfma_f32_16x16x32_bf16 a[108:111], v[152:155], v[104:107], 0
    v_add_f32 v20, v20, v75
    v_cvt_pk_bf16_f32 v132, v80, v81
    v_mfma_f32_16x16x32_bf16 a[108:111], v[156:159], v[120:123], a[108:111]
    v_exp_f32 v82, v82
    v_mfma_f32_16x16x32_bf16 v[64:67], a[192:195], v[160:163], v[48:51]
    v_exp_f32 v83, v83
    v_mfma_f32_16x16x32_bf16 v[64:67], a[196:199], v[164:167], v[64:67]
    ds_read_b32 v30, v46
    v_cvt_pk_bf16_f32 v133, v82, v83
    v_mfma_f32_16x16x32_bf16 v[64:67], a[200:203], v[168:171], v[64:67]
    v_add_f32 v21, v80, v81
    v_add_f32 v21, v21, v82
    v_mfma_f32_16x16x32_bf16 v[64:67], a[204:207], v[172:175], v[64:67]
    v_exp_f32 v68, v68
    v_mfma_f32_16x16x32_bf16 v[64:67], a[208:211], v[176:179], v[64:67]
    v_add_f32 v21, v21, v83
    v_add_f32 v19, v19, v68
    v_mfma_f32_16x16x32_bf16 v[64:67], a[212:215], v[180:183], v[64:67]
    v_exp_f32 v69, v69
    v_mfma_f32_16x16x32_bf16 v[72:75], a[192:195], v[184:187], v[52:55]
    v_exp_f32 v70, v70
    v_mfma_f32_16x16x32_bf16 v[72:75], a[196:199], v[188:191], v[72:75]
    v_exp_f32 v71, v71
    v_mfma_f32_16x16x32_bf16 v[72:75], a[200:203], v[192:195], v[72:75]
    s_waitcnt lgkmcnt(0)
    v_cmp_gt_u32 vcc, s93, v30
    v_cvt_pk_bf16_f32 v126, v68, v69
    v_mfma_f32_16x16x32_bf16 v[72:75], a[204:207], v[196:199], v[72:75]
    v_cvt_pk_bf16_f32 v127, v70, v71
    v_add_f32 v19, v19, v69
    v_mfma_f32_16x16x32_bf16 v[72:75], a[208:211], v[200:203], v[72:75]
    s_add_u32 m0, s33, 49152
    v_add_f32 v19, v19, v70
    v_add_f32 v19, v19, v71
    v_mfma_f32_16x16x32_bf16 v[72:75], a[212:215], v[204:207], v[72:75]
    s_cbranch_vccnz L_h0_3s_rare
L_h0_3s_back:
    v_exp_f32 v76, v76
    v_mfma_f32_16x16x32_bf16 v[80:83], a[192:195], v[208:211], v[56:59]
    s_add_u32 s93, s93, 4
    buffer_load_dwordx4 v9, s[20:23], s30 offen nt lds
    v_mfma_f32_16x16x32_bf16 v[80:83], a[196:199], v[212:215], v[80:83]
    v_exp_f32 v77, v77
    v_mfma_f32_16x16x32_bf16 v[80:83], a[200:203], v[216:219], v[80:83]
    v_exp_f32 v78, v78
    v_mfma_f32_16x16x32_bf16 v[80:83], a[204:207], v[220:223], v[80:83]
    v_exp_f32 v79, v79
    v_mfma_f32_16x16x32_bf16 v[80:83], a[208:211], v[224:227], v[80:83]
    ds_read_b64_tr_b16 a[240:241], v4 offset:1024
    v_cvt_pk_bf16_f32 v130, v76, v77
    v_mfma_f32_16x16x32_bf16 v[80:83], a[212:215], v[228:231], v[80:83]
    ds_read_b64_tr_b16 a[242:243], v4 offset:7168
    v_cvt_pk_bf16_f32 v131, v78, v79
    v_mfma_f32_16x16x32_bf16 v[68:71], a[216:219], v[160:163], v[48:51]
    ds_read_b64_tr_b16 a[244:245], v4 offset:13312
    v_add_f32 v20, v20, v76
    v_mfma_f32_16x16x32_bf16 v[68:71], a[220:223], v[164:167], v[68:71]
    ds_read_b64_tr_b16 a[246:247], v4 offset:19456
    v_add_f32 v20, v20, v77
    v_mfma_f32_16x16x32_bf16 v[68:71], a[224:227], v[168:171], v[68:71]
    ds_read_b64_tr_b16 a[248:249], v5 offset:1024
    v_add_f32 v20, v20, v78
    v_mfma_f32_16x16x32_bf16 v[68:71], a[228:231], v[172:175], v[68:71]
    s_add_u32 m0, s33, 61440
    ds_read_b64_tr_b16 a[250:251], v5 offset:7168
    v_add_f32 v20, v20, v79
    v_mfma_f32_16x16x32_bf16 v[68:71], a[232:235], v[176:179], v[68:71]
    buffer_load_dwordx4 v9, s[20:23], s32 offen nt lds
    v_mfma_f32_16x16x32_bf16 v[68:71], a[236:239], v[180:183], v[68:71]
    v_exp_f32 v84, v84
    v_mfma_f32_16x16x32_bf16 v[76:79], a[216:219], v[184:187], v[52:55]
    v_exp_f32 v85, v85
    v_mfma_f32_16x16x32_bf16 v[76:79], a[220:223], v[188:191], v[76:79]
    v_exp_f32 v86, v86
    v_mfma_f32_16x16x32_bf16 v[76:79], a[224:227], v[192:195], v[76:79]
    v_exp_f32 v87, v87
    v_mfma_f32_16x16x32_bf16 v[76:79], a[228:231], v[196:199], v[76:79]
    ds_read_b64_tr_b16 a[252:253], v5 offset:13312
    v_cvt_pk_bf16_f32 v134, v84, v85
    v_mfma_f32_16x16x32_bf16 v[76:79], a[232:235], v[200:203], v[76:79]
    ds_read_b64_tr_b16 a[254:255], v5 offset:19456
    v_cvt_pk_bf16_f32 v135, v86, v87
    v_mfma_f32_16x16x32_bf16 v[76:79], a[236:239], v[204:207], v[76:79]
    v_add_f32 v21, v21, v84
    v_add_f32 v21, v21, v85
    v_add_f32 v21, v21, v86
    v_add_f32 v21, v21, v87
    v_mfma_f32_16x16x32_bf16 v[84:87], a[216:219], v[208:211], v[56:59]
    v_exp_f32 v88, v88
    v_mfma_f32_16x16x32_bf16 v[84:87], a[220:223], v[212:215], v[84:87]
    s_add_u32 m0, s33, 36864
    v_exp_f32 v89, v89
    v_mfma_f32_16x16x32_bf16 v[84:87], a[224:227], v[216:219], v[84:87]
    buffer_load_dwordx4 v8, s[16:19], s29 offen nt lds
    v_mfma_f32_16x16x32_bf16 v[84:87], a[228:231], v[220:223], v[84:87]
    ds_read_b64_tr_b16 v[152:153], v6 offset:1024
    v_cvt_pk_bf16_f32 v136, v88, v89
    v_mfma_f32_16x16x32_bf16 v[84:87], a[232:235], v[224:227], v[84:87]
    ds_read_b64_tr_b16 v[154:155], v6 offset:7168
    v_add_f32 v22, v88, v89
    v_mfma_f32_16x16x32_bf16 v[84:87], a[236:239], v[228:231], v[84:87]
    s_waitcnt lgkmcnt(2)
    v_exp_f32 v90, v90
    v_mfma_f32_16x16x32_bf16 a[160:163], a[240:243], v[108:111], 0
    ds_read_b64_tr_b16 v[156:157], v6 offset:13312
    v_add_f32 v22, v22, v90
    v_mfma_f32_16x16x32_bf16 a[16:19], a[240:243], v[96:99], 0
    v_exp_f32 v91, v91
    v_mfma_f32_16x16x32_bf16 a[16:19], a[244:247], v[112:115], a[16:19]
    ds_read_b64_tr_b16 v[158:159], v6 offset:19456
    v_cvt_pk_bf16_f32 v137, v90, v91
    v_mfma_f32_16x16x32_bf16 a[64:67], a[240:243], v[100:103], 0
    ds_read_b128 a[192:195], v2
    v_add_f32 v22, v22, v91
    v_mfma_f32_16x16x32_bf16 a[64:67], a[244:247], v[116:119], a[64:67]
    v_exp_f32 v92, v92
    v_mfma_f32_16x16x32_bf16 a[112:115], a[240:243], v[104:107], 0
    s_add_u32 m0, s33, 37760
    ds_read_b64_tr_b16 a[240:241], v7 offset:1024
    v_add_f32 v22, v22, v92
    v_mfma_f32_16x16x32_bf16 a[112:115], a[244:247], v[120:123], a[112:115]
    buffer_load_dwordx4 v8, s[16:19], s29 offen offset:128 nt lds
    v_mfma_f32_16x16x32_bf16 a[164:167], a[248:251], v[108:111], 0
    v_exp_f32 v93, v93
    v_mfma_f32_16x16x32_bf16 a[20:23], a[248:251], v[96:99], 0
    ds_read_b64_tr_b16 a[242:243], v7 offset:7168
    v_cvt_pk_bf16_f32 v138, v92, v93
    v_mfma_f32_16x16x32_bf16 a[20:23], a[252:255], v[112:115], a[20:23]
    ds_read_b64_tr_b16 a[244:245], v7 offset:13312
    v_add_f32 v22, v22, v93
    v_mfma_f32_16x16x32_bf16 a[68:71], a[248:251], v[100:103], 0
    v_exp_f32 v94, v94
    v_mfma_f32_16x16x32_bf16 a[68:71], a[252:255], v[116:119], a[68:71]
    ds_read_b64_tr_b16 a[246:247], v7 offset:19456
    v_add_f32 v22, v22, v94
    v_mfma_f32_16x16x32_bf16 a[116:119], a[248:251], v[104:107], 0
    ds_read_b128 a[196:199], v3
    v_mfma_f32_16x16x32_bf16 a[116:119], a[252:255], v[120:123], a[116:119]
    s_waitcnt lgkmcnt(4)
    v_exp_f32 v95, v95
    v_mfma_f32_16x16x32_bf16 a[168:171], v[152:155], v[108:111], 0
    ds_read_b128 a[200:203], v2 offset:1024
    v_cvt_pk_bf16_f32 v139, v94, v95
    v_mfma_f32_16x16x32_bf16 a[24:27], v[152:155], v[96:99], 0
    ds_read_b64_tr_b16 a[248:249], v4 offset:2048
    v_add_f32 v22, v22, v95
    v_mfma_f32_16x16x32_bf16 a[24:27], v[156:159], v[112:115], a[24:27]
    s_add_u32 m0, s33, 38656
    ds_read_b64_tr_b16 a[250:251], v4 offset:8192
    ds_read_b64_tr_b16 a[252:253], v4 offset:14336
    v_mfma_f32_16x16x32_bf16 a[72:75], v[152:155], v[100:103], 0
    buffer_load_dwordx4 v8, s[16:19], s29 offen offset:256 nt lds
    v_mfma_f32_16x16x32_bf16 a[72:75], v[156:159], v[116:119], a[72:75]
    s_add_u32 s29, s29, 12288
    ds_read_b128 a[204:207], v3 offset:1024
    v_mfma_f32_16x16x32_bf16 a[120:123], v[152:155], v[104:107], 0
    ds_read_b64_tr_b16 a[254:255], v4 offset:20480
    ds_read_b64_tr_b16 v[152:153], v5 offset:2048
    v_mfma_f32_16x16x32_bf16 a[120:123], v[156:159], v[120:123], a[120:123]
    s_waitcnt lgkmcnt(7)
    ds_read_b128 a[208:211], v2 offset:2048
    v_mfma_f32_16x16x32_bf16 a[172:175], a[240:243], v[108:111], 0
    v_exp_f32 v64, v64
    v_mfma_f32_16x16x32_bf16 a[28:31], a[240:243], v[96:99], 0
    ds_read_b64_tr_b16 v[154:155], v5 offset:8192
    v_add_f32 v19, v19, v64
    v_mfma_f32_16x16x32_bf16 a[28:31], a[244:247], v[112:115], a[28:31]
    ds_read_b128 a[212:215], v3 offset:2048
    v_mfma_f32_16x16x32_bf16 a[76:79], a[240:243], v[100:103], 0
    v_exp_f32 v65, v65
    v_mfma_f32_16x16x32_bf16 a[76:79], a[244:247], v[116:119], a[76:79]
    ds_read_b64_tr_b16 v[156:157], v5 offset:14336
    v_cvt_pk_bf16_f32 v140, v64, v65
    v_mfma_f32_16x16x32_bf16 a[124:127], a[240:243], v[104:107], 0
    ds_read_b64_tr_b16 v[158:159], v5 offset:20480
    v_add_f32 v19, v19, v65
    v_mfma_f32_16x16x32_bf16 a[124:127], a[244:247], v[120:123], a[124:127]
    s_waitcnt lgkmcnt(4)
    ds_read_b128 a[216:219], v2 offset:6144
    v_mfma_f32_16x16x32_bf16 a[176:179], a[248:251], v[108:111], 0
    v_exp_f32 v66, v66
    v_mfma_f32_16x16x32_bf16 a[32:35], a[248:251], v[96:99], 0
    ds_read_b128 a[220:223], v3 offset:6144
    v_add_f32 v19, v19, v66
    v_mfma_f32_16x16x32_bf16 a[32:35], a[252:255], v[112:115], a[32:35]
    ds_read_b64_tr_b16 a[240:241], v6 offset:2048
    ds_read_b64_tr_b16 a[242:243], v6 offset:8192
    v_mfma_f32_16x16x32_bf16 a[80:83], a[248:251], v[100:103], 0
    v_exp_f32 v67, v67
    v_mfma_f32_16x16x32_bf16 a[80:83], a[252:255], v[116:119], a[80:83]
    ds_read_b64_tr_b16 a[244:245], v6 offset:14336
    v_cvt_pk_bf16_f32 v141, v66, v67
    v_mfma_f32_16x16x32_bf16 a[128:131], a[248:251], v[104:107], 0
    ds_read_b64_tr_b16 a[246:247], v6 offset:20480
    v_add_f32 v19, v19, v67
    v_mfma_f32_16x16x32_bf16 a[128:131], a[252:255], v[120:123], a[128:131]
    s_waitcnt lgkmcnt(5)
    ds_read_b128 a[224:227], v2 offset:7168
    v_mfma_f32_16x16x32_bf16 a[180:183], v[152:155], v[108:111], 0
    v_exp_f32 v68, v68
    v_mfma_f32_16x16x32_bf16 a[36:39], v[152:155], v[96:99], 0
    ds_read_b128 a[228:231], v3 offset:7168
    v_add_f32 v19, v19, v68
    v_mfma_f32_16x16x32_bf16 a[36:39], v[156:159], v[112:115], a[36:39]
    ds_read_b64_tr_b16 a[248:249], v7 offset:2048
    ds_read_b64_tr_b16 a[250:251], v7 offset:8192
    v_mfma_f32_16x16x32_bf16 a[84:87], v[152:155], v[100:103], 0
    ds_read_b128 a[232:235], v2 offset:8192
    v_mfma_f32_16x16x32_bf16 a[84:87], v[156:159], v[116:119], a[84:87]
    ds_read_b64_tr_b16 a[252:253], v7 offset:14336
    ds_read_b64_tr_b16 a[254:255], v7 offset:20480
    v_mfma_f32_16x16x32_bf16 a[132:135], v[152:155], v[104:107], 0
    v_exp_f32 v69, v69
    v_mfma_f32_16x16x32_bf16 a[132:135], v[156:159], v[120:123], a[132:135]
    s_waitcnt lgkmcnt(6)
    ds_read_b128 a[236:239], v3 offset:8192
    v_cvt_pk_bf16_f32 v142, v68, v69
    v_mfma_f32_16x16x32_bf16 a[184:187], a[240:243], v[108:111], 0
    v_exp_f32 v70, v70
    v_mfma_f32_16x16x32_bf16 a[40:43], a[240:243], v[96:99], 0
    s_waitcnt vmcnt(8)
    ds_inc_u32 v46, v46
    v_add_f32 v19, v19, v69
    v_mfma_f32_16x16x32_bf16 a[40:43], a[244:247], v[112:115], a[40:43]
    v_exp_f32 v71, v71
    v_mfma_f32_16x16x32_bf16 a[88:91], a[240:243], v[100:103], 0
    v_cvt_pk_bf16_f32 v143, v70, v71
    v_add_f32 v19, v19, v70
    v_mfma_f32_16x16x32_bf16 a[88:91], a[244:247], v[116:119], a[88:91]
    v_exp_f32 v72, v72
    v_mfma_f32_16x16x32_bf16 a[136:139], a[240:243], v[104:107], 0
    v_add_f32 v19, v19, v71
    v_add_f32 v20, v20, v72
    v_mfma_f32_16x16x32_bf16 a[136:139], a[244:247], v[120:123], a[136:139]
    s_waitcnt lgkmcnt(1)
    v_exp_f32 v73, v73
    v_mfma_f32_16x16x32_bf16 a[188:191], a[248:251], v[108:111], 0
    v_exp_f32 v74, v74
    v_mfma_f32_16x16x32_bf16 a[44:47], a[248:251], v[96:99], 0
    v_exp_f32 v75, v75
    v_mfma_f32_16x16x32_bf16 a[44:47], a[252:255], v[112:115], a[44:47]
    v_cvt_pk_bf16_f32 v144, v72, v73
    v_cvt_pk_bf16_f32 v145, v74, v75
    v_mfma_f32_16x16x32_bf16 a[92:95], a[248:251], v[100:103], 0
    v_exp_f32 v76, v76
    v_mfma_f32_16x16x32_bf16 a[92:95], a[252:255], v[116:119], a[92:95]
    v_exp_f32 v77, v77
    v_mfma_f32_16x16x32_bf16 a[140:143], a[248:251], v[104:107], 0
    v_exp_f32 v78, v78
    v_mfma_f32_16x16x32_bf16 a[140:143], a[252:255], v[120:123], a[140:143]
    v_exp_f32 v79, v79
    v_cvt_pk_bf16_f32 v146, v76, v77
    v_cvt_pk_bf16_f32 v147, v78, v79
    v_add_f32 v20, v20, v73
    v_add_f32 v20, v20, v74
    v_add_f32 v20, v20, v75
    v_add_f32 v20, v20, v76
    v_add_f32 v20, v20, v77
    v_add_f32 v20, v20, v78
    v_add_f32 v20, v20, v79
    v_exp_f32 v80, v80
    v_exp_f32 v81, v81
    v_exp_f32 v82, v82
    v_exp_f32 v83, v83
    v_cvt_pk_bf16_f32 v148, v80, v81
    v_cvt_pk_bf16_f32 v149, v82, v83
    v_exp_f32 v84, v84
    v_exp_f32 v85, v85
    v_exp_f32 v86, v86
    v_exp_f32 v87, v87
    v_cvt_pk_bf16_f32 v150, v84, v85
    v_cvt_pk_bf16_f32 v151, v86, v87
    v_add_f32 v21, v21, v80
    v_add_f32 v21, v21, v81
    v_add_f32 v21, v21, v82
    v_add_f32 v21, v21, v83
    v_add_f32 v21, v21, v84
    v_add_f32 v21, v21, v85
    v_add_f32 v21, v21, v86
    v_add_f32 v21, v21, v87
    v_max3_f32 v28, v19, v20, v21
    v_max_f32 v28, v28, v22
    s_mov_b32 s31, 6
.p2align 6
L_loop_01:
    v_mfma_f32_16x16x32_bf16 v[64:67], a[192:195], v[160:163], v[48:51]
    s_add_u32 s57, s31, 1
    s_and_b32 s57, s57, 4
    s_mul_i32 s82, s57, 41472
    v_mfma_f32_16x16x32_bf16 v[64:67], a[196:199], v[164:167], v[64:67]
    s_mul_i32 s91, s57, 800
    s_mul_i32 s87, s57, 768
    ds_read_b32 v30, v46
    v_mfma_f32_16x16x32_bf16 v[64:67], a[200:203], v[168:171], v[64:67]
    ds_read_b128 v[32:35], v47
    v_mfma_f32_16x16x32_bf16 v[64:67], a[204:207], v[172:175], v[64:67]
    ds_read_b128 v[36:39], v47 offset:128
    v_mfma_f32_16x16x32_bf16 v[64:67], a[208:211], v[176:179], v[64:67]
    ds_read_b128 v[40:43], v47 offset:256
    v_mfma_f32_16x16x32_bf16 v[64:67], a[212:215], v[180:183], v[64:67]
    v_mfma_f32_16x16x32_bf16 v[72:75], a[192:195], v[184:187], v[52:55]
    v_mfma_f32_16x16x32_bf16 v[72:75], a[196:199], v[188:191], v[72:75]
    v_cmp_lt_f32 vcc, s35, v28
    v_mfma_f32_16x16x32_bf16 v[72:75], a[200:203], v[192:195], v[72:75]
    s_waitcnt lgkmcnt(3)
    v_cmp_gt_u32 s[94:95], s93, v30
    v_mfma_f32_16x16x32_bf16 v[72:75], a[204:207], v[196:199], v[72:75]
    s_add_u32 m0, s33, 50048
    s_nop 0
    v_exp_f32 v64, v64
    v_mfma_f32_16x16x32_bf16 v[72:75], a[208:211], v[200:203], v[72:75]
    s_or_b64 vcc, vcc, s[94:95]
    v_exp_f32 v65, v65
    v_mfma_f32_16x16x32_bf16 v[72:75], a[212:215], v[204:207], v[72:75]
    s_cbranch_vccnz L_b01_3cs_rare
L_b01_3cs_back:
    ds_read_b64_tr_b16 v[152:153], v4 offset:24576
    v_cvt_pk_bf16_f32 v96, v64, v65
    v_mfma_f32_16x16x32_bf16 v[80:83], a[192:195], v[208:211], v[56:59]
    s_add_u32 s93, s93, 4
    buffer_load_dwordx4 v9, s[20:23], s30 offen offset:128 nt lds
    v_mfma_f32_16x16x32_bf16 v[80:83], a[196:199], v[212:215], v[80:83]
    ds_read_b64_tr_b16 v[154:155], v4 offset:30720
    v_add_f32 v12, v12, v19
    v_mfma_f32_16x16x32_bf16 v[80:83], a[200:203], v[216:219], v[80:83]
    ds_read_b64_tr_b16 v[156:157], v4 offset:36864
    v_add_f32 v13, v13, v20
    v_mfma_f32_16x16x32_bf16 v[80:83], a[204:207], v[220:223], v[80:83]
    ds_read_b64_tr_b16 v[158:159], v4 offset:43008
    v_add_f32 v14, v14, v21
    v_mfma_f32_16x16x32_bf16 v[80:83], a[208:211], v[224:227], v[80:83]
    ds_read_b64_tr_b16 a[240:241], v5 offset:24576
    v_add_f32 v15, v15, v22
    v_mfma_f32_16x16x32_bf16 v[80:83], a[212:215], v[228:231], v[80:83]
    ds_read_b64_tr_b16 a[242:243], v5 offset:30720
    v_add_f32 v16, v64, v65
    v_mfma_f32_16x16x32_bf16 v[88:91], a[192:195], v[232:235], v[60:63]
    v_exp_f32 v66, v66
    v_mfma_f32_16x16x32_bf16 v[88:91], a[196:199], v[236:239], v[88:91]
    s_add_u32 m0, s33, 50944
    ds_read_b128 a[192:195], v2 offset:12288
    v_add_f32 v16, v16, v66
    v_mfma_f32_16x16x32_bf16 v[88:91], a[200:203], v[240:243], v[88:91]
    buffer_load_dwordx4 v9, s[20:23], s30 offen offset:256 nt lds
    v_mfma_f32_16x16x32_bf16 v[88:91], a[204:207], v[244:247], v[88:91]
    v_exp_f32 v67, v67
    v_mfma_f32_16x16x32_bf16 v[88:91], a[208:211], v[248:251], v[88:91]
    ds_read_b128 a[196:199], v3 offset:12288
    v_cvt_pk_bf16_f32 v97, v66, v67
    v_mfma_f32_16x16x32_bf16 v[88:91], a[212:215], v[252:255], v[88:91]
    ds_read_b64_tr_b16 a[244:245], v5 offset:36864
    v_add_f32 v16, v16, v67
    v_mfma_f32_16x16x32_bf16 v[68:71], a[216:219], v[160:163], v[48:51]
    v_exp_f32 v72, v72
    v_mfma_f32_16x16x32_bf16 v[68:71], a[220:223], v[164:167], v[68:71]
    v_exp_f32 v73, v73
    v_mfma_f32_16x16x32_bf16 v[68:71], a[224:227], v[168:171], v[68:71]
    ds_read_b128 a[200:203], v2 offset:13312
    v_cvt_pk_bf16_f32 v100, v72, v73
    v_mfma_f32_16x16x32_bf16 v[68:71], a[228:231], v[172:175], v[68:71]
    s_add_u32 m0, s33, 62336
    ds_read_b64_tr_b16 a[246:247], v5 offset:43008
    v_add_f32 v17, v72, v73
    v_mfma_f32_16x16x32_bf16 v[68:71], a[232:235], v[176:179], v[68:71]
    buffer_load_dwordx4 v9, s[20:23], s32 offen offset:128 nt lds
    v_mfma_f32_16x16x32_bf16 v[68:71], a[236:239], v[180:183], v[68:71]
    v_exp_f32 v74, v74
    v_mfma_f32_16x16x32_bf16 v[76:79], a[216:219], v[184:187], v[52:55]
    ds_read_b128 a[204:207], v3 offset:13312
    v_add_f32 v17, v17, v74
    v_mfma_f32_16x16x32_bf16 v[76:79], a[220:223], v[188:191], v[76:79]
    v_exp_f32 v75, v75
    v_mfma_f32_16x16x32_bf16 v[76:79], a[224:227], v[192:195], v[76:79]
    ds_read_b128 a[208:211], v2 offset:14336
    v_cvt_pk_bf16_f32 v101, v74, v75
    v_mfma_f32_16x16x32_bf16 v[76:79], a[228:231], v[196:199], v[76:79]
    ds_read_b64_tr_b16 a[248:249], v6 offset:24576
    v_add_f32 v17, v17, v75
    v_mfma_f32_16x16x32_bf16 v[76:79], a[232:235], v[200:203], v[76:79]
    v_exp_f32 v80, v80
    v_mfma_f32_16x16x32_bf16 v[76:79], a[236:239], v[204:207], v[76:79]
    s_add_u32 m0, s33, 63232
    v_exp_f32 v81, v81
    v_mfma_f32_16x16x32_bf16 v[84:87], a[216:219], v[208:211], v[56:59]
    buffer_load_dwordx4 v9, s[20:23], s32 offen offset:256 nt lds
    v_mfma_f32_16x16x32_bf16 v[84:87], a[220:223], v[212:215], v[84:87]
    s_add_u32 s30, s30, 24576
    ds_read_b128 a[212:215], v3 offset:14336
    v_cvt_pk_bf16_f32 v104, v80, v81
    v_mfma_f32_16x16x32_bf16 v[84:87], a[224:227], v[216:219], v[84:87]
    s_add_u32 s32, s32, 24576
    ds_read_b64_tr_b16 a[250:251], v6 offset:30720
    v_add_f32 v18, v80, v81
    v_mfma_f32_16x16x32_bf16 v[84:87], a[228:231], v[220:223], v[84:87]
    v_exp_f32 v82, v82
    v_mfma_f32_16x16x32_bf16 v[84:87], a[232:235], v[224:227], v[84:87]
    ds_read_b64_tr_b16 a[252:253], v6 offset:36864
    v_add_f32 v18, v18, v82
    v_mfma_f32_16x16x32_bf16 v[84:87], a[236:239], v[228:231], v[84:87]
    v_exp_f32 v83, v83
    v_mfma_f32_16x16x32_bf16 v[92:95], a[216:219], v[232:235], v[60:63]
    ds_read_b128 a[216:219], v2 offset:18432
    v_cvt_pk_bf16_f32 v105, v82, v83
    v_mfma_f32_16x16x32_bf16 v[92:95], a[220:223], v[236:239], v[92:95]
    s_add_u32 m0, s33, 0
    ds_read_b64_tr_b16 a[254:255], v6 offset:43008
    v_add_f32 v18, v18, v83
    v_mfma_f32_16x16x32_bf16 v[92:95], a[224:227], v[240:243], v[92:95]
    buffer_load_dwordx4 v8, s[16:19], s29 offen nt lds
    v_mfma_f32_16x16x32_bf16 v[92:95], a[228:231], v[244:247], v[92:95]
    v_exp_f32 v68, v68
    v_mfma_f32_16x16x32_bf16 v[92:95], a[232:235], v[248:251], v[92:95]
    ds_read_b128 a[220:223], v3 offset:18432
    v_add_f32 v16, v16, v68
    v_mfma_f32_16x16x32_bf16 v[92:95], a[236:239], v[252:255], v[92:95]
    s_waitcnt lgkmcnt(3)
    v_exp_f32 v69, v69
    v_mfma_f32_16x16x32_bf16 a[144:147], v[152:155], v[136:139], a[144:147]
    ds_read_b128 a[224:227], v2 offset:19456
    v_cvt_pk_bf16_f32 v98, v68, v69
    v_mfma_f32_16x16x32_bf16 a[0:3], v[152:155], v[124:127], a[0:3]
    v_exp_f32 v70, v70
    v_mfma_f32_16x16x32_bf16 a[0:3], v[156:159], v[140:143], a[0:3]
    ds_read_b128 a[228:231], v3 offset:19456
    v_add_f32 v16, v16, v69
    v_mfma_f32_16x16x32_bf16 a[48:51], v[152:155], v[128:131], a[48:51]
    s_add_u32 m0, s33, 896
    v_exp_f32 v71, v71
    v_mfma_f32_16x16x32_bf16 a[48:51], v[156:159], v[144:147], a[48:51]
    buffer_load_dwordx4 v8, s[16:19], s29 offen offset:128 nt lds
    v_mfma_f32_16x16x32_bf16 a[96:99], v[152:155], v[132:135], a[96:99]
    ds_read_b64_tr_b16 v[152:153], v7 offset:24576
    v_cvt_pk_bf16_f32 v99, v70, v71
    v_mfma_f32_16x16x32_bf16 a[96:99], v[156:159], v[148:151], a[96:99]
    ds_read_b64_tr_b16 v[154:155], v7 offset:30720
    v_add_f32 v16, v16, v70
    v_mfma_f32_16x16x32_bf16 a[148:151], a[240:243], v[136:139], a[148:151]
    ds_read_b128 a[232:235], v2 offset:20480
    v_add_f32 v16, v16, v71
    v_mfma_f32_16x16x32_bf16 a[4:7], a[240:243], v[124:127], a[4:7]
    v_exp_f32 v76, v76
    v_mfma_f32_16x16x32_bf16 a[4:7], a[244:247], v[140:143], a[4:7]
    ds_read_b64_tr_b16 v[156:157], v7 offset:36864
    v_add_f32 v17, v17, v76
    v_mfma_f32_16x16x32_bf16 a[52:55], a[240:243], v[128:131], a[52:55]
    v_exp_f32 v77, v77
    v_mfma_f32_16x16x32_bf16 a[52:55], a[244:247], v[144:147], a[52:55]
    s_add_u32 m0, s33, 1792
    ds_read_b64_tr_b16 v[158:159], v7 offset:43008
    v_cvt_pk_bf16_f32 v102, v76, v77
    v_mfma_f32_16x16x32_bf16 a[100:103], a[240:243], v[132:135], a[100:103]
    buffer_load_dwordx4 v8, s[16:19], s29 offen offset:256 nt lds
    v_mfma_f32_16x16x32_bf16 a[100:103], a[244:247], v[148:151], a[100:103]
    s_add_u32 s29, s29, 12288
    ds_read_b128 a[236:239], v3 offset:20480
    v_add_f32 v17, v17, v77
    v_mfma_f32_16x16x32_bf16 a[152:155], a[248:251], v[136:139], a[152:155]
    v_exp_f32 v78, v78
    v_mfma_f32_16x16x32_bf16 a[8:11], a[248:251], v[124:127], a[8:11]
    s_waitcnt vmcnt(12) lgkmcnt(3)
    ds_inc_u32 v46, v46
    v_add_f32 v17, v17, v78
    v_mfma_f32_16x16x32_bf16 a[8:11], a[252:255], v[140:143], a[8:11]
    v_exp_f32 v79, v79
    v_mfma_f32_16x16x32_bf16 a[56:59], a[248:251], v[128:131], a[56:59]
    v_cvt_pk_bf16_f32 v103, v78, v79
    v_add_f32 v17, v17, v79
    v_mfma_f32_16x16x32_bf16 a[56:59], a[252:255], v[144:147], a[56:59]
    v_exp_f32 v84, v84
    v_mfma_f32_16x16x32_bf16 a[104:107], a[248:251], v[132:135], a[104:107]
    v_exp_f32 v85, v85
    v_mfma_f32_16x16x32_bf16 a[104:107], a[252:255], v[148:151], a[104:107]
    v_exp_f32 v86, v86
    v_mfma_f32_16x16x32_bf16 a[156:159], v[152:155], v[136:139], a[156:159]
    v_exp_f32 v87, v87
    v_mfma_f32_16x16x32_bf16 a[12:15], v[152:155], v[124:127], a[12:15]
    s_waitcnt lgkmcnt(0)
    v_cvt_pk_bf16_f32 v106, v84, v85
    v_cvt_pk_bf16_f32 v107, v86, v87
    v_mfma_f32_16x16x32_bf16 a[12:15], v[156:159], v[140:143], a[12:15]
    v_add_f32 v18, v18, v84
    v_add_f32 v18, v18, v85
    v_mfma_f32_16x16x32_bf16 a[60:63], v[152:155], v[128:131], a[60:63]
    v_add_f32 v18, v18, v86
    v_add_f32 v18, v18, v87
    v_mfma_f32_16x16x32_bf16 a[60:63], v[156:159], v[144:147], a[60:63]
    v_exp_f32 v88, v88
    v_mfma_f32_16x16x32_bf16 a[108:111], v[152:155], v[132:135], a[108:111]
    v_exp_f32 v89, v89
    v_mfma_f32_16x16x32_bf16 a[108:111], v[156:159], v[148:151], a[108:111]
    v_exp_f32 v90, v90
    v_mfma_f32_16x16x32_bf16 v[64:67], a[192:195], v[160:163], v[48:51]
    v_exp_f32 v91, v91
    v_mfma_f32_16x16x32_bf16 v[64:67], a[196:199], v[164:167], v[64:67]
    ds_read_b32 v30, v46
    v_cvt_pk_bf16_f32 v108, v88, v89
    v_mfma_f32_16x16x32_bf16 v[64:67], a[200:203], v[168:171], v[64:67]
    v_exp_f32 v92, v92
    v_mfma_f32_16x16x32_bf16 v[64:67], a[204:207], v[172:175], v[64:67]
    v_exp_f32 v93, v93
    v_mfma_f32_16x16x32_bf16 v[64:67], a[208:211], v[176:179], v[64:67]
    v_exp_f32 v94, v94
    v_mfma_f32_16x16x32_bf16 v[64:67], a[212:215], v[180:183], v[64:67]
    v_exp_f32 v95, v95
    v_mfma_f32_16x16x32_bf16 v[72:75], a[192:195], v[184:187], v[52:55]
    v_cvt_pk_bf16_f32 v109, v90, v91
    v_cvt_pk_bf16_f32 v110, v92, v93
    v_mfma_f32_16x16x32_bf16 v[72:75], a[196:199], v[188:191], v[72:75]
    v_cvt_pk_bf16_f32 v111, v94, v95
    v_add_f32 v22, v88, v89
    v_mfma_f32_16x16x32_bf16 v[72:75], a[200:203], v[192:195], v[72:75]
    s_waitcnt lgkmcnt(0)
    v_cmp_gt_u32 vcc, s93, v30
    v_add_f32 v22, v22, v90
    v_mfma_f32_16x16x32_bf16 v[72:75], a[204:207], v[196:199], v[72:75]
    v_exp_f32 v64, v64
    v_mfma_f32_16x16x32_bf16 v[72:75], a[208:211], v[200:203], v[72:75]
    s_add_u32 m0, s33, 73728
    v_exp_f32 v65, v65
    v_mfma_f32_16x16x32_bf16 v[72:75], a[212:215], v[204:207], v[72:75]
    s_cbranch_vccnz L_b01_4s_rare
L_b01_4s_back:
    ds_read_b64_tr_b16 a[240:241], v4 offset:25600
    v_cvt_pk_bf16_f32 v112, v64, v65
    v_mfma_f32_16x16x32_bf16 v[80:83], a[192:195], v[208:211], v[56:59]
    s_add_u32 s93, s93, 4
    buffer_load_dwordx4 v9, s[20:23], s30 offen nt lds
    v_mfma_f32_16x16x32_bf16 v[80:83], a[196:199], v[212:215], v[80:83]
    ds_read_b64_tr_b16 a[242:243], v4 offset:31744
    v_add_f32 v16, v16, v64
    v_mfma_f32_16x16x32_bf16 v[80:83], a[200:203], v[216:219], v[80:83]
    ds_read_b64_tr_b16 a[244:245], v4 offset:37888
    v_add_f32 v16, v16, v65
    v_mfma_f32_16x16x32_bf16 v[80:83], a[204:207], v[220:223], v[80:83]
    ds_read_b64_tr_b16 a[246:247], v4 offset:44032
    v_add_f32 v22, v22, v91
    v_mfma_f32_16x16x32_bf16 v[80:83], a[208:211], v[224:227], v[80:83]
    ds_read_b64_tr_b16 a[248:249], v5 offset:25600
    v_add_f32 v22, v22, v92
    v_mfma_f32_16x16x32_bf16 v[80:83], a[212:215], v[228:231], v[80:83]
    ds_read_b64_tr_b16 a[250:251], v5 offset:31744
    v_add_f32 v22, v22, v93
    v_mfma_f32_16x16x32_bf16 v[68:71], a[216:219], v[160:163], v[48:51]
    ds_read_b64_tr_b16 a[252:253], v5 offset:37888
    v_add_f32 v22, v22, v94
    v_mfma_f32_16x16x32_bf16 v[68:71], a[220:223], v[164:167], v[68:71]
    ds_read_b64_tr_b16 a[254:255], v5 offset:44032
    v_add_f32 v22, v22, v95
    v_mfma_f32_16x16x32_bf16 v[68:71], a[224:227], v[168:171], v[68:71]
    v_exp_f32 v66, v66
    v_mfma_f32_16x16x32_bf16 v[68:71], a[228:231], v[172:175], v[68:71]
    s_add_u32 m0, s33, 86016
    ds_read_b64_tr_b16 v[152:153], v6 offset:25600
    v_add_f32 v16, v16, v66
    v_mfma_f32_16x16x32_bf16 v[68:71], a[232:235], v[176:179], v[68:71]
    buffer_load_dwordx4 v9, s[20:23], s32 offen nt lds
    v_mfma_f32_16x16x32_bf16 v[68:71], a[236:239], v[180:183], v[68:71]
    v_exp_f32 v67, v67
    v_mfma_f32_16x16x32_bf16 v[76:79], a[216:219], v[184:187], v[52:55]
    ds_read_b64_tr_b16 v[154:155], v6 offset:31744
    v_cvt_pk_bf16_f32 v113, v66, v67
    v_mfma_f32_16x16x32_bf16 v[76:79], a[220:223], v[188:191], v[76:79]
    ds_read_b64_tr_b16 v[156:157], v6 offset:37888
    v_add_f32 v16, v16, v67
    v_mfma_f32_16x16x32_bf16 v[76:79], a[224:227], v[192:195], v[76:79]
    v_exp_f32 v72, v72
    v_mfma_f32_16x16x32_bf16 v[76:79], a[228:231], v[196:199], v[76:79]
    ds_read_b64_tr_b16 v[158:159], v6 offset:44032
    v_add_f32 v17, v17, v72
    v_mfma_f32_16x16x32_bf16 v[76:79], a[232:235], v[200:203], v[76:79]
    v_exp_f32 v73, v73
    v_mfma_f32_16x16x32_bf16 v[76:79], a[236:239], v[204:207], v[76:79]
    ds_read_b128 a[192:195], v2 offset:24576
    v_cvt_pk_bf16_f32 v116, v72, v73
    v_mfma_f32_16x16x32_bf16 v[84:87], a[216:219], v[208:211], v[56:59]
    v_exp_f32 v74, v74
    v_mfma_f32_16x16x32_bf16 v[84:87], a[220:223], v[212:215], v[84:87]
    s_add_u32 m0, s33, 12288
    ds_read_b128 a[196:199], v3 offset:24576
    v_add_f32 v17, v17, v73
    v_mfma_f32_16x16x32_bf16 v[84:87], a[224:227], v[216:219], v[84:87]
    buffer_load_dwordx4 v8, s[16:19], s29 offen nt lds
    v_mfma_f32_16x16x32_bf16 v[84:87], a[228:231], v[220:223], v[84:87]
    ds_read_b128 a[200:203], v2 offset:25600
    v_add_f32 v17, v17, v74
    v_mfma_f32_16x16x32_bf16 v[84:87], a[232:235], v[224:227], v[84:87]
    v_exp_f32 v75, v75
    v_mfma_f32_16x16x32_bf16 v[84:87], a[236:239], v[228:231], v[84:87]
    s_waitcnt lgkmcnt(3)
    ds_read_b128 a[204:207], v3 offset:25600
    v_cvt_pk_bf16_f32 v117, v74, v75
    v_mfma_f32_16x16x32_bf16 a[160:163], a[240:243], v[136:139], a[160:163]
    v_exp_f32 v68, v68
    v_mfma_f32_16x16x32_bf16 a[16:19], a[240:243], v[124:127], a[16:19]
    ds_read_b128 a[208:211], v2 offset:26624
    v_add_f32 v17, v17, v75
    v_mfma_f32_16x16x32_bf16 a[16:19], a[244:247], v[140:143], a[16:19]
    v_exp_f32 v69, v69
    v_mfma_f32_16x16x32_bf16 a[64:67], a[240:243], v[128:131], a[64:67]
    ds_read_b128 a[212:215], v3 offset:26624
    v_cvt_pk_bf16_f32 v114, v68, v69
    v_mfma_f32_16x16x32_bf16 a[64:67], a[244:247], v[144:147], a[64:67]
    v_exp_f32 v70, v70
    v_mfma_f32_16x16x32_bf16 a[112:115], a[240:243], v[132:135], a[112:115]
    s_add_u32 m0, s33, 13184
    ds_read_b64_tr_b16 a[240:241], v7 offset:25600
    v_add_f32 v16, v16, v68
    v_mfma_f32_16x16x32_bf16 a[112:115], a[244:247], v[148:151], a[112:115]
    buffer_load_dwordx4 v8, s[16:19], s29 offen offset:128 nt lds
    v_mfma_f32_16x16x32_bf16 a[164:167], a[248:251], v[136:139], a[164:167]
    ds_read_b64_tr_b16 a[242:243], v7 offset:31744
    v_add_f32 v16, v16, v69
    v_mfma_f32_16x16x32_bf16 a[20:23], a[248:251], v[124:127], a[20:23]
    ds_read_b64_tr_b16 a[244:245], v7 offset:37888
    v_add_f32 v16, v16, v70
    v_mfma_f32_16x16x32_bf16 a[20:23], a[252:255], v[140:143], a[20:23]
    v_exp_f32 v71, v71
    v_mfma_f32_16x16x32_bf16 a[68:71], a[248:251], v[128:131], a[68:71]
    ds_read_b64_tr_b16 a[246:247], v7 offset:44032
    v_cvt_pk_bf16_f32 v115, v70, v71
    v_mfma_f32_16x16x32_bf16 a[68:71], a[252:255], v[144:147], a[68:71]
    ds_read_b128 a[216:219], v2 offset:30720
    v_add_f32 v16, v16, v71
    v_mfma_f32_16x16x32_bf16 a[116:119], a[248:251], v[132:135], a[116:119]
    v_exp_f32 v76, v76
    v_mfma_f32_16x16x32_bf16 a[116:119], a[252:255], v[148:151], a[116:119]
    ds_read_b64_tr_b16 a[248:249], v4 offset:26624
    v_add_f32 v17, v17, v76
    v_mfma_f32_16x16x32_bf16 a[168:171], v[152:155], v[136:139], a[168:171]
    v_exp_f32 v77, v77
    v_mfma_f32_16x16x32_bf16 a[24:27], v[152:155], v[124:127], a[24:27]
    s_add_u32 m0, s33, 14080
    ds_read_b64_tr_b16 a[250:251], v4 offset:32768
    v_cvt_pk_bf16_f32 v118, v76, v77
    v_mfma_f32_16x16x32_bf16 a[24:27], v[156:159], v[140:143], a[24:27]
    buffer_load_dwordx4 v8, s[16:19], s29 offen offset:256 nt lds
    v_mfma_f32_16x16x32_bf16 a[72:75], v[152:155], v[128:131], a[72:75]
    s_add_u32 s29, s29, 12288
    ds_read_b64_tr_b16 a[252:253], v4 offset:38912
    v_add_f32 v17, v17, v77
    v_mfma_f32_16x16x32_bf16 a[72:75], v[156:159], v[144:147], a[72:75]
    ds_read_b64_tr_b16 a[254:255], v4 offset:45056
    v_add_u32 v47, s91, v47
    v_mfma_f32_16x16x32_bf16 a[120:123], v[152:155], v[132:135], a[120:123]
    v_exp_f32 v78, v78
    v_mfma_f32_16x16x32_bf16 a[120:123], v[156:159], v[148:151], a[120:123]
    s_waitcnt lgkmcnt(3)
    ds_read_b64_tr_b16 v[152:153], v5 offset:26624
    v_add_f32 v17, v17, v78
    v_mfma_f32_16x16x32_bf16 a[172:175], a[240:243], v[136:139], a[172:175]
    v_exp_f32 v79, v79
    v_mfma_f32_16x16x32_bf16 a[28:31], a[240:243], v[124:127], a[28:31]
    ds_read_b64_tr_b16 v[154:155], v5 offset:32768
    v_cvt_pk_bf16_f32 v119, v78, v79
    v_mfma_f32_16x16x32_bf16 a[28:31], a[244:247], v[140:143], a[28:31]
    ds_read_b64_tr_b16 v[156:157], v5 offset:38912
    v_add_f32 v17, v17, v79
    v_mfma_f32_16x16x32_bf16 a[76:79], a[240:243], v[128:131], a[76:79]
    v_exp_f32 v80, v80
    v_mfma_f32_16x16x32_bf16 a[76:79], a[244:247], v[144:147], a[76:79]
    ds_read_b64_tr_b16 v[158:159], v5 offset:45056
    v_add_f32 v18, v18, v80
    v_mfma_f32_16x16x32_bf16 a[124:127], a[240:243], v[132:135], a[124:127]
    v_exp_f32 v81, v81
    v_mfma_f32_16x16x32_bf16 a[124:127], a[244:247], v[148:151], a[124:127]
    s_waitcnt lgkmcnt(3)
    ds_read_b128 a[220:223], v3 offset:30720
    v_cvt_pk_bf16_f32 v120, v80, v81
    v_mfma_f32_16x16x32_bf16 a[176:179], a[248:251], v[136:139], a[176:179]
    ds_read_b64_tr_b16 a[240:241], v6 offset:26624
    v_add_f32 v18, v18, v81
    v_mfma_f32_16x16x32_bf16 a[32:35], a[248:251], v[124:127], a[32:35]
    v_exp_f32 v82, v82
    v_mfma_f32_16x16x32_bf16 a[32:35], a[252:255], v[140:143], a[32:35]
    ds_read_b64_tr_b16 a[242:243], v6 offset:32768
    v_add_f32 v18, v18, v82
    v_mfma_f32_16x16x32_bf16 a[80:83], a[248:251], v[128:131], a[80:83]
    v_exp_f32 v83, v83
    v_mfma_f32_16x16x32_bf16 a[80:83], a[252:255], v[144:147], a[80:83]
    ds_read_b64_tr_b16 a[244:245], v6 offset:38912
    v_cvt_pk_bf16_f32 v121, v82, v83
    v_mfma_f32_16x16x32_bf16 a[128:131], a[248:251], v[132:135], a[128:131]
    ds_read_b64_tr_b16 a[246:247], v6 offset:45056
    v_add_f32 v18, v18, v83
    v_mfma_f32_16x16x32_bf16 a[128:131], a[252:255], v[148:151], a[128:131]
    s_waitcnt lgkmcnt(4)
    ds_read_b128 a[224:227], v2 offset:31744
    v_mfma_f32_16x16x32_bf16 a[180:183], v[152:155], v[136:139], a[180:183]
    v_exp_f32 v84, v84
    v_mfma_f32_16x16x32_bf16 a[36:39], v[152:155], v[124:127], a[36:39]
    ds_read_b128 a[228:231], v3 offset:31744
    v_add_f32 v18, v18, v84
    v_mfma_f32_16x16x32_bf16 a[36:39], v[156:159], v[140:143], a[36:39]
    ds_read_b64_tr_b16 a[248:249], v7 offset:26624
    ds_read_b64_tr_b16 a[250:251], v7 offset:32768
    v_mfma_f32_16x16x32_bf16 a[84:87], v[152:155], v[128:131], a[84:87]
    ds_read_b128 a[232:235], v2 offset:32768
    v_mfma_f32_16x16x32_bf16 a[84:87], v[156:159], v[144:147], a[84:87]
    ds_read_b64_tr_b16 a[252:253], v7 offset:38912
    ds_read_b64_tr_b16 a[254:255], v7 offset:45056
    v_mfma_f32_16x16x32_bf16 a[132:135], v[152:155], v[132:135], a[132:135]
    v_exp_f32 v85, v85
    v_mfma_f32_16x16x32_bf16 a[132:135], v[156:159], v[148:151], a[132:135]
    s_waitcnt lgkmcnt(6)
    ds_read_b128 a[236:239], v3 offset:32768
    v_cvt_pk_bf16_f32 v122, v84, v85
    v_mfma_f32_16x16x32_bf16 a[184:187], a[240:243], v[136:139], a[184:187]
    v_exp_f32 v86, v86
    v_mfma_f32_16x16x32_bf16 a[40:43], a[240:243], v[124:127], a[40:43]
    s_waitcnt vmcnt(12)
    ds_inc_u32 v46, v46
    v_add_f32 v18, v18, v85
    v_mfma_f32_16x16x32_bf16 a[40:43], a[244:247], v[140:143], a[40:43]
    v_exp_f32 v87, v87
    v_mfma_f32_16x16x32_bf16 a[88:91], a[240:243], v[128:131], a[88:91]
    v_cvt_pk_bf16_f32 v123, v86, v87
    v_add_f32 v18, v18, v86
    v_mfma_f32_16x16x32_bf16 a[88:91], a[244:247], v[144:147], a[88:91]
    v_add_f32 v18, v18, v87
    v_max3_f32 v28, v16, v17, v18
    v_mfma_f32_16x16x32_bf16 a[136:139], a[240:243], v[132:135], a[136:139]
    v_max_f32 v28, v28, v22
    v_mfma_f32_16x16x32_bf16 a[136:139], a[244:247], v[148:151], a[136:139]
    s_waitcnt lgkmcnt(1)
    buffer_store_dwordx4 v[32:35], v23, s[80:83], s84 offen nt
    v_mfma_f32_16x16x32_bf16 a[188:191], a[248:251], v[136:139], a[188:191]
    v_mfma_f32_16x16x32_bf16 a[44:47], a[248:251], v[124:127], a[44:47]
    v_mfma_f32_16x16x32_bf16 a[44:47], a[252:255], v[140:143], a[44:47]
    v_mfma_f32_16x16x32_bf16 a[92:95], a[248:251], v[128:131], a[92:95]
    v_mfma_f32_16x16x32_bf16 a[92:95], a[252:255], v[144:147], a[92:95]
    v_mfma_f32_16x16x32_bf16 a[140:143], a[248:251], v[132:135], a[140:143]
    v_mfma_f32_16x16x32_bf16 a[140:143], a[252:255], v[148:151], a[140:143]
    v_mfma_f32_16x16x32_bf16 v[64:67], a[192:195], v[160:163], v[48:51]
    v_mfma_f32_16x16x32_bf16 v[64:67], a[196:199], v[164:167], v[64:67]
    ds_read_b32 v30, v46
    v_mfma_f32_16x16x32_bf16 v[64:67], a[200:203], v[168:171], v[64:67]
    buffer_store_dwordx4 v[36:39], v23, s[80:83], s84 offen offset:128 nt
    v_mfma_f32_16x16x32_bf16 v[64:67], a[204:207], v[172:175], v[64:67]
    v_mfma_f32_16x16x32_bf16 v[64:67], a[208:211], v[176:179], v[64:67]
    v_mfma_f32_16x16x32_bf16 v[64:67], a[212:215], v[180:183], v[64:67]
    v_mfma_f32_16x16x32_bf16 v[72:75], a[192:195], v[184:187], v[52:55]
    v_mfma_f32_16x16x32_bf16 v[72:75], a[196:199], v[188:191], v[72:75]
    v_cmp_lt_f32 vcc, s35, v28
    v_mfma_f32_16x16x32_bf16 v[72:75], a[200:203], v[192:195], v[72:75]
    s_waitcnt lgkmcnt(0)
    v_cmp_gt_u32 s[94:95], s93, v30
    v_mfma_f32_16x16x32_bf16 v[72:75], a[204:207], v[196:199], v[72:75]
    s_add_u32 m0, s33, 74624
    s_nop 0
    v_exp_f32 v64, v64
    v_mfma_f32_16x16x32_bf16 v[72:75], a[208:211], v[200:203], v[72:75]
    s_or_b64 vcc, vcc, s[94:95]
    v_exp_f32 v65, v65
    v_mfma_f32_16x16x32_bf16 v[72:75], a[212:215], v[204:207], v[72:75]
    s_cbranch_vccnz L_b01_5cs_rare
L_b01_5cs_back:
    ds_read_b64_tr_b16 v[152:153], v4
    v_cvt_pk_bf16_f32 v124, v64, v65
    v_mfma_f32_16x16x32_bf16 v[80:83], a[192:195], v[208:211], v[56:59]
    s_add_u32 s93, s93, 4
    buffer_load_dwordx4 v9, s[20:23], s30 offen offset:128 nt lds
    v_mfma_f32_16x16x32_bf16 v[80:83], a[196:199], v[212:215], v[80:83]
    ds_read_b64_tr_b16 v[154:155], v4 offset:6144
    v_add_f32 v12, v12, v16
    v_mfma_f32_16x16x32_bf16 v[80:83], a[200:203], v[216:219], v[80:83]
    ds_read_b64_tr_b16 v[156:157], v4 offset:12288
    v_add_f32 v13, v13, v17
    v_mfma_f32_16x16x32_bf16 v[80:83], a[204:207], v[220:223], v[80:83]
    ds_read_b64_tr_b16 v[158:159], v4 offset:18432
    v_add_f32 v14, v14, v18
    v_mfma_f32_16x16x32_bf16 v[80:83], a[208:211], v[224:227], v[80:83]
    ds_read_b64_tr_b16 a[240:241], v5
    v_add_f32 v15, v15, v22
    v_mfma_f32_16x16x32_bf16 v[80:83], a[212:215], v[228:231], v[80:83]
    ds_read_b64_tr_b16 a[242:243], v5 offset:6144
    v_add_f32 v19, v64, v65
    v_mfma_f32_16x16x32_bf16 v[88:91], a[192:195], v[232:235], v[60:63]
    v_exp_f32 v66, v66
    v_mfma_f32_16x16x32_bf16 v[88:91], a[196:199], v[236:239], v[88:91]
    s_add_u32 m0, s33, 75520
    ds_read_b128 a[192:195], v2 offset:36864
    v_add_f32 v19, v19, v66
    v_mfma_f32_16x16x32_bf16 v[88:91], a[200:203], v[240:243], v[88:91]
    buffer_load_dwordx4 v9, s[20:23], s30 offen offset:256 nt lds
    v_mfma_f32_16x16x32_bf16 v[88:91], a[204:207], v[244:247], v[88:91]
    v_exp_f32 v67, v67
    v_mfma_f32_16x16x32_bf16 v[88:91], a[208:211], v[248:251], v[88:91]
    ds_read_b128 a[196:199], v3 offset:36864
    v_cvt_pk_bf16_f32 v125, v66, v67
    v_mfma_f32_16x16x32_bf16 v[88:91], a[212:215], v[252:255], v[88:91]
    ds_read_b64_tr_b16 a[244:245], v5 offset:12288
    v_add_f32 v19, v19, v67
    v_mfma_f32_16x16x32_bf16 v[68:71], a[216:219], v[160:163], v[48:51]
    v_exp_f32 v72, v72
    v_mfma_f32_16x16x32_bf16 v[68:71], a[220:223], v[164:167], v[68:71]
    v_exp_f32 v73, v73
    v_mfma_f32_16x16x32_bf16 v[68:71], a[224:227], v[168:171], v[68:71]
    ds_read_b128 a[200:203], v2 offset:37888
    v_cvt_pk_bf16_f32 v128, v72, v73
    v_mfma_f32_16x16x32_bf16 v[68:71], a[228:231], v[172:175], v[68:71]
    s_add_u32 m0, s33, 86912
    ds_read_b64_tr_b16 a[246:247], v5 offset:18432
    v_add_f32 v20, v72, v73
    v_mfma_f32_16x16x32_bf16 v[68:71], a[232:235], v[176:179], v[68:71]
    buffer_load_dwordx4 v9, s[20:23], s32 offen offset:128 nt lds
    v_mfma_f32_16x16x32_bf16 v[68:71], a[236:239], v[180:183], v[68:71]
    v_exp_f32 v74, v74
    v_mfma_f32_16x16x32_bf16 v[76:79], a[216:219], v[184:187], v[52:55]
    ds_read_b128 a[204:207], v3 offset:37888
    v_add_f32 v20, v20, v74
    v_mfma_f32_16x16x32_bf16 v[76:79], a[220:223], v[188:191], v[76:79]
    v_exp_f32 v75, v75
    v_mfma_f32_16x16x32_bf16 v[76:79], a[224:227], v[192:195], v[76:79]
    ds_read_b128 a[208:211], v2 offset:38912
    v_cvt_pk_bf16_f32 v129, v74, v75
    v_mfma_f32_16x16x32_bf16 v[76:79], a[228:231], v[196:199], v[76:79]
    ds_read_b64_tr_b16 a[248:249], v6
    v_add_f32 v20, v20, v75
    v_mfma_f32_16x16x32_bf16 v[76:79], a[232:235], v[200:203], v[76:79]
    v_exp_f32 v80, v80
    v_mfma_f32_16x16x32_bf16 v[76:79], a[236:239], v[204:207], v[76:79]
    s_add_u32 m0, s33, 87808
    v_exp_f32 v81, v81
    v_mfma_f32_16x16x32_bf16 v[84:87], a[216:219], v[208:211], v[56:59]
    buffer_load_dwordx4 v9, s[20:23], s32 offen offset:256 nt lds
    v_mfma_f32_16x16x32_bf16 v[84:87], a[220:223], v[212:215], v[84:87]
    s_add_u32 s30, s30, 24576
    ds_read_b128 a[212:215], v3 offset:38912
    v_cvt_pk_bf16_f32 v132, v80, v81
    v_mfma_f32_16x16x32_bf16 v[84:87], a[224:227], v[216:219], v[84:87]
    s_add_u32 s32, s32, 24576
    ds_read_b64_tr_b16 a[250:251], v6 offset:6144
    v_add_f32 v21, v80, v81
    v_mfma_f32_16x16x32_bf16 v[84:87], a[228:231], v[220:223], v[84:87]
    v_exp_f32 v82, v82
    v_mfma_f32_16x16x32_bf16 v[84:87], a[232:235], v[224:227], v[84:87]
    ds_read_b64_tr_b16 a[252:253], v6 offset:12288
    v_add_f32 v21, v21, v82
    v_mfma_f32_16x16x32_bf16 v[84:87], a[236:239], v[228:231], v[84:87]
    v_exp_f32 v83, v83
    v_mfma_f32_16x16x32_bf16 v[92:95], a[216:219], v[232:235], v[60:63]
    ds_read_b128 a[216:219], v2 offset:43008
    v_cvt_pk_bf16_f32 v133, v82, v83
    v_mfma_f32_16x16x32_bf16 v[92:95], a[220:223], v[236:239], v[92:95]
    s_add_u32 m0, s33, 24576
    ds_read_b64_tr_b16 a[254:255], v6 offset:18432
    v_add_f32 v21, v21, v83
    v_mfma_f32_16x16x32_bf16 v[92:95], a[224:227], v[240:243], v[92:95]
    buffer_load_dwordx4 v8, s[16:19], s29 offen nt lds
    v_mfma_f32_16x16x32_bf16 v[92:95], a[228:231], v[244:247], v[92:95]
    v_exp_f32 v68, v68
    v_mfma_f32_16x16x32_bf16 v[92:95], a[232:235], v[248:251], v[92:95]
    ds_read_b128 a[220:223], v3 offset:43008
    v_add_f32 v19, v19, v68
    v_mfma_f32_16x16x32_bf16 v[92:95], a[236:239], v[252:255], v[92:95]
    s_waitcnt lgkmcnt(3)
    v_exp_f32 v69, v69
    v_mfma_f32_16x16x32_bf16 a[144:147], v[152:155], v[108:111], a[144:147]
    ds_read_b128 a[224:227], v2 offset:44032
    v_cvt_pk_bf16_f32 v126, v68, v69
    v_mfma_f32_16x16x32_bf16 a[0:3], v[152:155], v[96:99], a[0:3]
    v_exp_f32 v70, v70
    v_mfma_f32_16x16x32_bf16 a[0:3], v[156:159], v[112:115], a[0:3]
    ds_read_b128 a[228:231], v3 offset:44032
    v_add_f32 v19, v19, v69
    v_mfma_f32_16x16x32_bf16 a[48:51], v[152:155], v[100:103], a[48:51]
    s_add_u32 m0, s33, 25472
    v_exp_f32 v71, v71
    v_mfma_f32_16x16x32_bf16 a[48:51], v[156:159], v[116:119], a[48:51]
    buffer_load_dwordx4 v8, s[16:19], s29 offen offset:128 nt lds
    v_mfma_f32_16x16x32_bf16 a[96:99], v[152:155], v[104:107], a[96:99]
    ds_read_b64_tr_b16 v[152:153], v7
    v_cvt_pk_bf16_f32 v127, v70, v71
    v_mfma_f32_16x16x32_bf16 a[96:99], v[156:159], v[120:123], a[96:99]
    ds_read_b64_tr_b16 v[154:155], v7 offset:6144
    v_add_f32 v19, v19, v70
    v_mfma_f32_16x16x32_bf16 a[148:151], a[240:243], v[108:111], a[148:151]
    ds_read_b128 a[232:235], v2 offset:45056
    v_add_f32 v19, v19, v71
    v_mfma_f32_16x16x32_bf16 a[4:7], a[240:243], v[96:99], a[4:7]
    v_exp_f32 v76, v76
    v_mfma_f32_16x16x32_bf16 a[4:7], a[244:247], v[112:115], a[4:7]
    ds_read_b64_tr_b16 v[156:157], v7 offset:12288
    v_add_f32 v20, v20, v76
    v_mfma_f32_16x16x32_bf16 a[52:55], a[240:243], v[100:103], a[52:55]
    v_exp_f32 v77, v77
    v_mfma_f32_16x16x32_bf16 a[52:55], a[244:247], v[116:119], a[52:55]
    s_add_u32 m0, s33, 26368
    ds_read_b64_tr_b16 v[158:159], v7 offset:18432
    v_cvt_pk_bf16_f32 v130, v76, v77
    v_mfma_f32_16x16x32_bf16 a[100:103], a[240:243], v[104:107], a[100:103]
    buffer_load_dwordx4 v8, s[16:19], s29 offen offset:256 nt lds
    v_mfma_f32_16x16x32_bf16 a[100:103], a[244:247], v[120:123], a[100:103]
    s_add_u32 s29, s29, 12288
    ds_read_b128 a[236:239], v3 offset:45056
    v_add_f32 v20, v20, v77
    v_mfma_f32_16x16x32_bf16 a[152:155], a[248:251], v[108:111], a[152:155]
    v_exp_f32 v78, v78
    v_mfma_f32_16x16x32_bf16 a[8:11], a[248:251], v[96:99], a[8:11]
    s_waitcnt vmcnt(14) lgkmcnt(3)
    ds_inc_u32 v46, v46
    v_add_f32 v20, v20, v78
    v_mfma_f32_16x16x32_bf16 a[8:11], a[252:255], v[112:115], a[8:11]
    v_exp_f32 v79, v79
    v_mfma_f32_16x16x32_bf16 a[56:59], a[248:251], v[100:103], a[56:59]
    v_cvt_pk_bf16_f32 v131, v78, v79
    v_add_f32 v20, v20, v79
    v_mfma_f32_16x16x32_bf16 a[56:59], a[252:255], v[116:119], a[56:59]
    v_exp_f32 v84, v84
    v_mfma_f32_16x16x32_bf16 a[104:107], a[248:251], v[104:107], a[104:107]
    v_exp_f32 v85, v85
    v_mfma_f32_16x16x32_bf16 a[104:107], a[252:255], v[120:123], a[104:107]
    v_exp_f32 v86, v86
    v_mfma_f32_16x16x32_bf16 a[156:159], v[152:155], v[108:111], a[156:159]
    v_exp_f32 v87, v87
    v_mfma_f32_16x16x32_bf16 a[12:15], v[152:155], v[96:99], a[12:15]
    s_waitcnt lgkmcnt(0)
    v_cvt_pk_bf16_f32 v134, v84, v85
    v_cvt_pk_bf16_f32 v135, v86, v87
    v_mfma_f32_16x16x32_bf16 a[12:15], v[156:159], v[112:115], a[12:15]
    v_add_f32 v21, v21, v84
    v_add_f32 v21, v21, v85
    v_mfma_f32_16x16x32_bf16 a[60:63], v[152:155], v[100:103], a[60:63]
    v_add_f32 v21, v21, v86
    v_add_f32 v21, v21, v87
    v_mfma_f32_16x16x32_bf16 a[60:63], v[156:159], v[116:119], a[60:63]
    v_exp_f32 v88, v88
    v_mfma_f32_16x16x32_bf16 a[108:111], v[152:155], v[104:107], a[108:111]
    v_exp_f32 v89, v89
    v_mfma_f32_16x16x32_bf16 a[108:111], v[156:159], v[120:123], a[108:111]
    v_exp_f32 v90, v90
    v_mfma_f32_16x16x32_bf16 v[64:67], a[192:195], v[160:163], v[48:51]
    v_exp_f32 v91, v91
    v_mfma_f32_16x16x32_bf16 v[64:67], a[196:199], v[164:167], v[64:67]
    ds_read_b32 v30, v46
    v_cvt_pk_bf16_f32 v136, v88, v89
    v_mfma_f32_16x16x32_bf16 v[64:67], a[200:203], v[168:171], v[64:67]
    v_exp_f32 v92, v92
    v_mfma_f32_16x16x32_bf16 v[64:67], a[204:207], v[172:175], v[64:67]
    v_exp_f32 v93, v93
    v_mfma_f32_16x16x32_bf16 v[64:67], a[208:211], v[176:179], v[64:67]
    v_exp_f32 v94, v94
    v_mfma_f32_16x16x32_bf16 v[64:67], a[212:215], v[180:183], v[64:67]
    v_exp_f32 v95, v95
    v_mfma_f32_16x16x32_bf16 v[72:75], a[192:195], v[184:187], v[52:55]
    v_cvt_pk_bf16_f32 v137, v90, v91
    v_cvt_pk_bf16_f32 v138, v92, v93
    v_mfma_f32_16x16x32_bf16 v[72:75], a[196:199], v[188:191], v[72:75]
    v_cvt_pk_bf16_f32 v139, v94, v95
    v_add_f32 v22, v88, v89
    v_mfma_f32_16x16x32_bf16 v[72:75], a[200:203], v[192:195], v[72:75]
    s_waitcnt lgkmcnt(0)
    v_cmp_gt_u32 vcc, s93, v30
    v_add_f32 v22, v22, v90
    v_mfma_f32_16x16x32_bf16 v[72:75], a[204:207], v[196:199], v[72:75]
    v_exp_f32 v64, v64
    v_mfma_f32_16x16x32_bf16 v[72:75], a[208:211], v[200:203], v[72:75]
    s_add_u32 m0, s33, 49152
    v_exp_f32 v65, v65
    v_mfma_f32_16x16x32_bf16 v[72:75], a[212:215], v[204:207], v[72:75]
    s_cbranch_vccnz L_b01_6s_rare
L_b01_6s_back:
    ds_read_b64_tr_b16 a[240:241], v4 offset:1024
    v_cvt_pk_bf16_f32 v140, v64, v65
    v_mfma_f32_16x16x32_bf16 v[80:83], a[192:195], v[208:211], v[56:59]
    s_add_u32 s93, s93, 4
    buffer_load_dwordx4 v9, s[20:23], s30 offen nt lds
    v_mfma_f32_16x16x32_bf16 v[80:83], a[196:199], v[212:215], v[80:83]
    ds_read_b64_tr_b16 a[242:243], v4 offset:7168
    v_add_f32 v19, v19, v64
    v_mfma_f32_16x16x32_bf16 v[80:83], a[200:203], v[216:219], v[80:83]
    ds_read_b64_tr_b16 a[244:245], v4 offset:13312
    v_add_f32 v19, v19, v65
    v_mfma_f32_16x16x32_bf16 v[80:83], a[204:207], v[220:223], v[80:83]
    ds_read_b64_tr_b16 a[246:247], v4 offset:19456
    v_add_f32 v22, v22, v91
    v_mfma_f32_16x16x32_bf16 v[80:83], a[208:211], v[224:227], v[80:83]
    ds_read_b64_tr_b16 a[248:249], v5 offset:1024
    v_add_f32 v22, v22, v92
    v_mfma_f32_16x16x32_bf16 v[80:83], a[212:215], v[228:231], v[80:83]
    ds_read_b64_tr_b16 a[250:251], v5 offset:7168
    v_add_f32 v22, v22, v93
    v_mfma_f32_16x16x32_bf16 v[68:71], a[216:219], v[160:163], v[48:51]
    ds_read_b64_tr_b16 a[252:253], v5 offset:13312
    v_add_f32 v22, v22, v94
    v_mfma_f32_16x16x32_bf16 v[68:71], a[220:223], v[164:167], v[68:71]
    ds_read_b64_tr_b16 a[254:255], v5 offset:19456
    v_add_f32 v22, v22, v95
    v_mfma_f32_16x16x32_bf16 v[68:71], a[224:227], v[168:171], v[68:71]
    v_exp_f32 v66, v66
    v_mfma_f32_16x16x32_bf16 v[68:71], a[228:231], v[172:175], v[68:71]
    s_add_u32 m0, s33, 61440
    ds_read_b64_tr_b16 v[152:153], v6 offset:1024
    v_add_f32 v19, v19, v66
    v_mfma_f32_16x16x32_bf16 v[68:71], a[232:235], v[176:179], v[68:71]
    buffer_load_dwordx4 v9, s[20:23], s32 offen nt lds
    v_mfma_f32_16x16x32_bf16 v[68:71], a[236:239], v[180:183], v[68:71]
    v_exp_f32 v67, v67
    v_mfma_f32_16x16x32_bf16 v[76:79], a[216:219], v[184:187], v[52:55]
    ds_read_b64_tr_b16 v[154:155], v6 offset:7168
    v_cvt_pk_bf16_f32 v141, v66, v67
    v_mfma_f32_16x16x32_bf16 v[76:79], a[220:223], v[188:191], v[76:79]
    ds_read_b64_tr_b16 v[156:157], v6 offset:13312
    v_add_f32 v19, v19, v67
    v_mfma_f32_16x16x32_bf16 v[76:79], a[224:227], v[192:195], v[76:79]
    v_exp_f32 v72, v72
    v_mfma_f32_16x16x32_bf16 v[76:79], a[228:231], v[196:199], v[76:79]
    ds_read_b64_tr_b16 v[158:159], v6 offset:19456
    v_add_f32 v20, v20, v72
    v_mfma_f32_16x16x32_bf16 v[76:79], a[232:235], v[200:203], v[76:79]
    v_exp_f32 v73, v73
    v_mfma_f32_16x16x32_bf16 v[76:79], a[236:239], v[204:207], v[76:79]
    ds_read_b128 a[192:195], v2
    v_cvt_pk_bf16_f32 v144, v72, v73
    v_mfma_f32_16x16x32_bf16 v[84:87], a[216:219], v[208:211], v[56:59]
    v_exp_f32 v74, v74
    v_mfma_f32_16x16x32_bf16 v[84:87], a[220:223], v[212:215], v[84:87]
    s_add_u32 m0, s33, 36864
    ds_read_b128 a[196:199], v3
    v_add_f32 v20, v20, v73
    v_mfma_f32_16x16x32_bf16 v[84:87], a[224:227], v[216:219], v[84:87]
    buffer_load_dwordx4 v8, s[16:19], s29 offen nt lds
    v_mfma_f32_16x16x32_bf16 v[84:87], a[228:231], v[220:223], v[84:87]
    ds_read_b128 a[200:203], v2 offset:1024
    v_add_f32 v20, v20, v74
    v_mfma_f32_16x16x32_bf16 v[84:87], a[232:235], v[224:227], v[84:87]
    v_exp_f32 v75, v75
    v_mfma_f32_16x16x32_bf16 v[84:87], a[236:239], v[228:231], v[84:87]
    s_waitcnt lgkmcnt(3)
    ds_read_b128 a[204:207], v3 offset:1024
    v_cvt_pk_bf16_f32 v145, v74, v75
    v_mfma_f32_16x16x32_bf16 a[160:163], a[240:243], v[108:111], a[160:163]
    v_exp_f32 v68, v68
    v_mfma_f32_16x16x32_bf16 a[16:19], a[240:243], v[96:99], a[16:19]
    ds_read_b128 a[208:211], v2 offset:2048
    v_add_f32 v20, v20, v75
    v_mfma_f32_16x16x32_bf16 a[16:19], a[244:247], v[112:115], a[16:19]
    v_exp_f32 v69, v69
    v_mfma_f32_16x16x32_bf16 a[64:67], a[240:243], v[100:103], a[64:67]
    ds_read_b128 a[212:215], v3 offset:2048
    v_cvt_pk_bf16_f32 v142, v68, v69
    v_mfma_f32_16x16x32_bf16 a[64:67], a[244:247], v[116:119], a[64:67]
    v_exp_f32 v70, v70
    v_mfma_f32_16x16x32_bf16 a[112:115], a[240:243], v[104:107], a[112:115]
    s_add_u32 m0, s33, 37760
    ds_read_b64_tr_b16 a[240:241], v7 offset:1024
    v_add_f32 v19, v19, v68
    v_mfma_f32_16x16x32_bf16 a[112:115], a[244:247], v[120:123], a[112:115]
    buffer_load_dwordx4 v8, s[16:19], s29 offen offset:128 nt lds
    v_mfma_f32_16x16x32_bf16 a[164:167], a[248:251], v[108:111], a[164:167]
    ds_read_b64_tr_b16 a[242:243], v7 offset:7168
    v_add_f32 v19, v19, v69
    v_mfma_f32_16x16x32_bf16 a[20:23], a[248:251], v[96:99], a[20:23]
    ds_read_b64_tr_b16 a[244:245], v7 offset:13312
    v_add_f32 v19, v19, v70
    v_mfma_f32_16x16x32_bf16 a[20:23], a[252:255], v[112:115], a[20:23]
    v_exp_f32 v71, v71
    v_mfma_f32_16x16x32_bf16 a[68:71], a[248:251], v[100:103], a[68:71]
    ds_read_b64_tr_b16 a[246:247], v7 offset:19456
    v_cvt_pk_bf16_f32 v143, v70, v71
    v_mfma_f32_16x16x32_bf16 a[68:71], a[252:255], v[116:119], a[68:71]
    ds_read_b128 a[216:219], v2 offset:6144
    v_add_f32 v19, v19, v71
    v_mfma_f32_16x16x32_bf16 a[116:119], a[248:251], v[104:107], a[116:119]
    v_exp_f32 v76, v76
    v_mfma_f32_16x16x32_bf16 a[116:119], a[252:255], v[120:123], a[116:119]
    ds_read_b64_tr_b16 a[248:249], v4 offset:2048
    v_add_f32 v20, v20, v76
    v_mfma_f32_16x16x32_bf16 a[168:171], v[152:155], v[108:111], a[168:171]
    v_exp_f32 v77, v77
    v_mfma_f32_16x16x32_bf16 a[24:27], v[152:155], v[96:99], a[24:27]
    s_add_u32 m0, s33, 38656
    ds_read_b64_tr_b16 a[250:251], v4 offset:8192
    v_cvt_pk_bf16_f32 v146, v76, v77
    v_mfma_f32_16x16x32_bf16 a[24:27], v[156:159], v[112:115], a[24:27]
    buffer_load_dwordx4 v8, s[16:19], s29 offen offset:256 nt lds
    v_mfma_f32_16x16x32_bf16 a[72:75], v[152:155], v[100:103], a[72:75]
    s_add_u32 s29, s29, 12288
    ds_read_b64_tr_b16 a[252:253], v4 offset:14336
    v_add_f32 v20, v20, v77
    v_mfma_f32_16x16x32_bf16 a[72:75], v[156:159], v[116:119], a[72:75]
    ds_read_b64_tr_b16 a[254:255], v4 offset:20480
    v_mfma_f32_16x16x32_bf16 a[120:123], v[152:155], v[104:107], a[120:123]
    v_exp_f32 v78, v78
    v_mfma_f32_16x16x32_bf16 a[120:123], v[156:159], v[120:123], a[120:123]
    s_waitcnt lgkmcnt(3)
    ds_read_b64_tr_b16 v[152:153], v5 offset:2048
    v_add_f32 v20, v20, v78
    v_mfma_f32_16x16x32_bf16 a[172:175], a[240:243], v[108:111], a[172:175]
    v_exp_f32 v79, v79
    v_mfma_f32_16x16x32_bf16 a[28:31], a[240:243], v[96:99], a[28:31]
    ds_read_b64_tr_b16 v[154:155], v5 offset:8192
    v_cvt_pk_bf16_f32 v147, v78, v79
    v_mfma_f32_16x16x32_bf16 a[28:31], a[244:247], v[112:115], a[28:31]
    ds_read_b64_tr_b16 v[156:157], v5 offset:14336
    v_add_f32 v20, v20, v79
    v_mfma_f32_16x16x32_bf16 a[76:79], a[240:243], v[100:103], a[76:79]
    v_exp_f32 v80, v80
    v_mfma_f32_16x16x32_bf16 a[76:79], a[244:247], v[116:119], a[76:79]
    ds_read_b64_tr_b16 v[158:159], v5 offset:20480
    v_add_f32 v21, v21, v80
    v_mfma_f32_16x16x32_bf16 a[124:127], a[240:243], v[104:107], a[124:127]
    v_exp_f32 v81, v81
    v_mfma_f32_16x16x32_bf16 a[124:127], a[244:247], v[120:123], a[124:127]
    s_waitcnt lgkmcnt(3)
    ds_read_b128 a[220:223], v3 offset:6144
    v_cvt_pk_bf16_f32 v148, v80, v81
    v_mfma_f32_16x16x32_bf16 a[176:179], a[248:251], v[108:111], a[176:179]
    ds_read_b64_tr_b16 a[240:241], v6 offset:2048
    v_add_f32 v21, v21, v81
    v_mfma_f32_16x16x32_bf16 a[32:35], a[248:251], v[96:99], a[32:35]
    v_exp_f32 v82, v82
    v_mfma_f32_16x16x32_bf16 a[32:35], a[252:255], v[112:115], a[32:35]
    ds_read_b64_tr_b16 a[242:243], v6 offset:8192
    v_add_f32 v21, v21, v82
    v_mfma_f32_16x16x32_bf16 a[80:83], a[248:251], v[100:103], a[80:83]
    v_exp_f32 v83, v83
    v_mfma_f32_16x16x32_bf16 a[80:83], a[252:255], v[116:119], a[80:83]
    ds_read_b64_tr_b16 a[244:245], v6 offset:14336
    v_cvt_pk_bf16_f32 v149, v82, v83
    v_mfma_f32_16x16x32_bf16 a[128:131], a[248:251], v[104:107], a[128:131]
    ds_read_b64_tr_b16 a[246:247], v6 offset:20480
    v_add_f32 v21, v21, v83
    v_mfma_f32_16x16x32_bf16 a[128:131], a[252:255], v[120:123], a[128:131]
    s_waitcnt lgkmcnt(4)
    ds_read_b128 a[224:227], v2 offset:7168
    v_mfma_f32_16x16x32_bf16 a[180:183], v[152:155], v[108:111], a[180:183]
    v_exp_f32 v84, v84
    v_mfma_f32_16x16x32_bf16 a[36:39], v[152:155], v[96:99], a[36:39]
    ds_read_b128 a[228:231], v3 offset:7168
    v_add_f32 v21, v21, v84
    v_mfma_f32_16x16x32_bf16 a[36:39], v[156:159], v[112:115], a[36:39]
    ds_read_b64_tr_b16 a[248:249], v7 offset:2048
    ds_read_b64_tr_b16 a[250:251], v7 offset:8192
    v_mfma_f32_16x16x32_bf16 a[84:87], v[152:155], v[100:103], a[84:87]
    ds_read_b128 a[232:235], v2 offset:8192
    v_mfma_f32_16x16x32_bf16 a[84:87], v[156:159], v[116:119], a[84:87]
    ds_read_b64_tr_b16 a[252:253], v7 offset:14336
    ds_read_b64_tr_b16 a[254:255], v7 offset:20480
    v_mfma_f32_16x16x32_bf16 a[132:135], v[152:155], v[104:107], a[132:135]
    v_exp_f32 v85, v85
    v_mfma_f32_16x16x32_bf16 a[132:135], v[156:159], v[120:123], a[132:135]
    s_waitcnt lgkmcnt(6)
    ds_read_b128 a[236:239], v3 offset:8192
    v_cvt_pk_bf16_f32 v150, v84, v85
    v_mfma_f32_16x16x32_bf16 a[184:187], a[240:243], v[108:111], a[184:187]
    v_exp_f32 v86, v86
    v_mfma_f32_16x16x32_bf16 a[40:43], a[240:243], v[96:99], a[40:43]
    s_waitcnt vmcnt(14)
    ds_inc_u32 v46, v46
    v_add_f32 v21, v21, v85
    v_mfma_f32_16x16x32_bf16 a[40:43], a[244:247], v[112:115], a[40:43]
    v_exp_f32 v87, v87
    v_mfma_f32_16x16x32_bf16 a[88:91], a[240:243], v[100:103], a[88:91]
    v_cvt_pk_bf16_f32 v151, v86, v87
    v_add_f32 v21, v21, v86
    v_mfma_f32_16x16x32_bf16 a[88:91], a[244:247], v[116:119], a[88:91]
    v_add_f32 v21, v21, v87
    v_max3_f32 v28, v19, v20, v21
    v_mfma_f32_16x16x32_bf16 a[136:139], a[240:243], v[104:107], a[136:139]
    v_max_f32 v28, v28, v22
    v_mfma_f32_16x16x32_bf16 a[136:139], a[244:247], v[120:123], a[136:139]
    s_waitcnt lgkmcnt(1)
    buffer_store_dwordx4 v[40:43], v23, s[80:83], s84 offen offset:256 nt
    v_mfma_f32_16x16x32_bf16 a[188:191], a[248:251], v[108:111], a[188:191]
    s_add_u32 s84, s84, s87
    v_mfma_f32_16x16x32_bf16 a[44:47], a[248:251], v[96:99], a[44:47]
    v_mfma_f32_16x16x32_bf16 a[44:47], a[252:255], v[112:115], a[44:47]
    v_mfma_f32_16x16x32_bf16 a[92:95], a[248:251], v[100:103], a[92:95]
    v_mfma_f32_16x16x32_bf16 a[92:95], a[252:255], v[116:119], a[92:95]
    v_mfma_f32_16x16x32_bf16 a[140:143], a[248:251], v[104:107], a[140:143]
    v_mfma_f32_16x16x32_bf16 a[140:143], a[252:255], v[120:123], a[140:143]
    s_sub_u32 s31, s31, 1
    s_cbranch_scc0 L_loop_01
L_after_01:
    s_waitcnt vmcnt(9) lgkmcnt(0)
    s_barrier
    s_add_u32 s93, s93, 4
    s_mov_b32 s48, s90
    s_xor_b32 s49, s90, 16384
    s_add_u32 s50, s90, 256
    s_add_u32 s51, s90, 6656
    ds_read_b64_tr_b16 v[152:153], v4 offset:26624
    ds_read_b64_tr_b16 v[154:155], v4 offset:32768
    ds_read_b64_tr_b16 v[156:157], v4 offset:38912
    ds_read_b64_tr_b16 v[158:159], v4 offset:45056
    ds_read_b64_tr_b16 a[240:241], v5 offset:26624
    ds_read_b64_tr_b16 a[242:243], v5 offset:32768
    ds_read_b64_tr_b16 a[244:245], v5 offset:38912
    ds_read_b64_tr_b16 a[246:247], v5 offset:45056
    v_cmp_lt_f32 vcc, s35, v28
    s_nop 3
    s_cbranch_vccnz L_t01_31c_rare
L_t01_31c_back:
    s_mov_b32 s54, 6144
    s_mov_b32 s55, 12288
    v_lshl_add_u32 v36, v1, 4, s48
    v_add_f32 v12, v12, v19
    v_add_f32 v13, v13, v20
    v_add_f32 v14, v14, v21
    v_add_f32 v15, v15, v22
    v_and_b32 v45, 15, v1
    v_mul_u32_u24 v45, 400, v45
    v_mov_b32 v32, v12
    s_nop 1
    v_permlane32_swap_b32 v12, v32
    v_add_f32 v12, v12, v32
    v_mov_b32 v32, v12
    s_nop 1
    v_permlane16_swap_b32 v12, v32
    v_add_f32 v12, v12, v32
    v_rcp_f32 v40, v12
    v_lshrrev_b32 v29, 4, v1
    v_lshl_add_u32 v45, v29, 3, v45
    v_add_u32 v28, s51, v45
    v_lshrrev_b32 v45, 3, v1
    v_mov_b32 v33, v13
    s_nop 1
    v_permlane32_swap_b32 v13, v33
    v_add_f32 v13, v13, v33
    v_mov_b32 v33, v13
    s_nop 1
    v_permlane16_swap_b32 v13, v33
    v_add_f32 v13, v13, v33
    v_and_b32 v29, 7, v1
    s_waitcnt lgkmcnt(6)
    v_mfma_f32_16x16x32_bf16 a[176:179], v[152:155], v[136:139], a[176:179]
    ds_read_b64_tr_b16 a[248:249], v6 offset:26624
    v_lshlrev_b32 v29, 4, v29
    v_mfma_f32_16x16x32_bf16 a[32:35], v[152:155], v[124:127], a[32:35]
    s_waitcnt lgkmcnt(5)
    ds_read_b64_tr_b16 a[250:251], v6 offset:32768
    v_mul_u32_u24 v30, 400, v45
    v_mfma_f32_16x16x32_bf16 a[32:35], v[156:159], v[140:143], a[32:35]
    ds_read_b64_tr_b16 a[252:253], v6 offset:38912
    v_add3_u32 v30, v30, v29, s50
    v_mfma_f32_16x16x32_bf16 a[80:83], v[152:155], v[128:131], a[80:83]
    ds_read_b64_tr_b16 a[254:255], v6 offset:45056
    v_mov_b32 v34, v14
    v_mfma_f32_16x16x32_bf16 a[80:83], v[156:159], v[144:147], a[80:83]
    v_rcp_f32 v42, v13
    v_mfma_f32_16x16x32_bf16 a[128:131], v[152:155], v[132:135], a[128:131]
    ds_read_b64_tr_b16 v[152:153], v7 offset:26624
    v_mul_u32_u24 v31, 384, v45
    v_mfma_f32_16x16x32_bf16 a[128:131], v[156:159], v[148:151], a[128:131]
    s_waitcnt lgkmcnt(5)
    ds_read_b64_tr_b16 v[154:155], v7 offset:32768
    v_add3_u32 v31, v31, v29, s37
    v_mfma_f32_16x16x32_bf16 a[180:183], a[240:243], v[136:139], a[180:183]
    ds_read_b64_tr_b16 v[156:157], v7 offset:38912
    v_add_u32 v29, s38, v11
    v_mfma_f32_16x16x32_bf16 a[36:39], a[240:243], v[124:127], a[36:39]
    ds_read_b64_tr_b16 v[158:159], v7 offset:45056
    v_mov_b32 v35, v15
    v_mfma_f32_16x16x32_bf16 a[36:39], a[244:247], v[140:143], a[36:39]
    v_permlane32_swap_b32 v14, v34
    v_mfma_f32_16x16x32_bf16 a[84:87], a[240:243], v[128:131], a[84:87]
    v_add_f32 v14, v14, v34
    v_mov_b32 v34, v14
    v_mfma_f32_16x16x32_bf16 a[84:87], a[244:247], v[144:147], a[84:87]
    ds_write_b128 v36, a[176:179] offset:2048
    v_mfma_f32_16x16x32_bf16 a[132:135], a[240:243], v[132:135], a[132:135]
    ds_read_b64_tr_b16 a[240:241], v4 offset:25600
    v_mov_b32 v38, v60
    v_mfma_f32_16x16x32_bf16 a[132:135], a[244:247], v[148:151], a[132:135]
    s_waitcnt lgkmcnt(4)
    v_accvgpr_read_b32 v64, a32
    v_mul_f32 v64, v64, v40
    v_accvgpr_read_b32 v65, a33
    v_mul_f32 v65, v65, v40
    v_cvt_pk_bf16_f32 v96, v64, v65
    v_mfma_f32_16x16x32_bf16 a[184:187], a[248:251], v[136:139], a[184:187]
    v_accvgpr_read_b32 v66, a34
    v_mul_f32 v66, v66, v40
    v_accvgpr_read_b32 v67, a35
    v_mul_f32 v67, v67, v40
    v_cvt_pk_bf16_f32 v97, v66, v67
    v_mfma_f32_16x16x32_bf16 a[40:43], a[248:251], v[124:127], a[40:43]
    v_accvgpr_read_b32 v68, a36
    v_mul_f32 v68, v68, v40
    v_accvgpr_read_b32 v69, a37
    v_mul_f32 v69, v69, v40
    v_cvt_pk_bf16_f32 v98, v68, v69
    v_mfma_f32_16x16x32_bf16 a[40:43], a[252:255], v[140:143], a[40:43]
    v_accvgpr_read_b32 v70, a38
    v_mul_f32 v70, v70, v40
    v_mfma_f32_16x16x32_bf16 a[88:91], a[248:251], v[128:131], a[88:91]
    v_accvgpr_read_b32 v71, a39
    v_mul_f32 v71, v71, v40
    v_cvt_pk_bf16_f32 v99, v70, v71
    v_accvgpr_read_b32 v72, a80
    v_mul_f32 v72, v72, v42
    v_mfma_f32_16x16x32_bf16 a[88:91], a[252:255], v[144:147], a[88:91]
    ds_write2_b64 v28, v[96:97], v[98:99] offset0:0 offset1:4
    v_accvgpr_read_b32 v73, a81
    v_mul_f32 v73, v73, v42
    v_cvt_pk_bf16_f32 v100, v72, v73
    v_accvgpr_read_b32 v74, a82
    v_mul_f32 v74, v74, v42
    v_mfma_f32_16x16x32_bf16 a[136:139], a[248:251], v[132:135], a[136:139]
    ds_read_b64_tr_b16 a[242:243], v4 offset:31744
    v_accvgpr_read_b32 v75, a83
    v_mul_f32 v75, v75, v42
    v_cvt_pk_bf16_f32 v101, v74, v75
    v_mfma_f32_16x16x32_bf16 a[136:139], a[252:255], v[148:151], a[136:139]
    v_permlane16_swap_b32 v14, v34
    v_add_f32 v14, v14, v34
    v_rcp_f32 v44, v14
    v_accvgpr_read_b32 v76, a84
    v_mul_f32 v76, v76, v42
    v_accvgpr_read_b32 v77, a85
    v_mul_f32 v77, v77, v42
    v_cvt_pk_bf16_f32 v102, v76, v77
    v_mfma_f32_16x16x32_bf16 a[188:191], v[152:155], v[136:139], a[188:191]
    ds_read_b64_tr_b16 a[244:245], v4 offset:37888
    ds_read_b64_tr_b16 a[246:247], v4 offset:44032
    v_accvgpr_read_b32 v78, a86
    v_mul_f32 v78, v78, v42
    v_accvgpr_read_b32 v79, a87
    v_mul_f32 v79, v79, v42
    v_cvt_pk_bf16_f32 v103, v78, v79
    v_mfma_f32_16x16x32_bf16 a[44:47], v[152:155], v[124:127], a[44:47]
    s_waitcnt lgkmcnt(4)
    v_accvgpr_read_b32 v80, a128
    v_mul_f32 v80, v80, v44
    v_accvgpr_read_b32 v81, a129
    v_mul_f32 v81, v81, v44
    v_cvt_pk_bf16_f32 v96, v80, v81
    v_mfma_f32_16x16x32_bf16 a[44:47], v[156:159], v[140:143], a[44:47]
    ds_write2_b64 v28, v[100:101], v[102:103] offset0:16 offset1:20
    v_accvgpr_read_b32 v82, a130
    v_mul_f32 v82, v82, v44
    v_mfma_f32_16x16x32_bf16 a[92:95], v[152:155], v[128:131], a[92:95]
    v_accvgpr_read_b32 v83, a131
    v_mul_f32 v83, v83, v44
    v_cvt_pk_bf16_f32 v97, v82, v83
    v_accvgpr_read_b32 v84, a132
    v_mul_f32 v84, v84, v44
    v_mfma_f32_16x16x32_bf16 a[92:95], v[156:159], v[144:147], a[92:95]
    v_accvgpr_read_b32 v85, a133
    v_mul_f32 v85, v85, v44
    v_cvt_pk_bf16_f32 v98, v84, v85
    v_accvgpr_read_b32 v86, a134
    v_mul_f32 v86, v86, v44
    v_mfma_f32_16x16x32_bf16 a[140:143], v[152:155], v[132:135], a[140:143]
    ds_read_b64_tr_b16 a[248:249], v5 offset:25600
    ds_read_b64_tr_b16 a[250:251], v5 offset:31744
    v_accvgpr_read_b32 v87, a135
    v_mul_f32 v87, v87, v44
    v_cvt_pk_bf16_f32 v99, v86, v87
    v_mfma_f32_16x16x32_bf16 a[140:143], v[156:159], v[148:151], a[140:143]
    s_waitcnt lgkmcnt(5)
    v_accvgpr_read_b32 v88, a40
    v_mul_f32 v88, v88, v40
    v_accvgpr_read_b32 v89, a41
    v_mul_f32 v89, v89, v40
    v_cvt_pk_bf16_f32 v100, v88, v89
    v_mfma_f32_16x16x32_bf16 a[160:163], a[240:243], v[136:139], a[160:163]
    ds_read_b64_tr_b16 a[252:253], v5 offset:37888
    ds_read_b64_tr_b16 a[254:255], v5 offset:44032
    ds_write2_b64 v28, v[96:97], v[98:99] offset0:32 offset1:36
    v_accvgpr_read_b32 v90, a42
    v_mul_f32 v90, v90, v40
    v_accvgpr_read_b32 v91, a43
    v_mul_f32 v91, v91, v40
    v_cvt_pk_bf16_f32 v101, v90, v91
    v_mfma_f32_16x16x32_bf16 a[16:19], a[240:243], v[124:127], a[16:19]
    s_waitcnt lgkmcnt(6)
    v_accvgpr_read_b32 v92, a44
    v_mul_f32 v92, v92, v40
    v_accvgpr_read_b32 v93, a45
    v_mul_f32 v93, v93, v40
    v_cvt_pk_bf16_f32 v102, v92, v93
    v_mfma_f32_16x16x32_bf16 a[16:19], a[244:247], v[140:143], a[16:19]
    v_accvgpr_read_b32 v94, a46
    v_mul_f32 v94, v94, v40
    v_mfma_f32_16x16x32_bf16 a[64:67], a[240:243], v[128:131], a[64:67]
    v_accvgpr_read_b32 v95, a47
    v_mul_f32 v95, v95, v40
    v_cvt_pk_bf16_f32 v103, v94, v95
    v_accvgpr_read_b32 v64, a88
    v_mul_f32 v64, v64, v42
    v_mfma_f32_16x16x32_bf16 a[64:67], a[244:247], v[144:147], a[64:67]
    ds_write2_b64 v28, v[100:101], v[102:103] offset0:8 offset1:12
    v_accvgpr_read_b32 v65, a89
    v_mul_f32 v65, v65, v42
    v_cvt_pk_bf16_f32 v96, v64, v65
    v_accvgpr_read_b32 v66, a90
    v_mul_f32 v66, v66, v42
    v_mfma_f32_16x16x32_bf16 a[112:115], a[240:243], v[132:135], a[112:115]
    ds_read_b64_tr_b16 v[152:153], v6 offset:25600
    ds_read_b64_tr_b16 v[154:155], v6 offset:31744
    ds_read_b128 v[104:107], v30 offset:6400
    ds_read_b128 v[108:111], v30 offset:9600
    v_accvgpr_read_b32 v67, a91
    v_mul_f32 v67, v67, v42
    v_cvt_pk_bf16_f32 v97, v66, v67
    v_mfma_f32_16x16x32_bf16 a[112:115], a[244:247], v[148:151], a[112:115]
    s_waitcnt lgkmcnt(8)
    v_accvgpr_read_b32 v68, a92
    v_mul_f32 v68, v68, v42
    v_accvgpr_read_b32 v69, a93
    v_mul_f32 v69, v69, v42
    v_cvt_pk_bf16_f32 v98, v68, v69
    v_mfma_f32_16x16x32_bf16 a[164:167], a[248:251], v[136:139], a[164:167]
    ds_read_b64_tr_b16 v[156:157], v6 offset:37888
    ds_read_b64_tr_b16 v[158:159], v6 offset:44032
    v_accvgpr_read_b32 v70, a94
    v_mul_f32 v70, v70, v42
    v_accvgpr_read_b32 v71, a95
    v_mul_f32 v71, v71, v42
    v_cvt_pk_bf16_f32 v99, v70, v71
    v_mfma_f32_16x16x32_bf16 a[20:23], a[248:251], v[124:127], a[20:23]
    s_waitcnt lgkmcnt(7)
    v_accvgpr_read_b32 v72, a136
    v_mul_f32 v72, v72, v44
    v_accvgpr_read_b32 v73, a137
    v_mul_f32 v73, v73, v44
    v_cvt_pk_bf16_f32 v100, v72, v73
    v_mfma_f32_16x16x32_bf16 a[20:23], a[252:255], v[140:143], a[20:23]
    s_waitcnt lgkmcnt(3)
    buffer_store_dwordx4 v[104:107], v31, s[24:27], 0 offen offset:256 nt
    ds_write2_b64 v28, v[96:97], v[98:99] offset0:24 offset1:28
    v_accvgpr_read_b32 v74, a138
    v_mul_f32 v74, v74, v44
    v_mfma_f32_16x16x32_bf16 a[68:71], a[248:251], v[128:131], a[68:71]
    s_waitcnt lgkmcnt(3)
    buffer_store_dwordx4 v[108:111], v31, s[24:27], 0 offen offset:3328 nt
    ds_read_b128 v[112:115], v30 offset:6528
    ds_read_b128 v[116:119], v30 offset:9728
    v_accvgpr_read_b32 v75, a139
    v_mul_f32 v75, v75, v44
    v_cvt_pk_bf16_f32 v101, v74, v75
    v_accvgpr_read_b32 v76, a140
    v_mul_f32 v76, v76, v44
    v_mfma_f32_16x16x32_bf16 a[68:71], a[252:255], v[144:147], a[68:71]
    v_accvgpr_read_b32 v77, a141
    v_mul_f32 v77, v77, v44
    v_cvt_pk_bf16_f32 v102, v76, v77
    v_accvgpr_read_b32 v78, a142
    v_mul_f32 v78, v78, v44
    v_mfma_f32_16x16x32_bf16 a[116:119], a[248:251], v[132:135], a[116:119]
    ds_read_b64_tr_b16 a[240:241], v7 offset:25600
    ds_read_b64_tr_b16 a[242:243], v7 offset:31744
    v_accvgpr_read_b32 v79, a143
    v_mul_f32 v79, v79, v44
    v_cvt_pk_bf16_f32 v103, v78, v79
    v_mfma_f32_16x16x32_bf16 a[116:119], a[252:255], v[148:151], a[116:119]
    v_accvgpr_read_b32 v80, a16
    v_mul_f32 v80, v80, v40
    v_accvgpr_read_b32 v81, a17
    v_mul_f32 v81, v81, v40
    v_cvt_pk_bf16_f32 v96, v80, v81
    v_mfma_f32_16x16x32_bf16 a[168:171], v[152:155], v[136:139], a[168:171]
    s_waitcnt lgkmcnt(3)
    ds_read_b64_tr_b16 a[244:245], v7 offset:37888
    ds_read_b64_tr_b16 a[246:247], v7 offset:44032
    buffer_store_dwordx4 v[112:115], v31, s[24:27], s54 offen offset:256 nt
    ds_write2_b64 v28, v[100:101], v[102:103] offset0:40 offset1:44
    v_accvgpr_read_b32 v82, a18
    v_mul_f32 v82, v82, v40
    v_accvgpr_read_b32 v83, a19
    v_mul_f32 v83, v83, v40
    v_cvt_pk_bf16_f32 v97, v82, v83
    v_mfma_f32_16x16x32_bf16 a[24:27], v[152:155], v[124:127], a[24:27]
    s_waitcnt lgkmcnt(5)
    buffer_store_dwordx4 v[116:119], v31, s[24:27], s54 offen offset:3328 nt
    ds_read_b128 v[104:107], v30 offset:6656
    ds_read_b128 v[108:111], v30 offset:9856
    v_accvgpr_read_b32 v84, a20
    v_mul_f32 v84, v84, v40
    v_accvgpr_read_b32 v85, a21
    v_mul_f32 v85, v85, v40
    v_cvt_pk_bf16_f32 v98, v84, v85
    v_mfma_f32_16x16x32_bf16 a[24:27], v[156:159], v[140:143], a[24:27]
    v_accvgpr_read_b32 v86, a22
    v_mul_f32 v86, v86, v40
    v_mfma_f32_16x16x32_bf16 a[72:75], v[152:155], v[128:131], a[72:75]
    v_accvgpr_read_b32 v87, a23
    v_mul_f32 v87, v87, v40
    v_cvt_pk_bf16_f32 v99, v86, v87
    v_accvgpr_read_b32 v88, a64
    v_mul_f32 v88, v88, v42
    v_mfma_f32_16x16x32_bf16 a[72:75], v[156:159], v[144:147], a[72:75]
    ds_write2_b64 v28, v[96:97], v[98:99] offset0:0 offset1:4
    v_accvgpr_read_b32 v89, a65
    v_mul_f32 v89, v89, v42
    v_cvt_pk_bf16_f32 v100, v88, v89
    v_accvgpr_read_b32 v90, a66
    v_mul_f32 v90, v90, v42
    v_mfma_f32_16x16x32_bf16 a[120:123], v[152:155], v[132:135], a[120:123]
    s_waitcnt lgkmcnt(2)
    ds_read_b64_tr_b16 a[248:249], v4 offset:24576
    ds_read_b64_tr_b16 a[250:251], v4 offset:30720
    buffer_store_dwordx4 v[104:107], v31, s[24:27], s55 offen offset:256 nt
    v_accvgpr_read_b32 v91, a67
    v_mul_f32 v91, v91, v42
    v_cvt_pk_bf16_f32 v101, v90, v91
    v_mfma_f32_16x16x32_bf16 a[120:123], v[156:159], v[148:151], a[120:123]
    s_waitcnt lgkmcnt(3)
    buffer_store_dwordx4 v[108:111], v31, s[24:27], s55 offen offset:3328 nt
    v_accvgpr_read_b32 v92, a68
    v_mul_f32 v92, v92, v42
    v_accvgpr_read_b32 v93, a69
    v_mul_f32 v93, v93, v42
    v_cvt_pk_bf16_f32 v102, v92, v93
    v_mfma_f32_16x16x32_bf16 a[172:175], a[240:243], v[136:139], a[172:175]
    ds_read_b64_tr_b16 a[252:253], v4 offset:36864
    ds_read_b64_tr_b16 a[254:255], v4 offset:43008
    v_accvgpr_read_b32 v94, a70
    v_mul_f32 v94, v94, v42
    v_accvgpr_read_b32 v95, a71
    v_mul_f32 v95, v95, v42
    v_cvt_pk_bf16_f32 v103, v94, v95
    v_mfma_f32_16x16x32_bf16 a[28:31], a[240:243], v[124:127], a[28:31]
    v_accvgpr_read_b32 v64, a112
    v_mul_f32 v64, v64, v44
    v_accvgpr_read_b32 v65, a113
    v_mul_f32 v65, v65, v44
    v_cvt_pk_bf16_f32 v96, v64, v65
    v_mfma_f32_16x16x32_bf16 a[28:31], a[244:247], v[140:143], a[28:31]
    ds_write2_b64 v28, v[100:101], v[102:103] offset0:16 offset1:20
    v_accvgpr_read_b32 v66, a114
    v_mul_f32 v66, v66, v44
    v_mfma_f32_16x16x32_bf16 a[76:79], a[240:243], v[128:131], a[76:79]
    v_accvgpr_read_b32 v67, a115
    v_mul_f32 v67, v67, v44
    v_cvt_pk_bf16_f32 v97, v66, v67
    v_accvgpr_read_b32 v68, a116
    v_mul_f32 v68, v68, v44
    v_mfma_f32_16x16x32_bf16 a[76:79], a[244:247], v[144:147], a[76:79]
    ds_write_b128 v36, a[168:171]
    v_accvgpr_read_b32 v69, a117
    v_mul_f32 v69, v69, v44
    v_cvt_pk_bf16_f32 v98, v68, v69
    v_accvgpr_read_b32 v70, a118
    v_mul_f32 v70, v70, v44
    v_mfma_f32_16x16x32_bf16 a[124:127], a[240:243], v[132:135], a[124:127]
    ds_read_b64_tr_b16 v[152:153], v5 offset:24576
    ds_read_b64_tr_b16 v[154:155], v5 offset:30720
    v_accvgpr_read_b32 v71, a119
    v_mul_f32 v71, v71, v44
    v_cvt_pk_bf16_f32 v99, v70, v71
    v_mfma_f32_16x16x32_bf16 a[124:127], a[244:247], v[148:151], a[124:127]
    s_waitcnt lgkmcnt(6)
    ds_write2_b64 v28, v[96:97], v[98:99] offset0:32 offset1:36
    v_accvgpr_read_b32 v72, a24
    v_mul_f32 v72, v72, v40
    v_accvgpr_read_b32 v73, a25
    v_mul_f32 v73, v73, v40
    v_cvt_pk_bf16_f32 v100, v72, v73
    v_mfma_f32_16x16x32_bf16 a[144:147], a[248:251], v[136:139], a[144:147]
    ds_read_b64_tr_b16 v[156:157], v5 offset:36864
    ds_read_b64_tr_b16 v[158:159], v5 offset:43008
    v_accvgpr_read_b32 v74, a26
    v_mul_f32 v74, v74, v40
    v_accvgpr_read_b32 v75, a27
    v_mul_f32 v75, v75, v40
    v_cvt_pk_bf16_f32 v101, v74, v75
    v_mfma_f32_16x16x32_bf16 a[0:3], a[248:251], v[124:127], a[0:3]
    s_waitcnt lgkmcnt(7)
    ds_write_b128 v36, a[172:175] offset:1024
    v_accvgpr_read_b32 v76, a28
    v_mul_f32 v76, v76, v40
    v_accvgpr_read_b32 v77, a29
    v_mul_f32 v77, v77, v40
    v_cvt_pk_bf16_f32 v102, v76, v77
    v_mfma_f32_16x16x32_bf16 a[0:3], a[252:255], v[140:143], a[0:3]
    v_accvgpr_read_b32 v78, a30
    v_mul_f32 v78, v78, v40
    v_mfma_f32_16x16x32_bf16 a[48:51], a[248:251], v[128:131], a[48:51]
    v_accvgpr_read_b32 v79, a31
    v_mul_f32 v79, v79, v40
    v_cvt_pk_bf16_f32 v103, v78, v79
    v_accvgpr_read_b32 v80, a72
    v_mul_f32 v80, v80, v42
    v_mfma_f32_16x16x32_bf16 a[48:51], a[252:255], v[144:147], a[48:51]
    ds_write2_b64 v28, v[100:101], v[102:103] offset0:8 offset1:12
    v_accvgpr_read_b32 v81, a73
    v_mul_f32 v81, v81, v42
    v_cvt_pk_bf16_f32 v96, v80, v81
    v_accvgpr_read_b32 v82, a74
    v_mul_f32 v82, v82, v42
    v_mfma_f32_16x16x32_bf16 a[96:99], a[248:251], v[132:135], a[96:99]
    ds_read_b64_tr_b16 a[240:241], v6 offset:24576
    ds_read_b64_tr_b16 a[242:243], v6 offset:30720
    ds_read_b128 v[112:115], v30 offset:6400
    ds_read_b128 v[116:119], v30 offset:9600
    v_accvgpr_read_b32 v83, a75
    v_mul_f32 v83, v83, v42
    v_cvt_pk_bf16_f32 v97, v82, v83
    v_mfma_f32_16x16x32_bf16 a[96:99], a[252:255], v[148:151], a[96:99]
    s_waitcnt lgkmcnt(8)
    v_accvgpr_read_b32 v84, a76
    v_mul_f32 v84, v84, v42
    v_accvgpr_read_b32 v85, a77
    v_mul_f32 v85, v85, v42
    v_cvt_pk_bf16_f32 v98, v84, v85
    v_mfma_f32_16x16x32_bf16 a[148:151], v[152:155], v[136:139], a[148:151]
    ds_read_b64_tr_b16 a[244:245], v6 offset:36864
    ds_read_b64_tr_b16 a[246:247], v6 offset:43008
    v_accvgpr_read_b32 v86, a78
    v_mul_f32 v86, v86, v42
    v_accvgpr_read_b32 v87, a79
    v_mul_f32 v87, v87, v42
    v_cvt_pk_bf16_f32 v99, v86, v87
    v_mfma_f32_16x16x32_bf16 a[4:7], v[152:155], v[124:127], a[4:7]
    s_waitcnt lgkmcnt(7)
    v_accvgpr_read_b32 v88, a120
    v_mul_f32 v88, v88, v44
    v_accvgpr_read_b32 v89, a121
    v_mul_f32 v89, v89, v44
    v_cvt_pk_bf16_f32 v100, v88, v89
    v_mfma_f32_16x16x32_bf16 a[4:7], v[156:159], v[140:143], a[4:7]
    s_waitcnt lgkmcnt(3)
    ds_write_b128 v36, a[180:183] offset:3072
    buffer_store_dwordx4 v[112:115], v31, s[24:27], 0 offen offset:128 nt
    ds_write2_b64 v28, v[96:97], v[98:99] offset0:24 offset1:28
    v_accvgpr_read_b32 v90, a122
    v_mul_f32 v90, v90, v44
    v_mfma_f32_16x16x32_bf16 a[52:55], v[152:155], v[128:131], a[52:55]
    s_waitcnt lgkmcnt(4)
    buffer_store_dwordx4 v[116:119], v31, s[24:27], 0 offen offset:3200 nt
    ds_read_b128 v[104:107], v30 offset:6528
    ds_read_b128 v[108:111], v30 offset:9728
    v_accvgpr_read_b32 v91, a123
    v_mul_f32 v91, v91, v44
    v_cvt_pk_bf16_f32 v101, v90, v91
    v_accvgpr_read_b32 v92, a124
    v_mul_f32 v92, v92, v44
    v_mfma_f32_16x16x32_bf16 a[52:55], v[156:159], v[144:147], a[52:55]
    v_accvgpr_read_b32 v93, a125
    v_mul_f32 v93, v93, v44
    v_cvt_pk_bf16_f32 v102, v92, v93
    v_accvgpr_read_b32 v94, a126
    v_mul_f32 v94, v94, v44
    v_mfma_f32_16x16x32_bf16 a[100:103], v[152:155], v[132:135], a[100:103]
    ds_read_b64_tr_b16 a[248:249], v7 offset:24576
    ds_read_b64_tr_b16 a[250:251], v7 offset:30720
    v_accvgpr_read_b32 v95, a127
    v_mul_f32 v95, v95, v44
    v_cvt_pk_bf16_f32 v103, v94, v95
    v_mfma_f32_16x16x32_bf16 a[100:103], v[156:159], v[148:151], a[100:103]
    ds_write_b128 v36, a[184:187] offset:4096
    v_mfma_f32_16x16x32_bf16 a[152:155], a[240:243], v[136:139], a[152:155]
    s_waitcnt lgkmcnt(4)
    ds_read_b64_tr_b16 a[252:253], v7 offset:36864
    ds_read_b64_tr_b16 a[254:255], v7 offset:43008
    buffer_store_dwordx4 v[104:107], v31, s[24:27], s54 offen offset:128 nt
    ds_write2_b64 v28, v[100:101], v[102:103] offset0:40 offset1:44
    v_mfma_f32_16x16x32_bf16 a[8:11], a[240:243], v[124:127], a[8:11]
    s_waitcnt lgkmcnt(6)
    buffer_store_dwordx4 v[108:111], v31, s[24:27], s54 offen offset:3200 nt
    ds_read_b128 v[112:115], v30 offset:6656
    ds_read_b128 v[116:119], v30 offset:9856
    v_mfma_f32_16x16x32_bf16 a[8:11], a[244:247], v[140:143], a[8:11]
    v_permlane32_swap_b32 v15, v35
    v_mfma_f32_16x16x32_bf16 a[56:59], a[240:243], v[128:131], a[56:59]
    ds_write_b128 v36, a[188:191] offset:5120
    v_mfma_f32_16x16x32_bf16 a[56:59], a[244:247], v[144:147], a[56:59]
    v_add_f32 v15, v15, v35
    v_mov_b32 v35, v15
    v_mfma_f32_16x16x32_bf16 a[104:107], a[240:243], v[132:135], a[104:107]
    s_waitcnt lgkmcnt(2)
    buffer_store_dwordx4 v[112:115], v31, s[24:27], s55 offen offset:128 nt
    v_permlane16_swap_b32 v15, v35
    v_add_f32 v15, v15, v35
    v_mov_b32 v39, v15
    v_mfma_f32_16x16x32_bf16 a[104:107], a[244:247], v[148:151], a[104:107]
    s_waitcnt lgkmcnt(1)
    buffer_store_dwordx4 v[116:119], v31, s[24:27], s55 offen offset:3200 nt
    v_mfma_f32_16x16x32_bf16 a[156:159], a[248:251], v[136:139], a[156:159]
    v_lshl_add_u32 v37, v1, 4, s49
    v_lshl_add_u32 v41, v1, 3, s48
    v_mfma_f32_16x16x32_bf16 a[12:15], a[248:251], v[124:127], a[12:15]
    ds_write_b64 v41, v[38:39] offset:6144
    v_mfma_f32_16x16x32_bf16 a[12:15], a[252:255], v[140:143], a[12:15]
    v_lshl_add_u32 v43, v1, 3, s49
    v_mfma_f32_16x16x32_bf16 a[60:63], a[248:251], v[128:131], a[60:63]
    v_mfma_f32_16x16x32_bf16 a[60:63], a[252:255], v[144:147], a[60:63]
    v_mfma_f32_16x16x32_bf16 a[108:111], a[248:251], v[132:135], a[108:111]
    v_mfma_f32_16x16x32_bf16 a[108:111], a[252:255], v[148:151], a[108:111]
    s_waitcnt lgkmcnt(0)
    s_barrier
    ds_read_b64 v[38:39], v43 offset:6144
    ds_read_b128 v[128:131], v37
    ds_read_b128 v[132:135], v37 offset:1024
    ds_read_b128 v[136:139], v37 offset:2048
    ds_read_b128 v[140:143], v37 offset:3072
    ds_read_b128 v[144:147], v37 offset:4096
    ds_read_b128 v[148:151], v37 offset:5120
    v_accvgpr_read_b32 v64, a0
    v_accvgpr_read_b32 v65, a1
    v_accvgpr_read_b32 v66, a2
    v_accvgpr_read_b32 v67, a3
    v_accvgpr_read_b32 v68, a4
    v_accvgpr_read_b32 v69, a5
    v_accvgpr_read_b32 v70, a6
    v_accvgpr_read_b32 v71, a7
    v_pk_mul_f32 v[64:65], v[64:65], v[40:41] op_sel_hi:[1,0]
    v_pk_mul_f32 v[66:67], v[66:67], v[40:41] op_sel_hi:[1,0]
    v_pk_mul_f32 v[68:69], v[68:69], v[40:41] op_sel_hi:[1,0]
    v_pk_mul_f32 v[70:71], v[70:71], v[40:41] op_sel_hi:[1,0]
    v_cvt_pk_bf16_f32 v96, v64, v65
    v_cvt_pk_bf16_f32 v97, v66, v67
    v_cvt_pk_bf16_f32 v98, v68, v69
    v_cvt_pk_bf16_f32 v99, v70, v71
    s_waitcnt lgkmcnt(6)
    v_min_f32 v33, v60, v38
    v_sub_f32 v32, v33, v60
    v_sub_f32 v34, v33, v38
    v_exp_f32 v32, v32
    v_exp_f32 v34, v34
    v_accvgpr_read_b32 v72, a144
    v_accvgpr_read_b32 v73, a145
    v_accvgpr_read_b32 v74, a146
    v_accvgpr_read_b32 v75, a147
    v_accvgpr_read_b32 v76, a148
    v_accvgpr_read_b32 v77, a149
    v_accvgpr_read_b32 v78, a150
    v_accvgpr_read_b32 v79, a151
    v_mul_f32 v35, v15, v32
    v_fma_f32 v35, v39, v34, v35
    v_rcp_f32 v35, v35
    ds_write2_b64 v28, v[96:97], v[98:99] offset0:0 offset1:4
    v_mul_f32 v32, v32, v35
    v_mul_f32 v34, v34, v35
    s_waitcnt lgkmcnt(5)
    v_pk_mul_f32 v[72:73], v[72:73], v[32:33] op_sel_hi:[1,0]
    v_pk_mul_f32 v[74:75], v[74:75], v[32:33] op_sel_hi:[1,0]
    v_pk_mul_f32 v[76:77], v[76:77], v[32:33] op_sel_hi:[1,0]
    v_pk_mul_f32 v[78:79], v[78:79], v[32:33] op_sel_hi:[1,0]
    v_pk_fma_f32 v[72:73], v[128:129], v[34:35], v[72:73] op_sel_hi:[1,0,1]
    v_pk_fma_f32 v[74:75], v[130:131], v[34:35], v[74:75] op_sel_hi:[1,0,1]
    v_pk_fma_f32 v[76:77], v[132:133], v[34:35], v[76:77] op_sel_hi:[1,0,1]
    v_pk_fma_f32 v[78:79], v[134:135], v[34:35], v[78:79] op_sel_hi:[1,0,1]
    v_cvt_pk_bf16_f32 v100, v72, v73
    v_cvt_pk_bf16_f32 v101, v74, v75
    v_cvt_pk_bf16_f32 v102, v76, v77
    v_cvt_pk_bf16_f32 v103, v78, v79
    v_accvgpr_read_b32 v80, a48
    v_accvgpr_read_b32 v81, a49
    v_accvgpr_read_b32 v82, a50
    v_accvgpr_read_b32 v83, a51
    v_accvgpr_read_b32 v84, a52
    v_accvgpr_read_b32 v85, a53
    v_accvgpr_read_b32 v86, a54
    v_accvgpr_read_b32 v87, a55
    v_permlane16_swap_b32 v100, v102
    v_permlane16_swap_b32 v101, v103
    buffer_store_dwordx4 v[100:103], v29, s[24:27], 0 offen
    v_pk_mul_f32 v[80:81], v[80:81], v[42:43] op_sel_hi:[1,0]
    v_pk_mul_f32 v[82:83], v[82:83], v[42:43] op_sel_hi:[1,0]
    v_pk_mul_f32 v[84:85], v[84:85], v[42:43] op_sel_hi:[1,0]
    v_pk_mul_f32 v[86:87], v[86:87], v[42:43] op_sel_hi:[1,0]
    v_cvt_pk_bf16_f32 v96, v80, v81
    v_cvt_pk_bf16_f32 v97, v82, v83
    v_cvt_pk_bf16_f32 v98, v84, v85
    v_cvt_pk_bf16_f32 v99, v86, v87
    v_accvgpr_read_b32 v88, a152
    v_accvgpr_read_b32 v89, a153
    v_accvgpr_read_b32 v90, a154
    v_accvgpr_read_b32 v91, a155
    v_accvgpr_read_b32 v92, a156
    v_accvgpr_read_b32 v93, a157
    v_accvgpr_read_b32 v94, a158
    v_accvgpr_read_b32 v95, a159
    ds_write2_b64 v28, v[96:97], v[98:99] offset0:16 offset1:20
    s_waitcnt lgkmcnt(4)
    v_pk_mul_f32 v[88:89], v[88:89], v[32:33] op_sel_hi:[1,0]
    v_pk_mul_f32 v[90:91], v[90:91], v[32:33] op_sel_hi:[1,0]
    v_pk_mul_f32 v[92:93], v[92:93], v[32:33] op_sel_hi:[1,0]
    v_pk_mul_f32 v[94:95], v[94:95], v[32:33] op_sel_hi:[1,0]
    v_pk_fma_f32 v[88:89], v[136:137], v[34:35], v[88:89] op_sel_hi:[1,0,1]
    v_pk_fma_f32 v[90:91], v[138:139], v[34:35], v[90:91] op_sel_hi:[1,0,1]
    v_pk_fma_f32 v[92:93], v[140:141], v[34:35], v[92:93] op_sel_hi:[1,0,1]
    v_pk_fma_f32 v[94:95], v[142:143], v[34:35], v[94:95] op_sel_hi:[1,0,1]
    v_cvt_pk_bf16_f32 v100, v88, v89
    v_cvt_pk_bf16_f32 v101, v90, v91
    v_cvt_pk_bf16_f32 v102, v92, v93
    v_cvt_pk_bf16_f32 v103, v94, v95
    v_accvgpr_read_b32 v64, a96
    v_accvgpr_read_b32 v65, a97
    v_accvgpr_read_b32 v66, a98
    v_accvgpr_read_b32 v67, a99
    v_accvgpr_read_b32 v68, a100
    v_accvgpr_read_b32 v69, a101
    v_accvgpr_read_b32 v70, a102
    v_accvgpr_read_b32 v71, a103
    v_permlane16_swap_b32 v100, v102
    v_permlane16_swap_b32 v101, v103
    buffer_store_dwordx4 v[100:103], v29, s[24:27], 0 offen offset:64
    v_pk_mul_f32 v[64:65], v[64:65], v[44:45] op_sel_hi:[1,0]
    v_pk_mul_f32 v[66:67], v[66:67], v[44:45] op_sel_hi:[1,0]
    v_pk_mul_f32 v[68:69], v[68:69], v[44:45] op_sel_hi:[1,0]
    v_pk_mul_f32 v[70:71], v[70:71], v[44:45] op_sel_hi:[1,0]
    v_cvt_pk_bf16_f32 v96, v64, v65
    v_cvt_pk_bf16_f32 v97, v66, v67
    v_cvt_pk_bf16_f32 v98, v68, v69
    v_cvt_pk_bf16_f32 v99, v70, v71
    v_accvgpr_read_b32 v72, a160
    v_accvgpr_read_b32 v73, a161
    v_accvgpr_read_b32 v74, a162
    v_accvgpr_read_b32 v75, a163
    v_accvgpr_read_b32 v76, a164
    v_accvgpr_read_b32 v77, a165
    v_accvgpr_read_b32 v78, a166
    v_accvgpr_read_b32 v79, a167
    ds_write2_b64 v28, v[96:97], v[98:99] offset0:32 offset1:36
    s_waitcnt lgkmcnt(3)
    v_pk_mul_f32 v[72:73], v[72:73], v[32:33] op_sel_hi:[1,0]
    v_pk_mul_f32 v[74:75], v[74:75], v[32:33] op_sel_hi:[1,0]
    v_pk_mul_f32 v[76:77], v[76:77], v[32:33] op_sel_hi:[1,0]
    v_pk_mul_f32 v[78:79], v[78:79], v[32:33] op_sel_hi:[1,0]
    v_pk_fma_f32 v[72:73], v[144:145], v[34:35], v[72:73] op_sel_hi:[1,0,1]
    v_pk_fma_f32 v[74:75], v[146:147], v[34:35], v[74:75] op_sel_hi:[1,0,1]
    v_pk_fma_f32 v[76:77], v[148:149], v[34:35], v[76:77] op_sel_hi:[1,0,1]
    v_pk_fma_f32 v[78:79], v[150:151], v[34:35], v[78:79] op_sel_hi:[1,0,1]
    v_cvt_pk_bf16_f32 v100, v72, v73
    v_cvt_pk_bf16_f32 v101, v74, v75
    v_cvt_pk_bf16_f32 v102, v76, v77
    v_cvt_pk_bf16_f32 v103, v78, v79
    v_accvgpr_read_b32 v80, a8
    v_accvgpr_read_b32 v81, a9
    v_accvgpr_read_b32 v82, a10
    v_accvgpr_read_b32 v83, a11
    v_accvgpr_read_b32 v84, a12
    v_accvgpr_read_b32 v85, a13
    v_accvgpr_read_b32 v86, a14
    v_accvgpr_read_b32 v87, a15
    v_permlane16_swap_b32 v100, v102
    v_permlane16_swap_b32 v101, v103
    buffer_store_dwordx4 v[100:103], v29, s[24:27], 0 offen offset:128
    v_pk_mul_f32 v[80:81], v[80:81], v[40:41] op_sel_hi:[1,0]
    v_pk_mul_f32 v[82:83], v[82:83], v[40:41] op_sel_hi:[1,0]
    v_pk_mul_f32 v[84:85], v[84:85], v[40:41] op_sel_hi:[1,0]
    v_pk_mul_f32 v[86:87], v[86:87], v[40:41] op_sel_hi:[1,0]
    v_cvt_pk_bf16_f32 v96, v80, v81
    v_cvt_pk_bf16_f32 v97, v82, v83
    v_cvt_pk_bf16_f32 v98, v84, v85
    v_cvt_pk_bf16_f32 v99, v86, v87
    v_accvgpr_read_b32 v88, a56
    v_accvgpr_read_b32 v89, a57
    v_accvgpr_read_b32 v90, a58
    v_accvgpr_read_b32 v91, a59
    v_accvgpr_read_b32 v92, a60
    v_accvgpr_read_b32 v93, a61
    v_accvgpr_read_b32 v94, a62
    v_accvgpr_read_b32 v95, a63
    ds_write2_b64 v28, v[96:97], v[98:99] offset0:8 offset1:12
    ds_read_b128 v[104:107], v30 offset:6400
    ds_read_b128 v[108:111], v30 offset:9600
    v_pk_mul_f32 v[88:89], v[88:89], v[42:43] op_sel_hi:[1,0]
    v_pk_mul_f32 v[90:91], v[90:91], v[42:43] op_sel_hi:[1,0]
    v_pk_mul_f32 v[92:93], v[92:93], v[42:43] op_sel_hi:[1,0]
    v_pk_mul_f32 v[94:95], v[94:95], v[42:43] op_sel_hi:[1,0]
    v_cvt_pk_bf16_f32 v100, v88, v89
    v_cvt_pk_bf16_f32 v101, v90, v91
    v_cvt_pk_bf16_f32 v102, v92, v93
    v_cvt_pk_bf16_f32 v103, v94, v95
    v_accvgpr_read_b32 v64, a104
    v_accvgpr_read_b32 v65, a105
    v_accvgpr_read_b32 v66, a106
    v_accvgpr_read_b32 v67, a107
    v_accvgpr_read_b32 v68, a108
    v_accvgpr_read_b32 v69, a109
    v_accvgpr_read_b32 v70, a110
    v_accvgpr_read_b32 v71, a111
    ds_write2_b64 v28, v[100:101], v[102:103] offset0:24 offset1:28
    ds_read_b128 v[112:115], v30 offset:6528
    ds_read_b128 v[116:119], v30 offset:9728
    v_pk_mul_f32 v[64:65], v[64:65], v[44:45] op_sel_hi:[1,0]
    v_pk_mul_f32 v[66:67], v[66:67], v[44:45] op_sel_hi:[1,0]
    v_pk_mul_f32 v[68:69], v[68:69], v[44:45] op_sel_hi:[1,0]
    v_pk_mul_f32 v[70:71], v[70:71], v[44:45] op_sel_hi:[1,0]
    v_cvt_pk_bf16_f32 v96, v64, v65
    v_cvt_pk_bf16_f32 v97, v66, v67
    v_cvt_pk_bf16_f32 v98, v68, v69
    v_cvt_pk_bf16_f32 v99, v70, v71
    ds_write2_b64 v28, v[96:97], v[98:99] offset0:40 offset1:44
    ds_read_b128 v[120:123], v30 offset:6656
    ds_read_b128 v[124:127], v30 offset:9856
    s_waitcnt lgkmcnt(7)
    buffer_store_dwordx4 v[104:107], v31, s[24:27], 0 offen nt
    s_waitcnt lgkmcnt(6)
    buffer_store_dwordx4 v[108:111], v31, s[24:27], 0 offen offset:3072 nt
    s_waitcnt lgkmcnt(4)
    buffer_store_dwordx4 v[112:115], v31, s[24:27], s54 offen nt
    s_waitcnt lgkmcnt(3)
    buffer_store_dwordx4 v[116:119], v31, s[24:27], s54 offen offset:3072 nt
    s_waitcnt lgkmcnt(1)
    buffer_store_dwordx4 v[120:123], v31, s[24:27], s55 offen nt
    s_waitcnt lgkmcnt(0)
    buffer_store_dwordx4 v[124:127], v31, s[24:27], s55 offen offset:3072 nt
L_end:
    s_endpgm
L_start_1:
    s_waitcnt vmcnt(9) lgkmcnt(0)
    s_barrier
    ds_read_b128 a[192:195], v2
    ds_read_b128 a[196:199], v3
    ds_read_b128 a[200:203], v2 offset:1024
    ds_read_b128 a[204:207], v3 offset:1024
    ds_read_b128 a[208:211], v2 offset:2048
    ds_read_b128 a[212:215], v3 offset:2048
    ds_read_b128 a[216:219], v2 offset:6144
    ds_read_b128 a[220:223], v3 offset:6144
    ds_read_b128 a[224:227], v2 offset:7168
    ds_read_b128 a[228:231], v3 offset:7168
    ds_read_b128 a[232:235], v2 offset:8192
    ds_read_b128 a[236:239], v3 offset:8192
    ds_read_b128 a[0:3], v2 offset:12288
    ds_read_b128 a[4:7], v3 offset:12288
    ds_read_b128 a[8:11], v2 offset:13312
    ds_read_b128 a[12:15], v3 offset:13312
    ds_read_b128 a[16:19], v2 offset:14336
    ds_read_b128 a[20:23], v3 offset:14336
    ds_read_b128 a[24:27], v2 offset:18432
    ds_read_b128 a[28:31], v3 offset:18432
    ds_read_b128 a[32:35], v2 offset:19456
    ds_read_b128 a[36:39], v3 offset:19456
    ds_read_b128 a[40:43], v2 offset:20480
    ds_read_b128 a[44:47], v3 offset:20480
    v_add_u32 v24, s90, v2
    v_add_u32 v25, s90, v3
    ds_read_b128 v[160:163], v24
    ds_read_b128 v[164:167], v25
    ds_read_b128 v[168:171], v24 offset:1024
    ds_read_b128 v[172:175], v25 offset:1024
    ds_read_b128 v[176:179], v24 offset:2048
    ds_read_b128 v[180:183], v25 offset:2048
    s_waitcnt lgkmcnt(5)
    v_lshlrev_b32 v152, 16, v160
    v_and_b32 v153, 0xffff0000, v160
    v_lshlrev_b32 v154, 16, v161
    v_and_b32 v155, 0xffff0000, v161
    v_lshlrev_b32 v156, 16, v162
    v_and_b32 v157, 0xffff0000, v162
    v_lshlrev_b32 v158, 16, v163
    v_and_b32 v159, 0xffff0000, v163
    v_pk_mul_f32 v[152:153], v[152:153], s[42:43]
    v_pk_mul_f32 v[154:155], v[154:155], s[42:43]
    v_pk_mul_f32 v[156:157], v[156:157], s[42:43]
    v_pk_mul_f32 v[158:159], v[158:159], s[42:43]
    v_cvt_pk_bf16_f32 v160, v152, v153
    v_cvt_pk_bf16_f32 v161, v154, v155
    v_cvt_pk_bf16_f32 v162, v156, v157
    v_cvt_pk_bf16_f32 v163, v158, v159
    s_add_u32 s54, s39, 15360
    s_add_u32 m0, s47, 3072
    s_nop 0
    buffer_load_dwordx4 v26, s[12:15], s54 offen nt lds
    s_waitcnt lgkmcnt(4)
    v_lshlrev_b32 v152, 16, v164
    v_and_b32 v153, 0xffff0000, v164
    v_lshlrev_b32 v154, 16, v165
    v_and_b32 v155, 0xffff0000, v165
    v_lshlrev_b32 v156, 16, v166
    v_and_b32 v157, 0xffff0000, v166
    v_lshlrev_b32 v158, 16, v167
    v_and_b32 v159, 0xffff0000, v167
    v_pk_mul_f32 v[152:153], v[152:153], s[42:43]
    v_pk_mul_f32 v[154:155], v[154:155], s[42:43]
    v_pk_mul_f32 v[156:157], v[156:157], s[42:43]
    v_pk_mul_f32 v[158:159], v[158:159], s[42:43]
    v_cvt_pk_bf16_f32 v164, v152, v153
    v_cvt_pk_bf16_f32 v165, v154, v155
    v_cvt_pk_bf16_f32 v166, v156, v157
    v_cvt_pk_bf16_f32 v167, v158, v159
    s_add_u32 m0, s47, 3968
    s_nop 0
    buffer_load_dwordx4 v26, s[12:15], s54 offen offset:128 nt lds
    s_waitcnt lgkmcnt(3)
    v_lshlrev_b32 v152, 16, v168
    v_and_b32 v153, 0xffff0000, v168
    v_lshlrev_b32 v154, 16, v169
    v_and_b32 v155, 0xffff0000, v169
    v_lshlrev_b32 v156, 16, v170
    v_and_b32 v157, 0xffff0000, v170
    v_lshlrev_b32 v158, 16, v171
    v_and_b32 v159, 0xffff0000, v171
    v_pk_mul_f32 v[152:153], v[152:153], s[42:43]
    v_pk_mul_f32 v[154:155], v[154:155], s[42:43]
    v_pk_mul_f32 v[156:157], v[156:157], s[42:43]
    v_pk_mul_f32 v[158:159], v[158:159], s[42:43]
    v_cvt_pk_bf16_f32 v168, v152, v153
    v_cvt_pk_bf16_f32 v169, v154, v155
    v_cvt_pk_bf16_f32 v170, v156, v157
    v_cvt_pk_bf16_f32 v171, v158, v159
    s_add_u32 m0, s47, 4864
    s_nop 0
    buffer_load_dwordx4 v26, s[12:15], s54 offen offset:256 nt lds
    s_waitcnt lgkmcnt(2)
    v_lshlrev_b32 v152, 16, v172
    v_and_b32 v153, 0xffff0000, v172
    v_lshlrev_b32 v154, 16, v173
    v_and_b32 v155, 0xffff0000, v173
    v_lshlrev_b32 v156, 16, v174
    v_and_b32 v157, 0xffff0000, v174
    v_lshlrev_b32 v158, 16, v175
    v_and_b32 v159, 0xffff0000, v175
    v_pk_mul_f32 v[152:153], v[152:153], s[42:43]
    v_pk_mul_f32 v[154:155], v[154:155], s[42:43]
    v_pk_mul_f32 v[156:157], v[156:157], s[42:43]
    v_pk_mul_f32 v[158:159], v[158:159], s[42:43]
    v_cvt_pk_bf16_f32 v172, v152, v153
    v_cvt_pk_bf16_f32 v173, v154, v155
    v_cvt_pk_bf16_f32 v174, v156, v157
    v_cvt_pk_bf16_f32 v175, v158, v159
    buffer_load_dwordx4 v[232:235], v27, s[12:15], 0 offen
    s_waitcnt lgkmcnt(1)
    v_lshlrev_b32 v152, 16, v176
    v_and_b32 v153, 0xffff0000, v176
    v_lshlrev_b32 v154, 16, v177
    v_and_b32 v155, 0xffff0000, v177
    v_lshlrev_b32 v156, 16, v178
    v_and_b32 v157, 0xffff0000, v178
    v_lshlrev_b32 v158, 16, v179
    v_and_b32 v159, 0xffff0000, v179
    v_pk_mul_f32 v[152:153], v[152:153], s[42:43]
    v_pk_mul_f32 v[154:155], v[154:155], s[42:43]
    v_pk_mul_f32 v[156:157], v[156:157], s[42:43]
    v_pk_mul_f32 v[158:159], v[158:159], s[42:43]
    v_cvt_pk_bf16_f32 v176, v152, v153
    v_cvt_pk_bf16_f32 v177, v154, v155
    v_cvt_pk_bf16_f32 v178, v156, v157
    v_cvt_pk_bf16_f32 v179, v158, v159
    buffer_load_dwordx4 v[236:239], v27, s[12:15], 0 offen offset:64
    s_waitcnt lgkmcnt(0)
    v_lshlrev_b32 v152, 16, v180
    v_and_b32 v153, 0xffff0000, v180
    v_lshlrev_b32 v154, 16, v181
    v_and_b32 v155, 0xffff0000, v181
    v_lshlrev_b32 v156, 16, v182
    v_and_b32 v157, 0xffff0000, v182
    v_lshlrev_b32 v158, 16, v183
    v_and_b32 v159, 0xffff0000, v183
    v_pk_mul_f32 v[152:153], v[152:153], s[42:43]
    v_pk_mul_f32 v[154:155], v[154:155], s[42:43]
    v_pk_mul_f32 v[156:157], v[156:157], s[42:43]
    v_pk_mul_f32 v[158:159], v[158:159], s[42:43]
    v_cvt_pk_bf16_f32 v180, v152, v153
    v_cvt_pk_bf16_f32 v181, v154, v155
    v_cvt_pk_bf16_f32 v182, v156, v157
    v_cvt_pk_bf16_f32 v183, v158, v159
    buffer_load_dwordx4 v[240:243], v27, s[12:15], 0 offen offset:128
    v_mfma_f32_16x16x32_bf16 v[64:67], a[192:195], v[160:163], 0
    v_mfma_f32_16x16x32_bf16 v[64:67], a[196:199], v[164:167], v[64:67]
    v_mfma_f32_16x16x32_bf16 v[64:67], a[200:203], v[168:171], v[64:67]
    v_mfma_f32_16x16x32_bf16 v[64:67], a[204:207], v[172:175], v[64:67]
    v_mfma_f32_16x16x32_bf16 v[64:67], a[208:211], v[176:179], v[64:67]
    v_mfma_f32_16x16x32_bf16 v[64:67], a[212:215], v[180:183], v[64:67]
    v_mfma_f32_16x16x32_bf16 v[68:71], a[216:219], v[160:163], 0
    v_mfma_f32_16x16x32_bf16 v[68:71], a[220:223], v[164:167], v[68:71]
    v_mfma_f32_16x16x32_bf16 v[68:71], a[224:227], v[168:171], v[68:71]
    v_mfma_f32_16x16x32_bf16 v[68:71], a[228:231], v[172:175], v[68:71]
    v_mfma_f32_16x16x32_bf16 v[68:71], a[232:235], v[176:179], v[68:71]
    v_mfma_f32_16x16x32_bf16 v[68:71], a[236:239], v[180:183], v[68:71]
    s_nop 1
    v_max3_f32 v32, v64, v65, v66
    s_nop 4
    v_max3_f32 v32, v32, v67, v68
    v_max3_f32 v32, v32, v69, v70
    v_max_f32 v32, v32, v71
    v_mov_b32 v33, v32
    s_nop 1
    v_permlane32_swap_b32 v32, v33
    v_max_f32 v32, v32, v33
    v_mov_b32 v33, v32
    s_nop 1
    v_permlane16_swap_b32 v32, v33
    v_max_f32 v32, v32, v33
    v_sub_f32 v64, v64, v32
    v_exp_f32 v64, v64
    v_sub_f32 v65, v65, v32
    v_exp_f32 v65, v65
    v_sub_f32 v66, v66, v32
    v_exp_f32 v66, v66
    v_sub_f32 v67, v67, v32
    v_exp_f32 v67, v67
    v_cvt_pk_bf16_f32 v112, v64, v65
    v_cvt_pk_bf16_f32 v113, v66, v67
    v_add_f32 v16, v64, v65
    v_add_f32 v16, v16, v66
    v_add_f32 v16, v16, v67
    v_sub_f32 v48, 0, v32
    v_sub_f32 v49, 0, v32
    v_sub_f32 v50, 0, v32
    v_sub_f32 v51, 0, v32
    v_sub_f32 v68, v68, v32
    v_sub_f32 v69, v69, v32
    v_sub_f32 v70, v70, v32
    v_sub_f32 v71, v71, v32
    v_mfma_f32_16x16x32_bf16 v[64:67], a[0:3], v[160:163], v[48:51]
    v_mfma_f32_16x16x32_bf16 v[64:67], a[4:7], v[164:167], v[64:67]
    v_mfma_f32_16x16x32_bf16 v[64:67], a[8:11], v[168:171], v[64:67]
    v_exp_f32 v68, v68
    v_exp_f32 v69, v69
    v_exp_f32 v70, v70
    v_exp_f32 v71, v71
    v_mfma_f32_16x16x32_bf16 v[64:67], a[12:15], v[172:175], v[64:67]
    v_cvt_pk_bf16_f32 v114, v68, v69
    v_cvt_pk_bf16_f32 v115, v70, v71
    v_mfma_f32_16x16x32_bf16 v[64:67], a[16:19], v[176:179], v[64:67]
    v_add_f32 v16, v16, v68
    v_add_f32 v16, v16, v69
    v_mfma_f32_16x16x32_bf16 v[64:67], a[20:23], v[180:183], v[64:67]
    v_add_f32 v16, v16, v70
    v_add_f32 v16, v16, v71
    v_mfma_f32_16x16x32_bf16 v[68:71], a[24:27], v[160:163], v[48:51]
    v_mfma_f32_16x16x32_bf16 v[68:71], a[28:31], v[164:167], v[68:71]
    v_mfma_f32_16x16x32_bf16 v[68:71], a[32:35], v[168:171], v[68:71]
    v_mfma_f32_16x16x32_bf16 v[68:71], a[36:39], v[172:175], v[68:71]
    s_nop 1
    v_exp_f32 v64, v64
    v_mfma_f32_16x16x32_bf16 v[68:71], a[40:43], v[176:179], v[68:71]
    v_exp_f32 v65, v65
    v_mfma_f32_16x16x32_bf16 v[68:71], a[44:47], v[180:183], v[68:71]
    v_exp_f32 v66, v66
    s_waitcnt vmcnt(9)
    ds_read_b128 v[184:187], v24 offset:6144
    ds_read_b128 v[188:191], v25 offset:6144
    ds_read_b128 v[192:195], v24 offset:7168
    ds_read_b128 v[196:199], v25 offset:7168
    ds_read_b128 v[200:203], v24 offset:8192
    ds_read_b128 v[204:207], v25 offset:8192
    s_waitcnt lgkmcnt(5)
    v_lshlrev_b32 v152, 16, v184
    v_and_b32 v153, 0xffff0000, v184
    v_lshlrev_b32 v154, 16, v185
    v_and_b32 v155, 0xffff0000, v185
    v_lshlrev_b32 v156, 16, v186
    v_and_b32 v157, 0xffff0000, v186
    v_lshlrev_b32 v158, 16, v187
    v_and_b32 v159, 0xffff0000, v187
    v_pk_mul_f32 v[152:153], v[152:153], s[42:43]
    v_pk_mul_f32 v[154:155], v[154:155], s[42:43]
    v_pk_mul_f32 v[156:157], v[156:157], s[42:43]
    v_pk_mul_f32 v[158:159], v[158:159], s[42:43]
    v_cvt_pk_bf16_f32 v184, v152, v153
    v_cvt_pk_bf16_f32 v185, v154, v155
    v_cvt_pk_bf16_f32 v186, v156, v157
    v_cvt_pk_bf16_f32 v187, v158, v159
    buffer_load_dwordx4 v[244:247], v27, s[12:15], 0 offen offset:192
    s_waitcnt lgkmcnt(4)
    v_lshlrev_b32 v152, 16, v188
    v_and_b32 v153, 0xffff0000, v188
    v_lshlrev_b32 v154, 16, v189
    v_and_b32 v155, 0xffff0000, v189
    v_lshlrev_b32 v156, 16, v190
    v_and_b32 v157, 0xffff0000, v190
    v_lshlrev_b32 v158, 16, v191
    v_and_b32 v159, 0xffff0000, v191
    v_pk_mul_f32 v[152:153], v[152:153], s[42:43]
    v_pk_mul_f32 v[154:155], v[154:155], s[42:43]
    v_pk_mul_f32 v[156:157], v[156:157], s[42:43]
    v_pk_mul_f32 v[158:159], v[158:159], s[42:43]
    v_cvt_pk_bf16_f32 v188, v152, v153
    v_cvt_pk_bf16_f32 v189, v154, v155
    v_cvt_pk_bf16_f32 v190, v156, v157
    v_cvt_pk_bf16_f32 v191, v158, v159
    buffer_load_dwordx4 v[248:251], v27, s[12:15], 0 offen offset:256
    s_waitcnt lgkmcnt(3)
    v_lshlrev_b32 v152, 16, v192
    v_and_b32 v153, 0xffff0000, v192
    v_lshlrev_b32 v154, 16, v193
    v_and_b32 v155, 0xffff0000, v193
    v_lshlrev_b32 v156, 16, v194
    v_and_b32 v157, 0xffff0000, v194
    v_lshlrev_b32 v158, 16, v195
    v_and_b32 v159, 0xffff0000, v195
    v_pk_mul_f32 v[152:153], v[152:153], s[42:43]
    v_pk_mul_f32 v[154:155], v[154:155], s[42:43]
    v_pk_mul_f32 v[156:157], v[156:157], s[42:43]
    v_pk_mul_f32 v[158:159], v[158:159], s[42:43]
    v_cvt_pk_bf16_f32 v192, v152, v153
    v_cvt_pk_bf16_f32 v193, v154, v155
    v_cvt_pk_bf16_f32 v194, v156, v157
    v_cvt_pk_bf16_f32 v195, v158, v159
    buffer_load_dwordx4 v[252:255], v27, s[12:15], 0 offen offset:320
    s_waitcnt lgkmcnt(2)
    v_lshlrev_b32 v152, 16, v196
    v_and_b32 v153, 0xffff0000, v196
    v_lshlrev_b32 v154, 16, v197
    v_and_b32 v155, 0xffff0000, v197
    v_lshlrev_b32 v156, 16, v198
    v_and_b32 v157, 0xffff0000, v198
    v_lshlrev_b32 v158, 16, v199
    v_and_b32 v159, 0xffff0000, v199
    v_pk_mul_f32 v[152:153], v[152:153], s[42:43]
    v_pk_mul_f32 v[154:155], v[154:155], s[42:43]
    v_pk_mul_f32 v[156:157], v[156:157], s[42:43]
    v_pk_mul_f32 v[158:159], v[158:159], s[42:43]
    v_cvt_pk_bf16_f32 v196, v152, v153
    v_cvt_pk_bf16_f32 v197, v154, v155
    v_cvt_pk_bf16_f32 v198, v156, v157
    v_cvt_pk_bf16_f32 v199, v158, v159
    s_add_u32 m0, s33, 24576
    s_nop 0
    buffer_load_dwordx4 v8, s[16:19], s29 offen nt lds
    s_waitcnt lgkmcnt(1)
    v_lshlrev_b32 v152, 16, v200
    v_and_b32 v153, 0xffff0000, v200
    v_lshlrev_b32 v154, 16, v201
    v_and_b32 v155, 0xffff0000, v201
    v_lshlrev_b32 v156, 16, v202
    v_and_b32 v157, 0xffff0000, v202
    v_lshlrev_b32 v158, 16, v203
    v_and_b32 v159, 0xffff0000, v203
    v_pk_mul_f32 v[152:153], v[152:153], s[42:43]
    v_pk_mul_f32 v[154:155], v[154:155], s[42:43]
    v_pk_mul_f32 v[156:157], v[156:157], s[42:43]
    v_pk_mul_f32 v[158:159], v[158:159], s[42:43]
    v_cvt_pk_bf16_f32 v200, v152, v153
    v_cvt_pk_bf16_f32 v201, v154, v155
    v_cvt_pk_bf16_f32 v202, v156, v157
    v_cvt_pk_bf16_f32 v203, v158, v159
    s_add_u32 m0, s33, 25472
    s_nop 0
    buffer_load_dwordx4 v8, s[16:19], s29 offen offset:128 nt lds
    s_waitcnt lgkmcnt(0)
    v_lshlrev_b32 v152, 16, v204
    v_and_b32 v153, 0xffff0000, v204
    v_lshlrev_b32 v154, 16, v205
    v_and_b32 v155, 0xffff0000, v205
    v_lshlrev_b32 v156, 16, v206
    v_and_b32 v157, 0xffff0000, v206
    v_lshlrev_b32 v158, 16, v207
    v_and_b32 v159, 0xffff0000, v207
    v_pk_mul_f32 v[152:153], v[152:153], s[42:43]
    v_pk_mul_f32 v[154:155], v[154:155], s[42:43]
    v_pk_mul_f32 v[156:157], v[156:157], s[42:43]
    v_pk_mul_f32 v[158:159], v[158:159], s[42:43]
    v_cvt_pk_bf16_f32 v204, v152, v153
    v_cvt_pk_bf16_f32 v205, v154, v155
    v_cvt_pk_bf16_f32 v206, v156, v157
    v_cvt_pk_bf16_f32 v207, v158, v159
    s_add_u32 m0, s33, 26368
    s_nop 0
    buffer_load_dwordx4 v8, s[16:19], s29 offen offset:256 nt lds
    s_add_u32 s29, s29, 12288
    v_mfma_f32_16x16x32_bf16 v[72:75], a[192:195], v[184:187], 0
    v_exp_f32 v67, v67
    v_mfma_f32_16x16x32_bf16 v[72:75], a[196:199], v[188:191], v[72:75]
    v_cvt_pk_bf16_f32 v96, v64, v65
    v_cvt_pk_bf16_f32 v97, v66, v67
    v_mfma_f32_16x16x32_bf16 v[72:75], a[200:203], v[192:195], v[72:75]
    v_add_f32 v16, v16, v64
    v_add_f32 v16, v16, v65
    v_mfma_f32_16x16x32_bf16 v[72:75], a[204:207], v[196:199], v[72:75]
    v_add_f32 v16, v16, v66
    v_add_f32 v16, v16, v67
    v_mfma_f32_16x16x32_bf16 v[72:75], a[208:211], v[200:203], v[72:75]
    v_exp_f32 v68, v68
    v_mfma_f32_16x16x32_bf16 v[72:75], a[212:215], v[204:207], v[72:75]
    v_exp_f32 v69, v69
    v_mfma_f32_16x16x32_bf16 v[76:79], a[216:219], v[184:187], 0
    v_exp_f32 v70, v70
    v_mfma_f32_16x16x32_bf16 v[76:79], a[220:223], v[188:191], v[76:79]
    v_exp_f32 v71, v71
    v_mfma_f32_16x16x32_bf16 v[76:79], a[224:227], v[192:195], v[76:79]
    v_cvt_pk_bf16_f32 v98, v68, v69
    v_cvt_pk_bf16_f32 v99, v70, v71
    v_mfma_f32_16x16x32_bf16 v[76:79], a[228:231], v[196:199], v[76:79]
    v_add_f32 v16, v16, v68
    v_add_f32 v16, v16, v69
    v_mfma_f32_16x16x32_bf16 v[76:79], a[232:235], v[200:203], v[76:79]
    v_add_f32 v16, v16, v70
    v_add_f32 v16, v16, v71
    v_mfma_f32_16x16x32_bf16 v[76:79], a[236:239], v[204:207], v[76:79]
    v_max3_f32 v34, v72, v73, v74
    s_nop 6
    v_max3_f32 v34, v34, v75, v76
    v_max3_f32 v34, v34, v77, v78
    v_max_f32 v34, v34, v79
    v_mov_b32 v35, v34
    s_nop 1
    v_permlane32_swap_b32 v34, v35
    v_max_f32 v34, v34, v35
    v_mov_b32 v35, v34
    s_nop 1
    v_permlane16_swap_b32 v34, v35
    v_max_f32 v34, v34, v35
    v_sub_f32 v72, v72, v34
    v_exp_f32 v72, v72
    v_sub_f32 v73, v73, v34
    v_exp_f32 v73, v73
    v_sub_f32 v74, v74, v34
    v_exp_f32 v74, v74
    v_sub_f32 v75, v75, v34
    v_exp_f32 v75, v75
    v_cvt_pk_bf16_f32 v116, v72, v73
    v_cvt_pk_bf16_f32 v117, v74, v75
    v_add_f32 v17, v72, v73
    v_add_f32 v17, v17, v74
    v_add_f32 v17, v17, v75
    v_sub_f32 v52, 0, v34
    v_sub_f32 v53, 0, v34
    v_sub_f32 v54, 0, v34
    v_sub_f32 v55, 0, v34
    v_sub_f32 v76, v76, v34
    v_sub_f32 v77, v77, v34
    v_sub_f32 v78, v78, v34
    v_sub_f32 v79, v79, v34
    v_mfma_f32_16x16x32_bf16 v[72:75], a[0:3], v[184:187], v[52:55]
    v_mfma_f32_16x16x32_bf16 v[72:75], a[4:7], v[188:191], v[72:75]
    v_mfma_f32_16x16x32_bf16 v[72:75], a[8:11], v[192:195], v[72:75]
    v_exp_f32 v76, v76
    v_exp_f32 v77, v77
    v_exp_f32 v78, v78
    v_exp_f32 v79, v79
    v_mfma_f32_16x16x32_bf16 v[72:75], a[12:15], v[196:199], v[72:75]
    v_cvt_pk_bf16_f32 v118, v76, v77
    v_cvt_pk_bf16_f32 v119, v78, v79
    v_mfma_f32_16x16x32_bf16 v[72:75], a[16:19], v[200:203], v[72:75]
    v_add_f32 v17, v17, v76
    v_add_f32 v17, v17, v77
    v_mfma_f32_16x16x32_bf16 v[72:75], a[20:23], v[204:207], v[72:75]
    v_add_f32 v17, v17, v78
    v_add_f32 v17, v17, v79
    v_mfma_f32_16x16x32_bf16 v[76:79], a[24:27], v[184:187], v[52:55]
    v_mfma_f32_16x16x32_bf16 v[76:79], a[28:31], v[188:191], v[76:79]
    v_mfma_f32_16x16x32_bf16 v[76:79], a[32:35], v[192:195], v[76:79]
    v_mfma_f32_16x16x32_bf16 v[76:79], a[36:39], v[196:199], v[76:79]
    s_nop 1
    v_exp_f32 v72, v72
    v_mfma_f32_16x16x32_bf16 v[76:79], a[40:43], v[200:203], v[76:79]
    v_exp_f32 v73, v73
    v_mfma_f32_16x16x32_bf16 v[76:79], a[44:47], v[204:207], v[76:79]
    v_exp_f32 v74, v74
    v_add_u32 v24, s47, v2
    v_add_u32 v25, s47, v3
    s_waitcnt vmcnt(9)
    ds_read_b128 v[208:211], v24
    ds_read_b128 v[212:215], v25
    ds_read_b128 v[216:219], v24 offset:1024
    ds_read_b128 v[220:223], v25 offset:1024
    ds_read_b128 v[224:227], v24 offset:2048
    ds_read_b128 v[228:231], v25 offset:2048
    s_waitcnt lgkmcnt(5)
    v_lshlrev_b32 v152, 16, v208
    v_and_b32 v153, 0xffff0000, v208
    v_lshlrev_b32 v154, 16, v209
    v_and_b32 v155, 0xffff0000, v209
    v_lshlrev_b32 v156, 16, v210
    v_and_b32 v157, 0xffff0000, v210
    v_lshlrev_b32 v158, 16, v211
    v_and_b32 v159, 0xffff0000, v211
    v_pk_mul_f32 v[152:153], v[152:153], s[42:43]
    v_pk_mul_f32 v[154:155], v[154:155], s[42:43]
    v_pk_mul_f32 v[156:157], v[156:157], s[42:43]
    v_pk_mul_f32 v[158:159], v[158:159], s[42:43]
    v_cvt_pk_bf16_f32 v208, v152, v153
    v_cvt_pk_bf16_f32 v209, v154, v155
    v_cvt_pk_bf16_f32 v210, v156, v157
    v_cvt_pk_bf16_f32 v211, v158, v159
    s_add_u32 m0, s33, 49152
    s_nop 0
    buffer_load_dwordx4 v9, s[20:23], s30 offen nt lds
    s_waitcnt lgkmcnt(4)
    v_lshlrev_b32 v152, 16, v212
    v_and_b32 v153, 0xffff0000, v212
    v_lshlrev_b32 v154, 16, v213
    v_and_b32 v155, 0xffff0000, v213
    v_lshlrev_b32 v156, 16, v214
    v_and_b32 v157, 0xffff0000, v214
    v_lshlrev_b32 v158, 16, v215
    v_and_b32 v159, 0xffff0000, v215
    v_pk_mul_f32 v[152:153], v[152:153], s[42:43]
    v_pk_mul_f32 v[154:155], v[154:155], s[42:43]
    v_pk_mul_f32 v[156:157], v[156:157], s[42:43]
    v_pk_mul_f32 v[158:159], v[158:159], s[42:43]
    v_cvt_pk_bf16_f32 v212, v152, v153
    v_cvt_pk_bf16_f32 v213, v154, v155
    v_cvt_pk_bf16_f32 v214, v156, v157
    v_cvt_pk_bf16_f32 v215, v158, v159
    s_add_u32 m0, s33, 50048
    s_nop 0
    buffer_load_dwordx4 v9, s[20:23], s30 offen offset:128 nt lds
    s_waitcnt lgkmcnt(3)
    v_lshlrev_b32 v152, 16, v216
    v_and_b32 v153, 0xffff0000, v216
    v_lshlrev_b32 v154, 16, v217
    v_and_b32 v155, 0xffff0000, v217
    v_lshlrev_b32 v156, 16, v218
    v_and_b32 v157, 0xffff0000, v218
    v_lshlrev_b32 v158, 16, v219
    v_and_b32 v159, 0xffff0000, v219
    v_pk_mul_f32 v[152:153], v[152:153], s[42:43]
    v_pk_mul_f32 v[154:155], v[154:155], s[42:43]
    v_pk_mul_f32 v[156:157], v[156:157], s[42:43]
    v_pk_mul_f32 v[158:159], v[158:159], s[42:43]
    v_cvt_pk_bf16_f32 v216, v152, v153
    v_cvt_pk_bf16_f32 v217, v154, v155
    v_cvt_pk_bf16_f32 v218, v156, v157
    v_cvt_pk_bf16_f32 v219, v158, v159
    s_add_u32 m0, s33, 50944
    s_nop 0
    buffer_load_dwordx4 v9, s[20:23], s30 offen offset:256 nt lds
    s_waitcnt lgkmcnt(2)
    v_lshlrev_b32 v152, 16, v220
    v_and_b32 v153, 0xffff0000, v220
    v_lshlrev_b32 v154, 16, v221
    v_and_b32 v155, 0xffff0000, v221
    v_lshlrev_b32 v156, 16, v222
    v_and_b32 v157, 0xffff0000, v222
    v_lshlrev_b32 v158, 16, v223
    v_and_b32 v159, 0xffff0000, v223
    v_pk_mul_f32 v[152:153], v[152:153], s[42:43]
    v_pk_mul_f32 v[154:155], v[154:155], s[42:43]
    v_pk_mul_f32 v[156:157], v[156:157], s[42:43]
    v_pk_mul_f32 v[158:159], v[158:159], s[42:43]
    v_cvt_pk_bf16_f32 v220, v152, v153
    v_cvt_pk_bf16_f32 v221, v154, v155
    v_cvt_pk_bf16_f32 v222, v156, v157
    v_cvt_pk_bf16_f32 v223, v158, v159
    s_add_u32 m0, s33, 61440
    s_nop 0
    buffer_load_dwordx4 v9, s[20:23], s32 offen nt lds
    s_waitcnt lgkmcnt(1)
    v_lshlrev_b32 v152, 16, v224
    v_and_b32 v153, 0xffff0000, v224
    v_lshlrev_b32 v154, 16, v225
    v_and_b32 v155, 0xffff0000, v225
    v_lshlrev_b32 v156, 16, v226
    v_and_b32 v157, 0xffff0000, v226
    v_lshlrev_b32 v158, 16, v227
    v_and_b32 v159, 0xffff0000, v227
    v_pk_mul_f32 v[152:153], v[152:153], s[42:43]
    v_pk_mul_f32 v[154:155], v[154:155], s[42:43]
    v_pk_mul_f32 v[156:157], v[156:157], s[42:43]
    v_pk_mul_f32 v[158:159], v[158:159], s[42:43]
    v_cvt_pk_bf16_f32 v224, v152, v153
    v_cvt_pk_bf16_f32 v225, v154, v155
    v_cvt_pk_bf16_f32 v226, v156, v157
    v_cvt_pk_bf16_f32 v227, v158, v159
    s_add_u32 m0, s33, 62336
    s_nop 0
    buffer_load_dwordx4 v9, s[20:23], s32 offen offset:128 nt lds
    s_waitcnt lgkmcnt(0)
    v_lshlrev_b32 v152, 16, v228
    v_and_b32 v153, 0xffff0000, v228
    v_lshlrev_b32 v154, 16, v229
    v_and_b32 v155, 0xffff0000, v229
    v_lshlrev_b32 v156, 16, v230
    v_and_b32 v157, 0xffff0000, v230
    v_lshlrev_b32 v158, 16, v231
    v_and_b32 v159, 0xffff0000, v231
    v_pk_mul_f32 v[152:153], v[152:153], s[42:43]
    v_pk_mul_f32 v[154:155], v[154:155], s[42:43]
    v_pk_mul_f32 v[156:157], v[156:157], s[42:43]
    v_pk_mul_f32 v[158:159], v[158:159], s[42:43]
    v_cvt_pk_bf16_f32 v228, v152, v153
    v_cvt_pk_bf16_f32 v229, v154, v155
    v_cvt_pk_bf16_f32 v230, v156, v157
    v_cvt_pk_bf16_f32 v231, v158, v159
    s_add_u32 m0, s33, 63232
    s_nop 0
    buffer_load_dwordx4 v9, s[20:23], s32 offen offset:256 nt lds
    s_add_u32 s30, s30, 24576
    s_add_u32 s32, s32, 24576
    v_mfma_f32_16x16x32_bf16 v[80:83], a[192:195], v[208:211], 0
    v_exp_f32 v75, v75
    v_mfma_f32_16x16x32_bf16 v[80:83], a[196:199], v[212:215], v[80:83]
    v_cvt_pk_bf16_f32 v100, v72, v73
    v_cvt_pk_bf16_f32 v101, v74, v75
    v_mfma_f32_16x16x32_bf16 v[80:83], a[200:203], v[216:219], v[80:83]
    v_add_f32 v17, v17, v72
    v_add_f32 v17, v17, v73
    v_mfma_f32_16x16x32_bf16 v[80:83], a[204:207], v[220:223], v[80:83]
    v_add_f32 v17, v17, v74
    v_add_f32 v17, v17, v75
    v_mfma_f32_16x16x32_bf16 v[80:83], a[208:211], v[224:227], v[80:83]
    v_exp_f32 v76, v76
    v_mfma_f32_16x16x32_bf16 v[80:83], a[212:215], v[228:231], v[80:83]
    v_exp_f32 v77, v77
    v_mfma_f32_16x16x32_bf16 v[84:87], a[216:219], v[208:211], 0
    v_exp_f32 v78, v78
    v_mfma_f32_16x16x32_bf16 v[84:87], a[220:223], v[212:215], v[84:87]
    v_exp_f32 v79, v79
    v_mfma_f32_16x16x32_bf16 v[84:87], a[224:227], v[216:219], v[84:87]
    v_cvt_pk_bf16_f32 v102, v76, v77
    v_cvt_pk_bf16_f32 v103, v78, v79
    v_mfma_f32_16x16x32_bf16 v[84:87], a[228:231], v[220:223], v[84:87]
    v_add_f32 v17, v17, v76
    v_add_f32 v17, v17, v77
    v_mfma_f32_16x16x32_bf16 v[84:87], a[232:235], v[224:227], v[84:87]
    v_add_f32 v17, v17, v78
    v_add_f32 v17, v17, v79
    v_mfma_f32_16x16x32_bf16 v[84:87], a[236:239], v[228:231], v[84:87]
    v_max3_f32 v36, v80, v81, v82
    s_nop 6
    v_max3_f32 v36, v36, v83, v84
    v_max3_f32 v36, v36, v85, v86
    v_max_f32 v36, v36, v87
    v_mov_b32 v37, v36
    s_nop 1
    v_permlane32_swap_b32 v36, v37
    v_max_f32 v36, v36, v37
    v_mov_b32 v37, v36
    s_nop 1
    v_permlane16_swap_b32 v36, v37
    v_max_f32 v36, v36, v37
    v_sub_f32 v80, v80, v36
    v_exp_f32 v80, v80
    v_sub_f32 v81, v81, v36
    v_exp_f32 v81, v81
    v_sub_f32 v82, v82, v36
    v_exp_f32 v82, v82
    v_sub_f32 v83, v83, v36
    v_exp_f32 v83, v83
    v_cvt_pk_bf16_f32 v120, v80, v81
    v_cvt_pk_bf16_f32 v121, v82, v83
    v_add_f32 v18, v80, v81
    v_add_f32 v18, v18, v82
    v_add_f32 v18, v18, v83
    v_sub_f32 v56, 0, v36
    v_sub_f32 v57, 0, v36
    v_sub_f32 v58, 0, v36
    v_sub_f32 v59, 0, v36
    v_sub_f32 v84, v84, v36
    v_sub_f32 v85, v85, v36
    v_sub_f32 v86, v86, v36
    v_sub_f32 v87, v87, v36
    v_mfma_f32_16x16x32_bf16 v[80:83], a[0:3], v[208:211], v[56:59]
    v_mfma_f32_16x16x32_bf16 v[80:83], a[4:7], v[212:215], v[80:83]
    v_mfma_f32_16x16x32_bf16 v[80:83], a[8:11], v[216:219], v[80:83]
    v_exp_f32 v84, v84
    v_exp_f32 v85, v85
    v_exp_f32 v86, v86
    v_exp_f32 v87, v87
    v_mfma_f32_16x16x32_bf16 v[80:83], a[12:15], v[220:223], v[80:83]
    v_cvt_pk_bf16_f32 v122, v84, v85
    v_cvt_pk_bf16_f32 v123, v86, v87
    v_mfma_f32_16x16x32_bf16 v[80:83], a[16:19], v[224:227], v[80:83]
    v_add_f32 v18, v18, v84
    v_add_f32 v18, v18, v85
    v_mfma_f32_16x16x32_bf16 v[80:83], a[20:23], v[228:231], v[80:83]
    v_add_f32 v18, v18, v86
    v_add_f32 v18, v18, v87
    v_mfma_f32_16x16x32_bf16 v[84:87], a[24:27], v[208:211], v[56:59]
    v_mfma_f32_16x16x32_bf16 v[84:87], a[28:31], v[212:215], v[84:87]
    v_mfma_f32_16x16x32_bf16 v[84:87], a[32:35], v[216:219], v[84:87]
    v_mfma_f32_16x16x32_bf16 v[84:87], a[36:39], v[220:223], v[84:87]
    s_nop 1
    v_exp_f32 v80, v80
    v_mfma_f32_16x16x32_bf16 v[84:87], a[40:43], v[224:227], v[84:87]
    v_exp_f32 v81, v81
    v_mfma_f32_16x16x32_bf16 v[84:87], a[44:47], v[228:231], v[84:87]
    v_exp_f32 v82, v82
    s_waitcnt vmcnt(14)
    v_lshlrev_b32 v152, 16, v232
    v_and_b32 v153, 0xffff0000, v232
    v_lshlrev_b32 v154, 16, v233
    v_and_b32 v155, 0xffff0000, v233
    v_lshlrev_b32 v156, 16, v234
    v_and_b32 v157, 0xffff0000, v234
    v_lshlrev_b32 v158, 16, v235
    v_and_b32 v159, 0xffff0000, v235
    v_pk_mul_f32 v[152:153], v[152:153], s[42:43]
    v_pk_mul_f32 v[154:155], v[154:155], s[42:43]
    v_pk_mul_f32 v[156:157], v[156:157], s[42:43]
    v_pk_mul_f32 v[158:159], v[158:159], s[42:43]
    v_cvt_pk_bf16_f32 v232, v152, v153
    v_cvt_pk_bf16_f32 v233, v154, v155
    v_cvt_pk_bf16_f32 v234, v156, v157
    v_cvt_pk_bf16_f32 v235, v158, v159
    s_add_u32 m0, s33, 36864
    s_nop 0
    buffer_load_dwordx4 v8, s[16:19], s29 offen nt lds
    s_waitcnt vmcnt(14)
    v_lshlrev_b32 v152, 16, v236
    v_and_b32 v153, 0xffff0000, v236
    v_lshlrev_b32 v154, 16, v237
    v_and_b32 v155, 0xffff0000, v237
    v_lshlrev_b32 v156, 16, v238
    v_and_b32 v157, 0xffff0000, v238
    v_lshlrev_b32 v158, 16, v239
    v_and_b32 v159, 0xffff0000, v239
    v_pk_mul_f32 v[152:153], v[152:153], s[42:43]
    v_pk_mul_f32 v[154:155], v[154:155], s[42:43]
    v_pk_mul_f32 v[156:157], v[156:157], s[42:43]
    v_pk_mul_f32 v[158:159], v[158:159], s[42:43]
    v_cvt_pk_bf16_f32 v236, v152, v153
    v_cvt_pk_bf16_f32 v237, v154, v155
    v_cvt_pk_bf16_f32 v238, v156, v157
    v_cvt_pk_bf16_f32 v239, v158, v159
    s_add_u32 m0, s33, 37760
    s_nop 0
    buffer_load_dwordx4 v8, s[16:19], s29 offen offset:128 nt lds
    s_waitcnt vmcnt(14)
    v_lshlrev_b32 v152, 16, v240
    v_and_b32 v153, 0xffff0000, v240
    v_lshlrev_b32 v154, 16, v241
    v_and_b32 v155, 0xffff0000, v241
    v_lshlrev_b32 v156, 16, v242
    v_and_b32 v157, 0xffff0000, v242
    v_lshlrev_b32 v158, 16, v243
    v_and_b32 v159, 0xffff0000, v243
    v_pk_mul_f32 v[152:153], v[152:153], s[42:43]
    v_pk_mul_f32 v[154:155], v[154:155], s[42:43]
    v_pk_mul_f32 v[156:157], v[156:157], s[42:43]
    v_pk_mul_f32 v[158:159], v[158:159], s[42:43]
    v_cvt_pk_bf16_f32 v240, v152, v153
    v_cvt_pk_bf16_f32 v241, v154, v155
    v_cvt_pk_bf16_f32 v242, v156, v157
    v_cvt_pk_bf16_f32 v243, v158, v159
    s_add_u32 m0, s33, 38656
    s_nop 0
    buffer_load_dwordx4 v8, s[16:19], s29 offen offset:256 nt lds
    s_add_u32 s29, s29, 12288
    s_waitcnt vmcnt(14)
    v_lshlrev_b32 v152, 16, v244
    v_and_b32 v153, 0xffff0000, v244
    v_lshlrev_b32 v154, 16, v245
    v_and_b32 v155, 0xffff0000, v245
    v_lshlrev_b32 v156, 16, v246
    v_and_b32 v157, 0xffff0000, v246
    v_lshlrev_b32 v158, 16, v247
    v_and_b32 v159, 0xffff0000, v247
    v_pk_mul_f32 v[152:153], v[152:153], s[42:43]
    v_pk_mul_f32 v[154:155], v[154:155], s[42:43]
    v_pk_mul_f32 v[156:157], v[156:157], s[42:43]
    v_pk_mul_f32 v[158:159], v[158:159], s[42:43]
    v_cvt_pk_bf16_f32 v244, v152, v153
    v_cvt_pk_bf16_f32 v245, v154, v155
    v_cvt_pk_bf16_f32 v246, v156, v157
    v_cvt_pk_bf16_f32 v247, v158, v159
    s_waitcnt vmcnt(13)
    v_lshlrev_b32 v152, 16, v248
    v_and_b32 v153, 0xffff0000, v248
    v_lshlrev_b32 v154, 16, v249
    v_and_b32 v155, 0xffff0000, v249
    v_lshlrev_b32 v156, 16, v250
    v_and_b32 v157, 0xffff0000, v250
    v_lshlrev_b32 v158, 16, v251
    v_and_b32 v159, 0xffff0000, v251
    v_pk_mul_f32 v[152:153], v[152:153], s[42:43]
    v_pk_mul_f32 v[154:155], v[154:155], s[42:43]
    v_pk_mul_f32 v[156:157], v[156:157], s[42:43]
    v_pk_mul_f32 v[158:159], v[158:159], s[42:43]
    v_cvt_pk_bf16_f32 v248, v152, v153
    v_cvt_pk_bf16_f32 v249, v154, v155
    v_cvt_pk_bf16_f32 v250, v156, v157
    v_cvt_pk_bf16_f32 v251, v158, v159
    s_waitcnt vmcnt(12)
    v_lshlrev_b32 v152, 16, v252
    v_and_b32 v153, 0xffff0000, v252
    v_lshlrev_b32 v154, 16, v253
    v_and_b32 v155, 0xffff0000, v253
    v_lshlrev_b32 v156, 16, v254
    v_and_b32 v157, 0xffff0000, v254
    v_lshlrev_b32 v158, 16, v255
    v_and_b32 v159, 0xffff0000, v255
    v_pk_mul_f32 v[152:153], v[152:153], s[42:43]
    v_pk_mul_f32 v[154:155], v[154:155], s[42:43]
    v_pk_mul_f32 v[156:157], v[156:157], s[42:43]
    v_pk_mul_f32 v[158:159], v[158:159], s[42:43]
    v_cvt_pk_bf16_f32 v252, v152, v153
    v_cvt_pk_bf16_f32 v253, v154, v155
    v_cvt_pk_bf16_f32 v254, v156, v157
    v_cvt_pk_bf16_f32 v255, v158, v159
    s_add_u32 s48, s52, 0
    s_mul_i32 s49, s48, 165888
    s_add_u32 s24, s10, s49
    s_addc_u32 s25, s11, 0
    s_mov_b32 s37, s39
    s_mov_b32 s38, s40
    s_mov_b32 s48, 0x7149f2ca
    s_cmp_ge_u32 s38, 165888
    s_cselect_b32 s86, s48, 0xff800000
    s_xor_b32 s49, s53, 1
    s_mul_i32 s49, s49, 86016
    s_mul_i32 s50, s28, 18432
    s_add_u32 s39, s49, s50
    s_lshr_b32 s50, s28, 1
    s_mul_i32 s50, s50, 6144
    s_add_u32 s50, s50, 73728
    s_add_u32 s40, s49, s50
    s_mov_b32 s44, s39
    s_add_u32 s45, s39, 6144
    s_add_u32 s46, s39, 12288
    s_add_u32 s48, s52, 1
    s_mul_i32 s49, s48, 165888
    s_add_u32 s12, s4, s49
    s_addc_u32 s13, s5, 0
    s_mov_b32 s80, s12
    s_mov_b32 s81, s13
    s_mov_b32 s82, 0
    s_mov_b32 s84, s39
    s_mov_b32 s89, s90
    s_add_u32 s96, s39, 24576
    s_and_b32 s48, s28, 1
    s_mul_i32 s48, s48, 3072
    s_add_u32 s97, s40, s48
    s_min_u32 s97, s97, 162816
    s_mov_b32 s85, -13056
    s_add_u32 s48, s90, 13056
    v_lshl_add_u32 v44, v1, 4, s48
    v_mfma_f32_16x16x32_bf16 v[88:91], a[192:195], v[232:235], 0
    v_exp_f32 v83, v83
    v_mfma_f32_16x16x32_bf16 v[88:91], a[196:199], v[236:239], v[88:91]
    v_cvt_pk_bf16_f32 v104, v80, v81
    v_cvt_pk_bf16_f32 v105, v82, v83
    v_mfma_f32_16x16x32_bf16 v[88:91], a[200:203], v[240:243], v[88:91]
    v_add_f32 v18, v18, v80
    v_add_f32 v18, v18, v81
    v_mfma_f32_16x16x32_bf16 v[88:91], a[204:207], v[244:247], v[88:91]
    v_add_f32 v18, v18, v82
    v_add_f32 v18, v18, v83
    v_mfma_f32_16x16x32_bf16 v[88:91], a[208:211], v[248:251], v[88:91]
    v_exp_f32 v84, v84
    v_mfma_f32_16x16x32_bf16 v[88:91], a[212:215], v[252:255], v[88:91]
    v_exp_f32 v85, v85
    v_mfma_f32_16x16x32_bf16 v[92:95], a[216:219], v[232:235], 0
    v_exp_f32 v86, v86
    v_mfma_f32_16x16x32_bf16 v[92:95], a[220:223], v[236:239], v[92:95]
    v_exp_f32 v87, v87
    v_mfma_f32_16x16x32_bf16 v[92:95], a[224:227], v[240:243], v[92:95]
    v_cvt_pk_bf16_f32 v106, v84, v85
    v_cvt_pk_bf16_f32 v107, v86, v87
    v_mfma_f32_16x16x32_bf16 v[92:95], a[228:231], v[244:247], v[92:95]
    v_add_f32 v18, v18, v84
    v_add_f32 v18, v18, v85
    v_mfma_f32_16x16x32_bf16 v[92:95], a[232:235], v[248:251], v[92:95]
    v_add_f32 v18, v18, v86
    v_add_f32 v18, v18, v87
    v_mfma_f32_16x16x32_bf16 v[92:95], a[236:239], v[252:255], v[92:95]
    v_max3_f32 v28, v16, v17, v18
    s_waitcnt vmcnt(9)
    s_barrier
    ds_read_b128 a[192:195], v2 offset:24576
    ds_read_b128 a[196:199], v3 offset:24576
    ds_read_b128 a[200:203], v2 offset:25600
    ds_read_b128 a[204:207], v3 offset:25600
    ds_read_b128 a[208:211], v2 offset:26624
    ds_read_b128 a[212:215], v3 offset:26624
    ds_read_b128 a[216:219], v2 offset:30720
    ds_read_b128 a[220:223], v3 offset:30720
    ds_read_b128 a[224:227], v2 offset:31744
    ds_read_b128 a[228:231], v3 offset:31744
    s_add_u32 m0, s33, 0
    s_nop 0
    buffer_load_dwordx4 v8, s[16:19], s29 offen nt lds
    s_add_u32 m0, s33, 896
    s_nop 0
    buffer_load_dwordx4 v8, s[16:19], s29 offen offset:128 nt lds
    s_add_u32 m0, s33, 1792
    s_nop 0
    buffer_load_dwordx4 v8, s[16:19], s29 offen offset:256 nt lds
    s_add_u32 s29, s29, 12288
    s_add_u32 m0, s33, 73728
    s_nop 0
    buffer_load_dwordx4 v9, s[20:23], s30 offen nt lds
    s_add_u32 m0, s33, 86016
    s_nop 0
    buffer_load_dwordx4 v9, s[20:23], s32 offen nt lds
    v_max3_f32 v38, v88, v89, v90
    v_max3_f32 v38, v38, v91, v92
    v_max3_f32 v38, v38, v93, v94
    v_max3_f32 v38, v38, v95, s86
    v_mov_b32 v39, v38
    s_nop 1
    v_permlane32_swap_b32 v38, v39
    v_max_f32 v38, v38, v39
    v_mov_b32 v39, v38
    s_nop 1
    v_permlane16_swap_b32 v38, v39
    v_max_f32 v38, v38, v39
    v_sub_f32 v60, 0, v38
    v_sub_f32 v61, 0, v38
    v_sub_f32 v62, 0, v38
    v_sub_f32 v63, 0, v38
    s_nop 1
    v_mfma_f32_16x16x32_bf16 v[88:91], a[0:3], v[232:235], v[60:63]
    ds_read_b128 a[232:235], v2 offset:32768
    v_mfma_f32_16x16x32_bf16 v[88:91], a[4:7], v[236:239], v[88:91]
    v_mfma_f32_16x16x32_bf16 v[88:91], a[8:11], v[240:243], v[88:91]
    ds_read_b128 a[236:239], v3 offset:32768
    v_mfma_f32_16x16x32_bf16 v[88:91], a[12:15], v[244:247], v[88:91]
    v_mfma_f32_16x16x32_bf16 v[88:91], a[16:19], v[248:251], v[88:91]
    v_mfma_f32_16x16x32_bf16 v[88:91], a[20:23], v[252:255], v[88:91]
    v_mfma_f32_16x16x32_bf16 v[92:95], a[24:27], v[232:235], v[60:63]
    v_mfma_f32_16x16x32_bf16 v[92:95], a[28:31], v[236:239], v[92:95]
    v_mfma_f32_16x16x32_bf16 v[92:95], a[32:35], v[240:243], v[92:95]
    v_mfma_f32_16x16x32_bf16 v[92:95], a[36:39], v[244:247], v[92:95]
    s_nop 3
    v_exp_f32 v88, v88
    v_mfma_f32_16x16x32_bf16 v[92:95], a[40:43], v[248:251], v[92:95]
    v_exp_f32 v89, v89
    v_mfma_f32_16x16x32_bf16 v[92:95], a[44:47], v[252:255], v[92:95]
    v_exp_f32 v90, v90
    s_waitcnt vmcnt(5) lgkmcnt(0)
    s_barrier
    v_mfma_f32_16x16x32_bf16 v[64:67], a[192:195], v[160:163], v[48:51]
    s_add_u32 m0, s33, 12288
    v_exp_f32 v91, v91
    v_mfma_f32_16x16x32_bf16 v[64:67], a[196:199], v[164:167], v[64:67]
    buffer_load_dwordx4 v8, s[16:19], s29 offen nt lds
    v_mfma_f32_16x16x32_bf16 v[64:67], a[200:203], v[168:171], v[64:67]
    ds_read_b64_tr_b16 v[152:153], v4
    v_cvt_pk_bf16_f32 v108, v88, v89
    v_mfma_f32_16x16x32_bf16 v[64:67], a[204:207], v[172:175], v[64:67]
    v_exp_f32 v92, v92
    v_mfma_f32_16x16x32_bf16 v[64:67], a[208:211], v[176:179], v[64:67]
    v_exp_f32 v93, v93
    v_mfma_f32_16x16x32_bf16 v[64:67], a[212:215], v[180:183], v[64:67]
    s_add_u32 m0, s33, 13184
    v_exp_f32 v94, v94
    v_mfma_f32_16x16x32_bf16 v[72:75], a[192:195], v[184:187], v[52:55]
    buffer_load_dwordx4 v8, s[16:19], s29 offen offset:128 nt lds
    v_mfma_f32_16x16x32_bf16 v[72:75], a[196:199], v[188:191], v[72:75]
    v_exp_f32 v95, v95
    v_mfma_f32_16x16x32_bf16 v[72:75], a[200:203], v[192:195], v[72:75]
    ds_read_b64_tr_b16 v[154:155], v4 offset:6144
    v_cvt_pk_bf16_f32 v109, v90, v91
    v_mfma_f32_16x16x32_bf16 v[72:75], a[204:207], v[196:199], v[72:75]
    ds_read_b64_tr_b16 v[156:157], v4 offset:12288
    v_cvt_pk_bf16_f32 v110, v92, v93
    v_mfma_f32_16x16x32_bf16 v[72:75], a[208:211], v[200:203], v[72:75]
    s_add_u32 m0, s33, 14080
    ds_read_b64_tr_b16 v[158:159], v4 offset:18432
    v_cvt_pk_bf16_f32 v111, v94, v95
    v_mfma_f32_16x16x32_bf16 v[72:75], a[212:215], v[204:207], v[72:75]
    buffer_load_dwordx4 v8, s[16:19], s29 offen offset:256 nt lds
    v_mfma_f32_16x16x32_bf16 v[80:83], a[192:195], v[208:211], v[56:59]
    s_add_u32 s29, s29, 12288
    ds_read_b128 a[192:195], v2 offset:36864
    v_add_f32 v22, v88, v89
    v_mfma_f32_16x16x32_bf16 v[80:83], a[196:199], v[212:215], v[80:83]
    ds_read_b64_tr_b16 a[240:241], v5
    v_add_f32 v22, v22, v90
    v_mfma_f32_16x16x32_bf16 v[80:83], a[200:203], v[216:219], v[80:83]
    ds_read_b128 a[196:199], v3 offset:36864
    v_add_f32 v22, v22, v91
    v_mfma_f32_16x16x32_bf16 v[80:83], a[204:207], v[220:223], v[80:83]
    s_add_u32 m0, s33, 74624
    ds_read_b64_tr_b16 a[242:243], v5 offset:6144
    v_add_f32 v22, v22, v92
    v_mfma_f32_16x16x32_bf16 v[80:83], a[208:211], v[224:227], v[80:83]
    buffer_load_dwordx4 v9, s[20:23], s30 offen offset:128 nt lds
    v_mfma_f32_16x16x32_bf16 v[80:83], a[212:215], v[228:231], v[80:83]
    ds_read_b128 a[200:203], v2 offset:37888
    v_add_f32 v22, v22, v93
    v_mfma_f32_16x16x32_bf16 v[68:71], a[216:219], v[160:163], v[48:51]
    ds_read_b64_tr_b16 a[244:245], v5 offset:12288
    v_add_f32 v22, v22, v94
    v_mfma_f32_16x16x32_bf16 v[68:71], a[220:223], v[164:167], v[68:71]
    ds_read_b128 a[204:207], v3 offset:37888
    v_add_f32 v22, v22, v95
    v_mfma_f32_16x16x32_bf16 v[68:71], a[224:227], v[168:171], v[68:71]
    s_add_u32 m0, s33, 75520
    ds_read_b64_tr_b16 a[246:247], v5 offset:18432
    v_max_f32 v28, v28, v22
    v_mfma_f32_16x16x32_bf16 v[68:71], a[228:231], v[172:175], v[68:71]
    buffer_load_dwordx4 v9, s[20:23], s30 offen offset:256 nt lds
    v_mfma_f32_16x16x32_bf16 v[68:71], a[232:235], v[176:179], v[68:71]
    v_exp_f32 v64, v64
    v_mfma_f32_16x16x32_bf16 v[68:71], a[236:239], v[180:183], v[68:71]
    v_exp_f32 v65, v65
    v_mfma_f32_16x16x32_bf16 v[76:79], a[216:219], v[184:187], v[52:55]
    ds_read_b128 a[208:211], v2 offset:38912
    v_cvt_pk_bf16_f32 v140, v64, v65
    v_mfma_f32_16x16x32_bf16 v[76:79], a[220:223], v[188:191], v[76:79]
    s_add_u32 m0, s33, 86912
    ds_read_b64_tr_b16 a[248:249], v6
    v_add_f32 v19, v64, v65
    v_mfma_f32_16x16x32_bf16 v[76:79], a[224:227], v[192:195], v[76:79]
    buffer_load_dwordx4 v9, s[20:23], s32 offen offset:128 nt lds
    v_mfma_f32_16x16x32_bf16 v[76:79], a[228:231], v[196:199], v[76:79]
    v_exp_f32 v66, v66
    v_mfma_f32_16x16x32_bf16 v[76:79], a[232:235], v[200:203], v[76:79]
    ds_read_b128 a[212:215], v3 offset:38912
    v_add_f32 v19, v19, v66
    v_mfma_f32_16x16x32_bf16 v[76:79], a[236:239], v[204:207], v[76:79]
    v_exp_f32 v67, v67
    v_mfma_f32_16x16x32_bf16 v[84:87], a[216:219], v[208:211], v[56:59]
    ds_read_b128 a[216:219], v2 offset:43008
    v_cvt_pk_bf16_f32 v141, v66, v67
    v_mfma_f32_16x16x32_bf16 v[84:87], a[220:223], v[212:215], v[84:87]
    s_add_u32 m0, s33, 87808
    ds_read_b64_tr_b16 a[250:251], v6 offset:6144
    v_cmp_lt_f32 vcc, s35, v28
    v_mfma_f32_16x16x32_bf16 v[84:87], a[224:227], v[216:219], v[84:87]
    buffer_load_dwordx4 v9, s[20:23], s32 offen offset:256 nt lds
    v_mfma_f32_16x16x32_bf16 v[84:87], a[228:231], v[220:223], v[84:87]
    s_add_u32 s30, s30, 24576
    ds_read_b128 a[220:223], v3 offset:43008
    v_add_f32 v19, v19, v67
    v_mfma_f32_16x16x32_bf16 v[84:87], a[232:235], v[224:227], v[84:87]
    s_add_u32 m0, s33, 24576
    v_exp_f32 v72, v72
    v_mfma_f32_16x16x32_bf16 v[84:87], a[236:239], v[228:231], v[84:87]
    s_waitcnt lgkmcnt(3)
    s_cbranch_vccnz L_s1_2c_rare
L_s1_2c_back:
    v_exp_f32 v73, v73
    v_mfma_f32_16x16x32_bf16 a[0:3], v[152:155], v[112:115], 0
    s_add_u32 s32, s32, 24576
    buffer_load_dwordx4 v8, s[16:19], s29 offen nt lds
    v_mfma_f32_16x16x32_bf16 a[0:3], v[156:159], v[96:99], a[0:3]
    ds_read_b64_tr_b16 a[252:253], v6 offset:12288
    v_mov_b32 v12, v16
    v_mfma_f32_16x16x32_bf16 a[48:51], v[152:155], v[116:119], 0
    ds_read_b64_tr_b16 a[254:255], v6 offset:18432
    v_mov_b32 v13, v17
    v_mfma_f32_16x16x32_bf16 a[48:51], v[156:159], v[100:103], a[48:51]
    ds_read_b128 a[224:227], v2 offset:44032
    v_mov_b32 v14, v18
    v_mfma_f32_16x16x32_bf16 a[96:99], v[152:155], v[120:123], 0
    s_add_u32 m0, s33, 25472
    ds_read_b64_tr_b16 v[152:153], v7
    v_mov_b32 v15, v22
    v_mfma_f32_16x16x32_bf16 a[96:99], v[156:159], v[104:107], a[96:99]
    buffer_load_dwordx4 v8, s[16:19], s29 offen offset:128 nt lds
    v_mfma_f32_16x16x32_bf16 a[144:147], v[156:159], v[108:111], 0
    ds_read_b128 a[228:231], v3 offset:44032
    v_cvt_pk_bf16_f32 v144, v72, v73
    v_mfma_f32_16x16x32_bf16 a[4:7], a[240:243], v[112:115], 0
    ds_read_b64_tr_b16 v[154:155], v7 offset:6144
    v_add_f32 v20, v72, v73
    v_mfma_f32_16x16x32_bf16 a[4:7], a[244:247], v[96:99], a[4:7]
    v_exp_f32 v74, v74
    v_mfma_f32_16x16x32_bf16 a[52:55], a[240:243], v[116:119], 0
    ds_read_b64_tr_b16 v[156:157], v7 offset:12288
    v_add_f32 v20, v20, v74
    v_mfma_f32_16x16x32_bf16 a[52:55], a[244:247], v[100:103], a[52:55]
    ds_read_b64_tr_b16 v[158:159], v7 offset:18432
    v_mfma_f32_16x16x32_bf16 a[100:103], a[240:243], v[120:123], 0
    s_add_u32 m0, s33, 26368
    ds_read_b128 a[232:235], v2 offset:45056
    v_mfma_f32_16x16x32_bf16 a[100:103], a[244:247], v[104:107], a[100:103]
    buffer_load_dwordx4 v8, s[16:19], s29 offen offset:256 nt lds
    v_mfma_f32_16x16x32_bf16 a[148:151], a[244:247], v[108:111], 0
    s_waitcnt lgkmcnt(4)
    s_add_u32 s29, s29, 12288
    ds_read_b128 a[236:239], v3 offset:45056
    v_mfma_f32_16x16x32_bf16 a[8:11], a[248:251], v[112:115], 0
    v_exp_f32 v75, v75
    v_mfma_f32_16x16x32_bf16 a[8:11], a[252:255], v[96:99], a[8:11]
    s_waitcnt vmcnt(12)
    ds_inc_u32 v46, v46
    v_cvt_pk_bf16_f32 v145, v74, v75
    v_mfma_f32_16x16x32_bf16 a[56:59], a[248:251], v[116:119], 0
    v_exp_f32 v80, v80
    v_mfma_f32_16x16x32_bf16 a[56:59], a[252:255], v[100:103], a[56:59]
    v_exp_f32 v81, v81
    v_mfma_f32_16x16x32_bf16 a[104:107], a[248:251], v[120:123], 0
    v_add_f32 v20, v20, v75
    v_cvt_pk_bf16_f32 v148, v80, v81
    v_mfma_f32_16x16x32_bf16 a[104:107], a[252:255], v[104:107], a[104:107]
    v_exp_f32 v82, v82
    v_mfma_f32_16x16x32_bf16 a[152:155], a[252:255], v[108:111], 0
    s_waitcnt lgkmcnt(1)
    v_exp_f32 v83, v83
    v_mfma_f32_16x16x32_bf16 a[12:15], v[152:155], v[112:115], 0
    v_cvt_pk_bf16_f32 v149, v82, v83
    v_add_f32 v21, v80, v81
    v_mfma_f32_16x16x32_bf16 a[12:15], v[156:159], v[96:99], a[12:15]
    v_add_f32 v21, v21, v82
    v_add_f32 v21, v21, v83
    v_mfma_f32_16x16x32_bf16 a[60:63], v[152:155], v[116:119], 0
    v_exp_f32 v68, v68
    v_mfma_f32_16x16x32_bf16 a[60:63], v[156:159], v[100:103], a[60:63]
    v_exp_f32 v69, v69
    v_mfma_f32_16x16x32_bf16 a[108:111], v[152:155], v[120:123], 0
    v_exp_f32 v70, v70
    v_mfma_f32_16x16x32_bf16 a[108:111], v[156:159], v[104:107], a[108:111]
    v_exp_f32 v71, v71
    v_mfma_f32_16x16x32_bf16 a[156:159], v[156:159], v[108:111], 0
    v_cvt_pk_bf16_f32 v142, v68, v69
    v_cvt_pk_bf16_f32 v143, v70, v71
    v_mfma_f32_16x16x32_bf16 v[64:67], a[192:195], v[160:163], v[48:51]
    v_add_f32 v19, v19, v68
    v_add_f32 v19, v19, v69
    v_mfma_f32_16x16x32_bf16 v[64:67], a[196:199], v[164:167], v[64:67]
    v_add_f32 v19, v19, v70
    v_add_f32 v19, v19, v71
    v_mfma_f32_16x16x32_bf16 v[64:67], a[200:203], v[168:171], v[64:67]
    v_exp_f32 v76, v76
    v_mfma_f32_16x16x32_bf16 v[64:67], a[204:207], v[172:175], v[64:67]
    v_exp_f32 v77, v77
    v_mfma_f32_16x16x32_bf16 v[64:67], a[208:211], v[176:179], v[64:67]
    v_exp_f32 v78, v78
    v_mfma_f32_16x16x32_bf16 v[64:67], a[212:215], v[180:183], v[64:67]
    v_exp_f32 v79, v79
    v_mfma_f32_16x16x32_bf16 v[72:75], a[192:195], v[184:187], v[52:55]
    v_cvt_pk_bf16_f32 v146, v76, v77
    v_cvt_pk_bf16_f32 v147, v78, v79
    v_mfma_f32_16x16x32_bf16 v[72:75], a[196:199], v[188:191], v[72:75]
    v_add_f32 v20, v20, v76
    v_add_f32 v20, v20, v77
    v_mfma_f32_16x16x32_bf16 v[72:75], a[200:203], v[192:195], v[72:75]
    v_add_f32 v20, v20, v78
    v_add_f32 v20, v20, v79
    v_mfma_f32_16x16x32_bf16 v[72:75], a[204:207], v[196:199], v[72:75]
    v_exp_f32 v84, v84
    v_mfma_f32_16x16x32_bf16 v[72:75], a[208:211], v[200:203], v[72:75]
    v_exp_f32 v85, v85
    v_mfma_f32_16x16x32_bf16 v[72:75], a[212:215], v[204:207], v[72:75]
    v_exp_f32 v86, v86
    v_mfma_f32_16x16x32_bf16 v[80:83], a[192:195], v[208:211], v[56:59]
    v_exp_f32 v87, v87
    v_mfma_f32_16x16x32_bf16 v[80:83], a[196:199], v[212:215], v[80:83]
    ds_read_b32 v30, v46
    v_cvt_pk_bf16_f32 v150, v84, v85
    v_mfma_f32_16x16x32_bf16 v[80:83], a[200:203], v[216:219], v[80:83]
    v_cvt_pk_bf16_f32 v151, v86, v87
    v_add_f32 v21, v21, v84
    v_mfma_f32_16x16x32_bf16 v[80:83], a[204:207], v[220:223], v[80:83]
    v_add_f32 v21, v21, v85
    v_add_f32 v21, v21, v86
    v_mfma_f32_16x16x32_bf16 v[80:83], a[208:211], v[224:227], v[80:83]
    v_exp_f32 v64, v64
    v_mfma_f32_16x16x32_bf16 v[80:83], a[212:215], v[228:231], v[80:83]
    v_add_f32 v21, v21, v87
    v_add_f32 v19, v19, v64
    v_mfma_f32_16x16x32_bf16 v[88:91], a[192:195], v[232:235], v[60:63]
    v_exp_f32 v65, v65
    v_mfma_f32_16x16x32_bf16 v[88:91], a[196:199], v[236:239], v[88:91]
    v_exp_f32 v66, v66
    v_mfma_f32_16x16x32_bf16 v[88:91], a[200:203], v[240:243], v[88:91]
    s_waitcnt lgkmcnt(0)
    v_cmp_gt_u32 vcc, s93, v30
    v_cvt_pk_bf16_f32 v124, v64, v65
    v_mfma_f32_16x16x32_bf16 v[88:91], a[204:207], v[244:247], v[88:91]
    v_exp_f32 v67, v67
    v_mfma_f32_16x16x32_bf16 v[88:91], a[208:211], v[248:251], v[88:91]
    s_add_u32 m0, s33, 49152
    v_cvt_pk_bf16_f32 v125, v66, v67
    v_add_f32 v19, v19, v65
    v_mfma_f32_16x16x32_bf16 v[88:91], a[212:215], v[252:255], v[88:91]
    s_cbranch_vccnz L_s1_3s_rare
L_s1_3s_back:
    ds_read_b64_tr_b16 a[240:241], v4 offset:1024
    v_add_f32 v19, v19, v66
    v_mfma_f32_16x16x32_bf16 v[68:71], a[216:219], v[160:163], v[48:51]
    s_add_u32 s93, s93, 4
    buffer_load_dwordx4 v9, s[20:23], s30 offen nt lds
    v_mfma_f32_16x16x32_bf16 v[68:71], a[220:223], v[164:167], v[68:71]
    ds_read_b64_tr_b16 a[242:243], v4 offset:7168
    v_add_f32 v19, v19, v67
    v_mfma_f32_16x16x32_bf16 v[68:71], a[224:227], v[168:171], v[68:71]
    v_exp_f32 v72, v72
    v_mfma_f32_16x16x32_bf16 v[68:71], a[228:231], v[172:175], v[68:71]
    ds_read_b64_tr_b16 a[244:245], v4 offset:13312
    v_add_f32 v20, v20, v72
    v_mfma_f32_16x16x32_bf16 v[68:71], a[232:235], v[176:179], v[68:71]
    v_exp_f32 v73, v73
    v_mfma_f32_16x16x32_bf16 v[68:71], a[236:239], v[180:183], v[68:71]
    ds_read_b64_tr_b16 a[246:247], v4 offset:19456
    v_cvt_pk_bf16_f32 v128, v72, v73
    v_mfma_f32_16x16x32_bf16 v[76:79], a[216:219], v[184:187], v[52:55]
    ds_read_b64_tr_b16 a[248:249], v5 offset:1024
    v_add_f32 v20, v20, v73
    v_mfma_f32_16x16x32_bf16 v[76:79], a[220:223], v[188:191], v[76:79]
    v_exp_f32 v74, v74
    v_mfma_f32_16x16x32_bf16 v[76:79], a[224:227], v[192:195], v[76:79]
    ds_read_b64_tr_b16 a[250:251], v5 offset:7168
    v_add_f32 v20, v20, v74
    v_mfma_f32_16x16x32_bf16 v[76:79], a[228:231], v[196:199], v[76:79]
    s_add_u32 m0, s33, 61440
    v_exp_f32 v68, v68
    v_mfma_f32_16x16x32_bf16 v[76:79], a[232:235], v[200:203], v[76:79]
    buffer_load_dwordx4 v9, s[20:23], s32 offen nt lds
    v_mfma_f32_16x16x32_bf16 v[76:79], a[236:239], v[204:207], v[76:79]
    ds_read_b64_tr_b16 a[252:253], v5 offset:13312
    v_add_f32 v19, v19, v68
    v_mfma_f32_16x16x32_bf16 v[84:87], a[216:219], v[208:211], v[56:59]
    v_exp_f32 v69, v69
    v_mfma_f32_16x16x32_bf16 v[84:87], a[220:223], v[212:215], v[84:87]
    ds_read_b64_tr_b16 a[254:255], v5 offset:19456
    v_cvt_pk_bf16_f32 v126, v68, v69
    v_mfma_f32_16x16x32_bf16 v[84:87], a[224:227], v[216:219], v[84:87]
    ds_read_b64_tr_b16 v[152:153], v6 offset:1024
    v_add_f32 v19, v19, v69
    v_mfma_f32_16x16x32_bf16 v[84:87], a[228:231], v[220:223], v[84:87]
    v_exp_f32 v70, v70
    v_mfma_f32_16x16x32_bf16 v[84:87], a[232:235], v[224:227], v[84:87]
    ds_read_b64_tr_b16 v[154:155], v6 offset:7168
    v_add_f32 v19, v19, v70
    v_mfma_f32_16x16x32_bf16 v[84:87], a[236:239], v[228:231], v[84:87]
    v_exp_f32 v71, v71
    v_mfma_f32_16x16x32_bf16 v[92:95], a[216:219], v[232:235], v[60:63]
    ds_read_b64_tr_b16 v[156:157], v6 offset:13312
    v_cvt_pk_bf16_f32 v127, v70, v71
    v_mfma_f32_16x16x32_bf16 v[92:95], a[220:223], v[236:239], v[92:95]
    s_add_u32 m0, s33, 36864
    ds_read_b64_tr_b16 v[158:159], v6 offset:19456
    v_add_f32 v19, v19, v71
    v_mfma_f32_16x16x32_bf16 v[92:95], a[224:227], v[240:243], v[92:95]
    buffer_load_dwordx4 v8, s[16:19], s29 offen nt lds
    v_mfma_f32_16x16x32_bf16 v[92:95], a[228:231], v[244:247], v[92:95]
    v_exp_f32 v75, v75
    v_mfma_f32_16x16x32_bf16 v[92:95], a[232:235], v[248:251], v[92:95]
    ds_read_b128 a[192:195], v2
    v_cvt_pk_bf16_f32 v129, v74, v75
    v_mfma_f32_16x16x32_bf16 v[92:95], a[236:239], v[252:255], v[92:95]
    s_waitcnt lgkmcnt(3)
    v_exp_f32 v76, v76
    v_mfma_f32_16x16x32_bf16 a[16:19], a[240:243], v[112:115], 0
    ds_read_b128 a[196:199], v3
    v_add_f32 v20, v20, v75
    v_mfma_f32_16x16x32_bf16 a[16:19], a[244:247], v[96:99], a[16:19]
    v_exp_f32 v77, v77
    v_mfma_f32_16x16x32_bf16 a[64:67], a[240:243], v[116:119], 0
    ds_read_b128 a[200:203], v2 offset:1024
    v_cvt_pk_bf16_f32 v130, v76, v77
    v_mfma_f32_16x16x32_bf16 a[64:67], a[244:247], v[100:103], a[64:67]
    v_exp_f32 v78, v78
    v_mfma_f32_16x16x32_bf16 a[112:115], a[240:243], v[120:123], 0
    ds_read_b64_tr_b16 a[240:241], v7 offset:1024
    v_add_f32 v20, v20, v76
    v_mfma_f32_16x16x32_bf16 a[112:115], a[244:247], v[104:107], a[112:115]
    s_add_u32 m0, s33, 37760
    ds_read_b64_tr_b16 a[242:243], v7 offset:7168
    v_add_f32 v20, v20, v77
    v_mfma_f32_16x16x32_bf16 a[160:163], a[244:247], v[108:111], 0
    buffer_load_dwordx4 v8, s[16:19], s29 offen offset:128 nt lds
    v_mfma_f32_16x16x32_bf16 a[20:23], a[248:251], v[112:115], 0
    ds_read_b64_tr_b16 a[244:245], v7 offset:13312
    v_add_f32 v20, v20, v78
    v_mfma_f32_16x16x32_bf16 a[20:23], a[252:255], v[96:99], a[20:23]
    v_exp_f32 v79, v79
    v_mfma_f32_16x16x32_bf16 a[68:71], a[248:251], v[116:119], 0
    ds_read_b64_tr_b16 a[246:247], v7 offset:19456
    v_cvt_pk_bf16_f32 v131, v78, v79
    v_mfma_f32_16x16x32_bf16 a[68:71], a[252:255], v[100:103], a[68:71]
    ds_read_b128 a[204:207], v3 offset:1024
    v_add_f32 v20, v20, v79
    v_mfma_f32_16x16x32_bf16 a[116:119], a[248:251], v[120:123], 0
    v_exp_f32 v80, v80
    v_mfma_f32_16x16x32_bf16 a[116:119], a[252:255], v[104:107], a[116:119]
    ds_read_b64_tr_b16 a[248:249], v4 offset:2048
    v_add_f32 v21, v21, v80
    v_mfma_f32_16x16x32_bf16 a[164:167], a[252:255], v[108:111], 0
    v_exp_f32 v81, v81
    v_mfma_f32_16x16x32_bf16 a[24:27], v[152:155], v[112:115], 0
    s_waitcnt lgkmcnt(3)
    ds_read_b64_tr_b16 a[250:251], v4 offset:8192
    v_cvt_pk_bf16_f32 v132, v80, v81
    v_mfma_f32_16x16x32_bf16 a[24:27], v[156:159], v[96:99], a[24:27]
    s_add_u32 m0, s33, 38656
    ds_read_b64_tr_b16 a[252:253], v4 offset:14336
    v_add_f32 v21, v21, v81
    v_mfma_f32_16x16x32_bf16 a[72:75], v[152:155], v[116:119], 0
    buffer_load_dwordx4 v8, s[16:19], s29 offen offset:256 nt lds
    v_mfma_f32_16x16x32_bf16 a[72:75], v[156:159], v[100:103], a[72:75]
    s_add_u32 s29, s29, 12288
    ds_read_b64_tr_b16 a[254:255], v4 offset:20480
    v_mfma_f32_16x16x32_bf16 a[120:123], v[152:155], v[120:123], 0
    v_exp_f32 v82, v82
    v_mfma_f32_16x16x32_bf16 a[120:123], v[156:159], v[104:107], a[120:123]
    ds_read_b128 a[208:211], v2 offset:2048
    v_add_f32 v21, v21, v82
    v_mfma_f32_16x16x32_bf16 a[168:171], v[156:159], v[108:111], 0
    v_exp_f32 v83, v83
    v_mfma_f32_16x16x32_bf16 a[28:31], a[240:243], v[112:115], 0
    s_waitcnt lgkmcnt(3)
    ds_read_b64_tr_b16 v[152:153], v5 offset:2048
    v_cvt_pk_bf16_f32 v133, v82, v83
    v_mfma_f32_16x16x32_bf16 a[28:31], a[244:247], v[96:99], a[28:31]
    ds_read_b64_tr_b16 v[154:155], v5 offset:8192
    v_add_f32 v21, v21, v83
    v_mfma_f32_16x16x32_bf16 a[76:79], a[240:243], v[116:119], 0
    ds_read_b128 a[212:215], v3 offset:2048
    v_mfma_f32_16x16x32_bf16 a[76:79], a[244:247], v[100:103], a[76:79]
    ds_read_b64_tr_b16 v[156:157], v5 offset:14336
    ds_read_b64_tr_b16 v[158:159], v5 offset:20480
    v_mfma_f32_16x16x32_bf16 a[124:127], a[240:243], v[120:123], 0
    v_exp_f32 v84, v84
    v_mfma_f32_16x16x32_bf16 a[124:127], a[244:247], v[104:107], a[124:127]
    ds_read_b128 a[216:219], v2 offset:6144
    v_add_f32 v21, v21, v84
    v_mfma_f32_16x16x32_bf16 a[172:175], a[244:247], v[108:111], 0
    v_exp_f32 v85, v85
    v_mfma_f32_16x16x32_bf16 a[32:35], a[248:251], v[112:115], 0
    s_waitcnt lgkmcnt(5)
    ds_read_b128 a[220:223], v3 offset:6144
    v_cvt_pk_bf16_f32 v134, v84, v85
    v_mfma_f32_16x16x32_bf16 a[32:35], a[252:255], v[96:99], a[32:35]
    ds_read_b64_tr_b16 a[240:241], v6 offset:2048
    v_add_f32 v21, v21, v85
    v_mfma_f32_16x16x32_bf16 a[80:83], a[248:251], v[116:119], 0
    ds_read_b64_tr_b16 a[242:243], v6 offset:8192
    ds_read_b64_tr_b16 a[244:245], v6 offset:14336
    v_mfma_f32_16x16x32_bf16 a[80:83], a[252:255], v[100:103], a[80:83]
    ds_read_b64_tr_b16 a[246:247], v6 offset:20480
    v_mfma_f32_16x16x32_bf16 a[128:131], a[248:251], v[120:123], 0
    ds_read_b128 a[224:227], v2 offset:7168
    v_mfma_f32_16x16x32_bf16 a[128:131], a[252:255], v[104:107], a[128:131]
    v_exp_f32 v86, v86
    v_mfma_f32_16x16x32_bf16 a[176:179], a[252:255], v[108:111], 0
    s_waitcnt lgkmcnt(6)
    ds_read_b128 a[228:231], v3 offset:7168
    v_add_f32 v21, v21, v86
    v_mfma_f32_16x16x32_bf16 a[36:39], v[152:155], v[112:115], 0
    v_exp_f32 v87, v87
    v_mfma_f32_16x16x32_bf16 a[36:39], v[156:159], v[96:99], a[36:39]
    ds_read_b64_tr_b16 a[248:249], v7 offset:2048
    v_cvt_pk_bf16_f32 v135, v86, v87
    v_mfma_f32_16x16x32_bf16 a[84:87], v[152:155], v[116:119], 0
    ds_read_b64_tr_b16 a[250:251], v7 offset:8192
    v_add_f32 v21, v21, v87
    v_mfma_f32_16x16x32_bf16 a[84:87], v[156:159], v[100:103], a[84:87]
    ds_read_b64_tr_b16 a[252:253], v7 offset:14336
    v_max3_f32 v28, v19, v20, v21
    v_mfma_f32_16x16x32_bf16 a[132:135], v[152:155], v[120:123], 0
    ds_read_b64_tr_b16 a[254:255], v7 offset:20480
    v_mfma_f32_16x16x32_bf16 a[132:135], v[156:159], v[104:107], a[132:135]
    ds_read_b128 a[232:235], v2 offset:8192
    v_mfma_f32_16x16x32_bf16 a[180:183], v[156:159], v[108:111], 0
    s_waitcnt lgkmcnt(5)
    v_exp_f32 v88, v88
    v_mfma_f32_16x16x32_bf16 a[40:43], a[240:243], v[112:115], 0
    ds_read_b128 a[236:239], v3 offset:8192
    v_mfma_f32_16x16x32_bf16 a[40:43], a[244:247], v[96:99], a[40:43]
    s_waitcnt vmcnt(12)
    ds_inc_u32 v46, v46
    v_mfma_f32_16x16x32_bf16 a[88:91], a[240:243], v[116:119], 0
    v_exp_f32 v89, v89
    v_mfma_f32_16x16x32_bf16 a[88:91], a[244:247], v[100:103], a[88:91]
    v_exp_f32 v90, v90
    v_mfma_f32_16x16x32_bf16 a[136:139], a[240:243], v[120:123], 0
    v_exp_f32 v91, v91
    v_mfma_f32_16x16x32_bf16 a[136:139], a[244:247], v[104:107], a[136:139]
    v_cvt_pk_bf16_f32 v136, v88, v89
    v_cvt_pk_bf16_f32 v137, v90, v91
    v_mfma_f32_16x16x32_bf16 a[184:187], a[244:247], v[108:111], 0
    s_waitcnt lgkmcnt(2)
    v_exp_f32 v92, v92
    v_mfma_f32_16x16x32_bf16 a[44:47], a[248:251], v[112:115], 0
    v_exp_f32 v93, v93
    v_mfma_f32_16x16x32_bf16 a[44:47], a[252:255], v[96:99], a[44:47]
    v_exp_f32 v94, v94
    v_mfma_f32_16x16x32_bf16 a[92:95], a[248:251], v[116:119], 0
    v_exp_f32 v95, v95
    v_mfma_f32_16x16x32_bf16 a[92:95], a[252:255], v[100:103], a[92:95]
    v_cvt_pk_bf16_f32 v138, v92, v93
    v_cvt_pk_bf16_f32 v139, v94, v95
    v_mfma_f32_16x16x32_bf16 a[140:143], a[248:251], v[120:123], 0
    v_add_f32 v22, v88, v89
    v_add_f32 v22, v22, v90
    v_mfma_f32_16x16x32_bf16 a[140:143], a[252:255], v[104:107], a[140:143]
    v_add_f32 v22, v22, v91
    v_add_f32 v22, v22, v92
    v_mfma_f32_16x16x32_bf16 a[188:191], a[252:255], v[108:111], 0
    v_add_f32 v22, v22, v93
    v_add_f32 v22, v22, v94
    v_add_f32 v22, v22, v95
    v_max_f32 v28, v28, v22
    s_mov_b32 s31, 6
.p2align 6
L_loop_10:
    v_mfma_f32_16x16x32_bf16 v[64:67], a[192:195], v[160:163], v[48:51]
    s_add_u32 s57, s31, 1
    s_and_b32 s57, s57, 4
    s_lshl_b32 s87, s57, 4
    v_mfma_f32_16x16x32_bf16 v[64:67], a[196:199], v[164:167], v[64:67]
    s_mul_i32 s91, s87, 48
    s_mul_i32 s82, s87, 2592
    ds_read_b32 v30, v46
    v_mfma_f32_16x16x32_bf16 v[64:67], a[200:203], v[168:171], v[64:67]
    s_sub_i32 s57, 1, s31
    s_max_i32 s57, s57, 0
    s_mul_i32 s57, s57, 768
    v_mfma_f32_16x16x32_bf16 v[64:67], a[204:207], v[172:175], v[64:67]
    s_add_u32 s89, s89, s57
    s_mul_i32 s57, s31, 3072
    s_sub_u32 s57, s96, s57
    s_cmp_ge_u32 s31, 3
    s_cselect_b32 s92, s57, s97
    v_mfma_f32_16x16x32_bf16 v[64:67], a[208:211], v[176:179], v[64:67]
    s_waitcnt lgkmcnt(1)
    v_lshlrev_b32 v40, 16, v32
    v_and_b32 v41, 0xffff0000, v32
    v_mfma_f32_16x16x32_bf16 v[64:67], a[212:215], v[180:183], v[64:67]
    s_add_u32 s57, s31, 3
    v_mul_f32 v40, s42, v40
    v_mul_f32 v41, s42, v41
    v_mfma_f32_16x16x32_bf16 v[72:75], a[192:195], v[184:187], v[52:55]
    s_and_b32 s57, s57, 4
    v_cvt_pk_bf16_f32 v32, v40, v41
    v_lshlrev_b32 v42, 16, v33
    v_mfma_f32_16x16x32_bf16 v[72:75], a[196:199], v[188:191], v[72:75]
    s_xor_b32 s57, s57, 4
    v_cmp_lt_f32 vcc, s35, v28
    v_and_b32 v43, 0xffff0000, v33
    v_mfma_f32_16x16x32_bf16 v[72:75], a[200:203], v[192:195], v[72:75]
    s_waitcnt lgkmcnt(0)
    v_cmp_gt_u32 s[94:95], s93, v30
    v_mul_f32 v42, s42, v42
    v_mfma_f32_16x16x32_bf16 v[72:75], a[204:207], v[196:199], v[72:75]
    s_add_u32 m0, s33, 50048
    v_exp_f32 v64, v64
    v_mfma_f32_16x16x32_bf16 v[72:75], a[208:211], v[200:203], v[72:75]
    s_or_b64 vcc, vcc, s[94:95]
    v_exp_f32 v65, v65
    v_mfma_f32_16x16x32_bf16 v[72:75], a[212:215], v[204:207], v[72:75]
    s_cbranch_vccnz L_b10_3cs_rare
L_b10_3cs_back:
    ds_read_b64_tr_b16 v[152:153], v4 offset:24576
    v_cvt_pk_bf16_f32 v112, v64, v65
    v_mfma_f32_16x16x32_bf16 v[80:83], a[192:195], v[208:211], v[56:59]
    s_add_u32 s93, s93, 4
    buffer_load_dwordx4 v9, s[20:23], s30 offen offset:128 nt lds
    v_mfma_f32_16x16x32_bf16 v[80:83], a[196:199], v[212:215], v[80:83]
    s_lshl_b32 s57, s57, 24
    ds_read_b128 a[192:195], v2 offset:12288
    v_add_f32 v12, v12, v19
    v_mfma_f32_16x16x32_bf16 v[80:83], a[200:203], v[216:219], v[80:83]
    s_add_u32 s92, s92, s57
    ds_read_b64_tr_b16 v[154:155], v4 offset:30720
    v_add_f32 v13, v13, v20
    v_mfma_f32_16x16x32_bf16 v[80:83], a[204:207], v[220:223], v[80:83]
    ds_read_b128 a[196:199], v3 offset:12288
    v_add_f32 v14, v14, v21
    v_mfma_f32_16x16x32_bf16 v[80:83], a[208:211], v[224:227], v[80:83]
    ds_read_b64_tr_b16 v[156:157], v4 offset:36864
    v_add_f32 v15, v15, v22
    v_mfma_f32_16x16x32_bf16 v[80:83], a[212:215], v[228:231], v[80:83]
    s_add_u32 m0, s33, 50944
    ds_read_b128 a[200:203], v2 offset:13312
    v_add_f32 v16, v64, v65
    v_mfma_f32_16x16x32_bf16 v[68:71], a[216:219], v[160:163], v[48:51]
    buffer_load_dwordx4 v9, s[20:23], s30 offen offset:256 nt lds
    v_mfma_f32_16x16x32_bf16 v[68:71], a[220:223], v[164:167], v[68:71]
    v_exp_f32 v66, v66
    v_mfma_f32_16x16x32_bf16 v[68:71], a[224:227], v[168:171], v[68:71]
    ds_read_b64_tr_b16 v[158:159], v4 offset:43008
    v_add_f32 v16, v16, v66
    v_mfma_f32_16x16x32_bf16 v[68:71], a[228:231], v[172:175], v[68:71]
    v_exp_f32 v67, v67
    v_mfma_f32_16x16x32_bf16 v[68:71], a[232:235], v[176:179], v[68:71]
    ds_read_b128 a[204:207], v3 offset:13312
    v_cvt_pk_bf16_f32 v113, v66, v67
    v_mfma_f32_16x16x32_bf16 v[68:71], a[236:239], v[180:183], v[68:71]
    s_add_u32 m0, s33, 62336
    ds_read_b64_tr_b16 a[240:241], v5 offset:24576
    v_add_f32 v16, v16, v67
    v_mfma_f32_16x16x32_bf16 v[76:79], a[216:219], v[184:187], v[52:55]
    buffer_load_dwordx4 v9, s[20:23], s32 offen offset:128 nt lds
    v_mfma_f32_16x16x32_bf16 v[76:79], a[220:223], v[188:191], v[76:79]
    v_exp_f32 v72, v72
    v_mfma_f32_16x16x32_bf16 v[76:79], a[224:227], v[192:195], v[76:79]
    v_exp_f32 v73, v73
    v_mfma_f32_16x16x32_bf16 v[76:79], a[228:231], v[196:199], v[76:79]
    ds_read_b128 a[208:211], v2 offset:14336
    v_cvt_pk_bf16_f32 v116, v72, v73
    v_mfma_f32_16x16x32_bf16 v[76:79], a[232:235], v[200:203], v[76:79]
    ds_read_b64_tr_b16 a[242:243], v5 offset:30720
    v_add_f32 v17, v72, v73
    v_mfma_f32_16x16x32_bf16 v[76:79], a[236:239], v[204:207], v[76:79]
    s_add_u32 m0, s33, 63232
    v_exp_f32 v74, v74
    v_mfma_f32_16x16x32_bf16 v[84:87], a[216:219], v[208:211], v[56:59]
    buffer_load_dwordx4 v9, s[20:23], s32 offen offset:256 nt lds
    v_mfma_f32_16x16x32_bf16 v[84:87], a[220:223], v[212:215], v[84:87]
    s_add_u32 s30, s30, 24576
    ds_read_b128 a[212:215], v3 offset:14336
    v_add_f32 v17, v17, v74
    v_mfma_f32_16x16x32_bf16 v[84:87], a[224:227], v[216:219], v[84:87]
    s_add_u32 s32, s32, 24576
    ds_read_b64_tr_b16 a[244:245], v5 offset:36864
    ds_read_b64_tr_b16 a[246:247], v5 offset:43008
    v_mfma_f32_16x16x32_bf16 v[84:87], a[228:231], v[220:223], v[84:87]
    v_exp_f32 v75, v75
    v_mfma_f32_16x16x32_bf16 v[84:87], a[232:235], v[224:227], v[84:87]
    s_add_u32 m0, s33, 0
    ds_read_b128 a[216:219], v2 offset:18432
    v_cvt_pk_bf16_f32 v117, v74, v75
    v_mfma_f32_16x16x32_bf16 v[84:87], a[236:239], v[228:231], v[84:87]
    s_waitcnt lgkmcnt(4)
    ds_read_b64_tr_b16 a[248:249], v6 offset:24576
    v_add_f32 v17, v17, v75
    v_mfma_f32_16x16x32_bf16 a[0:3], v[152:155], v[140:143], a[0:3]
    buffer_load_dwordx4 v8, s[16:19], s29 offen nt lds
    v_mfma_f32_16x16x32_bf16 a[0:3], v[156:159], v[124:127], a[0:3]
    ds_read_b128 a[220:223], v3 offset:18432
    v_mul_f32 v43, s42, v43
    v_mfma_f32_16x16x32_bf16 a[48:51], v[152:155], v[144:147], a[48:51]
    ds_read_b64_tr_b16 a[250:251], v6 offset:30720
    ds_read_b64_tr_b16 a[252:253], v6 offset:36864
    v_mfma_f32_16x16x32_bf16 a[48:51], v[156:159], v[128:131], a[48:51]
    ds_read_b64_tr_b16 a[254:255], v6 offset:43008
    v_cvt_pk_bf16_f32 v33, v42, v43
    v_mfma_f32_16x16x32_bf16 a[96:99], v[152:155], v[148:151], a[96:99]
    ds_read_b128 a[224:227], v2 offset:19456
    v_lshlrev_b32 v40, 16, v34
    v_mfma_f32_16x16x32_bf16 a[96:99], v[156:159], v[132:135], a[96:99]
    s_add_u32 m0, s33, 896
    v_exp_f32 v80, v80
    v_mfma_f32_16x16x32_bf16 a[144:147], v[156:159], v[136:139], a[144:147]
    buffer_load_dwordx4 v8, s[16:19], s29 offen offset:128 nt lds
    v_mfma_f32_16x16x32_bf16 a[4:7], a[240:243], v[140:143], a[4:7]
    s_waitcnt lgkmcnt(5)
    ds_read_b128 a[228:231], v3 offset:19456
    v_and_b32 v41, 0xffff0000, v34
    v_mfma_f32_16x16x32_bf16 a[4:7], a[244:247], v[124:127], a[4:7]
    v_exp_f32 v81, v81
    v_mfma_f32_16x16x32_bf16 a[52:55], a[240:243], v[144:147], a[52:55]
    ds_read_b64_tr_b16 v[152:153], v7 offset:24576
    v_cvt_pk_bf16_f32 v120, v80, v81
    v_mfma_f32_16x16x32_bf16 a[52:55], a[244:247], v[128:131], a[52:55]
    ds_read_b64_tr_b16 v[154:155], v7 offset:30720
    v_add_f32 v18, v80, v81
    v_mfma_f32_16x16x32_bf16 a[100:103], a[240:243], v[148:151], a[100:103]
    ds_read_b64_tr_b16 v[156:157], v7 offset:36864
    ds_read_b64_tr_b16 v[158:159], v7 offset:43008
    v_mfma_f32_16x16x32_bf16 a[100:103], a[244:247], v[132:135], a[100:103]
    s_add_u32 m0, s33, 1792
    ds_read_b128 a[232:235], v2 offset:20480
    v_mul_f32 v40, s42, v40
    v_mfma_f32_16x16x32_bf16 a[148:151], a[244:247], v[136:139], a[148:151]
    s_waitcnt lgkmcnt(6)
    buffer_load_dwordx4 v8, s[16:19], s29 offen offset:256 nt lds
    v_mfma_f32_16x16x32_bf16 a[8:11], a[248:251], v[140:143], a[8:11]
    s_add_u32 s29, s29, 12288
    ds_read_b128 a[236:239], v3 offset:20480
    v_mul_f32 v41, s42, v41
    v_mfma_f32_16x16x32_bf16 a[8:11], a[252:255], v[124:127], a[8:11]
    s_waitcnt vmcnt(12)
    ds_inc_u32 v46, v46
    v_cvt_pk_bf16_f32 v34, v40, v41
    v_mfma_f32_16x16x32_bf16 a[56:59], a[248:251], v[144:147], a[56:59]
    v_exp_f32 v82, v82
    v_mfma_f32_16x16x32_bf16 a[56:59], a[252:255], v[128:131], a[56:59]
    v_exp_f32 v83, v83
    v_mfma_f32_16x16x32_bf16 a[104:107], a[248:251], v[148:151], a[104:107]
    v_cvt_pk_bf16_f32 v121, v82, v83
    v_add_f32 v18, v18, v82
    v_mfma_f32_16x16x32_bf16 a[104:107], a[252:255], v[132:135], a[104:107]
    v_exp_f32 v68, v68
    v_mfma_f32_16x16x32_bf16 a[152:155], a[252:255], v[136:139], a[152:155]
    s_waitcnt lgkmcnt(2)
    v_add_f32 v18, v18, v83
    v_add_f32 v16, v16, v68
    v_mfma_f32_16x16x32_bf16 a[12:15], v[152:155], v[140:143], a[12:15]
    v_exp_f32 v69, v69
    v_mfma_f32_16x16x32_bf16 a[12:15], v[156:159], v[124:127], a[12:15]
    v_exp_f32 v70, v70
    v_mfma_f32_16x16x32_bf16 a[60:63], v[152:155], v[144:147], a[60:63]
    v_exp_f32 v71, v71
    v_mfma_f32_16x16x32_bf16 a[60:63], v[156:159], v[128:131], a[60:63]
    v_cvt_pk_bf16_f32 v114, v68, v69
    v_cvt_pk_bf16_f32 v115, v70, v71
    v_mfma_f32_16x16x32_bf16 a[108:111], v[152:155], v[148:151], a[108:111]
    v_add_f32 v16, v16, v69
    v_add_f32 v16, v16, v70
    v_mfma_f32_16x16x32_bf16 a[108:111], v[156:159], v[132:135], a[108:111]
    v_exp_f32 v76, v76
    v_mfma_f32_16x16x32_bf16 a[156:159], v[156:159], v[136:139], a[156:159]
    v_add_f32 v16, v16, v71
    v_add_f32 v17, v17, v76
    v_mfma_f32_16x16x32_bf16 v[64:67], a[192:195], v[160:163], v[48:51]
    v_exp_f32 v77, v77
    v_mfma_f32_16x16x32_bf16 v[64:67], a[196:199], v[164:167], v[64:67]
    v_exp_f32 v78, v78
    v_mfma_f32_16x16x32_bf16 v[64:67], a[200:203], v[168:171], v[64:67]
    v_exp_f32 v79, v79
    v_mfma_f32_16x16x32_bf16 v[64:67], a[204:207], v[172:175], v[64:67]
    v_cvt_pk_bf16_f32 v118, v76, v77
    v_cvt_pk_bf16_f32 v119, v78, v79
    v_mfma_f32_16x16x32_bf16 v[64:67], a[208:211], v[176:179], v[64:67]
    v_add_f32 v17, v17, v77
    v_add_f32 v17, v17, v78
    v_mfma_f32_16x16x32_bf16 v[64:67], a[212:215], v[180:183], v[64:67]
    v_exp_f32 v84, v84
    v_mfma_f32_16x16x32_bf16 v[72:75], a[192:195], v[184:187], v[52:55]
    v_add_f32 v17, v17, v79
    v_add_f32 v18, v18, v84
    v_mfma_f32_16x16x32_bf16 v[72:75], a[196:199], v[188:191], v[72:75]
    v_exp_f32 v85, v85
    v_mfma_f32_16x16x32_bf16 v[72:75], a[200:203], v[192:195], v[72:75]
    v_exp_f32 v86, v86
    v_mfma_f32_16x16x32_bf16 v[72:75], a[204:207], v[196:199], v[72:75]
    v_exp_f32 v87, v87
    v_mfma_f32_16x16x32_bf16 v[72:75], a[208:211], v[200:203], v[72:75]
    v_cvt_pk_bf16_f32 v122, v84, v85
    v_cvt_pk_bf16_f32 v123, v86, v87
    v_mfma_f32_16x16x32_bf16 v[72:75], a[212:215], v[204:207], v[72:75]
    v_add_f32 v18, v18, v85
    v_add_f32 v18, v18, v86
    v_mfma_f32_16x16x32_bf16 v[80:83], a[192:195], v[208:211], v[56:59]
    v_exp_f32 v64, v64
    v_mfma_f32_16x16x32_bf16 v[80:83], a[196:199], v[212:215], v[80:83]
    ds_read_b32 v30, v46
    v_add_f32 v18, v18, v87
    v_mfma_f32_16x16x32_bf16 v[80:83], a[200:203], v[216:219], v[80:83]
    v_exp_f32 v65, v65
    v_mfma_f32_16x16x32_bf16 v[80:83], a[204:207], v[220:223], v[80:83]
    v_exp_f32 v66, v66
    v_mfma_f32_16x16x32_bf16 v[80:83], a[208:211], v[224:227], v[80:83]
    v_exp_f32 v67, v67
    v_mfma_f32_16x16x32_bf16 v[80:83], a[212:215], v[228:231], v[80:83]
    v_cvt_pk_bf16_f32 v96, v64, v65
    v_cvt_pk_bf16_f32 v97, v66, v67
    v_mfma_f32_16x16x32_bf16 v[88:91], a[192:195], v[232:235], v[60:63]
    v_add_f32 v16, v16, v64
    v_add_f32 v16, v16, v65
    v_mfma_f32_16x16x32_bf16 v[88:91], a[196:199], v[236:239], v[88:91]
    v_add_f32 v16, v16, v66
    v_add_f32 v16, v16, v67
    v_mfma_f32_16x16x32_bf16 v[88:91], a[200:203], v[240:243], v[88:91]
    s_waitcnt lgkmcnt(0)
    v_cmp_gt_u32 vcc, s93, v30
    v_lshlrev_b32 v42, 16, v35
    v_mfma_f32_16x16x32_bf16 v[88:91], a[204:207], v[244:247], v[88:91]
    v_exp_f32 v72, v72
    v_mfma_f32_16x16x32_bf16 v[88:91], a[208:211], v[248:251], v[88:91]
    s_add_u32 m0, s33, 73728
    v_exp_f32 v73, v73
    v_mfma_f32_16x16x32_bf16 v[88:91], a[212:215], v[252:255], v[88:91]
    s_cbranch_vccnz L_b10_4s_rare
L_b10_4s_back:
    ds_read_b64_tr_b16 a[240:241], v4 offset:25600
    v_cvt_pk_bf16_f32 v100, v72, v73
    v_mfma_f32_16x16x32_bf16 v[68:71], a[216:219], v[160:163], v[48:51]
    s_add_u32 s93, s93, 4
    buffer_load_dwordx4 v9, s[20:23], s30 offen nt lds
    v_mfma_f32_16x16x32_bf16 v[68:71], a[220:223], v[164:167], v[68:71]
    ds_read_b64_tr_b16 a[242:243], v4 offset:31744
    v_add_f32 v17, v17, v72
    v_mfma_f32_16x16x32_bf16 v[68:71], a[224:227], v[168:171], v[68:71]
    ds_read_b64_tr_b16 a[244:245], v4 offset:37888
    v_add_f32 v17, v17, v73
    v_mfma_f32_16x16x32_bf16 v[68:71], a[228:231], v[172:175], v[68:71]
    v_exp_f32 v74, v74
    v_mfma_f32_16x16x32_bf16 v[68:71], a[232:235], v[176:179], v[68:71]
    ds_read_b64_tr_b16 a[246:247], v4 offset:44032
    v_add_f32 v17, v17, v74
    v_mfma_f32_16x16x32_bf16 v[68:71], a[236:239], v[180:183], v[68:71]
    v_exp_f32 v75, v75
    v_mfma_f32_16x16x32_bf16 v[76:79], a[216:219], v[184:187], v[52:55]
    ds_read_b64_tr_b16 a[248:249], v5 offset:25600
    v_cvt_pk_bf16_f32 v101, v74, v75
    v_mfma_f32_16x16x32_bf16 v[76:79], a[220:223], v[188:191], v[76:79]
    ds_read_b64_tr_b16 a[250:251], v5 offset:31744
    v_add_f32 v17, v17, v75
    v_mfma_f32_16x16x32_bf16 v[76:79], a[224:227], v[192:195], v[76:79]
    v_exp_f32 v80, v80
    v_mfma_f32_16x16x32_bf16 v[76:79], a[228:231], v[196:199], v[76:79]
    s_add_u32 m0, s33, 86016
    ds_read_b64_tr_b16 a[252:253], v5 offset:37888
    v_add_f32 v18, v18, v80
    v_mfma_f32_16x16x32_bf16 v[76:79], a[232:235], v[200:203], v[76:79]
    buffer_load_dwordx4 v9, s[20:23], s32 offen nt lds
    v_mfma_f32_16x16x32_bf16 v[76:79], a[236:239], v[204:207], v[76:79]
    v_exp_f32 v68, v68
    v_mfma_f32_16x16x32_bf16 v[84:87], a[216:219], v[208:211], v[56:59]
    ds_read_b64_tr_b16 a[254:255], v5 offset:44032
    v_add_f32 v16, v16, v68
    v_mfma_f32_16x16x32_bf16 v[84:87], a[220:223], v[212:215], v[84:87]
    v_exp_f32 v69, v69
    v_mfma_f32_16x16x32_bf16 v[84:87], a[224:227], v[216:219], v[84:87]
    ds_read_b64_tr_b16 v[152:153], v6 offset:25600
    v_cvt_pk_bf16_f32 v98, v68, v69
    v_mfma_f32_16x16x32_bf16 v[84:87], a[228:231], v[220:223], v[84:87]
    ds_read_b64_tr_b16 v[154:155], v6 offset:31744
    v_add_f32 v16, v16, v69
    v_mfma_f32_16x16x32_bf16 v[84:87], a[232:235], v[224:227], v[84:87]
    v_exp_f32 v70, v70
    v_mfma_f32_16x16x32_bf16 v[84:87], a[236:239], v[228:231], v[84:87]
    ds_read_b64_tr_b16 v[156:157], v6 offset:37888
    v_add_f32 v16, v16, v70
    v_mfma_f32_16x16x32_bf16 v[92:95], a[216:219], v[232:235], v[60:63]
    v_exp_f32 v71, v71
    v_mfma_f32_16x16x32_bf16 v[92:95], a[220:223], v[236:239], v[92:95]
    s_add_u32 m0, s33, 12288
    ds_read_b64_tr_b16 v[158:159], v6 offset:44032
    v_cvt_pk_bf16_f32 v99, v70, v71
    v_mfma_f32_16x16x32_bf16 v[92:95], a[224:227], v[240:243], v[92:95]
    buffer_load_dwordx4 v8, s[16:19], s29 offen nt lds
    v_mfma_f32_16x16x32_bf16 v[92:95], a[228:231], v[244:247], v[92:95]
    ds_read_b128 a[192:195], v2 offset:24576
    v_add_f32 v16, v16, v71
    v_mfma_f32_16x16x32_bf16 v[92:95], a[232:235], v[248:251], v[92:95]
    v_exp_f32 v76, v76
    v_mfma_f32_16x16x32_bf16 v[92:95], a[236:239], v[252:255], v[92:95]
    s_waitcnt lgkmcnt(3)
    ds_read_b128 a[196:199], v3 offset:24576
    v_add_f32 v17, v17, v76
    v_mfma_f32_16x16x32_bf16 a[16:19], a[240:243], v[140:143], a[16:19]
    v_exp_f32 v77, v77
    v_mfma_f32_16x16x32_bf16 a[16:19], a[244:247], v[124:127], a[16:19]
    ds_read_b128 a[200:203], v2 offset:25600
    v_cvt_pk_bf16_f32 v102, v76, v77
    v_mfma_f32_16x16x32_bf16 a[64:67], a[240:243], v[144:147], a[64:67]
    v_exp_f32 v78, v78
    v_mfma_f32_16x16x32_bf16 a[64:67], a[244:247], v[128:131], a[64:67]
    ds_read_b128 a[204:207], v3 offset:25600
    v_add_f32 v17, v17, v77
    v_mfma_f32_16x16x32_bf16 a[112:115], a[240:243], v[148:151], a[112:115]
    ds_read_b64_tr_b16 a[240:241], v7 offset:25600
    v_add_f32 v17, v17, v78
    v_mfma_f32_16x16x32_bf16 a[112:115], a[244:247], v[132:135], a[112:115]
    s_add_u32 m0, s33, 13184
    v_exp_f32 v79, v79
    v_mfma_f32_16x16x32_bf16 a[160:163], a[244:247], v[136:139], a[160:163]
    buffer_load_dwordx4 v8, s[16:19], s29 offen offset:128 nt lds
    v_mfma_f32_16x16x32_bf16 a[20:23], a[248:251], v[140:143], a[20:23]
    ds_read_b64_tr_b16 a[242:243], v7 offset:31744
    v_cvt_pk_bf16_f32 v103, v78, v79
    v_mfma_f32_16x16x32_bf16 a[20:23], a[252:255], v[124:127], a[20:23]
    ds_read_b64_tr_b16 a[244:245], v7 offset:37888
    v_add_f32 v17, v17, v79
    v_mfma_f32_16x16x32_bf16 a[68:71], a[248:251], v[144:147], a[68:71]
    v_exp_f32 v81, v81
    v_mfma_f32_16x16x32_bf16 a[68:71], a[252:255], v[128:131], a[68:71]
    ds_read_b64_tr_b16 a[246:247], v7 offset:44032
    v_cvt_pk_bf16_f32 v104, v80, v81
    v_mfma_f32_16x16x32_bf16 a[116:119], a[248:251], v[148:151], a[116:119]
    ds_read_b64_tr_b16 a[248:249], v4 offset:26624
    v_add_f32 v18, v18, v81
    v_mfma_f32_16x16x32_bf16 a[116:119], a[252:255], v[132:135], a[116:119]
    v_exp_f32 v82, v82
    v_mfma_f32_16x16x32_bf16 a[164:167], a[252:255], v[136:139], a[164:167]
    ds_read_b64_tr_b16 a[250:251], v4 offset:32768
    v_add_f32 v18, v18, v82
    v_mfma_f32_16x16x32_bf16 a[24:27], v[152:155], v[140:143], a[24:27]
    s_waitcnt lgkmcnt(4)
    v_exp_f32 v83, v83
    v_mfma_f32_16x16x32_bf16 a[24:27], v[156:159], v[124:127], a[24:27]
    s_add_u32 m0, s33, 14080
    ds_read_b64_tr_b16 a[252:253], v4 offset:38912
    v_cvt_pk_bf16_f32 v105, v82, v83
    v_mfma_f32_16x16x32_bf16 a[72:75], v[152:155], v[144:147], a[72:75]
    buffer_load_dwordx4 v8, s[16:19], s29 offen offset:256 nt lds
    v_mfma_f32_16x16x32_bf16 a[72:75], v[156:159], v[128:131], a[72:75]
    s_add_u32 s29, s29, 12288
    ds_read_b64_tr_b16 a[254:255], v4 offset:45056
    v_add_f32 v18, v18, v83
    v_mfma_f32_16x16x32_bf16 a[120:123], v[152:155], v[148:151], a[120:123]
    v_exp_f32 v84, v84
    v_mfma_f32_16x16x32_bf16 a[120:123], v[156:159], v[132:135], a[120:123]
    ds_read_b128 a[208:211], v2 offset:26624
    v_add_f32 v18, v18, v84
    v_mfma_f32_16x16x32_bf16 a[168:171], v[156:159], v[136:139], a[168:171]
    v_exp_f32 v85, v85
    v_mfma_f32_16x16x32_bf16 a[28:31], a[240:243], v[140:143], a[28:31]
    s_waitcnt lgkmcnt(3)
    ds_read_b64_tr_b16 v[152:153], v5 offset:26624
    v_cvt_pk_bf16_f32 v106, v84, v85
    v_mfma_f32_16x16x32_bf16 a[28:31], a[244:247], v[124:127], a[28:31]
    ds_read_b64_tr_b16 v[154:155], v5 offset:32768
    v_add_f32 v18, v18, v85
    v_mfma_f32_16x16x32_bf16 a[76:79], a[240:243], v[144:147], a[76:79]
    ds_read_b128 a[212:215], v3 offset:26624
    v_and_b32 v43, 0xffff0000, v35
    v_mfma_f32_16x16x32_bf16 a[76:79], a[244:247], v[128:131], a[76:79]
    ds_read_b64_tr_b16 v[156:157], v5 offset:38912
    ds_read_b64_tr_b16 v[158:159], v5 offset:45056
    v_mfma_f32_16x16x32_bf16 a[124:127], a[240:243], v[148:151], a[124:127]
    v_exp_f32 v86, v86
    v_mfma_f32_16x16x32_bf16 a[124:127], a[244:247], v[132:135], a[124:127]
    ds_read_b128 a[216:219], v2 offset:30720
    v_add_f32 v18, v18, v86
    v_mfma_f32_16x16x32_bf16 a[172:175], a[244:247], v[136:139], a[172:175]
    v_exp_f32 v87, v87
    v_mfma_f32_16x16x32_bf16 a[32:35], a[248:251], v[140:143], a[32:35]
    s_waitcnt lgkmcnt(5)
    ds_read_b128 a[220:223], v3 offset:30720
    v_cvt_pk_bf16_f32 v107, v86, v87
    v_mfma_f32_16x16x32_bf16 a[32:35], a[252:255], v[124:127], a[32:35]
    ds_read_b64_tr_b16 a[240:241], v6 offset:26624
    v_add_f32 v18, v18, v87
    v_mfma_f32_16x16x32_bf16 a[80:83], a[248:251], v[144:147], a[80:83]
    ds_read_b64_tr_b16 a[242:243], v6 offset:32768
    v_max3_f32 v28, v16, v17, v18
    v_mfma_f32_16x16x32_bf16 a[80:83], a[252:255], v[128:131], a[80:83]
    ds_read_b64_tr_b16 a[244:245], v6 offset:38912
    ds_read_b64_tr_b16 a[246:247], v6 offset:45056
    v_mfma_f32_16x16x32_bf16 a[128:131], a[248:251], v[148:151], a[128:131]
    ds_read_b128 a[224:227], v2 offset:31744
    v_mul_f32 v42, s42, v42
    v_mfma_f32_16x16x32_bf16 a[128:131], a[252:255], v[132:135], a[128:131]
    v_exp_f32 v88, v88
    v_mfma_f32_16x16x32_bf16 a[176:179], a[252:255], v[136:139], a[176:179]
    s_waitcnt lgkmcnt(6)
    v_exp_f32 v89, v89
    v_mfma_f32_16x16x32_bf16 a[36:39], v[152:155], v[140:143], a[36:39]
    ds_read_b128 a[228:231], v3 offset:31744
    v_cvt_pk_bf16_f32 v108, v88, v89
    v_mfma_f32_16x16x32_bf16 a[36:39], v[156:159], v[124:127], a[36:39]
    ds_read_b64_tr_b16 a[248:249], v7 offset:26624
    v_add_f32 v22, v88, v89
    v_mfma_f32_16x16x32_bf16 a[84:87], v[152:155], v[144:147], a[84:87]
    s_add_u32 m0, s89, 0
    ds_read_b64_tr_b16 a[250:251], v7 offset:32768
    ds_read_b64_tr_b16 a[252:253], v7 offset:38912
    v_mfma_f32_16x16x32_bf16 a[84:87], v[156:159], v[128:131], a[84:87]
    ds_read_b64_tr_b16 a[254:255], v7 offset:45056
    buffer_load_dwordx4 v23, s[80:83], s84 offen nt lds
    v_mfma_f32_16x16x32_bf16 a[132:135], v[152:155], v[148:151], a[132:135]
    ds_read_b128 a[232:235], v2 offset:32768
    v_mul_f32 v43, s42, v43
    v_mfma_f32_16x16x32_bf16 a[132:135], v[156:159], v[132:135], a[132:135]
    v_exp_f32 v90, v90
    v_mfma_f32_16x16x32_bf16 a[180:183], v[156:159], v[136:139], a[180:183]
    s_waitcnt lgkmcnt(6)
    ds_read_b128 a[236:239], v3 offset:32768
    v_add_f32 v22, v22, v90
    v_mfma_f32_16x16x32_bf16 a[40:43], a[240:243], v[140:143], a[40:43]
    v_exp_f32 v91, v91
    v_mfma_f32_16x16x32_bf16 a[40:43], a[244:247], v[124:127], a[40:43]
    s_waitcnt vmcnt(13)
    ds_inc_u32 v46, v46
    v_cvt_pk_bf16_f32 v109, v90, v91
    v_mfma_f32_16x16x32_bf16 a[88:91], a[240:243], v[144:147], a[88:91]
    v_exp_f32 v92, v92
    v_mfma_f32_16x16x32_bf16 a[88:91], a[244:247], v[128:131], a[88:91]
    v_exp_f32 v93, v93
    v_mfma_f32_16x16x32_bf16 a[136:139], a[240:243], v[148:151], a[136:139]
    v_exp_f32 v94, v94
    v_mfma_f32_16x16x32_bf16 a[136:139], a[244:247], v[132:135], a[136:139]
    v_exp_f32 v95, v95
    v_mfma_f32_16x16x32_bf16 a[184:187], a[244:247], v[136:139], a[184:187]
    s_waitcnt lgkmcnt(1)
    v_cvt_pk_bf16_f32 v110, v92, v93
    v_cvt_pk_bf16_f32 v111, v94, v95
    v_mfma_f32_16x16x32_bf16 a[44:47], a[248:251], v[140:143], a[44:47]
    v_add_f32 v22, v22, v91
    v_add_f32 v22, v22, v92
    v_mfma_f32_16x16x32_bf16 a[44:47], a[252:255], v[124:127], a[44:47]
    v_add_f32 v22, v22, v93
    v_add_f32 v22, v22, v94
    v_mfma_f32_16x16x32_bf16 a[92:95], a[248:251], v[144:147], a[92:95]
    s_add_u32 m0, s89, 896
    v_add_f32 v22, v22, v95
    v_max_f32 v28, v28, v22
    v_mfma_f32_16x16x32_bf16 a[92:95], a[252:255], v[128:131], a[92:95]
    buffer_load_dwordx4 v23, s[80:83], s84 offen offset:128 nt lds
    v_mfma_f32_16x16x32_bf16 a[140:143], a[248:251], v[148:151], a[140:143]
    v_cvt_pk_bf16_f32 v35, v42, v43
    v_lshlrev_b32 v40, 16, v36
    v_mfma_f32_16x16x32_bf16 a[140:143], a[252:255], v[132:135], a[140:143]
    v_and_b32 v41, 0xffff0000, v36
    v_mul_f32 v40, s42, v40
    v_mfma_f32_16x16x32_bf16 a[188:191], a[252:255], v[136:139], a[188:191]
    v_mul_f32 v41, s42, v41
    v_cvt_pk_bf16_f32 v36, v40, v41
    v_mfma_f32_16x16x32_bf16 v[64:67], a[192:195], v[160:163], v[48:51]
    v_lshlrev_b32 v42, 16, v37
    v_and_b32 v43, 0xffff0000, v37
    v_mfma_f32_16x16x32_bf16 v[64:67], a[196:199], v[164:167], v[64:67]
    s_add_u32 m0, s89, 1792
    ds_read_b32 v30, v46
    v_mul_f32 v42, s42, v42
    v_mfma_f32_16x16x32_bf16 v[64:67], a[200:203], v[168:171], v[64:67]
    buffer_load_dwordx4 v23, s[80:83], s84 offen offset:256 nt lds
    v_mfma_f32_16x16x32_bf16 v[64:67], a[204:207], v[172:175], v[64:67]
    s_add_u32 s84, s84, s91
    v_mul_f32 v43, s42, v43
    v_cvt_pk_bf16_f32 v37, v42, v43
    v_mfma_f32_16x16x32_bf16 v[64:67], a[208:211], v[176:179], v[64:67]
    s_add_u32 s89, s89, s91
    buffer_load_dword v25, v47, s[12:15], s92 offen
    v_mfma_f32_16x16x32_bf16 v[64:67], a[212:215], v[180:183], v[64:67]
    v_lshlrev_b32 v40, 16, v38
    v_and_b32 v41, 0xffff0000, v38
    v_mfma_f32_16x16x32_bf16 v[72:75], a[192:195], v[184:187], v[52:55]
    v_mul_f32 v40, s42, v40
    v_mul_f32 v41, s42, v41
    v_mfma_f32_16x16x32_bf16 v[72:75], a[196:199], v[188:191], v[72:75]
    v_cmp_lt_f32 vcc, s35, v28
    v_cvt_pk_bf16_f32 v38, v40, v41
    v_mfma_f32_16x16x32_bf16 v[72:75], a[200:203], v[192:195], v[72:75]
    s_waitcnt lgkmcnt(0)
    v_cmp_gt_u32 s[94:95], s93, v30
    v_lshlrev_b32 v42, 16, v39
    v_mfma_f32_16x16x32_bf16 v[72:75], a[204:207], v[196:199], v[72:75]
    s_add_u32 m0, s33, 74624
    v_exp_f32 v64, v64
    v_mfma_f32_16x16x32_bf16 v[72:75], a[208:211], v[200:203], v[72:75]
    s_or_b64 vcc, vcc, s[94:95]
    v_exp_f32 v65, v65
    v_mfma_f32_16x16x32_bf16 v[72:75], a[212:215], v[204:207], v[72:75]
    s_cbranch_vccnz L_b10_5cs_rare
L_b10_5cs_back:
    ds_read_b64_tr_b16 v[152:153], v4
    v_cvt_pk_bf16_f32 v140, v64, v65
    v_mfma_f32_16x16x32_bf16 v[80:83], a[192:195], v[208:211], v[56:59]
    s_add_u32 s93, s93, 4
    buffer_load_dwordx4 v9, s[20:23], s30 offen offset:128 nt lds
    v_mfma_f32_16x16x32_bf16 v[80:83], a[196:199], v[212:215], v[80:83]
    ds_read_b128 a[192:195], v2 offset:36864
    v_add_f32 v12, v12, v16
    v_mfma_f32_16x16x32_bf16 v[80:83], a[200:203], v[216:219], v[80:83]
    ds_read_b64_tr_b16 v[154:155], v4 offset:6144
    v_add_f32 v13, v13, v17
    v_mfma_f32_16x16x32_bf16 v[80:83], a[204:207], v[220:223], v[80:83]
    ds_read_b128 a[196:199], v3 offset:36864
    v_add_f32 v14, v14, v18
    v_mfma_f32_16x16x32_bf16 v[80:83], a[208:211], v[224:227], v[80:83]
    ds_read_b64_tr_b16 v[156:157], v4 offset:12288
    v_add_f32 v15, v15, v22
    v_mfma_f32_16x16x32_bf16 v[80:83], a[212:215], v[228:231], v[80:83]
    s_add_u32 m0, s33, 75520
    ds_read_b128 a[200:203], v2 offset:37888
    v_add_f32 v19, v64, v65
    v_mfma_f32_16x16x32_bf16 v[68:71], a[216:219], v[160:163], v[48:51]
    buffer_load_dwordx4 v9, s[20:23], s30 offen offset:256 nt lds
    v_mfma_f32_16x16x32_bf16 v[68:71], a[220:223], v[164:167], v[68:71]
    v_exp_f32 v66, v66
    v_mfma_f32_16x16x32_bf16 v[68:71], a[224:227], v[168:171], v[68:71]
    ds_read_b64_tr_b16 v[158:159], v4 offset:18432
    v_add_f32 v19, v19, v66
    v_mfma_f32_16x16x32_bf16 v[68:71], a[228:231], v[172:175], v[68:71]
    v_exp_f32 v67, v67
    v_mfma_f32_16x16x32_bf16 v[68:71], a[232:235], v[176:179], v[68:71]
    ds_read_b128 a[204:207], v3 offset:37888
    v_cvt_pk_bf16_f32 v141, v66, v67
    v_mfma_f32_16x16x32_bf16 v[68:71], a[236:239], v[180:183], v[68:71]
    s_add_u32 m0, s33, 86912
    ds_read_b64_tr_b16 a[240:241], v5
    v_add_f32 v19, v19, v67
    v_mfma_f32_16x16x32_bf16 v[76:79], a[216:219], v[184:187], v[52:55]
    buffer_load_dwordx4 v9, s[20:23], s32 offen offset:128 nt lds
    v_mfma_f32_16x16x32_bf16 v[76:79], a[220:223], v[188:191], v[76:79]
    v_exp_f32 v72, v72
    v_mfma_f32_16x16x32_bf16 v[76:79], a[224:227], v[192:195], v[76:79]
    v_exp_f32 v73, v73
    v_mfma_f32_16x16x32_bf16 v[76:79], a[228:231], v[196:199], v[76:79]
    ds_read_b128 a[208:211], v2 offset:38912
    v_cvt_pk_bf16_f32 v144, v72, v73
    v_mfma_f32_16x16x32_bf16 v[76:79], a[232:235], v[200:203], v[76:79]
    ds_read_b64_tr_b16 a[242:243], v5 offset:6144
    v_add_f32 v20, v72, v73
    v_mfma_f32_16x16x32_bf16 v[76:79], a[236:239], v[204:207], v[76:79]
    s_add_u32 m0, s33, 87808
    v_exp_f32 v74, v74
    v_mfma_f32_16x16x32_bf16 v[84:87], a[216:219], v[208:211], v[56:59]
    buffer_load_dwordx4 v9, s[20:23], s32 offen offset:256 nt lds
    v_mfma_f32_16x16x32_bf16 v[84:87], a[220:223], v[212:215], v[84:87]
    s_add_u32 s30, s30, 24576
    ds_read_b128 a[212:215], v3 offset:38912
    v_add_f32 v20, v20, v74
    v_mfma_f32_16x16x32_bf16 v[84:87], a[224:227], v[216:219], v[84:87]
    s_add_u32 s32, s32, 24576
    ds_read_b64_tr_b16 a[244:245], v5 offset:12288
    ds_read_b64_tr_b16 a[246:247], v5 offset:18432
    v_mfma_f32_16x16x32_bf16 v[84:87], a[228:231], v[220:223], v[84:87]
    v_exp_f32 v75, v75
    v_mfma_f32_16x16x32_bf16 v[84:87], a[232:235], v[224:227], v[84:87]
    s_add_u32 m0, s33, 24576
    ds_read_b128 a[216:219], v2 offset:43008
    v_cvt_pk_bf16_f32 v145, v74, v75
    v_mfma_f32_16x16x32_bf16 v[84:87], a[236:239], v[228:231], v[84:87]
    s_waitcnt lgkmcnt(4)
    ds_read_b64_tr_b16 a[248:249], v6
    v_add_f32 v20, v20, v75
    v_mfma_f32_16x16x32_bf16 a[0:3], v[152:155], v[112:115], a[0:3]
    buffer_load_dwordx4 v8, s[16:19], s29 offen nt lds
    v_mfma_f32_16x16x32_bf16 a[0:3], v[156:159], v[96:99], a[0:3]
    ds_read_b128 a[220:223], v3 offset:43008
    v_and_b32 v43, 0xffff0000, v39
    v_mfma_f32_16x16x32_bf16 a[48:51], v[152:155], v[116:119], a[48:51]
    ds_read_b64_tr_b16 a[250:251], v6 offset:6144
    ds_read_b64_tr_b16 a[252:253], v6 offset:12288
    v_mfma_f32_16x16x32_bf16 a[48:51], v[156:159], v[100:103], a[48:51]
    ds_read_b64_tr_b16 a[254:255], v6 offset:18432
    v_mul_f32 v42, s42, v42
    v_mfma_f32_16x16x32_bf16 a[96:99], v[152:155], v[120:123], a[96:99]
    ds_read_b128 a[224:227], v2 offset:44032
    v_mul_f32 v43, s42, v43
    v_mfma_f32_16x16x32_bf16 a[96:99], v[156:159], v[104:107], a[96:99]
    s_add_u32 m0, s33, 25472
    v_exp_f32 v80, v80
    v_mfma_f32_16x16x32_bf16 a[144:147], v[156:159], v[108:111], a[144:147]
    buffer_load_dwordx4 v8, s[16:19], s29 offen offset:128 nt lds
    v_mfma_f32_16x16x32_bf16 a[4:7], a[240:243], v[112:115], a[4:7]
    s_waitcnt lgkmcnt(5)
    ds_read_b128 a[228:231], v3 offset:44032
    v_cvt_pk_bf16_f32 v39, v42, v43
    v_mfma_f32_16x16x32_bf16 a[4:7], a[244:247], v[96:99], a[4:7]
    v_exp_f32 v81, v81
    v_mfma_f32_16x16x32_bf16 a[52:55], a[240:243], v[116:119], a[52:55]
    ds_read_b64_tr_b16 v[152:153], v7
    v_cvt_pk_bf16_f32 v148, v80, v81
    v_mfma_f32_16x16x32_bf16 a[52:55], a[244:247], v[100:103], a[52:55]
    ds_read_b64_tr_b16 v[154:155], v7 offset:6144
    v_add_f32 v21, v80, v81
    v_mfma_f32_16x16x32_bf16 a[100:103], a[240:243], v[120:123], a[100:103]
    ds_read_b64_tr_b16 v[156:157], v7 offset:12288
    ds_read_b64_tr_b16 v[158:159], v7 offset:18432
    v_mfma_f32_16x16x32_bf16 a[100:103], a[244:247], v[104:107], a[100:103]
    s_add_u32 m0, s33, 26368
    ds_read_b128 a[232:235], v2 offset:45056
    v_xor_b32 v23, s87, v23
    v_mfma_f32_16x16x32_bf16 a[148:151], a[244:247], v[108:111], a[148:151]
    s_waitcnt lgkmcnt(6)
    buffer_load_dwordx4 v8, s[16:19], s29 offen offset:256 nt lds
    v_mfma_f32_16x16x32_bf16 a[8:11], a[248:251], v[112:115], a[8:11]
    s_add_u32 s29, s29, 12288
    ds_read_b128 a[236:239], v3 offset:45056
    v_mfma_f32_16x16x32_bf16 a[8:11], a[252:255], v[96:99], a[8:11]
    s_waitcnt vmcnt(16)
    ds_inc_u32 v46, v46
    v_mfma_f32_16x16x32_bf16 a[56:59], a[248:251], v[116:119], a[56:59]
    v_exp_f32 v82, v82
    v_mfma_f32_16x16x32_bf16 a[56:59], a[252:255], v[100:103], a[56:59]
    v_exp_f32 v83, v83
    v_mfma_f32_16x16x32_bf16 a[104:107], a[248:251], v[120:123], a[104:107]
    v_cvt_pk_bf16_f32 v149, v82, v83
    v_add_f32 v21, v21, v82
    v_mfma_f32_16x16x32_bf16 a[104:107], a[252:255], v[104:107], a[104:107]
    v_exp_f32 v68, v68
    v_mfma_f32_16x16x32_bf16 a[152:155], a[252:255], v[108:111], a[152:155]
    s_waitcnt lgkmcnt(2)
    v_add_f32 v21, v21, v83
    v_add_f32 v19, v19, v68
    v_mfma_f32_16x16x32_bf16 a[12:15], v[152:155], v[112:115], a[12:15]
    v_exp_f32 v69, v69
    v_mfma_f32_16x16x32_bf16 a[12:15], v[156:159], v[96:99], a[12:15]
    v_exp_f32 v70, v70
    v_mfma_f32_16x16x32_bf16 a[60:63], v[152:155], v[116:119], a[60:63]
    v_exp_f32 v71, v71
    v_mfma_f32_16x16x32_bf16 a[60:63], v[156:159], v[100:103], a[60:63]
    v_cvt_pk_bf16_f32 v142, v68, v69
    v_cvt_pk_bf16_f32 v143, v70, v71
    v_mfma_f32_16x16x32_bf16 a[108:111], v[152:155], v[120:123], a[108:111]
    v_add_f32 v19, v19, v69
    v_add_f32 v19, v19, v70
    v_mfma_f32_16x16x32_bf16 a[108:111], v[156:159], v[104:107], a[108:111]
    v_exp_f32 v76, v76
    v_mfma_f32_16x16x32_bf16 a[156:159], v[156:159], v[108:111], a[156:159]
    v_add_f32 v19, v19, v71
    v_add_f32 v20, v20, v76
    v_mfma_f32_16x16x32_bf16 v[64:67], a[192:195], v[160:163], v[48:51]
    v_exp_f32 v77, v77
    v_mfma_f32_16x16x32_bf16 v[64:67], a[196:199], v[164:167], v[64:67]
    v_exp_f32 v78, v78
    v_mfma_f32_16x16x32_bf16 v[64:67], a[200:203], v[168:171], v[64:67]
    v_exp_f32 v79, v79
    v_mfma_f32_16x16x32_bf16 v[64:67], a[204:207], v[172:175], v[64:67]
    v_cvt_pk_bf16_f32 v146, v76, v77
    v_cvt_pk_bf16_f32 v147, v78, v79
    v_mfma_f32_16x16x32_bf16 v[64:67], a[208:211], v[176:179], v[64:67]
    v_add_f32 v20, v20, v77
    v_add_f32 v20, v20, v78
    v_mfma_f32_16x16x32_bf16 v[64:67], a[212:215], v[180:183], v[64:67]
    v_exp_f32 v84, v84
    v_mfma_f32_16x16x32_bf16 v[72:75], a[192:195], v[184:187], v[52:55]
    v_add_f32 v20, v20, v79
    v_add_f32 v21, v21, v84
    v_mfma_f32_16x16x32_bf16 v[72:75], a[196:199], v[188:191], v[72:75]
    v_exp_f32 v85, v85
    v_mfma_f32_16x16x32_bf16 v[72:75], a[200:203], v[192:195], v[72:75]
    v_exp_f32 v86, v86
    v_mfma_f32_16x16x32_bf16 v[72:75], a[204:207], v[196:199], v[72:75]
    v_exp_f32 v87, v87
    v_mfma_f32_16x16x32_bf16 v[72:75], a[208:211], v[200:203], v[72:75]
    v_cvt_pk_bf16_f32 v150, v84, v85
    v_cvt_pk_bf16_f32 v151, v86, v87
    v_mfma_f32_16x16x32_bf16 v[72:75], a[212:215], v[204:207], v[72:75]
    v_add_f32 v21, v21, v85
    v_add_f32 v21, v21, v86
    v_mfma_f32_16x16x32_bf16 v[80:83], a[192:195], v[208:211], v[56:59]
    v_exp_f32 v64, v64
    v_mfma_f32_16x16x32_bf16 v[80:83], a[196:199], v[212:215], v[80:83]
    ds_read_b32 v30, v46
    v_add_f32 v21, v21, v87
    v_mfma_f32_16x16x32_bf16 v[80:83], a[200:203], v[216:219], v[80:83]
    v_exp_f32 v65, v65
    v_mfma_f32_16x16x32_bf16 v[80:83], a[204:207], v[220:223], v[80:83]
    v_exp_f32 v66, v66
    v_mfma_f32_16x16x32_bf16 v[80:83], a[208:211], v[224:227], v[80:83]
    v_exp_f32 v67, v67
    v_mfma_f32_16x16x32_bf16 v[80:83], a[212:215], v[228:231], v[80:83]
    v_cvt_pk_bf16_f32 v124, v64, v65
    v_cvt_pk_bf16_f32 v125, v66, v67
    v_mfma_f32_16x16x32_bf16 v[88:91], a[192:195], v[232:235], v[60:63]
    v_add_f32 v19, v19, v64
    v_add_f32 v19, v19, v65
    v_mfma_f32_16x16x32_bf16 v[88:91], a[196:199], v[236:239], v[88:91]
    v_add_f32 v19, v19, v66
    v_add_f32 v19, v19, v67
    v_mfma_f32_16x16x32_bf16 v[88:91], a[200:203], v[240:243], v[88:91]
    s_waitcnt lgkmcnt(0)
    v_cmp_gt_u32 vcc, s93, v30
    v_mfma_f32_16x16x32_bf16 v[88:91], a[204:207], v[244:247], v[88:91]
    v_exp_f32 v72, v72
    v_mfma_f32_16x16x32_bf16 v[88:91], a[208:211], v[248:251], v[88:91]
    s_add_u32 m0, s33, 49152
    v_exp_f32 v73, v73
    v_mfma_f32_16x16x32_bf16 v[88:91], a[212:215], v[252:255], v[88:91]
    s_cbranch_vccnz L_b10_6s_rare
L_b10_6s_back:
    ds_read_b64_tr_b16 a[240:241], v4 offset:1024
    v_cvt_pk_bf16_f32 v128, v72, v73
    v_mfma_f32_16x16x32_bf16 v[68:71], a[216:219], v[160:163], v[48:51]
    s_add_u32 s93, s93, 4
    buffer_load_dwordx4 v9, s[20:23], s30 offen nt lds
    v_mfma_f32_16x16x32_bf16 v[68:71], a[220:223], v[164:167], v[68:71]
    ds_read_b64_tr_b16 a[242:243], v4 offset:7168
    v_add_f32 v20, v20, v72
    v_mfma_f32_16x16x32_bf16 v[68:71], a[224:227], v[168:171], v[68:71]
    ds_read_b64_tr_b16 a[244:245], v4 offset:13312
    v_add_f32 v20, v20, v73
    v_mfma_f32_16x16x32_bf16 v[68:71], a[228:231], v[172:175], v[68:71]
    v_exp_f32 v74, v74
    v_mfma_f32_16x16x32_bf16 v[68:71], a[232:235], v[176:179], v[68:71]
    ds_read_b64_tr_b16 a[246:247], v4 offset:19456
    v_add_f32 v20, v20, v74
    v_mfma_f32_16x16x32_bf16 v[68:71], a[236:239], v[180:183], v[68:71]
    v_exp_f32 v75, v75
    v_mfma_f32_16x16x32_bf16 v[76:79], a[216:219], v[184:187], v[52:55]
    ds_read_b64_tr_b16 a[248:249], v5 offset:1024
    v_cvt_pk_bf16_f32 v129, v74, v75
    v_mfma_f32_16x16x32_bf16 v[76:79], a[220:223], v[188:191], v[76:79]
    ds_read_b64_tr_b16 a[250:251], v5 offset:7168
    v_add_f32 v20, v20, v75
    v_mfma_f32_16x16x32_bf16 v[76:79], a[224:227], v[192:195], v[76:79]
    v_exp_f32 v80, v80
    v_mfma_f32_16x16x32_bf16 v[76:79], a[228:231], v[196:199], v[76:79]
    s_add_u32 m0, s33, 61440
    ds_read_b64_tr_b16 a[252:253], v5 offset:13312
    v_add_f32 v21, v21, v80
    v_mfma_f32_16x16x32_bf16 v[76:79], a[232:235], v[200:203], v[76:79]
    buffer_load_dwordx4 v9, s[20:23], s32 offen nt lds
    v_mfma_f32_16x16x32_bf16 v[76:79], a[236:239], v[204:207], v[76:79]
    v_exp_f32 v68, v68
    v_mfma_f32_16x16x32_bf16 v[84:87], a[216:219], v[208:211], v[56:59]
    ds_read_b64_tr_b16 a[254:255], v5 offset:19456
    v_add_f32 v19, v19, v68
    v_mfma_f32_16x16x32_bf16 v[84:87], a[220:223], v[212:215], v[84:87]
    v_exp_f32 v69, v69
    v_mfma_f32_16x16x32_bf16 v[84:87], a[224:227], v[216:219], v[84:87]
    ds_read_b64_tr_b16 v[152:153], v6 offset:1024
    v_cvt_pk_bf16_f32 v126, v68, v69
    v_mfma_f32_16x16x32_bf16 v[84:87], a[228:231], v[220:223], v[84:87]
    ds_read_b64_tr_b16 v[154:155], v6 offset:7168
    v_add_f32 v19, v19, v69
    v_mfma_f32_16x16x32_bf16 v[84:87], a[232:235], v[224:227], v[84:87]
    v_exp_f32 v70, v70
    v_mfma_f32_16x16x32_bf16 v[84:87], a[236:239], v[228:231], v[84:87]
    ds_read_b64_tr_b16 v[156:157], v6 offset:13312
    v_add_f32 v19, v19, v70
    v_mfma_f32_16x16x32_bf16 v[92:95], a[216:219], v[232:235], v[60:63]
    v_exp_f32 v71, v71
    v_mfma_f32_16x16x32_bf16 v[92:95], a[220:223], v[236:239], v[92:95]
    s_add_u32 m0, s33, 36864
    ds_read_b64_tr_b16 v[158:159], v6 offset:19456
    v_cvt_pk_bf16_f32 v127, v70, v71
    v_mfma_f32_16x16x32_bf16 v[92:95], a[224:227], v[240:243], v[92:95]
    buffer_load_dwordx4 v8, s[16:19], s29 offen nt lds
    v_mfma_f32_16x16x32_bf16 v[92:95], a[228:231], v[244:247], v[92:95]
    ds_read_b128 a[192:195], v2
    v_add_f32 v19, v19, v71
    v_mfma_f32_16x16x32_bf16 v[92:95], a[232:235], v[248:251], v[92:95]
    v_exp_f32 v76, v76
    v_mfma_f32_16x16x32_bf16 v[92:95], a[236:239], v[252:255], v[92:95]
    s_waitcnt lgkmcnt(3)
    ds_read_b128 a[196:199], v3
    v_add_f32 v20, v20, v76
    v_mfma_f32_16x16x32_bf16 a[16:19], a[240:243], v[112:115], a[16:19]
    v_exp_f32 v77, v77
    v_mfma_f32_16x16x32_bf16 a[16:19], a[244:247], v[96:99], a[16:19]
    ds_read_b128 a[200:203], v2 offset:1024
    v_cvt_pk_bf16_f32 v130, v76, v77
    v_mfma_f32_16x16x32_bf16 a[64:67], a[240:243], v[116:119], a[64:67]
    v_exp_f32 v78, v78
    v_mfma_f32_16x16x32_bf16 a[64:67], a[244:247], v[100:103], a[64:67]
    ds_read_b128 a[204:207], v3 offset:1024
    v_add_f32 v20, v20, v77
    v_mfma_f32_16x16x32_bf16 a[112:115], a[240:243], v[120:123], a[112:115]
    ds_read_b64_tr_b16 a[240:241], v7 offset:1024
    v_add_f32 v20, v20, v78
    v_mfma_f32_16x16x32_bf16 a[112:115], a[244:247], v[104:107], a[112:115]
    s_add_u32 m0, s33, 37760
    v_exp_f32 v79, v79
    v_mfma_f32_16x16x32_bf16 a[160:163], a[244:247], v[108:111], a[160:163]
    buffer_load_dwordx4 v8, s[16:19], s29 offen offset:128 nt lds
    v_mfma_f32_16x16x32_bf16 a[20:23], a[248:251], v[112:115], a[20:23]
    ds_read_b64_tr_b16 a[242:243], v7 offset:7168
    v_cvt_pk_bf16_f32 v131, v78, v79
    v_mfma_f32_16x16x32_bf16 a[20:23], a[252:255], v[96:99], a[20:23]
    ds_read_b64_tr_b16 a[244:245], v7 offset:13312
    v_add_f32 v20, v20, v79
    v_mfma_f32_16x16x32_bf16 a[68:71], a[248:251], v[116:119], a[68:71]
    v_exp_f32 v81, v81
    v_mfma_f32_16x16x32_bf16 a[68:71], a[252:255], v[100:103], a[68:71]
    ds_read_b64_tr_b16 a[246:247], v7 offset:19456
    v_cvt_pk_bf16_f32 v132, v80, v81
    v_mfma_f32_16x16x32_bf16 a[116:119], a[248:251], v[120:123], a[116:119]
    ds_read_b64_tr_b16 a[248:249], v4 offset:2048
    v_add_f32 v21, v21, v81
    v_mfma_f32_16x16x32_bf16 a[116:119], a[252:255], v[104:107], a[116:119]
    v_exp_f32 v82, v82
    v_mfma_f32_16x16x32_bf16 a[164:167], a[252:255], v[108:111], a[164:167]
    ds_read_b64_tr_b16 a[250:251], v4 offset:8192
    v_add_f32 v21, v21, v82
    v_mfma_f32_16x16x32_bf16 a[24:27], v[152:155], v[112:115], a[24:27]
    s_waitcnt lgkmcnt(4)
    v_exp_f32 v83, v83
    v_mfma_f32_16x16x32_bf16 a[24:27], v[156:159], v[96:99], a[24:27]
    s_add_u32 m0, s33, 38656
    ds_read_b64_tr_b16 a[252:253], v4 offset:14336
    v_cvt_pk_bf16_f32 v133, v82, v83
    v_mfma_f32_16x16x32_bf16 a[72:75], v[152:155], v[116:119], a[72:75]
    buffer_load_dwordx4 v8, s[16:19], s29 offen offset:256 nt lds
    v_mfma_f32_16x16x32_bf16 a[72:75], v[156:159], v[100:103], a[72:75]
    s_add_u32 s29, s29, 12288
    ds_read_b64_tr_b16 a[254:255], v4 offset:20480
    v_add_f32 v21, v21, v83
    v_mfma_f32_16x16x32_bf16 a[120:123], v[152:155], v[120:123], a[120:123]
    v_exp_f32 v84, v84
    v_mfma_f32_16x16x32_bf16 a[120:123], v[156:159], v[104:107], a[120:123]
    ds_read_b128 a[208:211], v2 offset:2048
    v_add_f32 v21, v21, v84
    v_mfma_f32_16x16x32_bf16 a[168:171], v[156:159], v[108:111], a[168:171]
    v_exp_f32 v85, v85
    v_mfma_f32_16x16x32_bf16 a[28:31], a[240:243], v[112:115], a[28:31]
    s_waitcnt lgkmcnt(3)
    ds_read_b64_tr_b16 v[152:153], v5 offset:2048
    v_cvt_pk_bf16_f32 v134, v84, v85
    v_mfma_f32_16x16x32_bf16 a[28:31], a[244:247], v[96:99], a[28:31]
    ds_read_b64_tr_b16 v[154:155], v5 offset:8192
    v_add_f32 v21, v21, v85
    v_mfma_f32_16x16x32_bf16 a[76:79], a[240:243], v[116:119], a[76:79]
    ds_read_b128 a[212:215], v3 offset:2048
    v_mfma_f32_16x16x32_bf16 a[76:79], a[244:247], v[100:103], a[76:79]
    ds_read_b64_tr_b16 v[156:157], v5 offset:14336
    ds_read_b64_tr_b16 v[158:159], v5 offset:20480
    v_mfma_f32_16x16x32_bf16 a[124:127], a[240:243], v[120:123], a[124:127]
    v_exp_f32 v86, v86
    v_mfma_f32_16x16x32_bf16 a[124:127], a[244:247], v[104:107], a[124:127]
    ds_read_b128 a[216:219], v2 offset:6144
    v_add_f32 v21, v21, v86
    v_mfma_f32_16x16x32_bf16 a[172:175], a[244:247], v[108:111], a[172:175]
    v_exp_f32 v87, v87
    v_mfma_f32_16x16x32_bf16 a[32:35], a[248:251], v[112:115], a[32:35]
    s_waitcnt lgkmcnt(5)
    ds_read_b128 a[220:223], v3 offset:6144
    v_cvt_pk_bf16_f32 v135, v86, v87
    v_mfma_f32_16x16x32_bf16 a[32:35], a[252:255], v[96:99], a[32:35]
    ds_read_b64_tr_b16 a[240:241], v6 offset:2048
    v_add_f32 v21, v21, v87
    v_mfma_f32_16x16x32_bf16 a[80:83], a[248:251], v[116:119], a[80:83]
    ds_read_b64_tr_b16 a[242:243], v6 offset:8192
    v_max3_f32 v28, v19, v20, v21
    v_mfma_f32_16x16x32_bf16 a[80:83], a[252:255], v[100:103], a[80:83]
    ds_read_b64_tr_b16 a[244:245], v6 offset:14336
    ds_read_b64_tr_b16 a[246:247], v6 offset:20480
    v_mfma_f32_16x16x32_bf16 a[128:131], a[248:251], v[120:123], a[128:131]
    ds_read_b128 a[224:227], v2 offset:7168
    v_mfma_f32_16x16x32_bf16 a[128:131], a[252:255], v[104:107], a[128:131]
    v_exp_f32 v88, v88
    v_mfma_f32_16x16x32_bf16 a[176:179], a[252:255], v[108:111], a[176:179]
    s_waitcnt lgkmcnt(6)
    v_exp_f32 v89, v89
    v_mfma_f32_16x16x32_bf16 a[36:39], v[152:155], v[112:115], a[36:39]
    ds_read_b128 a[228:231], v3 offset:7168
    v_cvt_pk_bf16_f32 v136, v88, v89
    v_mfma_f32_16x16x32_bf16 a[36:39], v[156:159], v[96:99], a[36:39]
    ds_read_b64_tr_b16 a[248:249], v7 offset:2048
    v_add_f32 v22, v88, v89
    v_mfma_f32_16x16x32_bf16 a[84:87], v[152:155], v[116:119], a[84:87]
    ds_read_b64_tr_b16 a[250:251], v7 offset:8192
    ds_read_b64_tr_b16 a[252:253], v7 offset:14336
    v_mfma_f32_16x16x32_bf16 a[84:87], v[156:159], v[100:103], a[84:87]
    ds_read_b64_tr_b16 a[254:255], v7 offset:20480
    v_mfma_f32_16x16x32_bf16 a[132:135], v[152:155], v[120:123], a[132:135]
    ds_read_b128 a[232:235], v2 offset:8192
    v_mfma_f32_16x16x32_bf16 a[132:135], v[156:159], v[104:107], a[132:135]
    v_exp_f32 v90, v90
    v_mfma_f32_16x16x32_bf16 a[180:183], v[156:159], v[108:111], a[180:183]
    s_waitcnt lgkmcnt(6)
    ds_read_b128 a[236:239], v3 offset:8192
    v_add_f32 v22, v22, v90
    v_mfma_f32_16x16x32_bf16 a[40:43], a[240:243], v[112:115], a[40:43]
    v_exp_f32 v91, v91
    v_mfma_f32_16x16x32_bf16 a[40:43], a[244:247], v[96:99], a[40:43]
    s_waitcnt vmcnt(16)
    ds_inc_u32 v46, v46
    v_cvt_pk_bf16_f32 v137, v90, v91
    v_mfma_f32_16x16x32_bf16 a[88:91], a[240:243], v[116:119], a[88:91]
    v_exp_f32 v92, v92
    v_mfma_f32_16x16x32_bf16 a[88:91], a[244:247], v[100:103], a[88:91]
    ds_write_b128 v44, v[32:35]
    v_exp_f32 v93, v93
    v_mfma_f32_16x16x32_bf16 a[136:139], a[240:243], v[120:123], a[136:139]
    v_exp_f32 v94, v94
    v_mfma_f32_16x16x32_bf16 a[136:139], a[244:247], v[104:107], a[136:139]
    v_exp_f32 v95, v95
    v_mfma_f32_16x16x32_bf16 a[184:187], a[244:247], v[108:111], a[184:187]
    s_waitcnt lgkmcnt(2)
    v_cvt_pk_bf16_f32 v138, v92, v93
    v_cvt_pk_bf16_f32 v139, v94, v95
    v_mfma_f32_16x16x32_bf16 a[44:47], a[248:251], v[112:115], a[44:47]
    ds_write_b128 v44, v[36:39] offset:1024
    v_add_f32 v22, v22, v91
    v_add_f32 v22, v22, v92
    v_mfma_f32_16x16x32_bf16 a[44:47], a[252:255], v[96:99], a[44:47]
    v_add_f32 v22, v22, v93
    v_add_f32 v22, v22, v94
    v_add_u32 v44, s85, v44
    v_mfma_f32_16x16x32_bf16 a[92:95], a[248:251], v[116:119], a[92:95]
    s_waitcnt vmcnt(14)
    ds_read_b128 v[32:35], v44
    v_add_f32 v22, v22, v95
    v_max_f32 v28, v28, v22
    v_mfma_f32_16x16x32_bf16 a[92:95], a[252:255], v[100:103], a[92:95]
    ds_read_b128 v[36:39], v44 offset:1024
    v_mfma_f32_16x16x32_bf16 a[140:143], a[248:251], v[120:123], a[140:143]
    v_mfma_f32_16x16x32_bf16 a[140:143], a[252:255], v[104:107], a[140:143]
    v_mfma_f32_16x16x32_bf16 a[188:191], a[252:255], v[108:111], a[188:191]
    s_mov_b32 s85, 2048
    s_sub_u32 s31, s31, 1
    s_cbranch_scc0 L_loop_10
L_after_10:
    s_waitcnt vmcnt(8) lgkmcnt(0)
    s_barrier
    s_add_u32 s93, s93, 4
    s_mov_b32 s48, s90
    s_xor_b32 s49, s90, 16384
    s_add_u32 s50, s90, 256
    s_add_u32 s51, s90, 6656
    ds_read_b64_tr_b16 v[152:153], v4 offset:24576
    ds_read_b64_tr_b16 v[154:155], v4 offset:30720
    ds_read_b64_tr_b16 v[156:157], v4 offset:36864
    ds_read_b64_tr_b16 v[158:159], v4 offset:43008
    ds_read_b64_tr_b16 a[240:241], v5 offset:24576
    ds_read_b64_tr_b16 a[242:243], v5 offset:30720
    ds_read_b64_tr_b16 a[244:245], v5 offset:36864
    ds_read_b64_tr_b16 a[246:247], v5 offset:43008
    v_cmp_lt_f32 vcc, s35, v28
    s_nop 3
    s_cbranch_vccnz L_t10_31c_rare
L_t10_31c_back:
    s_add_u32 m0, s33, 50048
    s_mov_b32 s54, 6144
    s_mov_b32 s55, 12288
    v_add_u32 v24, s90, v2
    v_add_u32 v25, s90, v3
    v_lshl_add_u32 v36, v1, 4, s48
    v_add_u32 v26, s46, v10
    v_add_u32 v27, s40, v10
    v_add_f32 v12, v12, v19
    v_add_f32 v13, v13, v20
    v_add_f32 v14, v14, v21
    v_add_f32 v15, v15, v22
    v_mov_b32 v32, v12
    s_nop 1
    v_permlane32_swap_b32 v12, v32
    v_add_f32 v12, v12, v32
    v_mov_b32 v32, v12
    s_nop 1
    v_permlane16_swap_b32 v12, v32
    v_add_f32 v12, v12, v32
    v_rcp_f32 v40, v12
    v_mov_b32 v35, v15
    s_nop 1
    v_permlane32_swap_b32 v15, v35
    v_add_f32 v15, v15, v35
    v_mov_b32 v35, v15
    s_nop 1
    v_permlane16_swap_b32 v15, v35
    v_add_f32 v15, v15, v35
    v_mov_b32 v39, v15
    v_mov_b32 v33, v13
    v_mov_b32 v34, v14
    s_waitcnt lgkmcnt(6)
    v_mfma_f32_16x16x32_bf16 a[0:3], v[152:155], v[140:143], a[0:3]
    s_waitcnt lgkmcnt(4)
    buffer_load_dwordx4 v9, s[20:23], s30 offen offset:128 nt lds
    v_mfma_f32_16x16x32_bf16 a[0:3], v[156:159], v[124:127], a[0:3]
    ds_read_b64_tr_b16 a[248:249], v6 offset:24576
    v_mov_b32 v38, v60
    v_mfma_f32_16x16x32_bf16 a[48:51], v[152:155], v[144:147], a[48:51]
    ds_read_b64_tr_b16 a[250:251], v6 offset:30720
    v_lshl_add_u32 v37, v1, 4, s49
    v_mfma_f32_16x16x32_bf16 a[48:51], v[156:159], v[128:131], a[48:51]
    ds_read_b64_tr_b16 a[252:253], v6 offset:36864
    v_lshl_add_u32 v41, v1, 3, s48
    v_mfma_f32_16x16x32_bf16 a[96:99], v[152:155], v[148:151], a[96:99]
    ds_read_b64_tr_b16 a[254:255], v6 offset:43008
    v_lshl_add_u32 v43, v1, 3, s49
    v_mfma_f32_16x16x32_bf16 a[96:99], v[156:159], v[132:135], a[96:99]
    ds_read_b64_tr_b16 v[152:153], v7 offset:24576
    v_and_b32 v45, 15, v1
    v_mfma_f32_16x16x32_bf16 a[144:147], v[156:159], v[136:139], a[144:147]
    s_waitcnt lgkmcnt(5)
    buffer_load_dwordx4 v[208:211], v26, s[12:15], 0 offen
    v_mfma_f32_16x16x32_bf16 a[4:7], a[240:243], v[140:143], a[4:7]
    ds_read_b64_tr_b16 v[154:155], v7 offset:30720
    v_mul_u32_u24 v45, 400, v45
    v_mfma_f32_16x16x32_bf16 a[4:7], a[244:247], v[124:127], a[4:7]
    ds_read_b128 v[160:163], v24
    v_lshrrev_b32 v29, 4, v1
    v_mfma_f32_16x16x32_bf16 a[52:55], a[240:243], v[144:147], a[52:55]
    ds_read_b64_tr_b16 v[156:157], v7 offset:36864
    v_lshl_add_u32 v45, v29, 3, v45
    v_mfma_f32_16x16x32_bf16 a[52:55], a[244:247], v[128:131], a[52:55]
    s_add_u32 m0, s33, 50944
    ds_read_b64_tr_b16 v[158:159], v7 offset:43008
    v_add_u32 v28, s51, v45
    v_mfma_f32_16x16x32_bf16 a[100:103], a[240:243], v[148:151], a[100:103]
    buffer_load_dwordx4 v9, s[20:23], s30 offen offset:256 nt lds
    v_mfma_f32_16x16x32_bf16 a[100:103], a[244:247], v[132:135], a[100:103]
    ds_read_b128 v[164:167], v25
    v_lshrrev_b32 v45, 3, v1
    v_mfma_f32_16x16x32_bf16 a[148:151], a[244:247], v[136:139], a[148:151]
    s_waitcnt lgkmcnt(5)
    ds_read_b64_tr_b16 a[240:241], v4 offset:25600
    v_and_b32 v29, 7, v1
    v_mfma_f32_16x16x32_bf16 a[8:11], a[248:251], v[140:143], a[8:11]
    ds_read_b128 v[168:171], v24 offset:1024
    v_lshlrev_b32 v29, 4, v29
    v_mfma_f32_16x16x32_bf16 a[8:11], a[252:255], v[124:127], a[8:11]
    ds_read_b64_tr_b16 a[242:243], v4 offset:31744
    v_mul_u32_u24 v30, 400, v45
    v_mfma_f32_16x16x32_bf16 a[56:59], a[248:251], v[144:147], a[56:59]
    ds_read_b128 v[172:175], v25 offset:1024
    v_add3_u32 v30, v30, v29, s50
    v_mfma_f32_16x16x32_bf16 a[56:59], a[252:255], v[128:131], a[56:59]
    ds_read_b64_tr_b16 a[244:245], v4 offset:37888
    v_mul_u32_u24 v31, 384, v45
    v_mfma_f32_16x16x32_bf16 a[104:107], a[248:251], v[148:151], a[104:107]
    ds_read_b64_tr_b16 a[246:247], v4 offset:44032
    v_add3_u32 v31, v31, v29, s37
    v_mfma_f32_16x16x32_bf16 a[104:107], a[252:255], v[132:135], a[104:107]
    ds_read_b128 v[176:179], v24 offset:2048
    v_add_u32 v29, s38, v11
    v_mfma_f32_16x16x32_bf16 a[152:155], a[252:255], v[136:139], a[152:155]
    s_waitcnt lgkmcnt(6)
    buffer_load_dwordx4 v[212:215], v26, s[12:15], 0 offen offset:64
    v_mfma_f32_16x16x32_bf16 a[12:15], v[152:155], v[140:143], a[12:15]
    s_add_u32 m0, s33, 62336
    ds_read_b128 v[180:183], v25 offset:2048
    v_accvgpr_read_b32 v64, a0
    v_mfma_f32_16x16x32_bf16 a[12:15], v[156:159], v[124:127], a[12:15]
    buffer_load_dwordx4 v9, s[20:23], s32 offen offset:128 nt lds
    v_mfma_f32_16x16x32_bf16 a[60:63], v[152:155], v[144:147], a[60:63]
    ds_read_b128 v[184:187], v24 offset:6144
    v_mul_f32 v64, v64, v40
    v_mfma_f32_16x16x32_bf16 a[60:63], v[156:159], v[128:131], a[60:63]
    ds_read_b64_tr_b16 a[248:249], v5 offset:25600
    v_accvgpr_read_b32 v65, a1
    v_mfma_f32_16x16x32_bf16 a[108:111], v[152:155], v[148:151], a[108:111]
    ds_read_b64_tr_b16 a[250:251], v5 offset:31744
    v_mul_f32 v65, v65, v40
    v_mfma_f32_16x16x32_bf16 a[108:111], v[156:159], v[132:135], a[108:111]
    ds_read_b128 v[188:191], v25 offset:6144
    v_cvt_pk_bf16_f32 v96, v64, v65
    v_mfma_f32_16x16x32_bf16 a[156:159], v[156:159], v[136:139], a[156:159]
    s_waitcnt lgkmcnt(5)
    ds_read_b64_tr_b16 a[252:253], v5 offset:37888
    ds_read_b64_tr_b16 a[254:255], v5 offset:44032
    v_mfma_f32_16x16x32_bf16 a[16:19], a[240:243], v[140:143], a[16:19]
    ds_read_b128 v[192:195], v24 offset:7168
    v_accvgpr_read_b32 v66, a2
    v_mfma_f32_16x16x32_bf16 a[16:19], a[244:247], v[124:127], a[16:19]
    ds_read_b64_tr_b16 v[152:153], v6 offset:25600
    v_mul_f32 v66, v66, v40
    v_mfma_f32_16x16x32_bf16 a[64:67], a[240:243], v[144:147], a[64:67]
    ds_read_b128 v[196:199], v25 offset:7168
    v_accvgpr_read_b32 v67, a3
    v_mfma_f32_16x16x32_bf16 a[64:67], a[244:247], v[128:131], a[64:67]
    ds_read_b64_tr_b16 v[154:155], v6 offset:31744
    v_mul_f32 v67, v67, v40
    v_mfma_f32_16x16x32_bf16 a[112:115], a[240:243], v[148:151], a[112:115]
    s_add_u32 m0, s33, 63232
    ds_read_b128 v[200:203], v24 offset:8192
    v_cvt_pk_bf16_f32 v97, v66, v67
    v_mfma_f32_16x16x32_bf16 a[112:115], a[244:247], v[132:135], a[112:115]
    buffer_load_dwordx4 v9, s[20:23], s32 offen offset:256 nt lds
    v_mfma_f32_16x16x32_bf16 a[160:163], a[244:247], v[136:139], a[160:163]
    s_waitcnt lgkmcnt(5)
    ds_read_b64_tr_b16 v[156:157], v6 offset:37888
    ds_read_b64_tr_b16 v[158:159], v6 offset:44032
    ds_read_b128 v[204:207], v25 offset:8192
    v_mfma_f32_16x16x32_bf16 a[20:23], a[248:251], v[140:143], a[20:23]
    s_add_u32 s30, s30, 24576
    buffer_load_dwordx4 v[216:219], v26, s[12:15], 0 offen offset:128
    v_mfma_f32_16x16x32_bf16 a[20:23], a[252:255], v[124:127], a[20:23]
    s_add_u32 s32, s32, 24576
    ds_read_b64_tr_b16 a[240:241], v7 offset:25600
    v_accvgpr_read_b32 v68, a4
    v_mfma_f32_16x16x32_bf16 a[68:71], a[248:251], v[144:147], a[68:71]
    ds_read_b64_tr_b16 a[242:243], v7 offset:31744
    v_mul_f32 v68, v68, v40
    v_mfma_f32_16x16x32_bf16 a[68:71], a[252:255], v[128:131], a[68:71]
    ds_read_b64_tr_b16 a[244:245], v7 offset:37888
    v_accvgpr_read_b32 v69, a5
    v_mfma_f32_16x16x32_bf16 a[116:119], a[248:251], v[148:151], a[116:119]
    s_add_u32 m0, s33, 0
    ds_read_b64_tr_b16 a[246:247], v7 offset:44032
    v_mul_f32 v69, v69, v40
    v_mfma_f32_16x16x32_bf16 a[116:119], a[252:255], v[132:135], a[116:119]
    buffer_load_dwordx4 v8, s[16:19], s29 offen nt lds
    v_mfma_f32_16x16x32_bf16 a[164:167], a[252:255], v[136:139], a[164:167]
    s_waitcnt lgkmcnt(4)
    ds_read_b64_tr_b16 a[248:249], v4 offset:26624
    v_cvt_pk_bf16_f32 v98, v68, v69
    v_mfma_f32_16x16x32_bf16 a[24:27], v[152:155], v[140:143], a[24:27]
    ds_read_b64_tr_b16 a[250:251], v4 offset:32768
    v_accvgpr_read_b32 v70, a6
    v_mfma_f32_16x16x32_bf16 a[24:27], v[156:159], v[124:127], a[24:27]
    ds_read_b64_tr_b16 a[252:253], v4 offset:38912
    v_mul_f32 v70, v70, v40
    v_mfma_f32_16x16x32_bf16 a[72:75], v[152:155], v[144:147], a[72:75]
    ds_read_b64_tr_b16 a[254:255], v4 offset:45056
    v_accvgpr_read_b32 v71, a7
    v_mfma_f32_16x16x32_bf16 a[72:75], v[156:159], v[128:131], a[72:75]
    ds_write_b128 v36, a[144:147]
    v_mfma_f32_16x16x32_bf16 a[120:123], v[152:155], v[148:151], a[120:123]
    ds_read_b64_tr_b16 v[152:153], v5 offset:26624
    v_mul_f32 v71, v71, v40
    v_mfma_f32_16x16x32_bf16 a[120:123], v[156:159], v[132:135], a[120:123]
    ds_read_b64_tr_b16 v[154:155], v5 offset:32768
    v_cvt_pk_bf16_f32 v99, v70, v71
    v_mfma_f32_16x16x32_bf16 a[168:171], v[156:159], v[136:139], a[168:171]
    s_waitcnt lgkmcnt(6)
    buffer_load_dwordx4 v[220:223], v26, s[12:15], 0 offen offset:192
    v_mfma_f32_16x16x32_bf16 a[28:31], a[240:243], v[140:143], a[28:31]
    s_add_u32 m0, s33, 896
    ds_read_b64_tr_b16 v[156:157], v5 offset:38912
    v_accvgpr_read_b32 v72, a8
    v_mfma_f32_16x16x32_bf16 a[28:31], a[244:247], v[124:127], a[28:31]
    buffer_load_dwordx4 v8, s[16:19], s29 offen offset:128 nt lds
    v_mfma_f32_16x16x32_bf16 a[76:79], a[240:243], v[144:147], a[76:79]
    ds_read_b64_tr_b16 v[158:159], v5 offset:45056
    v_mul_f32 v72, v72, v40
    v_mfma_f32_16x16x32_bf16 a[76:79], a[244:247], v[128:131], a[76:79]
    ds_write_b128 v36, a[148:151] offset:1024
    v_mfma_f32_16x16x32_bf16 a[124:127], a[240:243], v[148:151], a[124:127]
    ds_read_b64_tr_b16 a[240:241], v6 offset:26624
    v_accvgpr_read_b32 v73, a9
    v_mfma_f32_16x16x32_bf16 a[124:127], a[244:247], v[132:135], a[124:127]
    ds_read_b64_tr_b16 a[242:243], v6 offset:32768
    v_mul_f32 v73, v73, v40
    v_mfma_f32_16x16x32_bf16 a[172:175], a[244:247], v[136:139], a[172:175]
    s_waitcnt lgkmcnt(5)
    ds_read_b64_tr_b16 a[244:245], v6 offset:38912
    v_cvt_pk_bf16_f32 v100, v72, v73
    v_mfma_f32_16x16x32_bf16 a[32:35], a[248:251], v[140:143], a[32:35]
    ds_write_b128 v36, a[152:155] offset:2048
    v_mfma_f32_16x16x32_bf16 a[32:35], a[252:255], v[124:127], a[32:35]
    ds_read_b64_tr_b16 a[246:247], v6 offset:45056
    v_accvgpr_read_b32 v74, a10
    v_mfma_f32_16x16x32_bf16 a[80:83], a[248:251], v[144:147], a[80:83]
    v_permlane32_swap_b32 v13, v33
    v_mfma_f32_16x16x32_bf16 a[80:83], a[252:255], v[128:131], a[80:83]
    s_add_u32 m0, s33, 1792
    v_add_f32 v13, v13, v33
    v_mov_b32 v33, v13
    v_mfma_f32_16x16x32_bf16 a[128:131], a[248:251], v[148:151], a[128:131]
    buffer_load_dwordx4 v8, s[16:19], s29 offen offset:256 nt lds
    v_mfma_f32_16x16x32_bf16 a[128:131], a[252:255], v[132:135], a[128:131]
    s_add_u32 s29, s29, 12288
    ds_write_b128 v36, a[156:159] offset:3072
    v_mfma_f32_16x16x32_bf16 a[176:179], a[252:255], v[136:139], a[176:179]
    buffer_load_dwordx4 v[224:227], v26, s[12:15], 0 offen offset:256
    v_mfma_f32_16x16x32_bf16 a[36:39], v[152:155], v[140:143], a[36:39]
    s_waitcnt lgkmcnt(2)
    ds_read_b64_tr_b16 a[248:249], v7 offset:26624
    v_mul_f32 v74, v74, v40
    v_mfma_f32_16x16x32_bf16 a[36:39], v[156:159], v[124:127], a[36:39]
    ds_read_b64_tr_b16 a[250:251], v7 offset:32768
    v_accvgpr_read_b32 v75, a11
    v_mfma_f32_16x16x32_bf16 a[84:87], v[152:155], v[144:147], a[84:87]
    ds_read_b64_tr_b16 a[252:253], v7 offset:38912
    v_mul_f32 v75, v75, v40
    v_mfma_f32_16x16x32_bf16 a[84:87], v[156:159], v[128:131], a[84:87]
    ds_read_b64_tr_b16 a[254:255], v7 offset:45056
    v_cvt_pk_bf16_f32 v101, v74, v75
    v_mfma_f32_16x16x32_bf16 a[132:135], v[152:155], v[148:151], a[132:135]
    ds_write_b128 v36, a[160:163] offset:4096
    v_mfma_f32_16x16x32_bf16 a[132:135], v[156:159], v[132:135], a[132:135]
    v_permlane16_swap_b32 v13, v33
    v_mfma_f32_16x16x32_bf16 a[180:183], v[156:159], v[136:139], a[180:183]
    v_add_f32 v13, v13, v33
    v_accvgpr_read_b32 v76, a12
    v_mfma_f32_16x16x32_bf16 a[40:43], a[240:243], v[140:143], a[40:43]
    s_waitcnt lgkmcnt(4)
    v_rcp_f32 v42, v13
    v_mfma_f32_16x16x32_bf16 a[40:43], a[244:247], v[124:127], a[40:43]
    ds_write_b128 v36, a[164:167] offset:5120
    v_mfma_f32_16x16x32_bf16 a[88:91], a[240:243], v[144:147], a[88:91]
    v_permlane32_swap_b32 v14, v34
    v_mfma_f32_16x16x32_bf16 a[88:91], a[244:247], v[128:131], a[88:91]
    v_add_f32 v14, v14, v34
    v_mov_b32 v34, v14
    v_mfma_f32_16x16x32_bf16 a[136:139], a[240:243], v[148:151], a[136:139]
    v_mul_f32 v76, v76, v40
    v_accvgpr_read_b32 v77, a13
    v_mfma_f32_16x16x32_bf16 a[136:139], a[244:247], v[132:135], a[136:139]
    v_permlane16_swap_b32 v14, v34
    v_mfma_f32_16x16x32_bf16 a[184:187], a[244:247], v[136:139], a[184:187]
    s_waitcnt lgkmcnt(1)
    buffer_load_dwordx4 v[228:231], v26, s[12:15], 0 offen offset:320
    v_mfma_f32_16x16x32_bf16 a[44:47], a[248:251], v[140:143], a[44:47]
    v_add_f32 v14, v14, v34
    v_mul_f32 v77, v77, v40
    v_mfma_f32_16x16x32_bf16 a[44:47], a[252:255], v[124:127], a[44:47]
    v_rcp_f32 v44, v14
    v_mfma_f32_16x16x32_bf16 a[92:95], a[248:251], v[144:147], a[92:95]
    ds_write_b64 v41, v[38:39] offset:6144
    v_mfma_f32_16x16x32_bf16 a[92:95], a[252:255], v[128:131], a[92:95]
    v_cvt_pk_bf16_f32 v102, v76, v77
    v_accvgpr_read_b32 v78, a14
    v_mfma_f32_16x16x32_bf16 a[140:143], a[248:251], v[148:151], a[140:143]
    v_mul_f32 v78, v78, v40
    v_accvgpr_read_b32 v79, a15
    v_mfma_f32_16x16x32_bf16 a[140:143], a[252:255], v[132:135], a[140:143]
    v_mul_f32 v79, v79, v40
    v_cvt_pk_bf16_f32 v103, v78, v79
    v_mfma_f32_16x16x32_bf16 a[188:191], a[252:255], v[136:139], a[188:191]
    ds_write2_b64 v28, v[96:97], v[98:99] offset0:0 offset1:4
    ds_write2_b64 v28, v[100:101], v[102:103] offset0:8 offset1:12
    ds_read_b128 v[104:107], v30 offset:6400
    ds_read_b128 v[108:111], v30 offset:9600
    s_waitcnt vmcnt(18) lgkmcnt(0)
    s_barrier
    ds_read_b64 v[38:39], v43 offset:6144
    ds_read_b128 v[128:131], v37
    ds_read_b128 v[132:135], v37 offset:1024
    ds_read_b128 v[136:139], v37 offset:2048
    ds_read_b128 v[140:143], v37 offset:3072
    ds_read_b128 v[144:147], v37 offset:4096
    ds_read_b128 v[148:151], v37 offset:5120
    s_add_u32 m0, s33, 73728
    s_nop 0
    buffer_load_dwordx4 v9, s[20:23], s30 offen nt lds
    s_add_u32 m0, s33, 74624
    s_nop 0
    buffer_load_dwordx4 v9, s[20:23], s30 offen offset:128 nt lds
    s_add_u32 m0, s33, 75520
    s_nop 0
    buffer_load_dwordx4 v9, s[20:23], s30 offen offset:256 nt lds
    s_add_u32 m0, s33, 86016
    s_nop 0
    buffer_load_dwordx4 v9, s[20:23], s32 offen nt lds
    s_add_u32 m0, s33, 86912
    s_nop 0
    buffer_load_dwordx4 v9, s[20:23], s32 offen offset:128 nt lds
    s_add_u32 m0, s33, 87808
    s_nop 0
    buffer_load_dwordx4 v9, s[20:23], s32 offen offset:256 nt lds
    s_add_u32 s30, s30, 24576
    s_add_u32 s32, s32, 24576
    v_accvgpr_read_b32 v80, a16
    v_accvgpr_read_b32 v81, a17
    v_accvgpr_read_b32 v82, a18
    v_accvgpr_read_b32 v83, a19
    v_accvgpr_read_b32 v84, a20
    v_accvgpr_read_b32 v85, a21
    v_accvgpr_read_b32 v86, a22
    v_accvgpr_read_b32 v87, a23
    buffer_load_dwordx4 v[232:235], v27, s[12:15], 0 offen
    v_pk_mul_f32 v[80:81], v[80:81], v[40:41] op_sel_hi:[1,0]
    v_pk_mul_f32 v[82:83], v[82:83], v[40:41] op_sel_hi:[1,0]
    v_pk_mul_f32 v[84:85], v[84:85], v[40:41] op_sel_hi:[1,0]
    v_pk_mul_f32 v[86:87], v[86:87], v[40:41] op_sel_hi:[1,0]
    v_cvt_pk_bf16_f32 v96, v80, v81
    v_cvt_pk_bf16_f32 v97, v82, v83
    v_cvt_pk_bf16_f32 v98, v84, v85
    v_cvt_pk_bf16_f32 v99, v86, v87
    v_accvgpr_read_b32 v88, a24
    v_accvgpr_read_b32 v89, a25
    v_accvgpr_read_b32 v90, a26
    v_accvgpr_read_b32 v91, a27
    v_accvgpr_read_b32 v92, a28
    v_accvgpr_read_b32 v93, a29
    v_accvgpr_read_b32 v94, a30
    v_accvgpr_read_b32 v95, a31
    ds_write2_b64 v28, v[96:97], v[98:99] offset0:16 offset1:20
    buffer_load_dwordx4 v[236:239], v27, s[12:15], 0 offen offset:64
    v_pk_mul_f32 v[88:89], v[88:89], v[40:41] op_sel_hi:[1,0]
    v_pk_mul_f32 v[90:91], v[90:91], v[40:41] op_sel_hi:[1,0]
    v_pk_mul_f32 v[92:93], v[92:93], v[40:41] op_sel_hi:[1,0]
    v_pk_mul_f32 v[94:95], v[94:95], v[40:41] op_sel_hi:[1,0]
    v_cvt_pk_bf16_f32 v100, v88, v89
    v_cvt_pk_bf16_f32 v101, v90, v91
    v_cvt_pk_bf16_f32 v102, v92, v93
    v_cvt_pk_bf16_f32 v103, v94, v95
    v_accvgpr_read_b32 v64, a32
    v_accvgpr_read_b32 v65, a33
    v_accvgpr_read_b32 v66, a34
    v_accvgpr_read_b32 v67, a35
    v_accvgpr_read_b32 v68, a36
    v_accvgpr_read_b32 v69, a37
    v_accvgpr_read_b32 v70, a38
    v_accvgpr_read_b32 v71, a39
    ds_write2_b64 v28, v[100:101], v[102:103] offset0:24 offset1:28
    ds_read_b128 v[112:115], v30 offset:6528
    ds_read_b128 v[116:119], v30 offset:9728
    buffer_load_dwordx4 v[240:243], v27, s[12:15], 0 offen offset:128
    v_pk_mul_f32 v[64:65], v[64:65], v[40:41] op_sel_hi:[1,0]
    v_pk_mul_f32 v[66:67], v[66:67], v[40:41] op_sel_hi:[1,0]
    v_pk_mul_f32 v[68:69], v[68:69], v[40:41] op_sel_hi:[1,0]
    v_pk_mul_f32 v[70:71], v[70:71], v[40:41] op_sel_hi:[1,0]
    v_cvt_pk_bf16_f32 v96, v64, v65
    v_cvt_pk_bf16_f32 v97, v66, v67
    v_cvt_pk_bf16_f32 v98, v68, v69
    v_cvt_pk_bf16_f32 v99, v70, v71
    v_accvgpr_read_b32 v72, a40
    v_accvgpr_read_b32 v73, a41
    v_accvgpr_read_b32 v74, a42
    v_accvgpr_read_b32 v75, a43
    v_accvgpr_read_b32 v76, a44
    v_accvgpr_read_b32 v77, a45
    v_accvgpr_read_b32 v78, a46
    v_accvgpr_read_b32 v79, a47
    ds_write2_b64 v28, v[96:97], v[98:99] offset0:32 offset1:36
    buffer_load_dwordx4 v[244:247], v27, s[12:15], 0 offen offset:192
    v_pk_mul_f32 v[72:73], v[72:73], v[40:41] op_sel_hi:[1,0]
    v_pk_mul_f32 v[74:75], v[74:75], v[40:41] op_sel_hi:[1,0]
    v_pk_mul_f32 v[76:77], v[76:77], v[40:41] op_sel_hi:[1,0]
    v_pk_mul_f32 v[78:79], v[78:79], v[40:41] op_sel_hi:[1,0]
    v_cvt_pk_bf16_f32 v100, v72, v73
    v_cvt_pk_bf16_f32 v101, v74, v75
    v_cvt_pk_bf16_f32 v102, v76, v77
    v_cvt_pk_bf16_f32 v103, v78, v79
    v_accvgpr_read_b32 v80, a48
    v_accvgpr_read_b32 v81, a49
    v_accvgpr_read_b32 v82, a50
    v_accvgpr_read_b32 v83, a51
    v_accvgpr_read_b32 v84, a52
    v_accvgpr_read_b32 v85, a53
    v_accvgpr_read_b32 v86, a54
    v_accvgpr_read_b32 v87, a55
    ds_write2_b64 v28, v[100:101], v[102:103] offset0:40 offset1:44
    ds_read_b128 v[120:123], v30 offset:6656
    ds_read_b128 v[124:127], v30 offset:9856
    v_add_u32 v28, -6400, v28
    buffer_load_dwordx4 v[248:251], v27, s[12:15], 0 offen offset:256
    v_pk_mul_f32 v[80:81], v[80:81], v[42:43] op_sel_hi:[1,0]
    v_pk_mul_f32 v[82:83], v[82:83], v[42:43] op_sel_hi:[1,0]
    v_pk_mul_f32 v[84:85], v[84:85], v[42:43] op_sel_hi:[1,0]
    v_pk_mul_f32 v[86:87], v[86:87], v[42:43] op_sel_hi:[1,0]
    v_cvt_pk_bf16_f32 v96, v80, v81
    v_cvt_pk_bf16_f32 v97, v82, v83
    v_cvt_pk_bf16_f32 v98, v84, v85
    v_cvt_pk_bf16_f32 v99, v86, v87
    s_waitcnt lgkmcnt(0)
    s_barrier
    v_accvgpr_read_b32 v88, a56
    v_accvgpr_read_b32 v89, a57
    v_accvgpr_read_b32 v90, a58
    v_accvgpr_read_b32 v91, a59
    v_accvgpr_read_b32 v92, a60
    v_accvgpr_read_b32 v93, a61
    v_accvgpr_read_b32 v94, a62
    v_accvgpr_read_b32 v95, a63
    ds_write2_b64 v28, v[96:97], v[98:99] offset0:0 offset1:4
    buffer_load_dwordx4 v[252:255], v27, s[12:15], 0 offen offset:320
    v_pk_mul_f32 v[88:89], v[88:89], v[42:43] op_sel_hi:[1,0]
    v_pk_mul_f32 v[90:91], v[90:91], v[42:43] op_sel_hi:[1,0]
    v_pk_mul_f32 v[92:93], v[92:93], v[42:43] op_sel_hi:[1,0]
    v_pk_mul_f32 v[94:95], v[94:95], v[42:43] op_sel_hi:[1,0]
    v_cvt_pk_bf16_f32 v100, v88, v89
    v_cvt_pk_bf16_f32 v101, v90, v91
    v_cvt_pk_bf16_f32 v102, v92, v93
    v_cvt_pk_bf16_f32 v103, v94, v95
    v_accvgpr_read_b32 v64, a64
    v_accvgpr_read_b32 v65, a65
    v_accvgpr_read_b32 v66, a66
    v_accvgpr_read_b32 v67, a67
    v_accvgpr_read_b32 v68, a68
    v_accvgpr_read_b32 v69, a69
    v_accvgpr_read_b32 v70, a70
    v_accvgpr_read_b32 v71, a71
    ds_write2_b64 v28, v[100:101], v[102:103] offset0:8 offset1:12
    v_pk_mul_f32 v[64:65], v[64:65], v[42:43] op_sel_hi:[1,0]
    v_pk_mul_f32 v[66:67], v[66:67], v[42:43] op_sel_hi:[1,0]
    v_pk_mul_f32 v[68:69], v[68:69], v[42:43] op_sel_hi:[1,0]
    v_pk_mul_f32 v[70:71], v[70:71], v[42:43] op_sel_hi:[1,0]
    v_cvt_pk_bf16_f32 v96, v64, v65
    v_cvt_pk_bf16_f32 v97, v66, v67
    v_cvt_pk_bf16_f32 v98, v68, v69
    v_cvt_pk_bf16_f32 v99, v70, v71
    s_waitcnt vmcnt(23)
    v_lshlrev_b32 v152, 16, v208
    v_and_b32 v153, 0xffff0000, v208
    v_lshlrev_b32 v154, 16, v209
    v_and_b32 v155, 0xffff0000, v209
    v_lshlrev_b32 v156, 16, v210
    v_and_b32 v157, 0xffff0000, v210
    v_lshlrev_b32 v158, 16, v211
    v_and_b32 v159, 0xffff0000, v211
    v_pk_mul_f32 v[152:153], v[152:153], s[42:43]
    v_pk_mul_f32 v[154:155], v[154:155], s[42:43]
    v_pk_mul_f32 v[156:157], v[156:157], s[42:43]
    v_pk_mul_f32 v[158:159], v[158:159], s[42:43]
    v_cvt_pk_bf16_f32 v208, v152, v153
    v_cvt_pk_bf16_f32 v209, v154, v155
    v_cvt_pk_bf16_f32 v210, v156, v157
    v_cvt_pk_bf16_f32 v211, v158, v159
    v_accvgpr_read_b32 v72, a72
    v_accvgpr_read_b32 v73, a73
    v_accvgpr_read_b32 v74, a74
    v_accvgpr_read_b32 v75, a75
    v_accvgpr_read_b32 v76, a76
    v_accvgpr_read_b32 v77, a77
    v_accvgpr_read_b32 v78, a78
    v_accvgpr_read_b32 v79, a79
    ds_write2_b64 v28, v[96:97], v[98:99] offset0:16 offset1:20
    buffer_store_dwordx4 v[104:107], v31, s[24:27], 0 offen
    v_pk_mul_f32 v[72:73], v[72:73], v[42:43] op_sel_hi:[1,0]
    v_pk_mul_f32 v[74:75], v[74:75], v[42:43] op_sel_hi:[1,0]
    v_pk_mul_f32 v[76:77], v[76:77], v[42:43] op_sel_hi:[1,0]
    v_pk_mul_f32 v[78:79], v[78:79], v[42:43] op_sel_hi:[1,0]
    v_cvt_pk_bf16_f32 v100, v72, v73
    v_cvt_pk_bf16_f32 v101, v74, v75
    v_cvt_pk_bf16_f32 v102, v76, v77
    v_cvt_pk_bf16_f32 v103, v78, v79
    s_waitcnt vmcnt(22)
    v_lshlrev_b32 v152, 16, v212
    v_and_b32 v153, 0xffff0000, v212
    v_lshlrev_b32 v154, 16, v213
    v_and_b32 v155, 0xffff0000, v213
    v_lshlrev_b32 v156, 16, v214
    v_and_b32 v157, 0xffff0000, v214
    v_lshlrev_b32 v158, 16, v215
    v_and_b32 v159, 0xffff0000, v215
    v_pk_mul_f32 v[152:153], v[152:153], s[42:43]
    v_pk_mul_f32 v[154:155], v[154:155], s[42:43]
    v_pk_mul_f32 v[156:157], v[156:157], s[42:43]
    v_pk_mul_f32 v[158:159], v[158:159], s[42:43]
    v_cvt_pk_bf16_f32 v212, v152, v153
    v_cvt_pk_bf16_f32 v213, v154, v155
    v_cvt_pk_bf16_f32 v214, v156, v157
    v_cvt_pk_bf16_f32 v215, v158, v159
    v_accvgpr_read_b32 v80, a80
    v_accvgpr_read_b32 v81, a81
    v_accvgpr_read_b32 v82, a82
    v_accvgpr_read_b32 v83, a83
    v_accvgpr_read_b32 v84, a84
    v_accvgpr_read_b32 v85, a85
    v_accvgpr_read_b32 v86, a86
    v_accvgpr_read_b32 v87, a87
    ds_write2_b64 v28, v[100:101], v[102:103] offset0:24 offset1:28
    buffer_store_dwordx4 v[108:111], v31, s[24:27], 0 offen offset:3072
    v_pk_mul_f32 v[80:81], v[80:81], v[42:43] op_sel_hi:[1,0]
    v_pk_mul_f32 v[82:83], v[82:83], v[42:43] op_sel_hi:[1,0]
    v_pk_mul_f32 v[84:85], v[84:85], v[42:43] op_sel_hi:[1,0]
    v_pk_mul_f32 v[86:87], v[86:87], v[42:43] op_sel_hi:[1,0]
    v_cvt_pk_bf16_f32 v96, v80, v81
    v_cvt_pk_bf16_f32 v97, v82, v83
    v_cvt_pk_bf16_f32 v98, v84, v85
    v_cvt_pk_bf16_f32 v99, v86, v87
    s_waitcnt vmcnt(20)
    v_lshlrev_b32 v152, 16, v216
    v_and_b32 v153, 0xffff0000, v216
    v_lshlrev_b32 v154, 16, v217
    v_and_b32 v155, 0xffff0000, v217
    v_lshlrev_b32 v156, 16, v218
    v_and_b32 v157, 0xffff0000, v218
    v_lshlrev_b32 v158, 16, v219
    v_and_b32 v159, 0xffff0000, v219
    v_pk_mul_f32 v[152:153], v[152:153], s[42:43]
    v_pk_mul_f32 v[154:155], v[154:155], s[42:43]
    v_pk_mul_f32 v[156:157], v[156:157], s[42:43]
    v_pk_mul_f32 v[158:159], v[158:159], s[42:43]
    v_cvt_pk_bf16_f32 v216, v152, v153
    v_cvt_pk_bf16_f32 v217, v154, v155
    v_cvt_pk_bf16_f32 v218, v156, v157
    v_cvt_pk_bf16_f32 v219, v158, v159
    v_accvgpr_read_b32 v88, a88
    v_accvgpr_read_b32 v89, a89
    v_accvgpr_read_b32 v90, a90
    v_accvgpr_read_b32 v91, a91
    v_accvgpr_read_b32 v92, a92
    v_accvgpr_read_b32 v93, a93
    v_accvgpr_read_b32 v94, a94
    v_accvgpr_read_b32 v95, a95
    ds_write2_b64 v28, v[96:97], v[98:99] offset0:32 offset1:36
    buffer_store_dwordx4 v[112:115], v31, s[24:27], 0 offen offset:128
    v_pk_mul_f32 v[88:89], v[88:89], v[42:43] op_sel_hi:[1,0]
    v_pk_mul_f32 v[90:91], v[90:91], v[42:43] op_sel_hi:[1,0]
    v_pk_mul_f32 v[92:93], v[92:93], v[42:43] op_sel_hi:[1,0]
    v_pk_mul_f32 v[94:95], v[94:95], v[42:43] op_sel_hi:[1,0]
    v_cvt_pk_bf16_f32 v100, v88, v89
    v_cvt_pk_bf16_f32 v101, v90, v91
    v_cvt_pk_bf16_f32 v102, v92, v93
    v_cvt_pk_bf16_f32 v103, v94, v95
    s_waitcnt vmcnt(19)
    v_lshlrev_b32 v152, 16, v220
    v_and_b32 v153, 0xffff0000, v220
    v_lshlrev_b32 v154, 16, v221
    v_and_b32 v155, 0xffff0000, v221
    v_lshlrev_b32 v156, 16, v222
    v_and_b32 v157, 0xffff0000, v222
    v_lshlrev_b32 v158, 16, v223
    v_and_b32 v159, 0xffff0000, v223
    v_pk_mul_f32 v[152:153], v[152:153], s[42:43]
    v_pk_mul_f32 v[154:155], v[154:155], s[42:43]
    v_pk_mul_f32 v[156:157], v[156:157], s[42:43]
    v_pk_mul_f32 v[158:159], v[158:159], s[42:43]
    v_cvt_pk_bf16_f32 v220, v152, v153
    v_cvt_pk_bf16_f32 v221, v154, v155
    v_cvt_pk_bf16_f32 v222, v156, v157
    v_cvt_pk_bf16_f32 v223, v158, v159
    v_accvgpr_read_b32 v64, a96
    v_accvgpr_read_b32 v65, a97
    v_accvgpr_read_b32 v66, a98
    v_accvgpr_read_b32 v67, a99
    v_accvgpr_read_b32 v68, a100
    v_accvgpr_read_b32 v69, a101
    v_accvgpr_read_b32 v70, a102
    v_accvgpr_read_b32 v71, a103
    ds_write2_b64 v28, v[100:101], v[102:103] offset0:40 offset1:44
    v_add_u32 v28, 6400, v28
    buffer_store_dwordx4 v[116:119], v31, s[24:27], 0 offen offset:3200
    v_pk_mul_f32 v[64:65], v[64:65], v[44:45] op_sel_hi:[1,0]
    v_pk_mul_f32 v[66:67], v[66:67], v[44:45] op_sel_hi:[1,0]
    v_pk_mul_f32 v[68:69], v[68:69], v[44:45] op_sel_hi:[1,0]
    v_pk_mul_f32 v[70:71], v[70:71], v[44:45] op_sel_hi:[1,0]
    v_cvt_pk_bf16_f32 v96, v64, v65
    v_cvt_pk_bf16_f32 v97, v66, v67
    v_cvt_pk_bf16_f32 v98, v68, v69
    v_cvt_pk_bf16_f32 v99, v70, v71
    s_waitcnt vmcnt(17)
    v_lshlrev_b32 v152, 16, v224
    v_and_b32 v153, 0xffff0000, v224
    v_lshlrev_b32 v154, 16, v225
    v_and_b32 v155, 0xffff0000, v225
    v_lshlrev_b32 v156, 16, v226
    v_and_b32 v157, 0xffff0000, v226
    v_lshlrev_b32 v158, 16, v227
    v_and_b32 v159, 0xffff0000, v227
    v_pk_mul_f32 v[152:153], v[152:153], s[42:43]
    v_pk_mul_f32 v[154:155], v[154:155], s[42:43]
    v_pk_mul_f32 v[156:157], v[156:157], s[42:43]
    v_pk_mul_f32 v[158:159], v[158:159], s[42:43]
    v_cvt_pk_bf16_f32 v224, v152, v153
    v_cvt_pk_bf16_f32 v225, v154, v155
    v_cvt_pk_bf16_f32 v226, v156, v157
    v_cvt_pk_bf16_f32 v227, v158, v159
    v_accvgpr_read_b32 v72, a104
    v_accvgpr_read_b32 v73, a105
    v_accvgpr_read_b32 v74, a106
    v_accvgpr_read_b32 v75, a107
    v_accvgpr_read_b32 v76, a108
    v_accvgpr_read_b32 v77, a109
    v_accvgpr_read_b32 v78, a110
    v_accvgpr_read_b32 v79, a111
    ds_write2_b64 v28, v[96:97], v[98:99] offset0:0 offset1:4
    buffer_store_dwordx4 v[120:123], v31, s[24:27], 0 offen offset:256
    v_pk_mul_f32 v[72:73], v[72:73], v[44:45] op_sel_hi:[1,0]
    v_pk_mul_f32 v[74:75], v[74:75], v[44:45] op_sel_hi:[1,0]
    v_pk_mul_f32 v[76:77], v[76:77], v[44:45] op_sel_hi:[1,0]
    v_pk_mul_f32 v[78:79], v[78:79], v[44:45] op_sel_hi:[1,0]
    v_cvt_pk_bf16_f32 v100, v72, v73
    v_cvt_pk_bf16_f32 v101, v74, v75
    v_cvt_pk_bf16_f32 v102, v76, v77
    v_cvt_pk_bf16_f32 v103, v78, v79
    s_waitcnt vmcnt(17)
    v_lshlrev_b32 v152, 16, v228
    v_and_b32 v153, 0xffff0000, v228
    v_lshlrev_b32 v154, 16, v229
    v_and_b32 v155, 0xffff0000, v229
    v_lshlrev_b32 v156, 16, v230
    v_and_b32 v157, 0xffff0000, v230
    v_lshlrev_b32 v158, 16, v231
    v_and_b32 v159, 0xffff0000, v231
    v_pk_mul_f32 v[152:153], v[152:153], s[42:43]
    v_pk_mul_f32 v[154:155], v[154:155], s[42:43]
    v_pk_mul_f32 v[156:157], v[156:157], s[42:43]
    v_pk_mul_f32 v[158:159], v[158:159], s[42:43]
    v_cvt_pk_bf16_f32 v228, v152, v153
    v_cvt_pk_bf16_f32 v229, v154, v155
    v_cvt_pk_bf16_f32 v230, v156, v157
    v_cvt_pk_bf16_f32 v231, v158, v159
    v_accvgpr_read_b32 v80, a112
    v_accvgpr_read_b32 v81, a113
    v_accvgpr_read_b32 v82, a114
    v_accvgpr_read_b32 v83, a115
    v_accvgpr_read_b32 v84, a116
    v_accvgpr_read_b32 v85, a117
    v_accvgpr_read_b32 v86, a118
    v_accvgpr_read_b32 v87, a119
    ds_write2_b64 v28, v[100:101], v[102:103] offset0:8 offset1:12
    buffer_store_dwordx4 v[124:127], v31, s[24:27], 0 offen offset:3328
    v_pk_mul_f32 v[80:81], v[80:81], v[44:45] op_sel_hi:[1,0]
    v_pk_mul_f32 v[82:83], v[82:83], v[44:45] op_sel_hi:[1,0]
    v_pk_mul_f32 v[84:85], v[84:85], v[44:45] op_sel_hi:[1,0]
    v_pk_mul_f32 v[86:87], v[86:87], v[44:45] op_sel_hi:[1,0]
    v_cvt_pk_bf16_f32 v96, v80, v81
    v_cvt_pk_bf16_f32 v97, v82, v83
    v_cvt_pk_bf16_f32 v98, v84, v85
    v_cvt_pk_bf16_f32 v99, v86, v87
    s_waitcnt vmcnt(11)
    v_lshlrev_b32 v152, 16, v232
    v_and_b32 v153, 0xffff0000, v232
    v_lshlrev_b32 v154, 16, v233
    v_and_b32 v155, 0xffff0000, v233
    v_lshlrev_b32 v156, 16, v234
    v_and_b32 v157, 0xffff0000, v234
    v_lshlrev_b32 v158, 16, v235
    v_and_b32 v159, 0xffff0000, v235
    v_pk_mul_f32 v[152:153], v[152:153], s[42:43]
    v_pk_mul_f32 v[154:155], v[154:155], s[42:43]
    v_pk_mul_f32 v[156:157], v[156:157], s[42:43]
    v_pk_mul_f32 v[158:159], v[158:159], s[42:43]
    v_cvt_pk_bf16_f32 v232, v152, v153
    v_cvt_pk_bf16_f32 v233, v154, v155
    v_cvt_pk_bf16_f32 v234, v156, v157
    v_cvt_pk_bf16_f32 v235, v158, v159
    v_accvgpr_read_b32 v88, a120
    v_accvgpr_read_b32 v89, a121
    v_accvgpr_read_b32 v90, a122
    v_accvgpr_read_b32 v91, a123
    v_accvgpr_read_b32 v92, a124
    v_accvgpr_read_b32 v93, a125
    v_accvgpr_read_b32 v94, a126
    v_accvgpr_read_b32 v95, a127
    ds_write2_b64 v28, v[96:97], v[98:99] offset0:16 offset1:20
    v_pk_mul_f32 v[88:89], v[88:89], v[44:45] op_sel_hi:[1,0]
    v_pk_mul_f32 v[90:91], v[90:91], v[44:45] op_sel_hi:[1,0]
    v_pk_mul_f32 v[92:93], v[92:93], v[44:45] op_sel_hi:[1,0]
    v_pk_mul_f32 v[94:95], v[94:95], v[44:45] op_sel_hi:[1,0]
    v_cvt_pk_bf16_f32 v100, v88, v89
    v_cvt_pk_bf16_f32 v101, v90, v91
    v_cvt_pk_bf16_f32 v102, v92, v93
    v_cvt_pk_bf16_f32 v103, v94, v95
    s_waitcnt vmcnt(10)
    v_lshlrev_b32 v152, 16, v236
    v_and_b32 v153, 0xffff0000, v236
    v_lshlrev_b32 v154, 16, v237
    v_and_b32 v155, 0xffff0000, v237
    v_lshlrev_b32 v156, 16, v238
    v_and_b32 v157, 0xffff0000, v238
    v_lshlrev_b32 v158, 16, v239
    v_and_b32 v159, 0xffff0000, v239
    v_pk_mul_f32 v[152:153], v[152:153], s[42:43]
    v_pk_mul_f32 v[154:155], v[154:155], s[42:43]
    v_pk_mul_f32 v[156:157], v[156:157], s[42:43]
    v_pk_mul_f32 v[158:159], v[158:159], s[42:43]
    v_cvt_pk_bf16_f32 v236, v152, v153
    v_cvt_pk_bf16_f32 v237, v154, v155
    v_cvt_pk_bf16_f32 v238, v156, v157
    v_cvt_pk_bf16_f32 v239, v158, v159
    v_accvgpr_read_b32 v64, a128
    v_accvgpr_read_b32 v65, a129
    v_accvgpr_read_b32 v66, a130
    v_accvgpr_read_b32 v67, a131
    v_accvgpr_read_b32 v68, a132
    v_accvgpr_read_b32 v69, a133
    v_accvgpr_read_b32 v70, a134
    v_accvgpr_read_b32 v71, a135
    ds_write2_b64 v28, v[100:101], v[102:103] offset0:24 offset1:28
    v_pk_mul_f32 v[64:65], v[64:65], v[44:45] op_sel_hi:[1,0]
    v_pk_mul_f32 v[66:67], v[66:67], v[44:45] op_sel_hi:[1,0]
    v_pk_mul_f32 v[68:69], v[68:69], v[44:45] op_sel_hi:[1,0]
    v_pk_mul_f32 v[70:71], v[70:71], v[44:45] op_sel_hi:[1,0]
    v_cvt_pk_bf16_f32 v96, v64, v65
    v_cvt_pk_bf16_f32 v97, v66, v67
    v_cvt_pk_bf16_f32 v98, v68, v69
    v_cvt_pk_bf16_f32 v99, v70, v71
    s_waitcnt vmcnt(9)
    v_lshlrev_b32 v152, 16, v240
    v_and_b32 v153, 0xffff0000, v240
    v_lshlrev_b32 v154, 16, v241
    v_and_b32 v155, 0xffff0000, v241
    v_lshlrev_b32 v156, 16, v242
    v_and_b32 v157, 0xffff0000, v242
    v_lshlrev_b32 v158, 16, v243
    v_and_b32 v159, 0xffff0000, v243
    v_pk_mul_f32 v[152:153], v[152:153], s[42:43]
    v_pk_mul_f32 v[154:155], v[154:155], s[42:43]
    v_pk_mul_f32 v[156:157], v[156:157], s[42:43]
    v_pk_mul_f32 v[158:159], v[158:159], s[42:43]
    v_cvt_pk_bf16_f32 v240, v152, v153
    v_cvt_pk_bf16_f32 v241, v154, v155
    v_cvt_pk_bf16_f32 v242, v156, v157
    v_cvt_pk_bf16_f32 v243, v158, v159
    v_accvgpr_read_b32 v72, a136
    v_accvgpr_read_b32 v73, a137
    v_accvgpr_read_b32 v74, a138
    v_accvgpr_read_b32 v75, a139
    v_accvgpr_read_b32 v76, a140
    v_accvgpr_read_b32 v77, a141
    v_accvgpr_read_b32 v78, a142
    v_accvgpr_read_b32 v79, a143
    ds_write2_b64 v28, v[96:97], v[98:99] offset0:32 offset1:36
    v_pk_mul_f32 v[72:73], v[72:73], v[44:45] op_sel_hi:[1,0]
    v_pk_mul_f32 v[74:75], v[74:75], v[44:45] op_sel_hi:[1,0]
    v_pk_mul_f32 v[76:77], v[76:77], v[44:45] op_sel_hi:[1,0]
    v_pk_mul_f32 v[78:79], v[78:79], v[44:45] op_sel_hi:[1,0]
    v_cvt_pk_bf16_f32 v100, v72, v73
    v_cvt_pk_bf16_f32 v101, v74, v75
    v_cvt_pk_bf16_f32 v102, v76, v77
    v_cvt_pk_bf16_f32 v103, v78, v79
    s_waitcnt vmcnt(8)
    v_lshlrev_b32 v152, 16, v244
    v_and_b32 v153, 0xffff0000, v244
    v_lshlrev_b32 v154, 16, v245
    v_and_b32 v155, 0xffff0000, v245
    v_lshlrev_b32 v156, 16, v246
    v_and_b32 v157, 0xffff0000, v246
    v_lshlrev_b32 v158, 16, v247
    v_and_b32 v159, 0xffff0000, v247
    v_pk_mul_f32 v[152:153], v[152:153], s[42:43]
    v_pk_mul_f32 v[154:155], v[154:155], s[42:43]
    v_pk_mul_f32 v[156:157], v[156:157], s[42:43]
    v_pk_mul_f32 v[158:159], v[158:159], s[42:43]
    v_cvt_pk_bf16_f32 v244, v152, v153
    v_cvt_pk_bf16_f32 v245, v154, v155
    v_cvt_pk_bf16_f32 v246, v156, v157
    v_cvt_pk_bf16_f32 v247, v158, v159
    v_min_f32 v33, v60, v38
    v_sub_f32 v32, v33, v60
    v_sub_f32 v34, v33, v38
    v_exp_f32 v32, v32
    v_exp_f32 v34, v34
    v_accvgpr_read_b32 v80, a168
    v_accvgpr_read_b32 v81, a169
    v_accvgpr_read_b32 v82, a170
    v_accvgpr_read_b32 v83, a171
    v_accvgpr_read_b32 v84, a172
    v_accvgpr_read_b32 v85, a173
    v_accvgpr_read_b32 v86, a174
    v_accvgpr_read_b32 v87, a175
    v_mul_f32 v35, v15, v32
    v_fma_f32 v35, v39, v34, v35
    v_rcp_f32 v35, v35
    ds_write2_b64 v28, v[100:101], v[102:103] offset0:40 offset1:44
    v_mul_f32 v32, v32, v35
    v_mul_f32 v34, v34, v35
    v_pk_mul_f32 v[80:81], v[80:81], v[32:33] op_sel_hi:[1,0]
    v_pk_mul_f32 v[82:83], v[82:83], v[32:33] op_sel_hi:[1,0]
    v_pk_mul_f32 v[84:85], v[84:85], v[32:33] op_sel_hi:[1,0]
    v_pk_mul_f32 v[86:87], v[86:87], v[32:33] op_sel_hi:[1,0]
    v_pk_fma_f32 v[80:81], v[128:129], v[34:35], v[80:81] op_sel_hi:[1,0,1]
    v_pk_fma_f32 v[82:83], v[130:131], v[34:35], v[82:83] op_sel_hi:[1,0,1]
    v_pk_fma_f32 v[84:85], v[132:133], v[34:35], v[84:85] op_sel_hi:[1,0,1]
    v_pk_fma_f32 v[86:87], v[134:135], v[34:35], v[86:87] op_sel_hi:[1,0,1]
    v_cvt_pk_bf16_f32 v96, v80, v81
    v_cvt_pk_bf16_f32 v97, v82, v83
    v_cvt_pk_bf16_f32 v98, v84, v85
    v_cvt_pk_bf16_f32 v99, v86, v87
    s_waitcnt vmcnt(7)
    v_lshlrev_b32 v152, 16, v248
    v_and_b32 v153, 0xffff0000, v248
    v_lshlrev_b32 v154, 16, v249
    v_and_b32 v155, 0xffff0000, v249
    v_lshlrev_b32 v156, 16, v250
    v_and_b32 v157, 0xffff0000, v250
    v_lshlrev_b32 v158, 16, v251
    v_and_b32 v159, 0xffff0000, v251
    v_pk_mul_f32 v[152:153], v[152:153], s[42:43]
    v_pk_mul_f32 v[154:155], v[154:155], s[42:43]
    v_pk_mul_f32 v[156:157], v[156:157], s[42:43]
    v_pk_mul_f32 v[158:159], v[158:159], s[42:43]
    v_cvt_pk_bf16_f32 v248, v152, v153
    v_cvt_pk_bf16_f32 v249, v154, v155
    v_cvt_pk_bf16_f32 v250, v156, v157
    v_cvt_pk_bf16_f32 v251, v158, v159
    v_accvgpr_read_b32 v88, a176
    v_accvgpr_read_b32 v89, a177
    v_accvgpr_read_b32 v90, a178
    v_accvgpr_read_b32 v91, a179
    v_accvgpr_read_b32 v92, a180
    v_accvgpr_read_b32 v93, a181
    v_accvgpr_read_b32 v94, a182
    v_accvgpr_read_b32 v95, a183
    v_permlane16_swap_b32 v96, v98
    v_permlane16_swap_b32 v97, v99
    buffer_store_dwordx4 v[96:99], v29, s[24:27], 0 offen offset:192
    v_pk_mul_f32 v[88:89], v[88:89], v[32:33] op_sel_hi:[1,0]
    v_pk_mul_f32 v[90:91], v[90:91], v[32:33] op_sel_hi:[1,0]
    v_pk_mul_f32 v[92:93], v[92:93], v[32:33] op_sel_hi:[1,0]
    v_pk_mul_f32 v[94:95], v[94:95], v[32:33] op_sel_hi:[1,0]
    v_pk_fma_f32 v[88:89], v[136:137], v[34:35], v[88:89] op_sel_hi:[1,0,1]
    v_pk_fma_f32 v[90:91], v[138:139], v[34:35], v[90:91] op_sel_hi:[1,0,1]
    v_pk_fma_f32 v[92:93], v[140:141], v[34:35], v[92:93] op_sel_hi:[1,0,1]
    v_pk_fma_f32 v[94:95], v[142:143], v[34:35], v[94:95] op_sel_hi:[1,0,1]
    v_cvt_pk_bf16_f32 v100, v88, v89
    v_cvt_pk_bf16_f32 v101, v90, v91
    v_cvt_pk_bf16_f32 v102, v92, v93
    v_cvt_pk_bf16_f32 v103, v94, v95
    s_waitcnt vmcnt(7)
    v_lshlrev_b32 v152, 16, v252
    v_and_b32 v153, 0xffff0000, v252
    v_lshlrev_b32 v154, 16, v253
    v_and_b32 v155, 0xffff0000, v253
    v_lshlrev_b32 v156, 16, v254
    v_and_b32 v157, 0xffff0000, v254
    v_lshlrev_b32 v158, 16, v255
    v_and_b32 v159, 0xffff0000, v255
    v_pk_mul_f32 v[152:153], v[152:153], s[42:43]
    v_pk_mul_f32 v[154:155], v[154:155], s[42:43]
    v_pk_mul_f32 v[156:157], v[156:157], s[42:43]
    v_pk_mul_f32 v[158:159], v[158:159], s[42:43]
    v_cvt_pk_bf16_f32 v252, v152, v153
    v_cvt_pk_bf16_f32 v253, v154, v155
    v_cvt_pk_bf16_f32 v254, v156, v157
    v_cvt_pk_bf16_f32 v255, v158, v159
    v_accvgpr_read_b32 v64, a184
    v_accvgpr_read_b32 v65, a185
    v_accvgpr_read_b32 v66, a186
    v_accvgpr_read_b32 v67, a187
    v_accvgpr_read_b32 v68, a188
    v_accvgpr_read_b32 v69, a189
    v_accvgpr_read_b32 v70, a190
    v_accvgpr_read_b32 v71, a191
    v_permlane16_swap_b32 v100, v102
    v_permlane16_swap_b32 v101, v103
    buffer_store_dwordx4 v[100:103], v29, s[24:27], 0 offen offset:256
    v_pk_mul_f32 v[64:65], v[64:65], v[32:33] op_sel_hi:[1,0]
    v_pk_mul_f32 v[66:67], v[66:67], v[32:33] op_sel_hi:[1,0]
    v_pk_mul_f32 v[68:69], v[68:69], v[32:33] op_sel_hi:[1,0]
    v_pk_mul_f32 v[70:71], v[70:71], v[32:33] op_sel_hi:[1,0]
    v_pk_fma_f32 v[64:65], v[144:145], v[34:35], v[64:65] op_sel_hi:[1,0,1]
    v_pk_fma_f32 v[66:67], v[146:147], v[34:35], v[66:67] op_sel_hi:[1,0,1]
    v_pk_fma_f32 v[68:69], v[148:149], v[34:35], v[68:69] op_sel_hi:[1,0,1]
    v_pk_fma_f32 v[70:71], v[150:151], v[34:35], v[70:71] op_sel_hi:[1,0,1]
    v_cvt_pk_bf16_f32 v96, v64, v65
    v_cvt_pk_bf16_f32 v97, v66, v67
    v_cvt_pk_bf16_f32 v98, v68, v69
    v_cvt_pk_bf16_f32 v99, v70, v71
    s_nop 0
    v_permlane16_swap_b32 v96, v98
    v_permlane16_swap_b32 v97, v99
    buffer_store_dwordx4 v[96:99], v29, s[24:27], 0 offen offset:320
    s_mov_b32 s80, s24
    s_mov_b32 s81, s25
    s_mov_b32 s82, 0
    s_add_u32 s84, s37, 6144
    s_add_u32 s48, s90, 256
    v_lshrrev_b32 v47, 3, v1
    v_lshlrev_b32 v47, 4, v47
    v_add3_u32 v47, v47, v23, s48
    s_add_u32 s48, s52, 1
    s_mul_i32 s49, s48, 165888
    s_add_u32 s24, s10, s49
    s_addc_u32 s25, s11, 0
    s_mov_b32 s37, s39
    s_mov_b32 s38, s40
    s_mov_b32 s48, 0x7149f2ca
    s_cmp_ge_u32 s38, 165888
    s_cselect_b32 s86, s48, 0xff800000
    v_mfma_f32_16x16x32_bf16 v[64:67], a[192:195], v[160:163], 0
    v_mfma_f32_16x16x32_bf16 v[64:67], a[196:199], v[164:167], v[64:67]
    v_mfma_f32_16x16x32_bf16 v[64:67], a[200:203], v[168:171], v[64:67]
    v_mfma_f32_16x16x32_bf16 v[64:67], a[204:207], v[172:175], v[64:67]
    v_mfma_f32_16x16x32_bf16 v[64:67], a[208:211], v[176:179], v[64:67]
    v_mfma_f32_16x16x32_bf16 v[64:67], a[212:215], v[180:183], v[64:67]
    v_mfma_f32_16x16x32_bf16 v[68:71], a[216:219], v[160:163], 0
    v_mfma_f32_16x16x32_bf16 v[68:71], a[220:223], v[164:167], v[68:71]
    v_mfma_f32_16x16x32_bf16 v[68:71], a[224:227], v[168:171], v[68:71]
    v_mfma_f32_16x16x32_bf16 v[68:71], a[228:231], v[172:175], v[68:71]
    v_mfma_f32_16x16x32_bf16 v[68:71], a[232:235], v[176:179], v[68:71]
    v_mfma_f32_16x16x32_bf16 v[68:71], a[236:239], v[180:183], v[68:71]
    v_mfma_f32_16x16x32_bf16 v[72:75], a[192:195], v[184:187], 0
    v_mfma_f32_16x16x32_bf16 v[72:75], a[196:199], v[188:191], v[72:75]
    v_mfma_f32_16x16x32_bf16 v[72:75], a[200:203], v[192:195], v[72:75]
    v_mfma_f32_16x16x32_bf16 v[72:75], a[204:207], v[196:199], v[72:75]
    v_max3_f32 v32, v64, v65, v66
    s_nop 2
    v_max3_f32 v32, v32, v67, v68
    v_mfma_f32_16x16x32_bf16 v[72:75], a[208:211], v[200:203], v[72:75]
    v_max3_f32 v32, v32, v69, v70
    v_max_f32 v32, v32, v71
    v_mfma_f32_16x16x32_bf16 v[72:75], a[212:215], v[204:207], v[72:75]
    v_mov_b32 v33, v32
    v_mfma_f32_16x16x32_bf16 v[76:79], a[216:219], v[184:187], 0
    v_mfma_f32_16x16x32_bf16 v[76:79], a[220:223], v[188:191], v[76:79]
    v_permlane32_swap_b32 v32, v33
    v_mfma_f32_16x16x32_bf16 v[76:79], a[224:227], v[192:195], v[76:79]
    v_max_f32 v32, v32, v33
    v_mov_b32 v33, v32
    v_mfma_f32_16x16x32_bf16 v[76:79], a[228:231], v[196:199], v[76:79]
    v_mfma_f32_16x16x32_bf16 v[76:79], a[232:235], v[200:203], v[76:79]
    v_permlane16_swap_b32 v32, v33
    v_mfma_f32_16x16x32_bf16 v[76:79], a[236:239], v[204:207], v[76:79]
    v_max_f32 v32, v32, v33
    v_sub_f32 v64, v64, v32
    v_mfma_f32_16x16x32_bf16 v[80:83], a[192:195], v[208:211], 0
    v_sub_f32 v65, v65, v32
    v_sub_f32 v66, v66, v32
    v_mfma_f32_16x16x32_bf16 v[80:83], a[196:199], v[212:215], v[80:83]
    v_sub_f32 v67, v67, v32
    v_sub_f32 v68, v68, v32
    v_mfma_f32_16x16x32_bf16 v[80:83], a[200:203], v[216:219], v[80:83]
    v_sub_f32 v69, v69, v32
    v_sub_f32 v70, v70, v32
    v_mfma_f32_16x16x32_bf16 v[80:83], a[204:207], v[220:223], v[80:83]
    v_sub_f32 v71, v71, v32
    v_max3_f32 v34, v72, v73, v74
    v_mfma_f32_16x16x32_bf16 v[80:83], a[208:211], v[224:227], v[80:83]
    v_exp_f32 v64, v64
    v_mfma_f32_16x16x32_bf16 v[80:83], a[212:215], v[228:231], v[80:83]
    v_exp_f32 v65, v65
    v_mfma_f32_16x16x32_bf16 v[84:87], a[216:219], v[208:211], 0
    v_exp_f32 v66, v66
    v_mfma_f32_16x16x32_bf16 v[84:87], a[220:223], v[212:215], v[84:87]
    v_exp_f32 v67, v67
    v_mfma_f32_16x16x32_bf16 v[84:87], a[224:227], v[216:219], v[84:87]
    v_max3_f32 v34, v34, v75, v76
    v_max3_f32 v34, v34, v77, v78
    v_mfma_f32_16x16x32_bf16 v[84:87], a[228:231], v[220:223], v[84:87]
    v_max_f32 v34, v34, v79
    v_mov_b32 v35, v34
    v_mfma_f32_16x16x32_bf16 v[84:87], a[232:235], v[224:227], v[84:87]
    v_sub_f32 v48, 0, v32
    v_sub_f32 v49, 0, v32
    v_mfma_f32_16x16x32_bf16 v[84:87], a[236:239], v[228:231], v[84:87]
    v_permlane32_swap_b32 v34, v35
    v_mfma_f32_16x16x32_bf16 v[88:91], a[192:195], v[232:235], 0
    ds_read_b128 a[192:195], v2 offset:12288
    v_max_f32 v34, v34, v35
    v_mfma_f32_16x16x32_bf16 v[88:91], a[196:199], v[236:239], v[88:91]
    ds_read_b128 a[196:199], v3 offset:12288
    v_mov_b32 v35, v34
    v_mfma_f32_16x16x32_bf16 v[88:91], a[200:203], v[240:243], v[88:91]
    ds_read_b128 a[200:203], v2 offset:13312
    v_sub_f32 v50, 0, v32
    v_mfma_f32_16x16x32_bf16 v[88:91], a[204:207], v[244:247], v[88:91]
    ds_read_b128 a[204:207], v3 offset:13312
    v_sub_f32 v51, 0, v32
    v_mfma_f32_16x16x32_bf16 v[88:91], a[208:211], v[248:251], v[88:91]
    ds_read_b128 a[208:211], v2 offset:14336
    v_cvt_pk_bf16_f32 v112, v64, v65
    v_mfma_f32_16x16x32_bf16 v[88:91], a[212:215], v[252:255], v[88:91]
    ds_read_b128 a[212:215], v3 offset:14336
    v_cvt_pk_bf16_f32 v113, v66, v67
    v_mfma_f32_16x16x32_bf16 v[92:95], a[216:219], v[232:235], 0
    ds_read_b128 a[216:219], v2 offset:18432
    v_add_f32 v16, v64, v65
    v_mfma_f32_16x16x32_bf16 v[92:95], a[220:223], v[236:239], v[92:95]
    ds_read_b128 a[220:223], v3 offset:18432
    v_add_f32 v16, v16, v66
    v_mfma_f32_16x16x32_bf16 v[92:95], a[224:227], v[240:243], v[92:95]
    ds_read_b128 a[224:227], v2 offset:19456
    v_add_f32 v16, v16, v67
    v_mfma_f32_16x16x32_bf16 v[92:95], a[228:231], v[244:247], v[92:95]
    ds_read_b128 a[228:231], v3 offset:19456
    v_permlane16_swap_b32 v34, v35
    v_max_f32 v34, v34, v35
    v_mfma_f32_16x16x32_bf16 v[92:95], a[232:235], v[248:251], v[92:95]
    ds_read_b128 a[232:235], v2 offset:20480
    v_sub_f32 v72, v72, v34
    v_mfma_f32_16x16x32_bf16 v[92:95], a[236:239], v[252:255], v[92:95]
    s_waitcnt lgkmcnt(6)
    ds_read_b128 a[236:239], v3 offset:20480
    v_sub_f32 v73, v73, v34
    v_sub_f32 v74, v74, v34
    v_sub_f32 v75, v75, v34
    v_sub_f32 v76, v76, v34
    v_sub_f32 v77, v77, v34
    v_sub_f32 v78, v78, v34
    v_sub_f32 v79, v79, v34
    v_mfma_f32_16x16x32_bf16 v[64:67], a[192:195], v[160:163], v[48:51]
    v_exp_f32 v72, v72
    v_mfma_f32_16x16x32_bf16 v[64:67], a[196:199], v[164:167], v[64:67]
    v_exp_f32 v73, v73
    v_mfma_f32_16x16x32_bf16 v[64:67], a[200:203], v[168:171], v[64:67]
    v_exp_f32 v74, v74
    v_exp_f32 v75, v75
    v_mfma_f32_16x16x32_bf16 v[64:67], a[204:207], v[172:175], v[64:67]
    v_max3_f32 v36, v80, v81, v82
    v_max3_f32 v36, v36, v83, v84
    v_max3_f32 v36, v36, v85, v86
    v_max_f32 v36, v36, v87
    v_mov_b32 v37, v36
    s_nop 1
    v_permlane32_swap_b32 v36, v37
    v_max_f32 v36, v36, v37
    v_mov_b32 v37, v36
    s_nop 1
    v_permlane16_swap_b32 v36, v37
    v_max_f32 v36, v36, v37
    v_mfma_f32_16x16x32_bf16 v[64:67], a[208:211], v[176:179], v[64:67]
    s_waitcnt lgkmcnt(2)
    v_sub_f32 v52, 0, v34
    v_sub_f32 v53, 0, v34
    v_sub_f32 v54, 0, v34
    v_sub_f32 v55, 0, v34
    v_mfma_f32_16x16x32_bf16 v[64:67], a[212:215], v[180:183], v[64:67]
    v_cvt_pk_bf16_f32 v116, v72, v73
    v_cvt_pk_bf16_f32 v117, v74, v75
    v_add_f32 v17, v72, v73
    v_add_f32 v17, v17, v74
    v_add_f32 v17, v17, v75
    v_sub_f32 v80, v80, v36
    v_sub_f32 v81, v81, v36
    v_sub_f32 v82, v82, v36
    v_sub_f32 v83, v83, v36
    v_sub_f32 v84, v84, v36
    v_sub_f32 v85, v85, v36
    v_sub_f32 v86, v86, v36
    v_sub_f32 v87, v87, v36
    v_mfma_f32_16x16x32_bf16 v[72:75], a[192:195], v[184:187], v[52:55]
    v_exp_f32 v80, v80
    v_mfma_f32_16x16x32_bf16 v[72:75], a[196:199], v[188:191], v[72:75]
    v_exp_f32 v81, v81
    v_mfma_f32_16x16x32_bf16 v[72:75], a[200:203], v[192:195], v[72:75]
    v_exp_f32 v82, v82
    v_exp_f32 v83, v83
    v_mfma_f32_16x16x32_bf16 v[72:75], a[204:207], v[196:199], v[72:75]
    v_max3_f32 v38, v88, v89, v90
    v_max3_f32 v38, v38, v91, v92
    v_max3_f32 v38, v38, v93, v94
    v_max3_f32 v38, v38, v95, s86
    v_mov_b32 v39, v38
    s_nop 1
    v_permlane32_swap_b32 v38, v39
    v_max_f32 v38, v38, v39
    v_mov_b32 v39, v38
    s_nop 1
    v_permlane16_swap_b32 v38, v39
    v_max_f32 v38, v38, v39
    v_mfma_f32_16x16x32_bf16 v[72:75], a[208:211], v[200:203], v[72:75]
    v_sub_f32 v56, 0, v36
    v_sub_f32 v57, 0, v36
    v_sub_f32 v58, 0, v36
    v_sub_f32 v59, 0, v36
    v_mfma_f32_16x16x32_bf16 v[72:75], a[212:215], v[204:207], v[72:75]
    v_cvt_pk_bf16_f32 v120, v80, v81
    v_cvt_pk_bf16_f32 v121, v82, v83
    v_add_f32 v18, v80, v81
    v_add_f32 v18, v18, v82
    v_add_f32 v18, v18, v83
    v_mfma_f32_16x16x32_bf16 v[80:83], a[192:195], v[208:211], v[56:59]
    v_sub_f32 v60, 0, v38
    v_sub_f32 v61, 0, v38
    v_mfma_f32_16x16x32_bf16 v[80:83], a[196:199], v[212:215], v[80:83]
    v_sub_f32 v62, 0, v38
    v_sub_f32 v63, 0, v38
    v_mfma_f32_16x16x32_bf16 v[80:83], a[200:203], v[216:219], v[80:83]
    v_exp_f32 v68, v68
    v_mfma_f32_16x16x32_bf16 v[80:83], a[204:207], v[220:223], v[80:83]
    v_exp_f32 v69, v69
    v_mfma_f32_16x16x32_bf16 v[80:83], a[208:211], v[224:227], v[80:83]
    v_exp_f32 v70, v70
    v_mfma_f32_16x16x32_bf16 v[80:83], a[212:215], v[228:231], v[80:83]
    v_exp_f32 v71, v71
    v_mfma_f32_16x16x32_bf16 v[88:91], a[192:195], v[232:235], v[60:63]
    ds_read_b128 a[192:195], v2 offset:24576
    v_cvt_pk_bf16_f32 v114, v68, v69
    v_mfma_f32_16x16x32_bf16 v[88:91], a[196:199], v[236:239], v[88:91]
    ds_read_b128 a[196:199], v3 offset:24576
    v_cvt_pk_bf16_f32 v115, v70, v71
    v_mfma_f32_16x16x32_bf16 v[88:91], a[200:203], v[240:243], v[88:91]
    ds_read_b128 a[200:203], v2 offset:25600
    v_add_f32 v16, v16, v68
    v_mfma_f32_16x16x32_bf16 v[88:91], a[204:207], v[244:247], v[88:91]
    ds_read_b128 a[204:207], v3 offset:25600
    v_add_f32 v16, v16, v69
    v_mfma_f32_16x16x32_bf16 v[88:91], a[208:211], v[248:251], v[88:91]
    ds_read_b128 a[208:211], v2 offset:26624
    v_add_f32 v16, v16, v70
    v_mfma_f32_16x16x32_bf16 v[88:91], a[212:215], v[252:255], v[88:91]
    ds_read_b128 a[212:215], v3 offset:26624
    v_add_f32 v16, v16, v71
    v_mfma_f32_16x16x32_bf16 v[68:71], a[216:219], v[160:163], v[48:51]
    v_exp_f32 v76, v76
    v_mfma_f32_16x16x32_bf16 v[68:71], a[220:223], v[164:167], v[68:71]
    v_exp_f32 v77, v77
    v_mfma_f32_16x16x32_bf16 v[68:71], a[224:227], v[168:171], v[68:71]
    v_exp_f32 v78, v78
    v_exp_f32 v79, v79
    v_mfma_f32_16x16x32_bf16 v[68:71], a[228:231], v[172:175], v[68:71]
    s_waitcnt lgkmcnt(3)
    v_cvt_pk_bf16_f32 v118, v76, v77
    v_cvt_pk_bf16_f32 v119, v78, v79
    v_mfma_f32_16x16x32_bf16 v[68:71], a[232:235], v[176:179], v[68:71]
    v_add_f32 v17, v17, v76
    v_add_f32 v17, v17, v77
    v_mfma_f32_16x16x32_bf16 v[68:71], a[236:239], v[180:183], v[68:71]
    v_add_f32 v17, v17, v78
    v_add_f32 v17, v17, v79
    v_mfma_f32_16x16x32_bf16 v[76:79], a[216:219], v[184:187], v[52:55]
    v_exp_f32 v84, v84
    v_mfma_f32_16x16x32_bf16 v[76:79], a[220:223], v[188:191], v[76:79]
    v_exp_f32 v85, v85
    v_mfma_f32_16x16x32_bf16 v[76:79], a[224:227], v[192:195], v[76:79]
    v_exp_f32 v86, v86
    v_exp_f32 v87, v87
    v_mfma_f32_16x16x32_bf16 v[76:79], a[228:231], v[196:199], v[76:79]
    v_cvt_pk_bf16_f32 v122, v84, v85
    v_cvt_pk_bf16_f32 v123, v86, v87
    v_mfma_f32_16x16x32_bf16 v[76:79], a[232:235], v[200:203], v[76:79]
    v_add_f32 v18, v18, v84
    v_add_f32 v18, v18, v85
    v_mfma_f32_16x16x32_bf16 v[76:79], a[236:239], v[204:207], v[76:79]
    v_add_f32 v18, v18, v86
    v_add_f32 v18, v18, v87
    v_mfma_f32_16x16x32_bf16 v[84:87], a[216:219], v[208:211], v[56:59]
    v_exp_f32 v64, v64
    v_mfma_f32_16x16x32_bf16 v[84:87], a[220:223], v[212:215], v[84:87]
    v_exp_f32 v65, v65
    v_mfma_f32_16x16x32_bf16 v[84:87], a[224:227], v[216:219], v[84:87]
    v_exp_f32 v66, v66
    v_mfma_f32_16x16x32_bf16 v[84:87], a[228:231], v[220:223], v[84:87]
    v_exp_f32 v67, v67
    v_mfma_f32_16x16x32_bf16 v[84:87], a[232:235], v[224:227], v[84:87]
    v_cvt_pk_bf16_f32 v96, v64, v65
    v_cvt_pk_bf16_f32 v97, v66, v67
    v_mfma_f32_16x16x32_bf16 v[84:87], a[236:239], v[228:231], v[84:87]
    v_add_f32 v16, v16, v64
    v_add_f32 v16, v16, v65
    v_mfma_f32_16x16x32_bf16 v[92:95], a[216:219], v[232:235], v[60:63]
    ds_read_b128 a[216:219], v2 offset:30720
    v_add_f32 v16, v16, v66
    v_mfma_f32_16x16x32_bf16 v[92:95], a[220:223], v[236:239], v[92:95]
    ds_read_b128 a[220:223], v3 offset:30720
    v_add_f32 v16, v16, v67
    v_mfma_f32_16x16x32_bf16 v[92:95], a[224:227], v[240:243], v[92:95]
    ds_read_b128 a[224:227], v2 offset:31744
    v_mfma_f32_16x16x32_bf16 v[92:95], a[228:231], v[244:247], v[92:95]
    ds_read_b128 a[228:231], v3 offset:31744
    v_mfma_f32_16x16x32_bf16 v[92:95], a[232:235], v[248:251], v[92:95]
    ds_read_b128 a[232:235], v2 offset:32768
    v_mfma_f32_16x16x32_bf16 v[92:95], a[236:239], v[252:255], v[92:95]
    ds_read_b128 a[236:239], v3 offset:32768
    s_waitcnt lgkmcnt(0)
    s_barrier
    v_mfma_f32_16x16x32_bf16 v[64:67], a[192:195], v[160:163], v[48:51]
    v_exp_f32 v72, v72
    v_mfma_f32_16x16x32_bf16 v[64:67], a[196:199], v[164:167], v[64:67]
    v_exp_f32 v73, v73
    v_mfma_f32_16x16x32_bf16 v[64:67], a[200:203], v[168:171], v[64:67]
    s_add_u32 m0, s33, 12288
    v_exp_f32 v74, v74
    v_exp_f32 v75, v75
    v_mfma_f32_16x16x32_bf16 v[64:67], a[204:207], v[172:175], v[64:67]
    buffer_load_dwordx4 v8, s[16:19], s29 offen nt lds
    v_mfma_f32_16x16x32_bf16 v[64:67], a[208:211], v[176:179], v[64:67]
    ds_read_b64_tr_b16 v[152:153], v4
    v_cvt_pk_bf16_f32 v100, v72, v73
    v_mfma_f32_16x16x32_bf16 v[64:67], a[212:215], v[180:183], v[64:67]
    v_cvt_pk_bf16_f32 v101, v74, v75
    v_add_f32 v17, v17, v72
    v_add_f32 v17, v17, v73
    v_add_f32 v17, v17, v74
    v_add_f32 v17, v17, v75
    v_mfma_f32_16x16x32_bf16 v[72:75], a[192:195], v[184:187], v[52:55]
    v_exp_f32 v80, v80
    v_mfma_f32_16x16x32_bf16 v[72:75], a[196:199], v[188:191], v[72:75]
    v_exp_f32 v81, v81
    v_mfma_f32_16x16x32_bf16 v[72:75], a[200:203], v[192:195], v[72:75]
    v_exp_f32 v82, v82
    v_exp_f32 v83, v83
    v_mfma_f32_16x16x32_bf16 v[72:75], a[204:207], v[196:199], v[72:75]
    ds_read_b64_tr_b16 v[154:155], v4 offset:6144
    v_cvt_pk_bf16_f32 v104, v80, v81
    v_mfma_f32_16x16x32_bf16 v[72:75], a[208:211], v[200:203], v[72:75]
    ds_read_b64_tr_b16 v[156:157], v4 offset:12288
    v_cvt_pk_bf16_f32 v105, v82, v83
    v_mfma_f32_16x16x32_bf16 v[72:75], a[212:215], v[204:207], v[72:75]
    s_add_u32 m0, s33, 13184
    v_add_f32 v18, v18, v80
    v_add_f32 v18, v18, v81
    v_add_f32 v18, v18, v82
    v_add_f32 v18, v18, v83
    v_mfma_f32_16x16x32_bf16 v[80:83], a[192:195], v[208:211], v[56:59]
    buffer_load_dwordx4 v8, s[16:19], s29 offen offset:128 nt lds
    v_mfma_f32_16x16x32_bf16 v[80:83], a[196:199], v[212:215], v[80:83]
    v_exp_f32 v68, v68
    v_mfma_f32_16x16x32_bf16 v[80:83], a[200:203], v[216:219], v[80:83]
    v_exp_f32 v69, v69
    v_exp_f32 v70, v70
    v_exp_f32 v71, v71
    v_mfma_f32_16x16x32_bf16 v[80:83], a[204:207], v[220:223], v[80:83]
    ds_read_b128 a[192:195], v2 offset:36864
    v_cvt_pk_bf16_f32 v98, v68, v69
    v_mfma_f32_16x16x32_bf16 v[80:83], a[208:211], v[224:227], v[80:83]
    ds_read_b64_tr_b16 v[158:159], v4 offset:18432
    v_cvt_pk_bf16_f32 v99, v70, v71
    v_mfma_f32_16x16x32_bf16 v[80:83], a[212:215], v[228:231], v[80:83]
    v_add_f32 v16, v16, v68
    v_add_f32 v16, v16, v69
    v_add_f32 v16, v16, v70
    v_add_f32 v16, v16, v71
    v_mfma_f32_16x16x32_bf16 v[68:71], a[216:219], v[160:163], v[48:51]
    v_exp_f32 v76, v76
    v_mfma_f32_16x16x32_bf16 v[68:71], a[220:223], v[164:167], v[68:71]
    v_exp_f32 v77, v77
    v_mfma_f32_16x16x32_bf16 v[68:71], a[224:227], v[168:171], v[68:71]
    v_exp_f32 v78, v78
    v_exp_f32 v79, v79
    v_mfma_f32_16x16x32_bf16 v[68:71], a[228:231], v[172:175], v[68:71]
    s_add_u32 m0, s33, 14080
    ds_read_b128 a[196:199], v3 offset:36864
    v_cvt_pk_bf16_f32 v102, v76, v77
    v_mfma_f32_16x16x32_bf16 v[68:71], a[232:235], v[176:179], v[68:71]
    buffer_load_dwordx4 v8, s[16:19], s29 offen offset:256 nt lds
    v_mfma_f32_16x16x32_bf16 v[68:71], a[236:239], v[180:183], v[68:71]
    s_add_u32 s29, s29, 12288
    v_cvt_pk_bf16_f32 v103, v78, v79
    v_add_f32 v17, v17, v76
    v_add_f32 v17, v17, v77
    v_add_f32 v17, v17, v78
    v_add_f32 v17, v17, v79
    v_mfma_f32_16x16x32_bf16 v[76:79], a[216:219], v[184:187], v[52:55]
    ds_read_b128 a[200:203], v2 offset:37888
    v_mfma_f32_16x16x32_bf16 v[76:79], a[220:223], v[188:191], v[76:79]
    v_exp_f32 v84, v84
    v_mfma_f32_16x16x32_bf16 v[76:79], a[224:227], v[192:195], v[76:79]
    v_exp_f32 v85, v85
    v_exp_f32 v86, v86
    v_exp_f32 v87, v87
    v_mfma_f32_16x16x32_bf16 v[76:79], a[228:231], v[196:199], v[76:79]
    v_exp_f32 v88, v88
    v_exp_f32 v89, v89
    v_exp_f32 v90, v90
    v_exp_f32 v91, v91
    v_exp_f32 v92, v92
    v_exp_f32 v93, v93
    v_exp_f32 v94, v94
    v_exp_f32 v95, v95
    v_mfma_f32_16x16x32_bf16 v[76:79], a[232:235], v[200:203], v[76:79]
    ds_read_b128 a[204:207], v3 offset:37888
    v_cvt_pk_bf16_f32 v106, v84, v85
    v_mfma_f32_16x16x32_bf16 v[76:79], a[236:239], v[204:207], v[76:79]
    v_cvt_pk_bf16_f32 v107, v86, v87
    v_add_f32 v18, v18, v84
    v_add_f32 v18, v18, v85
    v_add_f32 v18, v18, v86
    v_add_f32 v18, v18, v87
    v_mfma_f32_16x16x32_bf16 v[84:87], a[216:219], v[208:211], v[56:59]
    s_add_u32 m0, s33, 24576
    v_cvt_pk_bf16_f32 v108, v88, v89
    v_cvt_pk_bf16_f32 v109, v90, v91
    v_cvt_pk_bf16_f32 v110, v92, v93
    v_cvt_pk_bf16_f32 v111, v94, v95
    v_add_f32 v22, v88, v89
    v_add_f32 v22, v22, v90
    v_add_f32 v22, v22, v91
    v_add_f32 v22, v22, v92
    v_add_f32 v22, v22, v93
    v_add_f32 v22, v22, v94
    v_add_f32 v22, v22, v95
    v_mfma_f32_16x16x32_bf16 v[84:87], a[220:223], v[212:215], v[84:87]
    ds_read_b128 a[208:211], v2 offset:38912
    buffer_load_dwordx4 v8, s[16:19], s29 offen nt lds
    v_max3_f32 v28, v16, v17, v18
    v_mfma_f32_16x16x32_bf16 v[84:87], a[224:227], v[216:219], v[84:87]
    v_max_f32 v28, v28, v22
    v_cmp_lt_f32 vcc, s35, v28
    v_mfma_f32_16x16x32_bf16 v[84:87], a[228:231], v[220:223], v[84:87]
    ds_read_b64_tr_b16 a[240:241], v5
    ds_read_b64_tr_b16 a[242:243], v5 offset:6144
    v_mfma_f32_16x16x32_bf16 v[84:87], a[232:235], v[224:227], v[84:87]
    ds_read_b128 a[212:215], v3 offset:38912
    v_mfma_f32_16x16x32_bf16 v[84:87], a[236:239], v[228:231], v[84:87]
    s_waitcnt lgkmcnt(4)
    s_cbranch_vccnz L_h1_2c_rare
L_h1_2c_back:
    ds_read_b64_tr_b16 a[244:245], v5 offset:12288
    ds_read_b64_tr_b16 a[246:247], v5 offset:18432
    v_mfma_f32_16x16x32_bf16 a[0:3], v[152:155], v[112:115], 0
    s_add_u32 m0, s33, 25472
    ds_read_b128 a[216:219], v2 offset:43008
    v_mov_b32 v12, v16
    v_mfma_f32_16x16x32_bf16 a[0:3], v[156:159], v[96:99], a[0:3]
    buffer_load_dwordx4 v8, s[16:19], s29 offen offset:128 nt lds
    v_mfma_f32_16x16x32_bf16 a[48:51], v[152:155], v[116:119], 0
    ds_read_b128 a[220:223], v3 offset:43008
    v_mov_b32 v13, v17
    v_mfma_f32_16x16x32_bf16 a[48:51], v[156:159], v[100:103], a[48:51]
    ds_read_b64_tr_b16 a[248:249], v6
    v_mov_b32 v14, v18
    v_mfma_f32_16x16x32_bf16 a[96:99], v[152:155], v[120:123], 0
    ds_read_b64_tr_b16 a[250:251], v6 offset:6144
    v_mov_b32 v15, v22
    v_mfma_f32_16x16x32_bf16 a[96:99], v[156:159], v[104:107], a[96:99]
    ds_read_b64_tr_b16 a[252:253], v6 offset:12288
    ds_read_b64_tr_b16 a[254:255], v6 offset:18432
    v_mfma_f32_16x16x32_bf16 a[144:147], v[156:159], v[108:111], 0
    s_waitcnt lgkmcnt(6)
    ds_read_b128 a[224:227], v2 offset:44032
    v_mfma_f32_16x16x32_bf16 a[4:7], a[240:243], v[112:115], 0
    v_exp_f32 v64, v64
    v_mfma_f32_16x16x32_bf16 a[4:7], a[244:247], v[96:99], a[4:7]
    ds_read_b128 a[228:231], v3 offset:44032
    v_mfma_f32_16x16x32_bf16 a[52:55], a[240:243], v[116:119], 0
    ds_read_b64_tr_b16 v[152:153], v7
    ds_read_b64_tr_b16 v[154:155], v7 offset:6144
    v_mfma_f32_16x16x32_bf16 a[52:55], a[244:247], v[100:103], a[52:55]
    ds_read_b64_tr_b16 v[156:157], v7 offset:12288
    ds_read_b64_tr_b16 v[158:159], v7 offset:18432
    v_mfma_f32_16x16x32_bf16 a[100:103], a[240:243], v[120:123], 0
    s_add_u32 m0, s33, 26368
    ds_read_b128 a[232:235], v2 offset:45056
    v_mfma_f32_16x16x32_bf16 a[100:103], a[244:247], v[104:107], a[100:103]
    buffer_load_dwordx4 v8, s[16:19], s29 offen offset:256 nt lds
    v_mfma_f32_16x16x32_bf16 a[148:151], a[244:247], v[108:111], 0
    s_waitcnt lgkmcnt(6)
    s_add_u32 s29, s29, 12288
    ds_read_b128 a[236:239], v3 offset:45056
    v_mfma_f32_16x16x32_bf16 a[8:11], a[248:251], v[112:115], 0
    v_exp_f32 v65, v65
    v_mfma_f32_16x16x32_bf16 a[8:11], a[252:255], v[96:99], a[8:11]
    ds_inc_u32 v46, v46
    v_cvt_pk_bf16_f32 v140, v64, v65
    v_mfma_f32_16x16x32_bf16 a[56:59], a[248:251], v[116:119], 0
    v_exp_f32 v66, v66
    v_mfma_f32_16x16x32_bf16 a[56:59], a[252:255], v[100:103], a[56:59]
    v_exp_f32 v67, v67
    v_mfma_f32_16x16x32_bf16 a[104:107], a[248:251], v[120:123], 0
    v_cvt_pk_bf16_f32 v141, v66, v67
    v_add_f32 v19, v64, v65
    v_mfma_f32_16x16x32_bf16 a[104:107], a[252:255], v[104:107], a[104:107]
    v_add_f32 v19, v19, v66
    v_add_f32 v19, v19, v67
    v_mfma_f32_16x16x32_bf16 a[152:155], a[252:255], v[108:111], 0
    s_waitcnt lgkmcnt(1)
    v_exp_f32 v72, v72
    v_mfma_f32_16x16x32_bf16 a[12:15], v[152:155], v[112:115], 0
    v_exp_f32 v73, v73
    v_mfma_f32_16x16x32_bf16 a[12:15], v[156:159], v[96:99], a[12:15]
    v_exp_f32 v74, v74
    v_mfma_f32_16x16x32_bf16 a[60:63], v[152:155], v[116:119], 0
    v_exp_f32 v75, v75
    v_mfma_f32_16x16x32_bf16 a[60:63], v[156:159], v[100:103], a[60:63]
    v_cvt_pk_bf16_f32 v144, v72, v73
    v_cvt_pk_bf16_f32 v145, v74, v75
    v_mfma_f32_16x16x32_bf16 a[108:111], v[152:155], v[120:123], 0
    v_add_f32 v20, v72, v73
    v_add_f32 v20, v20, v74
    v_mfma_f32_16x16x32_bf16 a[108:111], v[156:159], v[104:107], a[108:111]
    v_exp_f32 v80, v80
    v_mfma_f32_16x16x32_bf16 a[156:159], v[156:159], v[108:111], 0
    v_exp_f32 v81, v81
    v_mfma_f32_16x16x32_bf16 v[64:67], a[192:195], v[160:163], v[48:51]
    v_add_f32 v20, v20, v75
    v_cvt_pk_bf16_f32 v148, v80, v81
    v_mfma_f32_16x16x32_bf16 v[64:67], a[196:199], v[164:167], v[64:67]
    v_exp_f32 v82, v82
    v_mfma_f32_16x16x32_bf16 v[64:67], a[200:203], v[168:171], v[64:67]
    v_exp_f32 v83, v83
    v_mfma_f32_16x16x32_bf16 v[64:67], a[204:207], v[172:175], v[64:67]
    v_cvt_pk_bf16_f32 v149, v82, v83
    v_add_f32 v21, v80, v81
    v_mfma_f32_16x16x32_bf16 v[64:67], a[208:211], v[176:179], v[64:67]
    v_add_f32 v21, v21, v82
    v_add_f32 v21, v21, v83
    v_mfma_f32_16x16x32_bf16 v[64:67], a[212:215], v[180:183], v[64:67]
    v_exp_f32 v68, v68
    v_mfma_f32_16x16x32_bf16 v[72:75], a[192:195], v[184:187], v[52:55]
    v_exp_f32 v69, v69
    v_mfma_f32_16x16x32_bf16 v[72:75], a[196:199], v[188:191], v[72:75]
    v_exp_f32 v70, v70
    v_mfma_f32_16x16x32_bf16 v[72:75], a[200:203], v[192:195], v[72:75]
    v_exp_f32 v71, v71
    v_mfma_f32_16x16x32_bf16 v[72:75], a[204:207], v[196:199], v[72:75]
    v_cvt_pk_bf16_f32 v142, v68, v69
    v_cvt_pk_bf16_f32 v143, v70, v71
    v_mfma_f32_16x16x32_bf16 v[72:75], a[208:211], v[200:203], v[72:75]
    v_add_f32 v19, v19, v68
    v_add_f32 v19, v19, v69
    v_mfma_f32_16x16x32_bf16 v[72:75], a[212:215], v[204:207], v[72:75]
    v_add_f32 v19, v19, v70
    v_add_f32 v19, v19, v71
    v_mfma_f32_16x16x32_bf16 v[80:83], a[192:195], v[208:211], v[56:59]
    v_exp_f32 v76, v76
    v_mfma_f32_16x16x32_bf16 v[80:83], a[196:199], v[212:215], v[80:83]
    ds_read_b32 v30, v46
    v_add_f32 v20, v20, v76
    v_mfma_f32_16x16x32_bf16 v[80:83], a[200:203], v[216:219], v[80:83]
    v_exp_f32 v77, v77
    v_mfma_f32_16x16x32_bf16 v[80:83], a[204:207], v[220:223], v[80:83]
    v_exp_f32 v78, v78
    v_mfma_f32_16x16x32_bf16 v[80:83], a[208:211], v[224:227], v[80:83]
    v_exp_f32 v79, v79
    v_mfma_f32_16x16x32_bf16 v[80:83], a[212:215], v[228:231], v[80:83]
    v_cvt_pk_bf16_f32 v146, v76, v77
    v_cvt_pk_bf16_f32 v147, v78, v79
    v_mfma_f32_16x16x32_bf16 v[88:91], a[192:195], v[232:235], v[60:63]
    v_add_f32 v20, v20, v77
    v_add_f32 v20, v20, v78
    v_mfma_f32_16x16x32_bf16 v[88:91], a[196:199], v[236:239], v[88:91]
    v_exp_f32 v84, v84
    v_mfma_f32_16x16x32_bf16 v[88:91], a[200:203], v[240:243], v[88:91]
    s_waitcnt lgkmcnt(0)
    v_cmp_gt_u32 vcc, s93, v30
    v_add_f32 v20, v20, v79
    v_mfma_f32_16x16x32_bf16 v[88:91], a[204:207], v[244:247], v[88:91]
    v_exp_f32 v85, v85
    v_mfma_f32_16x16x32_bf16 v[88:91], a[208:211], v[248:251], v[88:91]
    s_add_u32 m0, s33, 49152
    v_exp_f32 v86, v86
    v_mfma_f32_16x16x32_bf16 v[88:91], a[212:215], v[252:255], v[88:91]
    s_cbranch_vccnz L_h1_3s_rare
L_h1_3s_back:
    v_exp_f32 v87, v87
    v_mfma_f32_16x16x32_bf16 v[68:71], a[216:219], v[160:163], v[48:51]
    s_add_u32 s93, s93, 4
    buffer_load_dwordx4 v9, s[20:23], s30 offen nt lds
    v_mfma_f32_16x16x32_bf16 v[68:71], a[220:223], v[164:167], v[68:71]
    ds_read_b64_tr_b16 a[240:241], v4 offset:1024
    v_cvt_pk_bf16_f32 v150, v84, v85
    v_mfma_f32_16x16x32_bf16 v[68:71], a[224:227], v[168:171], v[68:71]
    ds_read_b64_tr_b16 a[242:243], v4 offset:7168
    v_cvt_pk_bf16_f32 v151, v86, v87
    v_mfma_f32_16x16x32_bf16 v[68:71], a[228:231], v[172:175], v[68:71]
    ds_read_b64_tr_b16 a[244:245], v4 offset:13312
    v_add_f32 v21, v21, v84
    v_mfma_f32_16x16x32_bf16 v[68:71], a[232:235], v[176:179], v[68:71]
    ds_read_b64_tr_b16 a[246:247], v4 offset:19456
    v_add_f32 v21, v21, v85
    v_mfma_f32_16x16x32_bf16 v[68:71], a[236:239], v[180:183], v[68:71]
    ds_read_b64_tr_b16 a[248:249], v5 offset:1024
    v_add_f32 v21, v21, v86
    v_mfma_f32_16x16x32_bf16 v[76:79], a[216:219], v[184:187], v[52:55]
    ds_read_b64_tr_b16 a[250:251], v5 offset:7168
    v_add_f32 v21, v21, v87
    v_mfma_f32_16x16x32_bf16 v[76:79], a[220:223], v[188:191], v[76:79]
    v_exp_f32 v64, v64
    v_mfma_f32_16x16x32_bf16 v[76:79], a[224:227], v[192:195], v[76:79]
    ds_read_b64_tr_b16 a[252:253], v5 offset:13312
    v_add_f32 v19, v19, v64
    v_mfma_f32_16x16x32_bf16 v[76:79], a[228:231], v[196:199], v[76:79]
    s_add_u32 m0, s33, 61440
    v_exp_f32 v65, v65
    v_mfma_f32_16x16x32_bf16 v[76:79], a[232:235], v[200:203], v[76:79]
    buffer_load_dwordx4 v9, s[20:23], s32 offen nt lds
    v_mfma_f32_16x16x32_bf16 v[76:79], a[236:239], v[204:207], v[76:79]
    ds_read_b64_tr_b16 a[254:255], v5 offset:19456
    v_cvt_pk_bf16_f32 v124, v64, v65
    v_mfma_f32_16x16x32_bf16 v[84:87], a[216:219], v[208:211], v[56:59]
    ds_read_b64_tr_b16 v[152:153], v6 offset:1024
    v_add_f32 v19, v19, v65
    v_mfma_f32_16x16x32_bf16 v[84:87], a[220:223], v[212:215], v[84:87]
    v_exp_f32 v66, v66
    v_mfma_f32_16x16x32_bf16 v[84:87], a[224:227], v[216:219], v[84:87]
    ds_read_b64_tr_b16 v[154:155], v6 offset:7168
    v_add_f32 v19, v19, v66
    v_mfma_f32_16x16x32_bf16 v[84:87], a[228:231], v[220:223], v[84:87]
    v_exp_f32 v67, v67
    v_mfma_f32_16x16x32_bf16 v[84:87], a[232:235], v[224:227], v[84:87]
    ds_read_b64_tr_b16 v[156:157], v6 offset:13312
    v_cvt_pk_bf16_f32 v125, v66, v67
    v_mfma_f32_16x16x32_bf16 v[84:87], a[236:239], v[228:231], v[84:87]
    ds_read_b64_tr_b16 v[158:159], v6 offset:19456
    v_add_f32 v19, v19, v67
    v_mfma_f32_16x16x32_bf16 v[92:95], a[216:219], v[232:235], v[60:63]
    v_exp_f32 v68, v68
    v_mfma_f32_16x16x32_bf16 v[92:95], a[220:223], v[236:239], v[92:95]
    s_add_u32 m0, s33, 36864
    ds_read_b128 a[192:195], v2
    v_add_f32 v19, v19, v68
    v_mfma_f32_16x16x32_bf16 v[92:95], a[224:227], v[240:243], v[92:95]
    buffer_load_dwordx4 v8, s[16:19], s29 offen nt lds
    v_mfma_f32_16x16x32_bf16 v[92:95], a[228:231], v[244:247], v[92:95]
    v_exp_f32 v69, v69
    v_mfma_f32_16x16x32_bf16 v[92:95], a[232:235], v[248:251], v[92:95]
    ds_read_b128 a[196:199], v3
    v_cvt_pk_bf16_f32 v126, v68, v69
    v_mfma_f32_16x16x32_bf16 v[92:95], a[236:239], v[252:255], v[92:95]
    s_waitcnt lgkmcnt(3)
    v_exp_f32 v70, v70
    v_mfma_f32_16x16x32_bf16 a[16:19], a[240:243], v[112:115], 0
    ds_read_b128 a[200:203], v2 offset:1024
    v_add_f32 v19, v19, v69
    v_mfma_f32_16x16x32_bf16 a[16:19], a[244:247], v[96:99], a[16:19]
    v_exp_f32 v71, v71
    v_mfma_f32_16x16x32_bf16 a[64:67], a[240:243], v[116:119], 0
    ds_read_b128 a[204:207], v3 offset:1024
    v_cvt_pk_bf16_f32 v127, v70, v71
    v_mfma_f32_16x16x32_bf16 a[64:67], a[244:247], v[100:103], a[64:67]
    v_add_f32 v19, v19, v70
    v_add_f32 v19, v19, v71
    v_mfma_f32_16x16x32_bf16 a[112:115], a[240:243], v[120:123], 0
    v_exp_f32 v72, v72
    v_mfma_f32_16x16x32_bf16 a[112:115], a[244:247], v[104:107], a[112:115]
    s_add_u32 m0, s33, 37760
    ds_read_b64_tr_b16 a[240:241], v7 offset:1024
    v_add_f32 v20, v20, v72
    v_mfma_f32_16x16x32_bf16 a[160:163], a[244:247], v[108:111], 0
    buffer_load_dwordx4 v8, s[16:19], s29 offen offset:128 nt lds
    v_mfma_f32_16x16x32_bf16 a[20:23], a[248:251], v[112:115], 0
    v_exp_f32 v73, v73
    v_mfma_f32_16x16x32_bf16 a[20:23], a[252:255], v[96:99], a[20:23]
    ds_read_b64_tr_b16 a[242:243], v7 offset:7168
    v_cvt_pk_bf16_f32 v128, v72, v73
    v_mfma_f32_16x16x32_bf16 a[68:71], a[248:251], v[116:119], 0
    ds_read_b64_tr_b16 a[244:245], v7 offset:13312
    v_add_f32 v20, v20, v73
    v_mfma_f32_16x16x32_bf16 a[68:71], a[252:255], v[100:103], a[68:71]
    ds_read_b64_tr_b16 a[246:247], v7 offset:19456
    v_mfma_f32_16x16x32_bf16 a[116:119], a[248:251], v[120:123], 0
    v_exp_f32 v74, v74
    v_mfma_f32_16x16x32_bf16 a[116:119], a[252:255], v[104:107], a[116:119]
    ds_read_b64_tr_b16 a[248:249], v4 offset:2048
    v_add_f32 v20, v20, v74
    v_mfma_f32_16x16x32_bf16 a[164:167], a[252:255], v[108:111], 0
    v_exp_f32 v75, v75
    v_mfma_f32_16x16x32_bf16 a[24:27], v[152:155], v[112:115], 0
    s_waitcnt lgkmcnt(4)
    ds_read_b64_tr_b16 a[250:251], v4 offset:8192
    v_cvt_pk_bf16_f32 v129, v74, v75
    v_mfma_f32_16x16x32_bf16 a[24:27], v[156:159], v[96:99], a[24:27]
    s_add_u32 m0, s33, 38656
    ds_read_b64_tr_b16 a[252:253], v4 offset:14336
    v_add_f32 v20, v20, v75
    v_mfma_f32_16x16x32_bf16 a[72:75], v[152:155], v[116:119], 0
    buffer_load_dwordx4 v8, s[16:19], s29 offen offset:256 nt lds
    v_mfma_f32_16x16x32_bf16 a[72:75], v[156:159], v[100:103], a[72:75]
    s_add_u32 s29, s29, 12288
    ds_read_b64_tr_b16 a[254:255], v4 offset:20480
    v_mfma_f32_16x16x32_bf16 a[120:123], v[152:155], v[120:123], 0
    v_exp_f32 v76, v76
    v_mfma_f32_16x16x32_bf16 a[120:123], v[156:159], v[104:107], a[120:123]
    ds_read_b128 a[208:211], v2 offset:2048
    v_add_f32 v20, v20, v76
    v_mfma_f32_16x16x32_bf16 a[168:171], v[156:159], v[108:111], 0
    s_waitcnt lgkmcnt(4)
    v_exp_f32 v77, v77
    v_mfma_f32_16x16x32_bf16 a[28:31], a[240:243], v[112:115], 0
    ds_read_b64_tr_b16 v[152:153], v5 offset:2048
    v_cvt_pk_bf16_f32 v130, v76, v77
    v_mfma_f32_16x16x32_bf16 a[28:31], a[244:247], v[96:99], a[28:31]
    ds_read_b64_tr_b16 v[154:155], v5 offset:8192
    v_add_f32 v20, v20, v77
    v_mfma_f32_16x16x32_bf16 a[76:79], a[240:243], v[116:119], 0
    ds_read_b128 a[212:215], v3 offset:2048
    v_mfma_f32_16x16x32_bf16 a[76:79], a[244:247], v[100:103], a[76:79]
    ds_read_b64_tr_b16 v[156:157], v5 offset:14336
    ds_read_b64_tr_b16 v[158:159], v5 offset:20480
    v_mfma_f32_16x16x32_bf16 a[124:127], a[240:243], v[120:123], 0
    v_exp_f32 v78, v78
    v_mfma_f32_16x16x32_bf16 a[124:127], a[244:247], v[104:107], a[124:127]
    ds_read_b128 a[216:219], v2 offset:6144
    v_add_f32 v20, v20, v78
    v_mfma_f32_16x16x32_bf16 a[172:175], a[244:247], v[108:111], 0
    s_waitcnt lgkmcnt(6)
    v_exp_f32 v79, v79
    v_mfma_f32_16x16x32_bf16 a[32:35], a[248:251], v[112:115], 0
    ds_read_b128 a[220:223], v3 offset:6144
    v_cvt_pk_bf16_f32 v131, v78, v79
    v_mfma_f32_16x16x32_bf16 a[32:35], a[252:255], v[96:99], a[32:35]
    ds_read_b64_tr_b16 a[240:241], v6 offset:2048
    v_add_f32 v20, v20, v79
    v_mfma_f32_16x16x32_bf16 a[80:83], a[248:251], v[116:119], 0
    ds_read_b64_tr_b16 a[242:243], v6 offset:8192
    ds_read_b64_tr_b16 a[244:245], v6 offset:14336
    v_mfma_f32_16x16x32_bf16 a[80:83], a[252:255], v[100:103], a[80:83]
    ds_read_b64_tr_b16 a[246:247], v6 offset:20480
    v_mfma_f32_16x16x32_bf16 a[128:131], a[248:251], v[120:123], 0
    ds_read_b128 a[224:227], v2 offset:7168
    v_mfma_f32_16x16x32_bf16 a[128:131], a[252:255], v[104:107], a[128:131]
    v_exp_f32 v80, v80
    v_mfma_f32_16x16x32_bf16 a[176:179], a[252:255], v[108:111], 0
    s_waitcnt lgkmcnt(6)
    ds_read_b128 a[228:231], v3 offset:7168
    v_add_f32 v21, v21, v80
    v_mfma_f32_16x16x32_bf16 a[36:39], v[152:155], v[112:115], 0
    v_exp_f32 v81, v81
    v_mfma_f32_16x16x32_bf16 a[36:39], v[156:159], v[96:99], a[36:39]
    ds_read_b64_tr_b16 a[248:249], v7 offset:2048
    v_cvt_pk_bf16_f32 v132, v80, v81
    v_mfma_f32_16x16x32_bf16 a[84:87], v[152:155], v[116:119], 0
    ds_read_b64_tr_b16 a[250:251], v7 offset:8192
    v_add_f32 v21, v21, v81
    v_mfma_f32_16x16x32_bf16 a[84:87], v[156:159], v[100:103], a[84:87]
    ds_read_b64_tr_b16 a[252:253], v7 offset:14336
    ds_read_b64_tr_b16 a[254:255], v7 offset:20480
    v_mfma_f32_16x16x32_bf16 a[132:135], v[152:155], v[120:123], 0
    ds_read_b128 a[232:235], v2 offset:8192
    v_mfma_f32_16x16x32_bf16 a[132:135], v[156:159], v[104:107], a[132:135]
    v_exp_f32 v82, v82
    v_mfma_f32_16x16x32_bf16 a[180:183], v[156:159], v[108:111], 0
    s_waitcnt lgkmcnt(5)
    ds_read_b128 a[236:239], v3 offset:8192
    v_add_f32 v21, v21, v82
    v_mfma_f32_16x16x32_bf16 a[40:43], a[240:243], v[112:115], 0
    v_exp_f32 v83, v83
    v_mfma_f32_16x16x32_bf16 a[40:43], a[244:247], v[96:99], a[40:43]
    s_waitcnt vmcnt(8)
    ds_inc_u32 v46, v46
    v_cvt_pk_bf16_f32 v133, v82, v83
    v_mfma_f32_16x16x32_bf16 a[88:91], a[240:243], v[116:119], 0
    v_exp_f32 v84, v84
    v_mfma_f32_16x16x32_bf16 a[88:91], a[244:247], v[100:103], a[88:91]
    v_exp_f32 v85, v85
    v_mfma_f32_16x16x32_bf16 a[136:139], a[240:243], v[120:123], 0
    v_exp_f32 v86, v86
    v_mfma_f32_16x16x32_bf16 a[136:139], a[244:247], v[104:107], a[136:139]
    v_exp_f32 v87, v87
    v_mfma_f32_16x16x32_bf16 a[184:187], a[244:247], v[108:111], 0
    s_waitcnt lgkmcnt(1)
    v_cvt_pk_bf16_f32 v134, v84, v85
    v_cvt_pk_bf16_f32 v135, v86, v87
    v_mfma_f32_16x16x32_bf16 a[44:47], a[248:251], v[112:115], 0
    v_add_f32 v21, v21, v83
    v_add_f32 v21, v21, v84
    v_mfma_f32_16x16x32_bf16 a[44:47], a[252:255], v[96:99], a[44:47]
    v_add_f32 v21, v21, v85
    v_add_f32 v21, v21, v86
    v_mfma_f32_16x16x32_bf16 a[92:95], a[248:251], v[116:119], 0
    v_add_f32 v21, v21, v87
    v_max3_f32 v28, v19, v20, v21
    v_mfma_f32_16x16x32_bf16 a[92:95], a[252:255], v[100:103], a[92:95]
    v_exp_f32 v88, v88
    v_mfma_f32_16x16x32_bf16 a[140:143], a[248:251], v[120:123], 0
    v_exp_f32 v89, v89
    v_mfma_f32_16x16x32_bf16 a[140:143], a[252:255], v[104:107], a[140:143]
    v_exp_f32 v90, v90
    v_mfma_f32_16x16x32_bf16 a[188:191], a[252:255], v[108:111], 0
    v_exp_f32 v91, v91
    v_cvt_pk_bf16_f32 v136, v88, v89
    v_cvt_pk_bf16_f32 v137, v90, v91
    v_exp_f32 v92, v92
    v_exp_f32 v93, v93
    v_exp_f32 v94, v94
    v_exp_f32 v95, v95
    v_cvt_pk_bf16_f32 v138, v92, v93
    v_cvt_pk_bf16_f32 v139, v94, v95
    v_add_f32 v22, v88, v89
    v_add_f32 v22, v22, v90
    v_add_f32 v22, v22, v91
    v_add_f32 v22, v22, v92
    v_add_f32 v22, v22, v93
    v_add_f32 v22, v22, v94
    v_add_f32 v22, v22, v95
    v_max_f32 v28, v28, v22
    s_mov_b32 s31, 6
.p2align 6
L_loop_11:
    v_mfma_f32_16x16x32_bf16 v[64:67], a[192:195], v[160:163], v[48:51]
    s_add_u32 s57, s31, 1
    s_and_b32 s57, s57, 4
    s_mul_i32 s82, s57, 41472
    v_mfma_f32_16x16x32_bf16 v[64:67], a[196:199], v[164:167], v[64:67]
    s_mul_i32 s91, s57, 800
    s_mul_i32 s87, s57, 768
    ds_read_b32 v30, v46
    v_mfma_f32_16x16x32_bf16 v[64:67], a[200:203], v[168:171], v[64:67]
    ds_read_b128 v[32:35], v47
    v_mfma_f32_16x16x32_bf16 v[64:67], a[204:207], v[172:175], v[64:67]
    ds_read_b128 v[36:39], v47 offset:128
    v_mfma_f32_16x16x32_bf16 v[64:67], a[208:211], v[176:179], v[64:67]
    ds_read_b128 v[40:43], v47 offset:256
    v_mfma_f32_16x16x32_bf16 v[64:67], a[212:215], v[180:183], v[64:67]
    v_mfma_f32_16x16x32_bf16 v[72:75], a[192:195], v[184:187], v[52:55]
    v_mfma_f32_16x16x32_bf16 v[72:75], a[196:199], v[188:191], v[72:75]
    v_cmp_lt_f32 vcc, s35, v28
    v_mfma_f32_16x16x32_bf16 v[72:75], a[200:203], v[192:195], v[72:75]
    s_waitcnt lgkmcnt(3)
    v_cmp_gt_u32 s[94:95], s93, v30
    v_mfma_f32_16x16x32_bf16 v[72:75], a[204:207], v[196:199], v[72:75]
    s_add_u32 m0, s33, 50048
    s_nop 0
    v_exp_f32 v64, v64
    v_mfma_f32_16x16x32_bf16 v[72:75], a[208:211], v[200:203], v[72:75]
    s_or_b64 vcc, vcc, s[94:95]
    v_exp_f32 v65, v65
    v_mfma_f32_16x16x32_bf16 v[72:75], a[212:215], v[204:207], v[72:75]
    s_cbranch_vccnz L_b11_3cs_rare
L_b11_3cs_back:
    ds_read_b64_tr_b16 v[152:153], v4 offset:24576
    v_cvt_pk_bf16_f32 v112, v64, v65
    v_mfma_f32_16x16x32_bf16 v[80:83], a[192:195], v[208:211], v[56:59]
    s_add_u32 s93, s93, 4
    buffer_load_dwordx4 v9, s[20:23], s30 offen offset:128 nt lds
    v_mfma_f32_16x16x32_bf16 v[80:83], a[196:199], v[212:215], v[80:83]
    ds_read_b128 a[192:195], v2 offset:12288
    v_add_f32 v12, v12, v19
    v_mfma_f32_16x16x32_bf16 v[80:83], a[200:203], v[216:219], v[80:83]
    ds_read_b64_tr_b16 v[154:155], v4 offset:30720
    v_add_f32 v13, v13, v20
    v_mfma_f32_16x16x32_bf16 v[80:83], a[204:207], v[220:223], v[80:83]
    ds_read_b128 a[196:199], v3 offset:12288
    v_add_f32 v14, v14, v21
    v_mfma_f32_16x16x32_bf16 v[80:83], a[208:211], v[224:227], v[80:83]
    ds_read_b64_tr_b16 v[156:157], v4 offset:36864
    v_add_f32 v15, v15, v22
    v_mfma_f32_16x16x32_bf16 v[80:83], a[212:215], v[228:231], v[80:83]
    s_add_u32 m0, s33, 50944
    ds_read_b128 a[200:203], v2 offset:13312
    v_add_f32 v16, v64, v65
    v_mfma_f32_16x16x32_bf16 v[68:71], a[216:219], v[160:163], v[48:51]
    buffer_load_dwordx4 v9, s[20:23], s30 offen offset:256 nt lds
    v_mfma_f32_16x16x32_bf16 v[68:71], a[220:223], v[164:167], v[68:71]
    v_exp_f32 v66, v66
    v_mfma_f32_16x16x32_bf16 v[68:71], a[224:227], v[168:171], v[68:71]
    ds_read_b64_tr_b16 v[158:159], v4 offset:43008
    v_add_f32 v16, v16, v66
    v_mfma_f32_16x16x32_bf16 v[68:71], a[228:231], v[172:175], v[68:71]
    v_exp_f32 v67, v67
    v_mfma_f32_16x16x32_bf16 v[68:71], a[232:235], v[176:179], v[68:71]
    ds_read_b128 a[204:207], v3 offset:13312
    v_cvt_pk_bf16_f32 v113, v66, v67
    v_mfma_f32_16x16x32_bf16 v[68:71], a[236:239], v[180:183], v[68:71]
    s_add_u32 m0, s33, 62336
    ds_read_b64_tr_b16 a[240:241], v5 offset:24576
    v_add_f32 v16, v16, v67
    v_mfma_f32_16x16x32_bf16 v[76:79], a[216:219], v[184:187], v[52:55]
    buffer_load_dwordx4 v9, s[20:23], s32 offen offset:128 nt lds
    v_mfma_f32_16x16x32_bf16 v[76:79], a[220:223], v[188:191], v[76:79]
    v_exp_f32 v72, v72
    v_mfma_f32_16x16x32_bf16 v[76:79], a[224:227], v[192:195], v[76:79]
    v_exp_f32 v73, v73
    v_mfma_f32_16x16x32_bf16 v[76:79], a[228:231], v[196:199], v[76:79]
    ds_read_b128 a[208:211], v2 offset:14336
    v_cvt_pk_bf16_f32 v116, v72, v73
    v_mfma_f32_16x16x32_bf16 v[76:79], a[232:235], v[200:203], v[76:79]
    ds_read_b64_tr_b16 a[242:243], v5 offset:30720
    v_add_f32 v17, v72, v73
    v_mfma_f32_16x16x32_bf16 v[76:79], a[236:239], v[204:207], v[76:79]
    s_add_u32 m0, s33, 63232
    v_exp_f32 v74, v74
    v_mfma_f32_16x16x32_bf16 v[84:87], a[216:219], v[208:211], v[56:59]
    buffer_load_dwordx4 v9, s[20:23], s32 offen offset:256 nt lds
    v_mfma_f32_16x16x32_bf16 v[84:87], a[220:223], v[212:215], v[84:87]
    s_add_u32 s30, s30, 24576
    ds_read_b128 a[212:215], v3 offset:14336
    v_add_f32 v17, v17, v74
    v_mfma_f32_16x16x32_bf16 v[84:87], a[224:227], v[216:219], v[84:87]
    s_add_u32 s32, s32, 24576
    ds_read_b64_tr_b16 a[244:245], v5 offset:36864
    ds_read_b64_tr_b16 a[246:247], v5 offset:43008
    v_mfma_f32_16x16x32_bf16 v[84:87], a[228:231], v[220:223], v[84:87]
    v_exp_f32 v75, v75
    v_mfma_f32_16x16x32_bf16 v[84:87], a[232:235], v[224:227], v[84:87]
    s_add_u32 m0, s33, 0
    ds_read_b128 a[216:219], v2 offset:18432
    v_cvt_pk_bf16_f32 v117, v74, v75
    v_mfma_f32_16x16x32_bf16 v[84:87], a[236:239], v[228:231], v[84:87]
    s_waitcnt lgkmcnt(4)
    ds_read_b64_tr_b16 a[248:249], v6 offset:24576
    v_add_f32 v17, v17, v75
    v_mfma_f32_16x16x32_bf16 a[0:3], v[152:155], v[140:143], a[0:3]
    buffer_load_dwordx4 v8, s[16:19], s29 offen nt lds
    v_mfma_f32_16x16x32_bf16 a[0:3], v[156:159], v[124:127], a[0:3]
    ds_read_b128 a[220:223], v3 offset:18432
    v_mfma_f32_16x16x32_bf16 a[48:51], v[152:155], v[144:147], a[48:51]
    ds_read_b64_tr_b16 a[250:251], v6 offset:30720
    ds_read_b64_tr_b16 a[252:253], v6 offset:36864
    v_mfma_f32_16x16x32_bf16 a[48:51], v[156:159], v[128:131], a[48:51]
    ds_read_b64_tr_b16 a[254:255], v6 offset:43008
    v_mfma_f32_16x16x32_bf16 a[96:99], v[152:155], v[148:151], a[96:99]
    ds_read_b128 a[224:227], v2 offset:19456
    v_mfma_f32_16x16x32_bf16 a[96:99], v[156:159], v[132:135], a[96:99]
    s_add_u32 m0, s33, 896
    v_exp_f32 v80, v80
    v_mfma_f32_16x16x32_bf16 a[144:147], v[156:159], v[136:139], a[144:147]
    buffer_load_dwordx4 v8, s[16:19], s29 offen offset:128 nt lds
    v_mfma_f32_16x16x32_bf16 a[4:7], a[240:243], v[140:143], a[4:7]
    s_waitcnt lgkmcnt(5)
    ds_read_b128 a[228:231], v3 offset:19456
    v_add_u32 v47, s91, v47
    v_mfma_f32_16x16x32_bf16 a[4:7], a[244:247], v[124:127], a[4:7]
    v_exp_f32 v81, v81
    v_mfma_f32_16x16x32_bf16 a[52:55], a[240:243], v[144:147], a[52:55]
    ds_read_b64_tr_b16 v[152:153], v7 offset:24576
    v_cvt_pk_bf16_f32 v120, v80, v81
    v_mfma_f32_16x16x32_bf16 a[52:55], a[244:247], v[128:131], a[52:55]
    ds_read_b64_tr_b16 v[154:155], v7 offset:30720
    v_add_f32 v18, v80, v81
    v_mfma_f32_16x16x32_bf16 a[100:103], a[240:243], v[148:151], a[100:103]
    ds_read_b64_tr_b16 v[156:157], v7 offset:36864
    ds_read_b64_tr_b16 v[158:159], v7 offset:43008
    v_mfma_f32_16x16x32_bf16 a[100:103], a[244:247], v[132:135], a[100:103]
    s_add_u32 m0, s33, 1792
    ds_read_b128 a[232:235], v2 offset:20480
    v_mfma_f32_16x16x32_bf16 a[148:151], a[244:247], v[136:139], a[148:151]
    s_waitcnt lgkmcnt(6)
    buffer_load_dwordx4 v8, s[16:19], s29 offen offset:256 nt lds
    v_mfma_f32_16x16x32_bf16 a[8:11], a[248:251], v[140:143], a[8:11]
    s_add_u32 s29, s29, 12288
    ds_read_b128 a[236:239], v3 offset:20480
    v_mfma_f32_16x16x32_bf16 a[8:11], a[252:255], v[124:127], a[8:11]
    s_waitcnt vmcnt(12)
    ds_inc_u32 v46, v46
    v_mfma_f32_16x16x32_bf16 a[56:59], a[248:251], v[144:147], a[56:59]
    v_exp_f32 v82, v82
    v_mfma_f32_16x16x32_bf16 a[56:59], a[252:255], v[128:131], a[56:59]
    v_exp_f32 v83, v83
    v_mfma_f32_16x16x32_bf16 a[104:107], a[248:251], v[148:151], a[104:107]
    v_cvt_pk_bf16_f32 v121, v82, v83
    v_add_f32 v18, v18, v82
    v_mfma_f32_16x16x32_bf16 a[104:107], a[252:255], v[132:135], a[104:107]
    v_exp_f32 v68, v68
    v_mfma_f32_16x16x32_bf16 a[152:155], a[252:255], v[136:139], a[152:155]
    s_waitcnt lgkmcnt(2)
    v_add_f32 v18, v18, v83
    v_add_f32 v16, v16, v68
    v_mfma_f32_16x16x32_bf16 a[12:15], v[152:155], v[140:143], a[12:15]
    v_exp_f32 v69, v69
    v_mfma_f32_16x16x32_bf16 a[12:15], v[156:159], v[124:127], a[12:15]
    v_exp_f32 v70, v70
    v_mfma_f32_16x16x32_bf16 a[60:63], v[152:155], v[144:147], a[60:63]
    v_exp_f32 v71, v71
    v_mfma_f32_16x16x32_bf16 a[60:63], v[156:159], v[128:131], a[60:63]
    v_cvt_pk_bf16_f32 v114, v68, v69
    v_cvt_pk_bf16_f32 v115, v70, v71
    v_mfma_f32_16x16x32_bf16 a[108:111], v[152:155], v[148:151], a[108:111]
    v_add_f32 v16, v16, v69
    v_add_f32 v16, v16, v70
    v_mfma_f32_16x16x32_bf16 a[108:111], v[156:159], v[132:135], a[108:111]
    v_exp_f32 v76, v76
    v_mfma_f32_16x16x32_bf16 a[156:159], v[156:159], v[136:139], a[156:159]
    v_add_f32 v16, v16, v71
    v_add_f32 v17, v17, v76
    v_mfma_f32_16x16x32_bf16 v[64:67], a[192:195], v[160:163], v[48:51]
    v_exp_f32 v77, v77
    v_mfma_f32_16x16x32_bf16 v[64:67], a[196:199], v[164:167], v[64:67]
    v_exp_f32 v78, v78
    v_mfma_f32_16x16x32_bf16 v[64:67], a[200:203], v[168:171], v[64:67]
    v_exp_f32 v79, v79
    v_mfma_f32_16x16x32_bf16 v[64:67], a[204:207], v[172:175], v[64:67]
    v_cvt_pk_bf16_f32 v118, v76, v77
    v_cvt_pk_bf16_f32 v119, v78, v79
    v_mfma_f32_16x16x32_bf16 v[64:67], a[208:211], v[176:179], v[64:67]
    v_add_f32 v17, v17, v77
    v_add_f32 v17, v17, v78
    v_mfma_f32_16x16x32_bf16 v[64:67], a[212:215], v[180:183], v[64:67]
    v_exp_f32 v84, v84
    v_mfma_f32_16x16x32_bf16 v[72:75], a[192:195], v[184:187], v[52:55]
    v_add_f32 v17, v17, v79
    v_add_f32 v18, v18, v84
    v_mfma_f32_16x16x32_bf16 v[72:75], a[196:199], v[188:191], v[72:75]
    v_exp_f32 v85, v85
    v_mfma_f32_16x16x32_bf16 v[72:75], a[200:203], v[192:195], v[72:75]
    v_exp_f32 v86, v86
    v_mfma_f32_16x16x32_bf16 v[72:75], a[204:207], v[196:199], v[72:75]
    v_exp_f32 v87, v87
    v_mfma_f32_16x16x32_bf16 v[72:75], a[208:211], v[200:203], v[72:75]
    v_cvt_pk_bf16_f32 v122, v84, v85
    v_cvt_pk_bf16_f32 v123, v86, v87
    v_mfma_f32_16x16x32_bf16 v[72:75], a[212:215], v[204:207], v[72:75]
    v_add_f32 v18, v18, v85
    v_add_f32 v18, v18, v86
    v_mfma_f32_16x16x32_bf16 v[80:83], a[192:195], v[208:211], v[56:59]
    v_exp_f32 v64, v64
    v_mfma_f32_16x16x32_bf16 v[80:83], a[196:199], v[212:215], v[80:83]
    ds_read_b32 v30, v46
    v_add_f32 v18, v18, v87
    v_mfma_f32_16x16x32_bf16 v[80:83], a[200:203], v[216:219], v[80:83]
    v_exp_f32 v65, v65
    v_mfma_f32_16x16x32_bf16 v[80:83], a[204:207], v[220:223], v[80:83]
    v_exp_f32 v66, v66
    v_mfma_f32_16x16x32_bf16 v[80:83], a[208:211], v[224:227], v[80:83]
    v_exp_f32 v67, v67
    v_mfma_f32_16x16x32_bf16 v[80:83], a[212:215], v[228:231], v[80:83]
    v_cvt_pk_bf16_f32 v96, v64, v65
    v_cvt_pk_bf16_f32 v97, v66, v67
    v_mfma_f32_16x16x32_bf16 v[88:91], a[192:195], v[232:235], v[60:63]
    v_add_f32 v16, v16, v64
    v_add_f32 v16, v16, v65
    v_mfma_f32_16x16x32_bf16 v[88:91], a[196:199], v[236:239], v[88:91]
    v_add_f32 v16, v16, v66
    v_add_f32 v16, v16, v67
    v_mfma_f32_16x16x32_bf16 v[88:91], a[200:203], v[240:243], v[88:91]
    s_waitcnt lgkmcnt(0)
    v_cmp_gt_u32 vcc, s93, v30
    v_mfma_f32_16x16x32_bf16 v[88:91], a[204:207], v[244:247], v[88:91]
    v_exp_f32 v72, v72
    v_mfma_f32_16x16x32_bf16 v[88:91], a[208:211], v[248:251], v[88:91]
    s_add_u32 m0, s33, 73728
    v_exp_f32 v73, v73
    v_mfma_f32_16x16x32_bf16 v[88:91], a[212:215], v[252:255], v[88:91]
    s_cbranch_vccnz L_b11_4s_rare
L_b11_4s_back:
    ds_read_b64_tr_b16 a[240:241], v4 offset:25600
    v_cvt_pk_bf16_f32 v100, v72, v73
    v_mfma_f32_16x16x32_bf16 v[68:71], a[216:219], v[160:163], v[48:51]
    s_add_u32 s93, s93, 4
    buffer_load_dwordx4 v9, s[20:23], s30 offen nt lds
    v_mfma_f32_16x16x32_bf16 v[68:71], a[220:223], v[164:167], v[68:71]
    ds_read_b64_tr_b16 a[242:243], v4 offset:31744
    v_add_f32 v17, v17, v72
    v_mfma_f32_16x16x32_bf16 v[68:71], a[224:227], v[168:171], v[68:71]
    ds_read_b64_tr_b16 a[244:245], v4 offset:37888
    v_add_f32 v17, v17, v73
    v_mfma_f32_16x16x32_bf16 v[68:71], a[228:231], v[172:175], v[68:71]
    v_exp_f32 v74, v74
    v_mfma_f32_16x16x32_bf16 v[68:71], a[232:235], v[176:179], v[68:71]
    ds_read_b64_tr_b16 a[246:247], v4 offset:44032
    v_add_f32 v17, v17, v74
    v_mfma_f32_16x16x32_bf16 v[68:71], a[236:239], v[180:183], v[68:71]
    v_exp_f32 v75, v75
    v_mfma_f32_16x16x32_bf16 v[76:79], a[216:219], v[184:187], v[52:55]
    ds_read_b64_tr_b16 a[248:249], v5 offset:25600
    v_cvt_pk_bf16_f32 v101, v74, v75
    v_mfma_f32_16x16x32_bf16 v[76:79], a[220:223], v[188:191], v[76:79]
    ds_read_b64_tr_b16 a[250:251], v5 offset:31744
    v_add_f32 v17, v17, v75
    v_mfma_f32_16x16x32_bf16 v[76:79], a[224:227], v[192:195], v[76:79]
    v_exp_f32 v80, v80
    v_mfma_f32_16x16x32_bf16 v[76:79], a[228:231], v[196:199], v[76:79]
    s_add_u32 m0, s33, 86016
    ds_read_b64_tr_b16 a[252:253], v5 offset:37888
    v_add_f32 v18, v18, v80
    v_mfma_f32_16x16x32_bf16 v[76:79], a[232:235], v[200:203], v[76:79]
    buffer_load_dwordx4 v9, s[20:23], s32 offen nt lds
    v_mfma_f32_16x16x32_bf16 v[76:79], a[236:239], v[204:207], v[76:79]
    v_exp_f32 v68, v68
    v_mfma_f32_16x16x32_bf16 v[84:87], a[216:219], v[208:211], v[56:59]
    ds_read_b64_tr_b16 a[254:255], v5 offset:44032
    v_add_f32 v16, v16, v68
    v_mfma_f32_16x16x32_bf16 v[84:87], a[220:223], v[212:215], v[84:87]
    v_exp_f32 v69, v69
    v_mfma_f32_16x16x32_bf16 v[84:87], a[224:227], v[216:219], v[84:87]
    ds_read_b64_tr_b16 v[152:153], v6 offset:25600
    v_cvt_pk_bf16_f32 v98, v68, v69
    v_mfma_f32_16x16x32_bf16 v[84:87], a[228:231], v[220:223], v[84:87]
    ds_read_b64_tr_b16 v[154:155], v6 offset:31744
    v_add_f32 v16, v16, v69
    v_mfma_f32_16x16x32_bf16 v[84:87], a[232:235], v[224:227], v[84:87]
    v_exp_f32 v70, v70
    v_mfma_f32_16x16x32_bf16 v[84:87], a[236:239], v[228:231], v[84:87]
    ds_read_b64_tr_b16 v[156:157], v6 offset:37888
    v_add_f32 v16, v16, v70
    v_mfma_f32_16x16x32_bf16 v[92:95], a[216:219], v[232:235], v[60:63]
    v_exp_f32 v71, v71
    v_mfma_f32_16x16x32_bf16 v[92:95], a[220:223], v[236:239], v[92:95]
    s_add_u32 m0, s33, 12288
    ds_read_b64_tr_b16 v[158:159], v6 offset:44032
    v_cvt_pk_bf16_f32 v99, v70, v71
    v_mfma_f32_16x16x32_bf16 v[92:95], a[224:227], v[240:243], v[92:95]
    buffer_load_dwordx4 v8, s[16:19], s29 offen nt lds
    v_mfma_f32_16x16x32_bf16 v[92:95], a[228:231], v[244:247], v[92:95]
    ds_read_b128 a[192:195], v2 offset:24576
    v_add_f32 v16, v16, v71
    v_mfma_f32_16x16x32_bf16 v[92:95], a[232:235], v[248:251], v[92:95]
    v_exp_f32 v76, v76
    v_mfma_f32_16x16x32_bf16 v[92:95], a[236:239], v[252:255], v[92:95]
    s_waitcnt lgkmcnt(3)
    ds_read_b128 a[196:199], v3 offset:24576
    v_add_f32 v17, v17, v76
    v_mfma_f32_16x16x32_bf16 a[16:19], a[240:243], v[140:143], a[16:19]
    v_exp_f32 v77, v77
    v_mfma_f32_16x16x32_bf16 a[16:19], a[244:247], v[124:127], a[16:19]
    ds_read_b128 a[200:203], v2 offset:25600
    v_cvt_pk_bf16_f32 v102, v76, v77
    v_mfma_f32_16x16x32_bf16 a[64:67], a[240:243], v[144:147], a[64:67]
    v_exp_f32 v78, v78
    v_mfma_f32_16x16x32_bf16 a[64:67], a[244:247], v[128:131], a[64:67]
    ds_read_b128 a[204:207], v3 offset:25600
    v_add_f32 v17, v17, v77
    v_mfma_f32_16x16x32_bf16 a[112:115], a[240:243], v[148:151], a[112:115]
    ds_read_b64_tr_b16 a[240:241], v7 offset:25600
    v_add_f32 v17, v17, v78
    v_mfma_f32_16x16x32_bf16 a[112:115], a[244:247], v[132:135], a[112:115]
    s_add_u32 m0, s33, 13184
    v_exp_f32 v79, v79
    v_mfma_f32_16x16x32_bf16 a[160:163], a[244:247], v[136:139], a[160:163]
    buffer_load_dwordx4 v8, s[16:19], s29 offen offset:128 nt lds
    v_mfma_f32_16x16x32_bf16 a[20:23], a[248:251], v[140:143], a[20:23]
    ds_read_b64_tr_b16 a[242:243], v7 offset:31744
    v_cvt_pk_bf16_f32 v103, v78, v79
    v_mfma_f32_16x16x32_bf16 a[20:23], a[252:255], v[124:127], a[20:23]
    ds_read_b64_tr_b16 a[244:245], v7 offset:37888
    v_add_f32 v17, v17, v79
    v_mfma_f32_16x16x32_bf16 a[68:71], a[248:251], v[144:147], a[68:71]
    v_exp_f32 v81, v81
    v_mfma_f32_16x16x32_bf16 a[68:71], a[252:255], v[128:131], a[68:71]
    ds_read_b64_tr_b16 a[246:247], v7 offset:44032
    v_cvt_pk_bf16_f32 v104, v80, v81
    v_mfma_f32_16x16x32_bf16 a[116:119], a[248:251], v[148:151], a[116:119]
    ds_read_b64_tr_b16 a[248:249], v4 offset:26624
    v_add_f32 v18, v18, v81
    v_mfma_f32_16x16x32_bf16 a[116:119], a[252:255], v[132:135], a[116:119]
    v_exp_f32 v82, v82
    v_mfma_f32_16x16x32_bf16 a[164:167], a[252:255], v[136:139], a[164:167]
    ds_read_b64_tr_b16 a[250:251], v4 offset:32768
    v_add_f32 v18, v18, v82
    v_mfma_f32_16x16x32_bf16 a[24:27], v[152:155], v[140:143], a[24:27]
    s_waitcnt lgkmcnt(4)
    v_exp_f32 v83, v83
    v_mfma_f32_16x16x32_bf16 a[24:27], v[156:159], v[124:127], a[24:27]
    s_add_u32 m0, s33, 14080
    ds_read_b64_tr_b16 a[252:253], v4 offset:38912
    v_cvt_pk_bf16_f32 v105, v82, v83
    v_mfma_f32_16x16x32_bf16 a[72:75], v[152:155], v[144:147], a[72:75]
    buffer_load_dwordx4 v8, s[16:19], s29 offen offset:256 nt lds
    v_mfma_f32_16x16x32_bf16 a[72:75], v[156:159], v[128:131], a[72:75]
    s_add_u32 s29, s29, 12288
    ds_read_b64_tr_b16 a[254:255], v4 offset:45056
    v_add_f32 v18, v18, v83
    v_mfma_f32_16x16x32_bf16 a[120:123], v[152:155], v[148:151], a[120:123]
    v_exp_f32 v84, v84
    v_mfma_f32_16x16x32_bf16 a[120:123], v[156:159], v[132:135], a[120:123]
    ds_read_b128 a[208:211], v2 offset:26624
    v_add_f32 v18, v18, v84
    v_mfma_f32_16x16x32_bf16 a[168:171], v[156:159], v[136:139], a[168:171]
    v_exp_f32 v85, v85
    v_mfma_f32_16x16x32_bf16 a[28:31], a[240:243], v[140:143], a[28:31]
    s_waitcnt lgkmcnt(3)
    ds_read_b64_tr_b16 v[152:153], v5 offset:26624
    v_cvt_pk_bf16_f32 v106, v84, v85
    v_mfma_f32_16x16x32_bf16 a[28:31], a[244:247], v[124:127], a[28:31]
    ds_read_b64_tr_b16 v[154:155], v5 offset:32768
    v_add_f32 v18, v18, v85
    v_mfma_f32_16x16x32_bf16 a[76:79], a[240:243], v[144:147], a[76:79]
    ds_read_b128 a[212:215], v3 offset:26624
    v_mfma_f32_16x16x32_bf16 a[76:79], a[244:247], v[128:131], a[76:79]
    ds_read_b64_tr_b16 v[156:157], v5 offset:38912
    ds_read_b64_tr_b16 v[158:159], v5 offset:45056
    v_mfma_f32_16x16x32_bf16 a[124:127], a[240:243], v[148:151], a[124:127]
    v_exp_f32 v86, v86
    v_mfma_f32_16x16x32_bf16 a[124:127], a[244:247], v[132:135], a[124:127]
    ds_read_b128 a[216:219], v2 offset:30720
    v_add_f32 v18, v18, v86
    v_mfma_f32_16x16x32_bf16 a[172:175], a[244:247], v[136:139], a[172:175]
    v_exp_f32 v87, v87
    v_mfma_f32_16x16x32_bf16 a[32:35], a[248:251], v[140:143], a[32:35]
    s_waitcnt lgkmcnt(5)
    ds_read_b128 a[220:223], v3 offset:30720
    v_cvt_pk_bf16_f32 v107, v86, v87
    v_mfma_f32_16x16x32_bf16 a[32:35], a[252:255], v[124:127], a[32:35]
    ds_read_b64_tr_b16 a[240:241], v6 offset:26624
    v_add_f32 v18, v18, v87
    v_mfma_f32_16x16x32_bf16 a[80:83], a[248:251], v[144:147], a[80:83]
    ds_read_b64_tr_b16 a[242:243], v6 offset:32768
    v_max3_f32 v28, v16, v17, v18
    v_mfma_f32_16x16x32_bf16 a[80:83], a[252:255], v[128:131], a[80:83]
    ds_read_b64_tr_b16 a[244:245], v6 offset:38912
    ds_read_b64_tr_b16 a[246:247], v6 offset:45056
    v_mfma_f32_16x16x32_bf16 a[128:131], a[248:251], v[148:151], a[128:131]
    ds_read_b128 a[224:227], v2 offset:31744
    v_mfma_f32_16x16x32_bf16 a[128:131], a[252:255], v[132:135], a[128:131]
    v_exp_f32 v88, v88
    v_mfma_f32_16x16x32_bf16 a[176:179], a[252:255], v[136:139], a[176:179]
    s_waitcnt lgkmcnt(6)
    v_exp_f32 v89, v89
    v_mfma_f32_16x16x32_bf16 a[36:39], v[152:155], v[140:143], a[36:39]
    ds_read_b128 a[228:231], v3 offset:31744
    v_cvt_pk_bf16_f32 v108, v88, v89
    v_mfma_f32_16x16x32_bf16 a[36:39], v[156:159], v[124:127], a[36:39]
    ds_read_b64_tr_b16 a[248:249], v7 offset:26624
    v_add_f32 v22, v88, v89
    v_mfma_f32_16x16x32_bf16 a[84:87], v[152:155], v[144:147], a[84:87]
    ds_read_b64_tr_b16 a[250:251], v7 offset:32768
    ds_read_b64_tr_b16 a[252:253], v7 offset:38912
    v_mfma_f32_16x16x32_bf16 a[84:87], v[156:159], v[128:131], a[84:87]
    ds_read_b64_tr_b16 a[254:255], v7 offset:45056
    v_mfma_f32_16x16x32_bf16 a[132:135], v[152:155], v[148:151], a[132:135]
    ds_read_b128 a[232:235], v2 offset:32768
    v_mfma_f32_16x16x32_bf16 a[132:135], v[156:159], v[132:135], a[132:135]
    v_exp_f32 v90, v90
    v_mfma_f32_16x16x32_bf16 a[180:183], v[156:159], v[136:139], a[180:183]
    s_waitcnt lgkmcnt(6)
    ds_read_b128 a[236:239], v3 offset:32768
    v_add_f32 v22, v22, v90
    v_mfma_f32_16x16x32_bf16 a[40:43], a[240:243], v[140:143], a[40:43]
    v_exp_f32 v91, v91
    v_mfma_f32_16x16x32_bf16 a[40:43], a[244:247], v[124:127], a[40:43]
    s_waitcnt vmcnt(12)
    ds_inc_u32 v46, v46
    v_cvt_pk_bf16_f32 v109, v90, v91
    v_mfma_f32_16x16x32_bf16 a[88:91], a[240:243], v[144:147], a[88:91]
    v_exp_f32 v92, v92
    v_mfma_f32_16x16x32_bf16 a[88:91], a[244:247], v[128:131], a[88:91]
    v_exp_f32 v93, v93
    v_mfma_f32_16x16x32_bf16 a[136:139], a[240:243], v[148:151], a[136:139]
    v_exp_f32 v94, v94
    v_mfma_f32_16x16x32_bf16 a[136:139], a[244:247], v[132:135], a[136:139]
    v_exp_f32 v95, v95
    v_mfma_f32_16x16x32_bf16 a[184:187], a[244:247], v[136:139], a[184:187]
    s_waitcnt lgkmcnt(1)
    v_cvt_pk_bf16_f32 v110, v92, v93
    v_cvt_pk_bf16_f32 v111, v94, v95
    v_mfma_f32_16x16x32_bf16 a[44:47], a[248:251], v[140:143], a[44:47]
    v_add_f32 v22, v22, v91
    v_add_f32 v22, v22, v92
    v_mfma_f32_16x16x32_bf16 a[44:47], a[252:255], v[124:127], a[44:47]
    v_add_f32 v22, v22, v93
    v_add_f32 v22, v22, v94
    v_mfma_f32_16x16x32_bf16 a[92:95], a[248:251], v[144:147], a[92:95]
    v_add_f32 v22, v22, v95
    v_max_f32 v28, v28, v22
    v_mfma_f32_16x16x32_bf16 a[92:95], a[252:255], v[128:131], a[92:95]
    buffer_store_dwordx4 v[32:35], v23, s[80:83], s84 offen nt
    v_mfma_f32_16x16x32_bf16 a[140:143], a[248:251], v[148:151], a[140:143]
    v_mfma_f32_16x16x32_bf16 a[140:143], a[252:255], v[132:135], a[140:143]
    v_mfma_f32_16x16x32_bf16 a[188:191], a[252:255], v[136:139], a[188:191]
    v_mfma_f32_16x16x32_bf16 v[64:67], a[192:195], v[160:163], v[48:51]
    v_mfma_f32_16x16x32_bf16 v[64:67], a[196:199], v[164:167], v[64:67]
    ds_read_b32 v30, v46
    v_mfma_f32_16x16x32_bf16 v[64:67], a[200:203], v[168:171], v[64:67]
    v_mfma_f32_16x16x32_bf16 v[64:67], a[204:207], v[172:175], v[64:67]
    buffer_store_dwordx4 v[36:39], v23, s[80:83], s84 offen offset:128 nt
    v_mfma_f32_16x16x32_bf16 v[64:67], a[208:211], v[176:179], v[64:67]
    v_mfma_f32_16x16x32_bf16 v[64:67], a[212:215], v[180:183], v[64:67]
    v_mfma_f32_16x16x32_bf16 v[72:75], a[192:195], v[184:187], v[52:55]
    buffer_store_dwordx4 v[40:43], v23, s[80:83], s84 offen offset:256 nt
    v_mfma_f32_16x16x32_bf16 v[72:75], a[196:199], v[188:191], v[72:75]
    s_add_u32 s84, s84, s87
    v_cmp_lt_f32 vcc, s35, v28
    v_mfma_f32_16x16x32_bf16 v[72:75], a[200:203], v[192:195], v[72:75]
    s_waitcnt lgkmcnt(0)
    v_cmp_gt_u32 s[94:95], s93, v30
    v_mfma_f32_16x16x32_bf16 v[72:75], a[204:207], v[196:199], v[72:75]
    s_add_u32 m0, s33, 74624
    v_exp_f32 v64, v64
    v_mfma_f32_16x16x32_bf16 v[72:75], a[208:211], v[200:203], v[72:75]
    s_or_b64 vcc, vcc, s[94:95]
    v_exp_f32 v65, v65
    v_mfma_f32_16x16x32_bf16 v[72:75], a[212:215], v[204:207], v[72:75]
    s_cbranch_vccnz L_b11_5cs_rare
L_b11_5cs_back:
    ds_read_b64_tr_b16 v[152:153], v4
    v_cvt_pk_bf16_f32 v140, v64, v65
    v_mfma_f32_16x16x32_bf16 v[80:83], a[192:195], v[208:211], v[56:59]
    s_add_u32 s93, s93, 4
    buffer_load_dwordx4 v9, s[20:23], s30 offen offset:128 nt lds
    v_mfma_f32_16x16x32_bf16 v[80:83], a[196:199], v[212:215], v[80:83]
    ds_read_b128 a[192:195], v2 offset:36864
    v_add_f32 v12, v12, v16
    v_mfma_f32_16x16x32_bf16 v[80:83], a[200:203], v[216:219], v[80:83]
    ds_read_b64_tr_b16 v[154:155], v4 offset:6144
    v_add_f32 v13, v13, v17
    v_mfma_f32_16x16x32_bf16 v[80:83], a[204:207], v[220:223], v[80:83]
    ds_read_b128 a[196:199], v3 offset:36864
    v_add_f32 v14, v14, v18
    v_mfma_f32_16x16x32_bf16 v[80:83], a[208:211], v[224:227], v[80:83]
    ds_read_b64_tr_b16 v[156:157], v4 offset:12288
    v_add_f32 v15, v15, v22
    v_mfma_f32_16x16x32_bf16 v[80:83], a[212:215], v[228:231], v[80:83]
    s_add_u32 m0, s33, 75520
    ds_read_b128 a[200:203], v2 offset:37888
    v_add_f32 v19, v64, v65
    v_mfma_f32_16x16x32_bf16 v[68:71], a[216:219], v[160:163], v[48:51]
    buffer_load_dwordx4 v9, s[20:23], s30 offen offset:256 nt lds
    v_mfma_f32_16x16x32_bf16 v[68:71], a[220:223], v[164:167], v[68:71]
    v_exp_f32 v66, v66
    v_mfma_f32_16x16x32_bf16 v[68:71], a[224:227], v[168:171], v[68:71]
    ds_read_b64_tr_b16 v[158:159], v4 offset:18432
    v_add_f32 v19, v19, v66
    v_mfma_f32_16x16x32_bf16 v[68:71], a[228:231], v[172:175], v[68:71]
    v_exp_f32 v67, v67
    v_mfma_f32_16x16x32_bf16 v[68:71], a[232:235], v[176:179], v[68:71]
    ds_read_b128 a[204:207], v3 offset:37888
    v_cvt_pk_bf16_f32 v141, v66, v67
    v_mfma_f32_16x16x32_bf16 v[68:71], a[236:239], v[180:183], v[68:71]
    s_add_u32 m0, s33, 86912
    ds_read_b64_tr_b16 a[240:241], v5
    v_add_f32 v19, v19, v67
    v_mfma_f32_16x16x32_bf16 v[76:79], a[216:219], v[184:187], v[52:55]
    buffer_load_dwordx4 v9, s[20:23], s32 offen offset:128 nt lds
    v_mfma_f32_16x16x32_bf16 v[76:79], a[220:223], v[188:191], v[76:79]
    v_exp_f32 v72, v72
    v_mfma_f32_16x16x32_bf16 v[76:79], a[224:227], v[192:195], v[76:79]
    v_exp_f32 v73, v73
    v_mfma_f32_16x16x32_bf16 v[76:79], a[228:231], v[196:199], v[76:79]
    ds_read_b128 a[208:211], v2 offset:38912
    v_cvt_pk_bf16_f32 v144, v72, v73
    v_mfma_f32_16x16x32_bf16 v[76:79], a[232:235], v[200:203], v[76:79]
    ds_read_b64_tr_b16 a[242:243], v5 offset:6144
    v_add_f32 v20, v72, v73
    v_mfma_f32_16x16x32_bf16 v[76:79], a[236:239], v[204:207], v[76:79]
    s_add_u32 m0, s33, 87808
    v_exp_f32 v74, v74
    v_mfma_f32_16x16x32_bf16 v[84:87], a[216:219], v[208:211], v[56:59]
    buffer_load_dwordx4 v9, s[20:23], s32 offen offset:256 nt lds
    v_mfma_f32_16x16x32_bf16 v[84:87], a[220:223], v[212:215], v[84:87]
    s_add_u32 s30, s30, 24576
    ds_read_b128 a[212:215], v3 offset:38912
    v_add_f32 v20, v20, v74
    v_mfma_f32_16x16x32_bf16 v[84:87], a[224:227], v[216:219], v[84:87]
    s_add_u32 s32, s32, 24576
    ds_read_b64_tr_b16 a[244:245], v5 offset:12288
    ds_read_b64_tr_b16 a[246:247], v5 offset:18432
    v_mfma_f32_16x16x32_bf16 v[84:87], a[228:231], v[220:223], v[84:87]
    v_exp_f32 v75, v75
    v_mfma_f32_16x16x32_bf16 v[84:87], a[232:235], v[224:227], v[84:87]
    s_add_u32 m0, s33, 24576
    ds_read_b128 a[216:219], v2 offset:43008
    v_cvt_pk_bf16_f32 v145, v74, v75
    v_mfma_f32_16x16x32_bf16 v[84:87], a[236:239], v[228:231], v[84:87]
    s_waitcnt lgkmcnt(4)
    ds_read_b64_tr_b16 a[248:249], v6
    v_add_f32 v20, v20, v75
    v_mfma_f32_16x16x32_bf16 a[0:3], v[152:155], v[112:115], a[0:3]
    buffer_load_dwordx4 v8, s[16:19], s29 offen nt lds
    v_mfma_f32_16x16x32_bf16 a[0:3], v[156:159], v[96:99], a[0:3]
    ds_read_b128 a[220:223], v3 offset:43008
    v_mfma_f32_16x16x32_bf16 a[48:51], v[152:155], v[116:119], a[48:51]
    ds_read_b64_tr_b16 a[250:251], v6 offset:6144
    ds_read_b64_tr_b16 a[252:253], v6 offset:12288
    v_mfma_f32_16x16x32_bf16 a[48:51], v[156:159], v[100:103], a[48:51]
    ds_read_b64_tr_b16 a[254:255], v6 offset:18432
    v_mfma_f32_16x16x32_bf16 a[96:99], v[152:155], v[120:123], a[96:99]
    ds_read_b128 a[224:227], v2 offset:44032
    v_mfma_f32_16x16x32_bf16 a[96:99], v[156:159], v[104:107], a[96:99]
    s_add_u32 m0, s33, 25472
    v_exp_f32 v80, v80
    v_mfma_f32_16x16x32_bf16 a[144:147], v[156:159], v[108:111], a[144:147]
    buffer_load_dwordx4 v8, s[16:19], s29 offen offset:128 nt lds
    v_mfma_f32_16x16x32_bf16 a[4:7], a[240:243], v[112:115], a[4:7]
    s_waitcnt lgkmcnt(5)
    ds_read_b128 a[228:231], v3 offset:44032
    v_mfma_f32_16x16x32_bf16 a[4:7], a[244:247], v[96:99], a[4:7]
    v_exp_f32 v81, v81
    v_mfma_f32_16x16x32_bf16 a[52:55], a[240:243], v[116:119], a[52:55]
    ds_read_b64_tr_b16 v[152:153], v7
    v_cvt_pk_bf16_f32 v148, v80, v81
    v_mfma_f32_16x16x32_bf16 a[52:55], a[244:247], v[100:103], a[52:55]
    ds_read_b64_tr_b16 v[154:155], v7 offset:6144
    v_add_f32 v21, v80, v81
    v_mfma_f32_16x16x32_bf16 a[100:103], a[240:243], v[120:123], a[100:103]
    ds_read_b64_tr_b16 v[156:157], v7 offset:12288
    ds_read_b64_tr_b16 v[158:159], v7 offset:18432
    v_mfma_f32_16x16x32_bf16 a[100:103], a[244:247], v[104:107], a[100:103]
    s_add_u32 m0, s33, 26368
    ds_read_b128 a[232:235], v2 offset:45056
    v_mfma_f32_16x16x32_bf16 a[148:151], a[244:247], v[108:111], a[148:151]
    s_waitcnt lgkmcnt(6)
    buffer_load_dwordx4 v8, s[16:19], s29 offen offset:256 nt lds
    v_mfma_f32_16x16x32_bf16 a[8:11], a[248:251], v[112:115], a[8:11]
    s_add_u32 s29, s29, 12288
    ds_read_b128 a[236:239], v3 offset:45056
    v_mfma_f32_16x16x32_bf16 a[8:11], a[252:255], v[96:99], a[8:11]
    s_waitcnt vmcnt(15)
    ds_inc_u32 v46, v46
    v_mfma_f32_16x16x32_bf16 a[56:59], a[248:251], v[116:119], a[56:59]
    v_exp_f32 v82, v82
    v_mfma_f32_16x16x32_bf16 a[56:59], a[252:255], v[100:103], a[56:59]
    v_exp_f32 v83, v83
    v_mfma_f32_16x16x32_bf16 a[104:107], a[248:251], v[120:123], a[104:107]
    v_cvt_pk_bf16_f32 v149, v82, v83
    v_add_f32 v21, v21, v82
    v_mfma_f32_16x16x32_bf16 a[104:107], a[252:255], v[104:107], a[104:107]
    v_exp_f32 v68, v68
    v_mfma_f32_16x16x32_bf16 a[152:155], a[252:255], v[108:111], a[152:155]
    s_waitcnt lgkmcnt(2)
    v_add_f32 v21, v21, v83
    v_add_f32 v19, v19, v68
    v_mfma_f32_16x16x32_bf16 a[12:15], v[152:155], v[112:115], a[12:15]
    v_exp_f32 v69, v69
    v_mfma_f32_16x16x32_bf16 a[12:15], v[156:159], v[96:99], a[12:15]
    v_exp_f32 v70, v70
    v_mfma_f32_16x16x32_bf16 a[60:63], v[152:155], v[116:119], a[60:63]
    v_exp_f32 v71, v71
    v_mfma_f32_16x16x32_bf16 a[60:63], v[156:159], v[100:103], a[60:63]
    v_cvt_pk_bf16_f32 v142, v68, v69
    v_cvt_pk_bf16_f32 v143, v70, v71
    v_mfma_f32_16x16x32_bf16 a[108:111], v[152:155], v[120:123], a[108:111]
    v_add_f32 v19, v19, v69
    v_add_f32 v19, v19, v70
    v_mfma_f32_16x16x32_bf16 a[108:111], v[156:159], v[104:107], a[108:111]
    v_exp_f32 v76, v76
    v_mfma_f32_16x16x32_bf16 a[156:159], v[156:159], v[108:111], a[156:159]
    v_add_f32 v19, v19, v71
    v_add_f32 v20, v20, v76
    v_mfma_f32_16x16x32_bf16 v[64:67], a[192:195], v[160:163], v[48:51]
    v_exp_f32 v77, v77
    v_mfma_f32_16x16x32_bf16 v[64:67], a[196:199], v[164:167], v[64:67]
    v_exp_f32 v78, v78
    v_mfma_f32_16x16x32_bf16 v[64:67], a[200:203], v[168:171], v[64:67]
    v_exp_f32 v79, v79
    v_mfma_f32_16x16x32_bf16 v[64:67], a[204:207], v[172:175], v[64:67]
    v_cvt_pk_bf16_f32 v146, v76, v77
    v_cvt_pk_bf16_f32 v147, v78, v79
    v_mfma_f32_16x16x32_bf16 v[64:67], a[208:211], v[176:179], v[64:67]
    v_add_f32 v20, v20, v77
    v_add_f32 v20, v20, v78
    v_mfma_f32_16x16x32_bf16 v[64:67], a[212:215], v[180:183], v[64:67]
    v_exp_f32 v84, v84
    v_mfma_f32_16x16x32_bf16 v[72:75], a[192:195], v[184:187], v[52:55]
    v_add_f32 v20, v20, v79
    v_add_f32 v21, v21, v84
    v_mfma_f32_16x16x32_bf16 v[72:75], a[196:199], v[188:191], v[72:75]
    v_exp_f32 v85, v85
    v_mfma_f32_16x16x32_bf16 v[72:75], a[200:203], v[192:195], v[72:75]
    v_exp_f32 v86, v86
    v_mfma_f32_16x16x32_bf16 v[72:75], a[204:207], v[196:199], v[72:75]
    v_exp_f32 v87, v87
    v_mfma_f32_16x16x32_bf16 v[72:75], a[208:211], v[200:203], v[72:75]
    v_cvt_pk_bf16_f32 v150, v84, v85
    v_cvt_pk_bf16_f32 v151, v86, v87
    v_mfma_f32_16x16x32_bf16 v[72:75], a[212:215], v[204:207], v[72:75]
    v_add_f32 v21, v21, v85
    v_add_f32 v21, v21, v86
    v_mfma_f32_16x16x32_bf16 v[80:83], a[192:195], v[208:211], v[56:59]
    v_exp_f32 v64, v64
    v_mfma_f32_16x16x32_bf16 v[80:83], a[196:199], v[212:215], v[80:83]
    ds_read_b32 v30, v46
    v_add_f32 v21, v21, v87
    v_mfma_f32_16x16x32_bf16 v[80:83], a[200:203], v[216:219], v[80:83]
    v_exp_f32 v65, v65
    v_mfma_f32_16x16x32_bf16 v[80:83], a[204:207], v[220:223], v[80:83]
    v_exp_f32 v66, v66
    v_mfma_f32_16x16x32_bf16 v[80:83], a[208:211], v[224:227], v[80:83]
    v_exp_f32 v67, v67
    v_mfma_f32_16x16x32_bf16 v[80:83], a[212:215], v[228:231], v[80:83]
    v_cvt_pk_bf16_f32 v124, v64, v65
    v_cvt_pk_bf16_f32 v125, v66, v67
    v_mfma_f32_16x16x32_bf16 v[88:91], a[192:195], v[232:235], v[60:63]
    v_add_f32 v19, v19, v64
    v_add_f32 v19, v19, v65
    v_mfma_f32_16x16x32_bf16 v[88:91], a[196:199], v[236:239], v[88:91]
    v_add_f32 v19, v19, v66
    v_add_f32 v19, v19, v67
    v_mfma_f32_16x16x32_bf16 v[88:91], a[200:203], v[240:243], v[88:91]
    s_waitcnt lgkmcnt(0)
    v_cmp_gt_u32 vcc, s93, v30
    v_mfma_f32_16x16x32_bf16 v[88:91], a[204:207], v[244:247], v[88:91]
    v_exp_f32 v72, v72
    v_mfma_f32_16x16x32_bf16 v[88:91], a[208:211], v[248:251], v[88:91]
    s_add_u32 m0, s33, 49152
    v_exp_f32 v73, v73
    v_mfma_f32_16x16x32_bf16 v[88:91], a[212:215], v[252:255], v[88:91]
    s_cbranch_vccnz L_b11_6s_rare
L_b11_6s_back:
    ds_read_b64_tr_b16 a[240:241], v4 offset:1024
    v_cvt_pk_bf16_f32 v128, v72, v73
    v_mfma_f32_16x16x32_bf16 v[68:71], a[216:219], v[160:163], v[48:51]
    s_add_u32 s93, s93, 4
    buffer_load_dwordx4 v9, s[20:23], s30 offen nt lds
    v_mfma_f32_16x16x32_bf16 v[68:71], a[220:223], v[164:167], v[68:71]
    ds_read_b64_tr_b16 a[242:243], v4 offset:7168
    v_add_f32 v20, v20, v72
    v_mfma_f32_16x16x32_bf16 v[68:71], a[224:227], v[168:171], v[68:71]
    ds_read_b64_tr_b16 a[244:245], v4 offset:13312
    v_add_f32 v20, v20, v73
    v_mfma_f32_16x16x32_bf16 v[68:71], a[228:231], v[172:175], v[68:71]
    v_exp_f32 v74, v74
    v_mfma_f32_16x16x32_bf16 v[68:71], a[232:235], v[176:179], v[68:71]
    ds_read_b64_tr_b16 a[246:247], v4 offset:19456
    v_add_f32 v20, v20, v74
    v_mfma_f32_16x16x32_bf16 v[68:71], a[236:239], v[180:183], v[68:71]
    v_exp_f32 v75, v75
    v_mfma_f32_16x16x32_bf16 v[76:79], a[216:219], v[184:187], v[52:55]
    ds_read_b64_tr_b16 a[248:249], v5 offset:1024
    v_cvt_pk_bf16_f32 v129, v74, v75
    v_mfma_f32_16x16x32_bf16 v[76:79], a[220:223], v[188:191], v[76:79]
    ds_read_b64_tr_b16 a[250:251], v5 offset:7168
    v_add_f32 v20, v20, v75
    v_mfma_f32_16x16x32_bf16 v[76:79], a[224:227], v[192:195], v[76:79]
    v_exp_f32 v80, v80
    v_mfma_f32_16x16x32_bf16 v[76:79], a[228:231], v[196:199], v[76:79]
    s_add_u32 m0, s33, 61440
    ds_read_b64_tr_b16 a[252:253], v5 offset:13312
    v_add_f32 v21, v21, v80
    v_mfma_f32_16x16x32_bf16 v[76:79], a[232:235], v[200:203], v[76:79]
    buffer_load_dwordx4 v9, s[20:23], s32 offen nt lds
    v_mfma_f32_16x16x32_bf16 v[76:79], a[236:239], v[204:207], v[76:79]
    v_exp_f32 v68, v68
    v_mfma_f32_16x16x32_bf16 v[84:87], a[216:219], v[208:211], v[56:59]
    ds_read_b64_tr_b16 a[254:255], v5 offset:19456
    v_add_f32 v19, v19, v68
    v_mfma_f32_16x16x32_bf16 v[84:87], a[220:223], v[212:215], v[84:87]
    v_exp_f32 v69, v69
    v_mfma_f32_16x16x32_bf16 v[84:87], a[224:227], v[216:219], v[84:87]
    ds_read_b64_tr_b16 v[152:153], v6 offset:1024
    v_cvt_pk_bf16_f32 v126, v68, v69
    v_mfma_f32_16x16x32_bf16 v[84:87], a[228:231], v[220:223], v[84:87]
    ds_read_b64_tr_b16 v[154:155], v6 offset:7168
    v_add_f32 v19, v19, v69
    v_mfma_f32_16x16x32_bf16 v[84:87], a[232:235], v[224:227], v[84:87]
    v_exp_f32 v70, v70
    v_mfma_f32_16x16x32_bf16 v[84:87], a[236:239], v[228:231], v[84:87]
    ds_read_b64_tr_b16 v[156:157], v6 offset:13312
    v_add_f32 v19, v19, v70
    v_mfma_f32_16x16x32_bf16 v[92:95], a[216:219], v[232:235], v[60:63]
    v_exp_f32 v71, v71
    v_mfma_f32_16x16x32_bf16 v[92:95], a[220:223], v[236:239], v[92:95]
    s_add_u32 m0, s33, 36864
    ds_read_b64_tr_b16 v[158:159], v6 offset:19456
    v_cvt_pk_bf16_f32 v127, v70, v71
    v_mfma_f32_16x16x32_bf16 v[92:95], a[224:227], v[240:243], v[92:95]
    buffer_load_dwordx4 v8, s[16:19], s29 offen nt lds
    v_mfma_f32_16x16x32_bf16 v[92:95], a[228:231], v[244:247], v[92:95]
    ds_read_b128 a[192:195], v2
    v_add_f32 v19, v19, v71
    v_mfma_f32_16x16x32_bf16 v[92:95], a[232:235], v[248:251], v[92:95]
    v_exp_f32 v76, v76
    v_mfma_f32_16x16x32_bf16 v[92:95], a[236:239], v[252:255], v[92:95]
    s_waitcnt lgkmcnt(3)
    ds_read_b128 a[196:199], v3
    v_add_f32 v20, v20, v76
    v_mfma_f32_16x16x32_bf16 a[16:19], a[240:243], v[112:115], a[16:19]
    v_exp_f32 v77, v77
    v_mfma_f32_16x16x32_bf16 a[16:19], a[244:247], v[96:99], a[16:19]
    ds_read_b128 a[200:203], v2 offset:1024
    v_cvt_pk_bf16_f32 v130, v76, v77
    v_mfma_f32_16x16x32_bf16 a[64:67], a[240:243], v[116:119], a[64:67]
    v_exp_f32 v78, v78
    v_mfma_f32_16x16x32_bf16 a[64:67], a[244:247], v[100:103], a[64:67]
    ds_read_b128 a[204:207], v3 offset:1024
    v_add_f32 v20, v20, v77
    v_mfma_f32_16x16x32_bf16 a[112:115], a[240:243], v[120:123], a[112:115]
    ds_read_b64_tr_b16 a[240:241], v7 offset:1024
    v_add_f32 v20, v20, v78
    v_mfma_f32_16x16x32_bf16 a[112:115], a[244:247], v[104:107], a[112:115]
    s_add_u32 m0, s33, 37760
    v_exp_f32 v79, v79
    v_mfma_f32_16x16x32_bf16 a[160:163], a[244:247], v[108:111], a[160:163]
    buffer_load_dwordx4 v8, s[16:19], s29 offen offset:128 nt lds
    v_mfma_f32_16x16x32_bf16 a[20:23], a[248:251], v[112:115], a[20:23]
    ds_read_b64_tr_b16 a[242:243], v7 offset:7168
    v_cvt_pk_bf16_f32 v131, v78, v79
    v_mfma_f32_16x16x32_bf16 a[20:23], a[252:255], v[96:99], a[20:23]
    ds_read_b64_tr_b16 a[244:245], v7 offset:13312
    v_add_f32 v20, v20, v79
    v_mfma_f32_16x16x32_bf16 a[68:71], a[248:251], v[116:119], a[68:71]
    v_exp_f32 v81, v81
    v_mfma_f32_16x16x32_bf16 a[68:71], a[252:255], v[100:103], a[68:71]
    ds_read_b64_tr_b16 a[246:247], v7 offset:19456
    v_cvt_pk_bf16_f32 v132, v80, v81
    v_mfma_f32_16x16x32_bf16 a[116:119], a[248:251], v[120:123], a[116:119]
    ds_read_b64_tr_b16 a[248:249], v4 offset:2048
    v_add_f32 v21, v21, v81
    v_mfma_f32_16x16x32_bf16 a[116:119], a[252:255], v[104:107], a[116:119]
    v_exp_f32 v82, v82
    v_mfma_f32_16x16x32_bf16 a[164:167], a[252:255], v[108:111], a[164:167]
    ds_read_b64_tr_b16 a[250:251], v4 offset:8192
    v_add_f32 v21, v21, v82
    v_mfma_f32_16x16x32_bf16 a[24:27], v[152:155], v[112:115], a[24:27]
    s_waitcnt lgkmcnt(4)
    v_exp_f32 v83, v83
    v_mfma_f32_16x16x32_bf16 a[24:27], v[156:159], v[96:99], a[24:27]
    s_add_u32 m0, s33, 38656
    ds_read_b64_tr_b16 a[252:253], v4 offset:14336
    v_cvt_pk_bf16_f32 v133, v82, v83
    v_mfma_f32_16x16x32_bf16 a[72:75], v[152:155], v[116:119], a[72:75]
    buffer_load_dwordx4 v8, s[16:19], s29 offen offset:256 nt lds
    v_mfma_f32_16x16x32_bf16 a[72:75], v[156:159], v[100:103], a[72:75]
    s_add_u32 s29, s29, 12288
    ds_read_b64_tr_b16 a[254:255], v4 offset:20480
    v_add_f32 v21, v21, v83
    v_mfma_f32_16x16x32_bf16 a[120:123], v[152:155], v[120:123], a[120:123]
    v_exp_f32 v84, v84
    v_mfma_f32_16x16x32_bf16 a[120:123], v[156:159], v[104:107], a[120:123]
    ds_read_b128 a[208:211], v2 offset:2048
    v_add_f32 v21, v21, v84
    v_mfma_f32_16x16x32_bf16 a[168:171], v[156:159], v[108:111], a[168:171]
    v_exp_f32 v85, v85
    v_mfma_f32_16x16x32_bf16 a[28:31], a[240:243], v[112:115], a[28:31]
    s_waitcnt lgkmcnt(3)
    ds_read_b64_tr_b16 v[152:153], v5 offset:2048
    v_cvt_pk_bf16_f32 v134, v84, v85
    v_mfma_f32_16x16x32_bf16 a[28:31], a[244:247], v[96:99], a[28:31]
    ds_read_b64_tr_b16 v[154:155], v5 offset:8192
    v_add_f32 v21, v21, v85
    v_mfma_f32_16x16x32_bf16 a[76:79], a[240:243], v[116:119], a[76:79]
    ds_read_b128 a[212:215], v3 offset:2048
    v_mfma_f32_16x16x32_bf16 a[76:79], a[244:247], v[100:103], a[76:79]
    ds_read_b64_tr_b16 v[156:157], v5 offset:14336
    ds_read_b64_tr_b16 v[158:159], v5 offset:20480
    v_mfma_f32_16x16x32_bf16 a[124:127], a[240:243], v[120:123], a[124:127]
    v_exp_f32 v86, v86
    v_mfma_f32_16x16x32_bf16 a[124:127], a[244:247], v[104:107], a[124:127]
    ds_read_b128 a[216:219], v2 offset:6144
    v_add_f32 v21, v21, v86
    v_mfma_f32_16x16x32_bf16 a[172:175], a[244:247], v[108:111], a[172:175]
    v_exp_f32 v87, v87
    v_mfma_f32_16x16x32_bf16 a[32:35], a[248:251], v[112:115], a[32:35]
    s_waitcnt lgkmcnt(5)
    ds_read_b128 a[220:223], v3 offset:6144
    v_cvt_pk_bf16_f32 v135, v86, v87
    v_mfma_f32_16x16x32_bf16 a[32:35], a[252:255], v[96:99], a[32:35]
    ds_read_b64_tr_b16 a[240:241], v6 offset:2048
    v_add_f32 v21, v21, v87
    v_mfma_f32_16x16x32_bf16 a[80:83], a[248:251], v[116:119], a[80:83]
    ds_read_b64_tr_b16 a[242:243], v6 offset:8192
    v_max3_f32 v28, v19, v20, v21
    v_mfma_f32_16x16x32_bf16 a[80:83], a[252:255], v[100:103], a[80:83]
    ds_read_b64_tr_b16 a[244:245], v6 offset:14336
    ds_read_b64_tr_b16 a[246:247], v6 offset:20480
    v_mfma_f32_16x16x32_bf16 a[128:131], a[248:251], v[120:123], a[128:131]
    ds_read_b128 a[224:227], v2 offset:7168
    v_mfma_f32_16x16x32_bf16 a[128:131], a[252:255], v[104:107], a[128:131]
    v_exp_f32 v88, v88
    v_mfma_f32_16x16x32_bf16 a[176:179], a[252:255], v[108:111], a[176:179]
    s_waitcnt lgkmcnt(6)
    v_exp_f32 v89, v89
    v_mfma_f32_16x16x32_bf16 a[36:39], v[152:155], v[112:115], a[36:39]
    ds_read_b128 a[228:231], v3 offset:7168
    v_cvt_pk_bf16_f32 v136, v88, v89
    v_mfma_f32_16x16x32_bf16 a[36:39], v[156:159], v[96:99], a[36:39]
    ds_read_b64_tr_b16 a[248:249], v7 offset:2048
    v_add_f32 v22, v88, v89
    v_mfma_f32_16x16x32_bf16 a[84:87], v[152:155], v[116:119], a[84:87]
    ds_read_b64_tr_b16 a[250:251], v7 offset:8192
    ds_read_b64_tr_b16 a[252:253], v7 offset:14336
    v_mfma_f32_16x16x32_bf16 a[84:87], v[156:159], v[100:103], a[84:87]
    ds_read_b64_tr_b16 a[254:255], v7 offset:20480
    v_mfma_f32_16x16x32_bf16 a[132:135], v[152:155], v[120:123], a[132:135]
    ds_read_b128 a[232:235], v2 offset:8192
    v_mfma_f32_16x16x32_bf16 a[132:135], v[156:159], v[104:107], a[132:135]
    v_exp_f32 v90, v90
    v_mfma_f32_16x16x32_bf16 a[180:183], v[156:159], v[108:111], a[180:183]
    s_waitcnt lgkmcnt(6)
    ds_read_b128 a[236:239], v3 offset:8192
    v_add_f32 v22, v22, v90
    v_mfma_f32_16x16x32_bf16 a[40:43], a[240:243], v[112:115], a[40:43]
    v_exp_f32 v91, v91
    v_mfma_f32_16x16x32_bf16 a[40:43], a[244:247], v[96:99], a[40:43]
    s_waitcnt vmcnt(15)
    ds_inc_u32 v46, v46
    v_cvt_pk_bf16_f32 v137, v90, v91
    v_mfma_f32_16x16x32_bf16 a[88:91], a[240:243], v[116:119], a[88:91]
    v_exp_f32 v92, v92
    v_mfma_f32_16x16x32_bf16 a[88:91], a[244:247], v[100:103], a[88:91]
    v_exp_f32 v93, v93
    v_mfma_f32_16x16x32_bf16 a[136:139], a[240:243], v[120:123], a[136:139]
    v_exp_f32 v94, v94
    v_mfma_f32_16x16x32_bf16 a[136:139], a[244:247], v[104:107], a[136:139]
    v_exp_f32 v95, v95
    v_mfma_f32_16x16x32_bf16 a[184:187], a[244:247], v[108:111], a[184:187]
    s_waitcnt lgkmcnt(1)
    v_cvt_pk_bf16_f32 v138, v92, v93
    v_cvt_pk_bf16_f32 v139, v94, v95
    v_mfma_f32_16x16x32_bf16 a[44:47], a[248:251], v[112:115], a[44:47]
    v_add_f32 v22, v22, v91
    v_add_f32 v22, v22, v92
    v_mfma_f32_16x16x32_bf16 a[44:47], a[252:255], v[96:99], a[44:47]
    v_add_f32 v22, v22, v93
    v_add_f32 v22, v22, v94
    v_mfma_f32_16x16x32_bf16 a[92:95], a[248:251], v[116:119], a[92:95]
    v_add_f32 v22, v22, v95
    v_max_f32 v28, v28, v22
    v_mfma_f32_16x16x32_bf16 a[92:95], a[252:255], v[100:103], a[92:95]
    v_mfma_f32_16x16x32_bf16 a[140:143], a[248:251], v[120:123], a[140:143]
    v_mfma_f32_16x16x32_bf16 a[140:143], a[252:255], v[104:107], a[140:143]
    v_mfma_f32_16x16x32_bf16 a[188:191], a[252:255], v[108:111], a[188:191]
    s_sub_u32 s31, s31, 1
    s_cbranch_scc0 L_loop_11
L_after_11:
    s_waitcnt vmcnt(8) lgkmcnt(0)
    s_barrier
    s_add_u32 s93, s93, 4
    s_mov_b32 s48, s90
    s_xor_b32 s49, s90, 16384
    s_add_u32 s50, s90, 256
    s_add_u32 s51, s90, 6656
    ds_read_b64_tr_b16 v[152:153], v4 offset:24576
    ds_read_b64_tr_b16 v[154:155], v4 offset:30720
    ds_read_b64_tr_b16 v[156:157], v4 offset:36864
    ds_read_b64_tr_b16 v[158:159], v4 offset:43008
    ds_read_b64_tr_b16 a[240:241], v5 offset:24576
    ds_read_b64_tr_b16 a[242:243], v5 offset:30720
    ds_read_b64_tr_b16 a[244:245], v5 offset:36864
    ds_read_b64_tr_b16 a[246:247], v5 offset:43008
    v_cmp_lt_f32 vcc, s35, v28
    s_nop 3
    s_cbranch_vccnz L_t11_31c_rare
L_t11_31c_back:
    s_mov_b32 s54, 6144
    s_mov_b32 s55, 12288
    v_lshl_add_u32 v36, v1, 4, s48
    v_add_f32 v12, v12, v19
    v_add_f32 v13, v13, v20
    v_add_f32 v14, v14, v21
    v_add_f32 v15, v15, v22
    v_and_b32 v45, 15, v1
    v_mul_u32_u24 v45, 400, v45
    v_mov_b32 v32, v12
    s_nop 1
    v_permlane32_swap_b32 v12, v32
    v_add_f32 v12, v12, v32
    v_mov_b32 v32, v12
    s_nop 1
    v_permlane16_swap_b32 v12, v32
    v_add_f32 v12, v12, v32
    v_rcp_f32 v40, v12
    v_lshrrev_b32 v29, 4, v1
    v_lshl_add_u32 v45, v29, 3, v45
    v_add_u32 v28, s51, v45
    v_lshrrev_b32 v45, 3, v1
    v_mov_b32 v33, v13
    s_nop 1
    v_permlane32_swap_b32 v13, v33
    v_add_f32 v13, v13, v33
    v_mov_b32 v33, v13
    s_nop 1
    v_permlane16_swap_b32 v13, v33
    v_add_f32 v13, v13, v33
    v_and_b32 v29, 7, v1
    s_waitcnt lgkmcnt(6)
    v_mfma_f32_16x16x32_bf16 a[0:3], v[152:155], v[140:143], a[0:3]
    s_waitcnt lgkmcnt(4)
    ds_read_b64_tr_b16 a[248:249], v6 offset:24576
    v_lshlrev_b32 v29, 4, v29
    v_mfma_f32_16x16x32_bf16 a[0:3], v[156:159], v[124:127], a[0:3]
    ds_read_b64_tr_b16 a[250:251], v6 offset:30720
    v_mul_u32_u24 v30, 400, v45
    v_mfma_f32_16x16x32_bf16 a[48:51], v[152:155], v[144:147], a[48:51]
    ds_read_b64_tr_b16 a[252:253], v6 offset:36864
    v_add3_u32 v30, v30, v29, s50
    v_mfma_f32_16x16x32_bf16 a[48:51], v[156:159], v[128:131], a[48:51]
    ds_read_b64_tr_b16 a[254:255], v6 offset:43008
    v_mov_b32 v34, v14
    v_mfma_f32_16x16x32_bf16 a[96:99], v[152:155], v[148:151], a[96:99]
    ds_read_b64_tr_b16 v[152:153], v7 offset:24576
    v_mul_u32_u24 v31, 384, v45
    v_mfma_f32_16x16x32_bf16 a[96:99], v[156:159], v[132:135], a[96:99]
    ds_read_b64_tr_b16 v[154:155], v7 offset:30720
    v_add3_u32 v31, v31, v29, s37
    v_mfma_f32_16x16x32_bf16 a[144:147], v[156:159], v[136:139], a[144:147]
    s_waitcnt lgkmcnt(6)
    ds_read_b64_tr_b16 v[156:157], v7 offset:36864
    v_add_u32 v29, s38, v11
    v_mfma_f32_16x16x32_bf16 a[4:7], a[240:243], v[140:143], a[4:7]
    ds_read_b64_tr_b16 v[158:159], v7 offset:43008
    v_mov_b32 v35, v15
    v_mfma_f32_16x16x32_bf16 a[4:7], a[244:247], v[124:127], a[4:7]
    v_rcp_f32 v42, v13
    v_mfma_f32_16x16x32_bf16 a[52:55], a[240:243], v[144:147], a[52:55]
    v_permlane32_swap_b32 v14, v34
    v_mfma_f32_16x16x32_bf16 a[52:55], a[244:247], v[128:131], a[52:55]
    v_add_f32 v14, v14, v34
    v_mov_b32 v34, v14
    v_mfma_f32_16x16x32_bf16 a[100:103], a[240:243], v[148:151], a[100:103]
    ds_read_b64_tr_b16 a[240:241], v4 offset:25600
    v_mov_b32 v38, v60
    v_mfma_f32_16x16x32_bf16 a[100:103], a[244:247], v[132:135], a[100:103]
    v_accvgpr_read_b32 v64, a0
    v_mul_f32 v64, v64, v40
    v_accvgpr_read_b32 v65, a1
    v_mul_f32 v65, v65, v40
    v_cvt_pk_bf16_f32 v96, v64, v65
    v_mfma_f32_16x16x32_bf16 a[148:151], a[244:247], v[136:139], a[148:151]
    s_waitcnt lgkmcnt(2)
    v_accvgpr_read_b32 v66, a2
    v_mul_f32 v66, v66, v40
    v_accvgpr_read_b32 v67, a3
    v_mul_f32 v67, v67, v40
    v_cvt_pk_bf16_f32 v97, v66, v67
    v_mfma_f32_16x16x32_bf16 a[8:11], a[248:251], v[140:143], a[8:11]
    v_accvgpr_read_b32 v68, a4
    v_mul_f32 v68, v68, v40
    v_accvgpr_read_b32 v69, a5
    v_mul_f32 v69, v69, v40
    v_cvt_pk_bf16_f32 v98, v68, v69
    v_mfma_f32_16x16x32_bf16 a[8:11], a[252:255], v[124:127], a[8:11]
    v_accvgpr_read_b32 v70, a6
    v_mul_f32 v70, v70, v40
    v_mfma_f32_16x16x32_bf16 a[56:59], a[248:251], v[144:147], a[56:59]
    v_accvgpr_read_b32 v71, a7
    v_mul_f32 v71, v71, v40
    v_cvt_pk_bf16_f32 v99, v70, v71
    v_accvgpr_read_b32 v72, a48
    v_mul_f32 v72, v72, v42
    v_mfma_f32_16x16x32_bf16 a[56:59], a[252:255], v[128:131], a[56:59]
    ds_write2_b64 v28, v[96:97], v[98:99] offset0:0 offset1:4
    v_accvgpr_read_b32 v73, a49
    v_mul_f32 v73, v73, v42
    v_cvt_pk_bf16_f32 v100, v72, v73
    v_accvgpr_read_b32 v74, a50
    v_mul_f32 v74, v74, v42
    v_mfma_f32_16x16x32_bf16 a[104:107], a[248:251], v[148:151], a[104:107]
    v_accvgpr_read_b32 v75, a51
    v_mul_f32 v75, v75, v42
    v_cvt_pk_bf16_f32 v101, v74, v75
    v_mfma_f32_16x16x32_bf16 a[104:107], a[252:255], v[132:135], a[104:107]
    ds_read_b64_tr_b16 a[242:243], v4 offset:31744
    v_accvgpr_read_b32 v76, a52
    v_mul_f32 v76, v76, v42
    v_accvgpr_read_b32 v77, a53
    v_mul_f32 v77, v77, v42
    v_cvt_pk_bf16_f32 v102, v76, v77
    v_mfma_f32_16x16x32_bf16 a[152:155], a[252:255], v[136:139], a[152:155]
    ds_read_b64_tr_b16 a[244:245], v4 offset:37888
    ds_read_b64_tr_b16 a[246:247], v4 offset:44032
    v_permlane16_swap_b32 v14, v34
    v_add_f32 v14, v14, v34
    v_rcp_f32 v44, v14
    v_accvgpr_read_b32 v78, a54
    v_mul_f32 v78, v78, v42
    v_accvgpr_read_b32 v79, a55
    v_mul_f32 v79, v79, v42
    v_cvt_pk_bf16_f32 v103, v78, v79
    v_mfma_f32_16x16x32_bf16 a[12:15], v[152:155], v[140:143], a[12:15]
    s_waitcnt lgkmcnt(4)
    v_accvgpr_read_b32 v80, a96
    v_mul_f32 v80, v80, v44
    v_accvgpr_read_b32 v81, a97
    v_mul_f32 v81, v81, v44
    v_cvt_pk_bf16_f32 v96, v80, v81
    v_mfma_f32_16x16x32_bf16 a[12:15], v[156:159], v[124:127], a[12:15]
    ds_write2_b64 v28, v[100:101], v[102:103] offset0:16 offset1:20
    v_accvgpr_read_b32 v82, a98
    v_mul_f32 v82, v82, v44
    v_mfma_f32_16x16x32_bf16 a[60:63], v[152:155], v[144:147], a[60:63]
    v_accvgpr_read_b32 v83, a99
    v_mul_f32 v83, v83, v44
    v_cvt_pk_bf16_f32 v97, v82, v83
    v_accvgpr_read_b32 v84, a100
    v_mul_f32 v84, v84, v44
    v_mfma_f32_16x16x32_bf16 a[60:63], v[156:159], v[128:131], a[60:63]
    v_accvgpr_read_b32 v85, a101
    v_mul_f32 v85, v85, v44
    v_cvt_pk_bf16_f32 v98, v84, v85
    v_accvgpr_read_b32 v86, a102
    v_mul_f32 v86, v86, v44
    v_mfma_f32_16x16x32_bf16 a[108:111], v[152:155], v[148:151], a[108:111]
    v_accvgpr_read_b32 v87, a103
    v_mul_f32 v87, v87, v44
    v_cvt_pk_bf16_f32 v99, v86, v87
    v_mfma_f32_16x16x32_bf16 a[108:111], v[156:159], v[132:135], a[108:111]
    ds_read_b64_tr_b16 a[248:249], v5 offset:25600
    ds_read_b64_tr_b16 a[250:251], v5 offset:31744
    v_accvgpr_read_b32 v88, a8
    v_mul_f32 v88, v88, v40
    v_accvgpr_read_b32 v89, a9
    v_mul_f32 v89, v89, v40
    v_cvt_pk_bf16_f32 v100, v88, v89
    v_mfma_f32_16x16x32_bf16 a[156:159], v[156:159], v[136:139], a[156:159]
    s_waitcnt lgkmcnt(3)
    ds_read_b64_tr_b16 a[252:253], v5 offset:37888
    ds_read_b64_tr_b16 a[254:255], v5 offset:44032
    ds_write2_b64 v28, v[96:97], v[98:99] offset0:32 offset1:36
    v_accvgpr_read_b32 v90, a10
    v_mul_f32 v90, v90, v40
    v_accvgpr_read_b32 v91, a11
    v_mul_f32 v91, v91, v40
    v_cvt_pk_bf16_f32 v101, v90, v91
    v_mfma_f32_16x16x32_bf16 a[16:19], a[240:243], v[140:143], a[16:19]
    v_accvgpr_read_b32 v92, a12
    v_mul_f32 v92, v92, v40
    v_accvgpr_read_b32 v93, a13
    v_mul_f32 v93, v93, v40
    v_cvt_pk_bf16_f32 v102, v92, v93
    v_mfma_f32_16x16x32_bf16 a[16:19], a[244:247], v[124:127], a[16:19]
    v_accvgpr_read_b32 v94, a14
    v_mul_f32 v94, v94, v40
    v_mfma_f32_16x16x32_bf16 a[64:67], a[240:243], v[144:147], a[64:67]
    v_accvgpr_read_b32 v95, a15
    v_mul_f32 v95, v95, v40
    v_cvt_pk_bf16_f32 v103, v94, v95
    v_accvgpr_read_b32 v64, a56
    v_mul_f32 v64, v64, v42
    v_mfma_f32_16x16x32_bf16 a[64:67], a[244:247], v[128:131], a[64:67]
    ds_write2_b64 v28, v[100:101], v[102:103] offset0:8 offset1:12
    v_accvgpr_read_b32 v65, a57
    v_mul_f32 v65, v65, v42
    v_cvt_pk_bf16_f32 v96, v64, v65
    v_accvgpr_read_b32 v66, a58
    v_mul_f32 v66, v66, v42
    v_mfma_f32_16x16x32_bf16 a[112:115], a[240:243], v[148:151], a[112:115]
    ds_read_b128 v[104:107], v30 offset:6400
    ds_read_b128 v[108:111], v30 offset:9600
    v_accvgpr_read_b32 v67, a59
    v_mul_f32 v67, v67, v42
    v_cvt_pk_bf16_f32 v97, v66, v67
    v_mfma_f32_16x16x32_bf16 a[112:115], a[244:247], v[132:135], a[112:115]
    ds_read_b64_tr_b16 v[152:153], v6 offset:25600
    ds_read_b64_tr_b16 v[154:155], v6 offset:31744
    v_accvgpr_read_b32 v68, a60
    v_mul_f32 v68, v68, v42
    v_accvgpr_read_b32 v69, a61
    v_mul_f32 v69, v69, v42
    v_cvt_pk_bf16_f32 v98, v68, v69
    v_mfma_f32_16x16x32_bf16 a[160:163], a[244:247], v[136:139], a[160:163]
    s_waitcnt lgkmcnt(5)
    ds_read_b64_tr_b16 v[156:157], v6 offset:37888
    ds_read_b64_tr_b16 v[158:159], v6 offset:44032
    v_accvgpr_read_b32 v70, a62
    v_mul_f32 v70, v70, v42
    v_accvgpr_read_b32 v71, a63
    v_mul_f32 v71, v71, v42
    v_cvt_pk_bf16_f32 v99, v70, v71
    v_mfma_f32_16x16x32_bf16 a[20:23], a[248:251], v[140:143], a[20:23]
    v_accvgpr_read_b32 v72, a104
    v_mul_f32 v72, v72, v44
    v_accvgpr_read_b32 v73, a105
    v_mul_f32 v73, v73, v44
    v_cvt_pk_bf16_f32 v100, v72, v73
    v_mfma_f32_16x16x32_bf16 a[20:23], a[252:255], v[124:127], a[20:23]
    s_waitcnt lgkmcnt(5)
    buffer_store_dwordx4 v[104:107], v31, s[24:27], 0 offen nt
    ds_write2_b64 v28, v[96:97], v[98:99] offset0:24 offset1:28
    v_accvgpr_read_b32 v74, a106
    v_mul_f32 v74, v74, v44
    v_mfma_f32_16x16x32_bf16 a[68:71], a[248:251], v[144:147], a[68:71]
    s_waitcnt lgkmcnt(5)
    buffer_store_dwordx4 v[108:111], v31, s[24:27], 0 offen offset:3072 nt
    ds_read_b128 v[112:115], v30 offset:6528
    ds_read_b128 v[116:119], v30 offset:9728
    v_accvgpr_read_b32 v75, a107
    v_mul_f32 v75, v75, v44
    v_cvt_pk_bf16_f32 v101, v74, v75
    v_accvgpr_read_b32 v76, a108
    v_mul_f32 v76, v76, v44
    v_mfma_f32_16x16x32_bf16 a[68:71], a[252:255], v[128:131], a[68:71]
    v_accvgpr_read_b32 v77, a109
    v_mul_f32 v77, v77, v44
    v_cvt_pk_bf16_f32 v102, v76, v77
    v_accvgpr_read_b32 v78, a110
    v_mul_f32 v78, v78, v44
    v_mfma_f32_16x16x32_bf16 a[116:119], a[248:251], v[148:151], a[116:119]
    v_accvgpr_read_b32 v79, a111
    v_mul_f32 v79, v79, v44
    v_cvt_pk_bf16_f32 v103, v78, v79
    v_mfma_f32_16x16x32_bf16 a[116:119], a[252:255], v[132:135], a[116:119]
    ds_read_b64_tr_b16 a[240:241], v7 offset:25600
    ds_read_b64_tr_b16 a[242:243], v7 offset:31744
    v_accvgpr_read_b32 v80, a16
    v_mul_f32 v80, v80, v40
    v_accvgpr_read_b32 v81, a17
    v_mul_f32 v81, v81, v40
    v_cvt_pk_bf16_f32 v96, v80, v81
    v_mfma_f32_16x16x32_bf16 a[164:167], a[252:255], v[136:139], a[164:167]
    s_waitcnt lgkmcnt(3)
    ds_read_b64_tr_b16 a[244:245], v7 offset:37888
    ds_read_b64_tr_b16 a[246:247], v7 offset:44032
    buffer_store_dwordx4 v[112:115], v31, s[24:27], s54 offen nt
    ds_write2_b64 v28, v[100:101], v[102:103] offset0:40 offset1:44
    v_accvgpr_read_b32 v82, a18
    v_mul_f32 v82, v82, v40
    v_accvgpr_read_b32 v83, a19
    v_mul_f32 v83, v83, v40
    v_cvt_pk_bf16_f32 v97, v82, v83
    v_mfma_f32_16x16x32_bf16 a[24:27], v[152:155], v[140:143], a[24:27]
    s_waitcnt lgkmcnt(5)
    buffer_store_dwordx4 v[116:119], v31, s[24:27], s54 offen offset:3072 nt
    ds_read_b128 v[104:107], v30 offset:6656
    ds_read_b128 v[108:111], v30 offset:9856
    v_accvgpr_read_b32 v84, a20
    v_mul_f32 v84, v84, v40
    v_accvgpr_read_b32 v85, a21
    v_mul_f32 v85, v85, v40
    v_cvt_pk_bf16_f32 v98, v84, v85
    v_mfma_f32_16x16x32_bf16 a[24:27], v[156:159], v[124:127], a[24:27]
    v_accvgpr_read_b32 v86, a22
    v_mul_f32 v86, v86, v40
    v_mfma_f32_16x16x32_bf16 a[72:75], v[152:155], v[144:147], a[72:75]
    v_accvgpr_read_b32 v87, a23
    v_mul_f32 v87, v87, v40
    v_cvt_pk_bf16_f32 v99, v86, v87
    v_accvgpr_read_b32 v88, a64
    v_mul_f32 v88, v88, v42
    v_mfma_f32_16x16x32_bf16 a[72:75], v[156:159], v[128:131], a[72:75]
    ds_write2_b64 v28, v[96:97], v[98:99] offset0:0 offset1:4
    v_accvgpr_read_b32 v89, a65
    v_mul_f32 v89, v89, v42
    v_cvt_pk_bf16_f32 v100, v88, v89
    v_accvgpr_read_b32 v90, a66
    v_mul_f32 v90, v90, v42
    v_mfma_f32_16x16x32_bf16 a[120:123], v[152:155], v[148:151], a[120:123]
    s_waitcnt lgkmcnt(2)
    buffer_store_dwordx4 v[104:107], v31, s[24:27], s55 offen nt
    v_accvgpr_read_b32 v91, a67
    v_mul_f32 v91, v91, v42
    v_cvt_pk_bf16_f32 v101, v90, v91
    v_mfma_f32_16x16x32_bf16 a[120:123], v[156:159], v[132:135], a[120:123]
    s_waitcnt lgkmcnt(1)
    ds_read_b64_tr_b16 a[248:249], v4 offset:26624
    ds_read_b64_tr_b16 a[250:251], v4 offset:32768
    buffer_store_dwordx4 v[108:111], v31, s[24:27], s55 offen offset:3072 nt
    v_accvgpr_read_b32 v92, a68
    v_mul_f32 v92, v92, v42
    v_accvgpr_read_b32 v93, a69
    v_mul_f32 v93, v93, v42
    v_cvt_pk_bf16_f32 v102, v92, v93
    v_mfma_f32_16x16x32_bf16 a[168:171], v[156:159], v[136:139], a[168:171]
    ds_read_b64_tr_b16 a[252:253], v4 offset:38912
    ds_read_b64_tr_b16 a[254:255], v4 offset:45056
    v_accvgpr_read_b32 v94, a70
    v_mul_f32 v94, v94, v42
    v_accvgpr_read_b32 v95, a71
    v_mul_f32 v95, v95, v42
    v_cvt_pk_bf16_f32 v103, v94, v95
    v_mfma_f32_16x16x32_bf16 a[28:31], a[240:243], v[140:143], a[28:31]
    v_accvgpr_read_b32 v64, a112
    v_mul_f32 v64, v64, v44
    v_accvgpr_read_b32 v65, a113
    v_mul_f32 v65, v65, v44
    v_cvt_pk_bf16_f32 v96, v64, v65
    v_mfma_f32_16x16x32_bf16 a[28:31], a[244:247], v[124:127], a[28:31]
    ds_write2_b64 v28, v[100:101], v[102:103] offset0:16 offset1:20
    v_accvgpr_read_b32 v66, a114
    v_mul_f32 v66, v66, v44
    v_mfma_f32_16x16x32_bf16 a[76:79], a[240:243], v[144:147], a[76:79]
    v_accvgpr_read_b32 v67, a115
    v_mul_f32 v67, v67, v44
    v_cvt_pk_bf16_f32 v97, v66, v67
    v_accvgpr_read_b32 v68, a116
    v_mul_f32 v68, v68, v44
    v_mfma_f32_16x16x32_bf16 a[76:79], a[244:247], v[128:131], a[76:79]
    v_accvgpr_read_b32 v69, a117
    v_mul_f32 v69, v69, v44
    v_cvt_pk_bf16_f32 v98, v68, v69
    v_accvgpr_read_b32 v70, a118
    v_mul_f32 v70, v70, v44
    v_mfma_f32_16x16x32_bf16 a[124:127], a[240:243], v[148:151], a[124:127]
    ds_write_b128 v36, a[144:147]
    v_accvgpr_read_b32 v71, a119
    v_mul_f32 v71, v71, v44
    v_cvt_pk_bf16_f32 v99, v70, v71
    v_mfma_f32_16x16x32_bf16 a[124:127], a[244:247], v[132:135], a[124:127]
    ds_read_b64_tr_b16 v[152:153], v5 offset:26624
    ds_read_b64_tr_b16 v[154:155], v5 offset:32768
    ds_write2_b64 v28, v[96:97], v[98:99] offset0:32 offset1:36
    v_accvgpr_read_b32 v72, a24
    v_mul_f32 v72, v72, v40
    v_accvgpr_read_b32 v73, a25
    v_mul_f32 v73, v73, v40
    v_cvt_pk_bf16_f32 v100, v72, v73
    v_mfma_f32_16x16x32_bf16 a[172:175], a[244:247], v[136:139], a[172:175]
    s_waitcnt lgkmcnt(5)
    ds_read_b64_tr_b16 v[156:157], v5 offset:38912
    ds_read_b64_tr_b16 v[158:159], v5 offset:45056
    v_accvgpr_read_b32 v74, a26
    v_mul_f32 v74, v74, v40
    v_accvgpr_read_b32 v75, a27
    v_mul_f32 v75, v75, v40
    v_cvt_pk_bf16_f32 v101, v74, v75
    v_mfma_f32_16x16x32_bf16 a[32:35], a[248:251], v[140:143], a[32:35]
    v_accvgpr_read_b32 v76, a28
    v_mul_f32 v76, v76, v40
    v_accvgpr_read_b32 v77, a29
    v_mul_f32 v77, v77, v40
    v_cvt_pk_bf16_f32 v102, v76, v77
    v_mfma_f32_16x16x32_bf16 a[32:35], a[252:255], v[124:127], a[32:35]
    ds_write_b128 v36, a[148:151] offset:1024
    v_accvgpr_read_b32 v78, a30
    v_mul_f32 v78, v78, v40
    v_mfma_f32_16x16x32_bf16 a[80:83], a[248:251], v[144:147], a[80:83]
    v_accvgpr_read_b32 v79, a31
    v_mul_f32 v79, v79, v40
    v_cvt_pk_bf16_f32 v103, v78, v79
    v_accvgpr_read_b32 v80, a72
    v_mul_f32 v80, v80, v42
    v_mfma_f32_16x16x32_bf16 a[80:83], a[252:255], v[128:131], a[80:83]
    ds_write2_b64 v28, v[100:101], v[102:103] offset0:8 offset1:12
    v_accvgpr_read_b32 v81, a73
    v_mul_f32 v81, v81, v42
    v_cvt_pk_bf16_f32 v96, v80, v81
    v_accvgpr_read_b32 v82, a74
    v_mul_f32 v82, v82, v42
    v_mfma_f32_16x16x32_bf16 a[128:131], a[248:251], v[148:151], a[128:131]
    ds_read_b128 v[112:115], v30 offset:6400
    ds_read_b128 v[116:119], v30 offset:9600
    v_accvgpr_read_b32 v83, a75
    v_mul_f32 v83, v83, v42
    v_cvt_pk_bf16_f32 v97, v82, v83
    v_mfma_f32_16x16x32_bf16 a[128:131], a[252:255], v[132:135], a[128:131]
    ds_read_b64_tr_b16 a[240:241], v6 offset:26624
    ds_read_b64_tr_b16 a[242:243], v6 offset:32768
    ds_write_b128 v36, a[152:155] offset:2048
    v_accvgpr_read_b32 v84, a76
    v_mul_f32 v84, v84, v42
    v_accvgpr_read_b32 v85, a77
    v_mul_f32 v85, v85, v42
    v_cvt_pk_bf16_f32 v98, v84, v85
    v_mfma_f32_16x16x32_bf16 a[176:179], a[252:255], v[136:139], a[176:179]
    s_waitcnt lgkmcnt(7)
    ds_read_b64_tr_b16 a[244:245], v6 offset:38912
    ds_read_b64_tr_b16 a[246:247], v6 offset:45056
    v_accvgpr_read_b32 v86, a78
    v_mul_f32 v86, v86, v42
    v_accvgpr_read_b32 v87, a79
    v_mul_f32 v87, v87, v42
    v_cvt_pk_bf16_f32 v99, v86, v87
    v_mfma_f32_16x16x32_bf16 a[36:39], v[152:155], v[140:143], a[36:39]
    v_accvgpr_read_b32 v88, a120
    v_mul_f32 v88, v88, v44
    v_accvgpr_read_b32 v89, a121
    v_mul_f32 v89, v89, v44
    v_cvt_pk_bf16_f32 v100, v88, v89
    v_mfma_f32_16x16x32_bf16 a[36:39], v[156:159], v[124:127], a[36:39]
    s_waitcnt lgkmcnt(6)
    buffer_store_dwordx4 v[112:115], v31, s[24:27], 0 offen offset:128 nt
    ds_write2_b64 v28, v[96:97], v[98:99] offset0:24 offset1:28
    v_accvgpr_read_b32 v90, a122
    v_mul_f32 v90, v90, v44
    v_mfma_f32_16x16x32_bf16 a[84:87], v[152:155], v[144:147], a[84:87]
    s_waitcnt lgkmcnt(6)
    ds_write_b128 v36, a[156:159] offset:3072
    buffer_store_dwordx4 v[116:119], v31, s[24:27], 0 offen offset:3200 nt
    ds_read_b128 v[104:107], v30 offset:6528
    ds_read_b128 v[108:111], v30 offset:9728
    v_accvgpr_read_b32 v91, a123
    v_mul_f32 v91, v91, v44
    v_cvt_pk_bf16_f32 v101, v90, v91
    v_accvgpr_read_b32 v92, a124
    v_mul_f32 v92, v92, v44
    v_mfma_f32_16x16x32_bf16 a[84:87], v[156:159], v[128:131], a[84:87]
    v_accvgpr_read_b32 v93, a125
    v_mul_f32 v93, v93, v44
    v_cvt_pk_bf16_f32 v102, v92, v93
    v_accvgpr_read_b32 v94, a126
    v_mul_f32 v94, v94, v44
    v_mfma_f32_16x16x32_bf16 a[132:135], v[152:155], v[148:151], a[132:135]
    v_accvgpr_read_b32 v95, a127
    v_mul_f32 v95, v95, v44
    v_cvt_pk_bf16_f32 v103, v94, v95
    v_mfma_f32_16x16x32_bf16 a[132:135], v[156:159], v[132:135], a[132:135]
    ds_read_b64_tr_b16 a[248:249], v7 offset:26624
    ds_read_b64_tr_b16 a[250:251], v7 offset:32768
    v_mfma_f32_16x16x32_bf16 a[180:183], v[156:159], v[136:139], a[180:183]
    s_waitcnt lgkmcnt(3)
    ds_read_b64_tr_b16 a[252:253], v7 offset:38912
    ds_read_b64_tr_b16 a[254:255], v7 offset:45056
    ds_write_b128 v36, a[160:163] offset:4096
    buffer_store_dwordx4 v[104:107], v31, s[24:27], s54 offen offset:128 nt
    ds_write2_b64 v28, v[100:101], v[102:103] offset0:40 offset1:44
    v_mfma_f32_16x16x32_bf16 a[40:43], a[240:243], v[140:143], a[40:43]
    s_waitcnt lgkmcnt(6)
    buffer_store_dwordx4 v[108:111], v31, s[24:27], s54 offen offset:3200 nt
    ds_read_b128 v[112:115], v30 offset:6656
    ds_read_b128 v[116:119], v30 offset:9856
    v_mfma_f32_16x16x32_bf16 a[40:43], a[244:247], v[124:127], a[40:43]
    v_permlane32_swap_b32 v15, v35
    v_mfma_f32_16x16x32_bf16 a[88:91], a[240:243], v[144:147], a[88:91]
    v_add_f32 v15, v15, v35
    v_mov_b32 v35, v15
    v_mfma_f32_16x16x32_bf16 a[88:91], a[244:247], v[128:131], a[88:91]
    ds_write_b128 v36, a[164:167] offset:5120
    v_mfma_f32_16x16x32_bf16 a[136:139], a[240:243], v[148:151], a[136:139]
    s_waitcnt lgkmcnt(2)
    buffer_store_dwordx4 v[112:115], v31, s[24:27], s55 offen offset:128 nt
    v_mfma_f32_16x16x32_bf16 a[136:139], a[244:247], v[132:135], a[136:139]
    s_waitcnt lgkmcnt(1)
    buffer_store_dwordx4 v[116:119], v31, s[24:27], s55 offen offset:3200 nt
    v_permlane16_swap_b32 v15, v35
    v_add_f32 v15, v15, v35
    v_mov_b32 v39, v15
    v_mfma_f32_16x16x32_bf16 a[184:187], a[244:247], v[136:139], a[184:187]
    v_lshl_add_u32 v37, v1, 4, s49
    v_lshl_add_u32 v41, v1, 3, s48
    v_mfma_f32_16x16x32_bf16 a[44:47], a[248:251], v[140:143], a[44:47]
    ds_write_b64 v41, v[38:39] offset:6144
    v_mfma_f32_16x16x32_bf16 a[44:47], a[252:255], v[124:127], a[44:47]
    v_lshl_add_u32 v43, v1, 3, s49
    v_mfma_f32_16x16x32_bf16 a[92:95], a[248:251], v[144:147], a[92:95]
    v_mfma_f32_16x16x32_bf16 a[92:95], a[252:255], v[128:131], a[92:95]
    v_mfma_f32_16x16x32_bf16 a[140:143], a[248:251], v[148:151], a[140:143]
    v_mfma_f32_16x16x32_bf16 a[140:143], a[252:255], v[132:135], a[140:143]
    v_mfma_f32_16x16x32_bf16 a[188:191], a[252:255], v[136:139], a[188:191]
    s_waitcnt lgkmcnt(0)
    s_barrier
    ds_read_b64 v[38:39], v43 offset:6144
    ds_read_b128 v[128:131], v37
    ds_read_b128 v[132:135], v37 offset:1024
    ds_read_b128 v[136:139], v37 offset:2048
    ds_read_b128 v[140:143], v37 offset:3072
    ds_read_b128 v[144:147], v37 offset:4096
    ds_read_b128 v[148:151], v37 offset:5120
    v_accvgpr_read_b32 v64, a32
    v_accvgpr_read_b32 v65, a33
    v_accvgpr_read_b32 v66, a34
    v_accvgpr_read_b32 v67, a35
    v_accvgpr_read_b32 v68, a36
    v_accvgpr_read_b32 v69, a37
    v_accvgpr_read_b32 v70, a38
    v_accvgpr_read_b32 v71, a39
    v_pk_mul_f32 v[64:65], v[64:65], v[40:41] op_sel_hi:[1,0]
    v_pk_mul_f32 v[66:67], v[66:67], v[40:41] op_sel_hi:[1,0]
    v_pk_mul_f32 v[68:69], v[68:69], v[40:41] op_sel_hi:[1,0]
    v_pk_mul_f32 v[70:71], v[70:71], v[40:41] op_sel_hi:[1,0]
    v_cvt_pk_bf16_f32 v96, v64, v65
    v_cvt_pk_bf16_f32 v97, v66, v67
    v_cvt_pk_bf16_f32 v98, v68, v69
    v_cvt_pk_bf16_f32 v99, v70, v71
    s_waitcnt lgkmcnt(6)
    v_min_f32 v33, v60, v38
    v_sub_f32 v32, v33, v60
    v_sub_f32 v34, v33, v38
    v_exp_f32 v32, v32
    v_exp_f32 v34, v34
    v_accvgpr_read_b32 v72, a168
    v_accvgpr_read_b32 v73, a169
    v_accvgpr_read_b32 v74, a170
    v_accvgpr_read_b32 v75, a171
    v_accvgpr_read_b32 v76, a172
    v_accvgpr_read_b32 v77, a173
    v_accvgpr_read_b32 v78, a174
    v_accvgpr_read_b32 v79, a175
    v_mul_f32 v35, v15, v32
    v_fma_f32 v35, v39, v34, v35
    v_rcp_f32 v35, v35
    ds_write2_b64 v28, v[96:97], v[98:99] offset0:0 offset1:4
    v_mul_f32 v32, v32, v35
    v_mul_f32 v34, v34, v35
    s_waitcnt lgkmcnt(5)
    v_pk_mul_f32 v[72:73], v[72:73], v[32:33] op_sel_hi:[1,0]
    v_pk_mul_f32 v[74:75], v[74:75], v[32:33] op_sel_hi:[1,0]
    v_pk_mul_f32 v[76:77], v[76:77], v[32:33] op_sel_hi:[1,0]
    v_pk_mul_f32 v[78:79], v[78:79], v[32:33] op_sel_hi:[1,0]
    v_pk_fma_f32 v[72:73], v[128:129], v[34:35], v[72:73] op_sel_hi:[1,0,1]
    v_pk_fma_f32 v[74:75], v[130:131], v[34:35], v[74:75] op_sel_hi:[1,0,1]
    v_pk_fma_f32 v[76:77], v[132:133], v[34:35], v[76:77] op_sel_hi:[1,0,1]
    v_pk_fma_f32 v[78:79], v[134:135], v[34:35], v[78:79] op_sel_hi:[1,0,1]
    v_cvt_pk_bf16_f32 v100, v72, v73
    v_cvt_pk_bf16_f32 v101, v74, v75
    v_cvt_pk_bf16_f32 v102, v76, v77
    v_cvt_pk_bf16_f32 v103, v78, v79
    v_accvgpr_read_b32 v80, a80
    v_accvgpr_read_b32 v81, a81
    v_accvgpr_read_b32 v82, a82
    v_accvgpr_read_b32 v83, a83
    v_accvgpr_read_b32 v84, a84
    v_accvgpr_read_b32 v85, a85
    v_accvgpr_read_b32 v86, a86
    v_accvgpr_read_b32 v87, a87
    v_permlane16_swap_b32 v100, v102
    v_permlane16_swap_b32 v101, v103
    buffer_store_dwordx4 v[100:103], v29, s[24:27], 0 offen offset:192
    v_pk_mul_f32 v[80:81], v[80:81], v[42:43] op_sel_hi:[1,0]
    v_pk_mul_f32 v[82:83], v[82:83], v[42:43] op_sel_hi:[1,0]
    v_pk_mul_f32 v[84:85], v[84:85], v[42:43] op_sel_hi:[1,0]
    v_pk_mul_f32 v[86:87], v[86:87], v[42:43] op_sel_hi:[1,0]
    v_cvt_pk_bf16_f32 v96, v80, v81
    v_cvt_pk_bf16_f32 v97, v82, v83
    v_cvt_pk_bf16_f32 v98, v84, v85
    v_cvt_pk_bf16_f32 v99, v86, v87
    v_accvgpr_read_b32 v88, a176
    v_accvgpr_read_b32 v89, a177
    v_accvgpr_read_b32 v90, a178
    v_accvgpr_read_b32 v91, a179
    v_accvgpr_read_b32 v92, a180
    v_accvgpr_read_b32 v93, a181
    v_accvgpr_read_b32 v94, a182
    v_accvgpr_read_b32 v95, a183
    ds_write2_b64 v28, v[96:97], v[98:99] offset0:16 offset1:20
    s_waitcnt lgkmcnt(4)
    v_pk_mul_f32 v[88:89], v[88:89], v[32:33] op_sel_hi:[1,0]
    v_pk_mul_f32 v[90:91], v[90:91], v[32:33] op_sel_hi:[1,0]
    v_pk_mul_f32 v[92:93], v[92:93], v[32:33] op_sel_hi:[1,0]
    v_pk_mul_f32 v[94:95], v[94:95], v[32:33] op_sel_hi:[1,0]
    v_pk_fma_f32 v[88:89], v[136:137], v[34:35], v[88:89] op_sel_hi:[1,0,1]
    v_pk_fma_f32 v[90:91], v[138:139], v[34:35], v[90:91] op_sel_hi:[1,0,1]
    v_pk_fma_f32 v[92:93], v[140:141], v[34:35], v[92:93] op_sel_hi:[1,0,1]
    v_pk_fma_f32 v[94:95], v[142:143], v[34:35], v[94:95] op_sel_hi:[1,0,1]
    v_cvt_pk_bf16_f32 v100, v88, v89
    v_cvt_pk_bf16_f32 v101, v90, v91
    v_cvt_pk_bf16_f32 v102, v92, v93
    v_cvt_pk_bf16_f32 v103, v94, v95
    v_accvgpr_read_b32 v64, a128
    v_accvgpr_read_b32 v65, a129
    v_accvgpr_read_b32 v66, a130
    v_accvgpr_read_b32 v67, a131
    v_accvgpr_read_b32 v68, a132
    v_accvgpr_read_b32 v69, a133
    v_accvgpr_read_b32 v70, a134
    v_accvgpr_read_b32 v71, a135
    v_permlane16_swap_b32 v100, v102
    v_permlane16_swap_b32 v101, v103
    buffer_store_dwordx4 v[100:103], v29, s[24:27], 0 offen offset:256
    v_pk_mul_f32 v[64:65], v[64:65], v[44:45] op_sel_hi:[1,0]
    v_pk_mul_f32 v[66:67], v[66:67], v[44:45] op_sel_hi:[1,0]
    v_pk_mul_f32 v[68:69], v[68:69], v[44:45] op_sel_hi:[1,0]
    v_pk_mul_f32 v[70:71], v[70:71], v[44:45] op_sel_hi:[1,0]
    v_cvt_pk_bf16_f32 v96, v64, v65
    v_cvt_pk_bf16_f32 v97, v66, v67
    v_cvt_pk_bf16_f32 v98, v68, v69
    v_cvt_pk_bf16_f32 v99, v70, v71
    v_accvgpr_read_b32 v72, a184
    v_accvgpr_read_b32 v73, a185
    v_accvgpr_read_b32 v74, a186
    v_accvgpr_read_b32 v75, a187
    v_accvgpr_read_b32 v76, a188
    v_accvgpr_read_b32 v77, a189
    v_accvgpr_read_b32 v78, a190
    v_accvgpr_read_b32 v79, a191
    ds_write2_b64 v28, v[96:97], v[98:99] offset0:32 offset1:36
    s_waitcnt lgkmcnt(3)
    v_pk_mul_f32 v[72:73], v[72:73], v[32:33] op_sel_hi:[1,0]
    v_pk_mul_f32 v[74:75], v[74:75], v[32:33] op_sel_hi:[1,0]
    v_pk_mul_f32 v[76:77], v[76:77], v[32:33] op_sel_hi:[1,0]
    v_pk_mul_f32 v[78:79], v[78:79], v[32:33] op_sel_hi:[1,0]
    v_pk_fma_f32 v[72:73], v[144:145], v[34:35], v[72:73] op_sel_hi:[1,0,1]
    v_pk_fma_f32 v[74:75], v[146:147], v[34:35], v[74:75] op_sel_hi:[1,0,1]
    v_pk_fma_f32 v[76:77], v[148:149], v[34:35], v[76:77] op_sel_hi:[1,0,1]
    v_pk_fma_f32 v[78:79], v[150:151], v[34:35], v[78:79] op_sel_hi:[1,0,1]
    v_cvt_pk_bf16_f32 v100, v72, v73
    v_cvt_pk_bf16_f32 v101, v74, v75
    v_cvt_pk_bf16_f32 v102, v76, v77
    v_cvt_pk_bf16_f32 v103, v78, v79
    v_accvgpr_read_b32 v80, a40
    v_accvgpr_read_b32 v81, a41
    v_accvgpr_read_b32 v82, a42
    v_accvgpr_read_b32 v83, a43
    v_accvgpr_read_b32 v84, a44
    v_accvgpr_read_b32 v85, a45
    v_accvgpr_read_b32 v86, a46
    v_accvgpr_read_b32 v87, a47
    v_permlane16_swap_b32 v100, v102
    v_permlane16_swap_b32 v101, v103
    buffer_store_dwordx4 v[100:103], v29, s[24:27], 0 offen offset:320
    v_pk_mul_f32 v[80:81], v[80:81], v[40:41] op_sel_hi:[1,0]
    v_pk_mul_f32 v[82:83], v[82:83], v[40:41] op_sel_hi:[1,0]
    v_pk_mul_f32 v[84:85], v[84:85], v[40:41] op_sel_hi:[1,0]
    v_pk_mul_f32 v[86:87], v[86:87], v[40:41] op_sel_hi:[1,0]
    v_cvt_pk_bf16_f32 v96, v80, v81
    v_cvt_pk_bf16_f32 v97, v82, v83
    v_cvt_pk_bf16_f32 v98, v84, v85
    v_cvt_pk_bf16_f32 v99, v86, v87
    v_accvgpr_read_b32 v88, a88
    v_accvgpr_read_b32 v89, a89
    v_accvgpr_read_b32 v90, a90
    v_accvgpr_read_b32 v91, a91
    v_accvgpr_read_b32 v92, a92
    v_accvgpr_read_b32 v93, a93
    v_accvgpr_read_b32 v94, a94
    v_accvgpr_read_b32 v95, a95
    ds_write2_b64 v28, v[96:97], v[98:99] offset0:8 offset1:12
    ds_read_b128 v[104:107], v30 offset:6400
    ds_read_b128 v[108:111], v30 offset:9600
    v_pk_mul_f32 v[88:89], v[88:89], v[42:43] op_sel_hi:[1,0]
    v_pk_mul_f32 v[90:91], v[90:91], v[42:43] op_sel_hi:[1,0]
    v_pk_mul_f32 v[92:93], v[92:93], v[42:43] op_sel_hi:[1,0]
    v_pk_mul_f32 v[94:95], v[94:95], v[42:43] op_sel_hi:[1,0]
    v_cvt_pk_bf16_f32 v100, v88, v89
    v_cvt_pk_bf16_f32 v101, v90, v91
    v_cvt_pk_bf16_f32 v102, v92, v93
    v_cvt_pk_bf16_f32 v103, v94, v95
    v_accvgpr_read_b32 v64, a136
    v_accvgpr_read_b32 v65, a137
    v_accvgpr_read_b32 v66, a138
    v_accvgpr_read_b32 v67, a139
    v_accvgpr_read_b32 v68, a140
    v_accvgpr_read_b32 v69, a141
    v_accvgpr_read_b32 v70, a142
    v_accvgpr_read_b32 v71, a143
    ds_write2_b64 v28, v[100:101], v[102:103] offset0:24 offset1:28
    ds_read_b128 v[112:115], v30 offset:6528
    ds_read_b128 v[116:119], v30 offset:9728
    v_pk_mul_f32 v[64:65], v[64:65], v[44:45] op_sel_hi:[1,0]
    v_pk_mul_f32 v[66:67], v[66:67], v[44:45] op_sel_hi:[1,0]
    v_pk_mul_f32 v[68:69], v[68:69], v[44:45] op_sel_hi:[1,0]
    v_pk_mul_f32 v[70:71], v[70:71], v[44:45] op_sel_hi:[1,0]
    v_cvt_pk_bf16_f32 v96, v64, v65
    v_cvt_pk_bf16_f32 v97, v66, v67
    v_cvt_pk_bf16_f32 v98, v68, v69
    v_cvt_pk_bf16_f32 v99, v70, v71
    ds_write2_b64 v28, v[96:97], v[98:99] offset0:40 offset1:44
    ds_read_b128 v[120:123], v30 offset:6656
    ds_read_b128 v[124:127], v30 offset:9856
    s_waitcnt lgkmcnt(7)
    buffer_store_dwordx4 v[104:107], v31, s[24:27], 0 offen offset:256 nt
    s_waitcnt lgkmcnt(6)
    buffer_store_dwordx4 v[108:111], v31, s[24:27], 0 offen offset:3328 nt
    s_waitcnt lgkmcnt(4)
    buffer_store_dwordx4 v[112:115], v31, s[24:27], s54 offen offset:256 nt
    s_waitcnt lgkmcnt(3)
    buffer_store_dwordx4 v[116:119], v31, s[24:27], s54 offen offset:3328 nt
    s_waitcnt lgkmcnt(1)
    buffer_store_dwordx4 v[120:123], v31, s[24:27], s55 offen offset:256 nt
    s_waitcnt lgkmcnt(0)
    buffer_store_dwordx4 v[124:127], v31, s[24:27], s55 offen offset:3328 nt
    s_endpgm
L_h0_3s_rare:
    s_mov_b32 s58, 0
L_h0_3s_spin:
    ds_read_b32 v30, v46
    s_add_u32 s58, s58, 1
    s_waitcnt lgkmcnt(0)
    v_cmp_gt_u32 s[94:95], s93, v30
    s_cmp_gt_u32 s58, 0x40000
    s_cbranch_scc1 L_h0_3s_spun
    s_cmp_lg_u64 s[94:95], 0
    s_cbranch_scc1 L_h0_3s_spin
L_h0_3s_spun:
    s_branch L_h0_3s_back
L_b00_4s_rare:
    s_mov_b32 s58, 0
L_b00_4s_spin:
    ds_read_b32 v30, v46
    s_add_u32 s58, s58, 1
    s_waitcnt lgkmcnt(0)
    v_cmp_gt_u32 s[94:95], s93, v30
    s_cmp_gt_u32 s58, 0x40000
    s_cbranch_scc1 L_b00_4s_spun
    s_cmp_lg_u64 s[94:95], 0
    s_cbranch_scc1 L_b00_4s_spin
L_b00_4s_spun:
    s_branch L_b00_4s_back
L_b00_6s_rare:
    s_mov_b32 s58, 0
L_b00_6s_spin:
    ds_read_b32 v30, v46
    s_add_u32 s58, s58, 1
    s_waitcnt lgkmcnt(0)
    v_cmp_gt_u32 s[94:95], s93, v30
    s_cmp_gt_u32 s58, 0x40000
    s_cbranch_scc1 L_b00_6s_spun
    s_cmp_lg_u64 s[94:95], 0
    s_cbranch_scc1 L_b00_6s_spin
L_b00_6s_spun:
    s_branch L_b00_6s_back
L_b01_4s_rare:
    s_mov_b32 s58, 0
L_b01_4s_spin:
    ds_read_b32 v30, v46
    s_add_u32 s58, s58, 1
    s_waitcnt lgkmcnt(0)
    v_cmp_gt_u32 s[94:95], s93, v30
    s_cmp_gt_u32 s58, 0x40000
    s_cbranch_scc1 L_b01_4s_spun
    s_cmp_lg_u64 s[94:95], 0
    s_cbranch_scc1 L_b01_4s_spin
L_b01_4s_spun:
    s_branch L_b01_4s_back
L_b01_6s_rare:
    s_mov_b32 s58, 0
L_b01_6s_spin:
    ds_read_b32 v30, v46
    s_add_u32 s58, s58, 1
    s_waitcnt lgkmcnt(0)
    v_cmp_gt_u32 s[94:95], s93, v30
    s_cmp_gt_u32 s58, 0x40000
    s_cbranch_scc1 L_b01_6s_spun
    s_cmp_lg_u64 s[94:95], 0
    s_cbranch_scc1 L_b01_6s_spin
L_b01_6s_spun:
    s_branch L_b01_6s_back
L_s0_3s_rare:
    s_mov_b32 s58, 0
L_s0_3s_spin:
    ds_read_b32 v30, v46
    s_add_u32 s58, s58, 1
    s_waitcnt lgkmcnt(0)
    v_cmp_gt_u32 s[94:95], s93, v30
    s_cmp_gt_u32 s58, 0x40000
    s_cbranch_scc1 L_s0_3s_spun
    s_cmp_lg_u64 s[94:95], 0
    s_cbranch_scc1 L_s0_3s_spin
L_s0_3s_spun:
    s_branch L_s0_3s_back
L_h0_2c_rare:
    s_mov_b32 s36, 0
    s_mov_b32 s54, 1
    s_mov_b32 s55, 393216
    s_add_u32 s55, s55, 0
    s_branch L_rare_0_0
L_b00_5cs_rare:
    s_mov_b32 s58, 0
L_b00_5cs_spin:
    ds_read_b32 v30, v46
    s_add_u32 s58, s58, 1
    s_waitcnt lgkmcnt(0)
    v_cmp_gt_u32 s[94:95], s93, v30
    s_cmp_gt_u32 s58, 0x40000
    s_cbranch_scc1 L_b00_5cs_spun
    s_cmp_lg_u64 s[94:95], 0
    s_cbranch_scc1 L_b00_5cs_spin
L_b00_5cs_spun:
    v_cmp_lt_f32 vcc, s35, v28
    s_nop 4
    s_cbranch_vccz L_b00_5cs_back
    s_mov_b32 s36, 4
    s_mov_b32 s54, 1
    s_mov_b32 s55, 0
    s_sub_u32 s56, 6, s31
    s_mul_i32 s56, s56, 49152
    s_add_u32 s55, s55, s56
    s_add_u32 s55, s55, 49152
    s_branch L_rare_0_0
L_b01_5cs_rare:
    s_mov_b32 s58, 0
L_b01_5cs_spin:
    ds_read_b32 v30, v46
    s_add_u32 s58, s58, 1
    s_waitcnt lgkmcnt(0)
    v_cmp_gt_u32 s[94:95], s93, v30
    s_cmp_gt_u32 s58, 0x40000
    s_cbranch_scc1 L_b01_5cs_spun
    s_cmp_lg_u64 s[94:95], 0
    s_cbranch_scc1 L_b01_5cs_spin
L_b01_5cs_spun:
    v_cmp_lt_f32 vcc, s35, v28
    s_nop 4
    s_cbranch_vccz L_b01_5cs_back
    s_mov_b32 s36, 8
    s_mov_b32 s54, 1
    s_mov_b32 s55, 393216
    s_sub_u32 s56, 6, s31
    s_mul_i32 s56, s56, 49152
    s_add_u32 s55, s55, s56
    s_add_u32 s55, s55, 49152
    s_branch L_rare_0_0
L_s0_2c_rare:
    s_mov_b32 s36, 12
    s_mov_b32 s54, 1
    s_mov_b32 s55, 0
    s_add_u32 s55, s55, 0
    s_branch L_rare_0_0
L_rare_0_0:
    s_waitcnt vmcnt(0) lgkmcnt(0)
    s_nop 15
    s_nop 15
    s_add_u32 s56, s55, 12288
    v_sub_f32 v24, 0, v48
    v_sub_f32 v25, 0, v52
    v_sub_f32 v26, 0, v56
    v_sub_f32 v27, 0, v60
    v_add_u32 v0, 0, v10
    buffer_load_dwordx4 v[124:127], v0, s[16:19], s55 offen
    buffer_load_dwordx4 v[128:131], v0, s[16:19], s55 offen offset:64
    buffer_load_dwordx4 v[132:135], v0, s[16:19], s55 offen offset:128
    buffer_load_dwordx4 v[136:139], v0, s[16:19], s55 offen offset:192
    buffer_load_dwordx4 v[140:143], v0, s[16:19], s55 offen offset:256
    buffer_load_dwordx4 v[144:147], v0, s[16:19], s55 offen offset:320
    s_waitcnt vmcnt(0)
    s_waitcnt vmcnt(0)
    v_mfma_f32_16x16x32_bf16 v[64:67], v[124:127], v[160:163], 0
    v_mfma_f32_16x16x32_bf16 v[64:67], v[128:131], v[164:167], v[64:67]
    v_mfma_f32_16x16x32_bf16 v[64:67], v[132:135], v[168:171], v[64:67]
    v_mfma_f32_16x16x32_bf16 v[64:67], v[136:139], v[172:175], v[64:67]
    v_mfma_f32_16x16x32_bf16 v[64:67], v[140:143], v[176:179], v[64:67]
    v_mfma_f32_16x16x32_bf16 v[64:67], v[144:147], v[180:183], v[64:67]
    v_mfma_f32_16x16x32_bf16 v[72:75], v[124:127], v[184:187], 0
    v_mfma_f32_16x16x32_bf16 v[72:75], v[128:131], v[188:191], v[72:75]
    v_mfma_f32_16x16x32_bf16 v[72:75], v[132:135], v[192:195], v[72:75]
    v_mfma_f32_16x16x32_bf16 v[72:75], v[136:139], v[196:199], v[72:75]
    v_mfma_f32_16x16x32_bf16 v[72:75], v[140:143], v[200:203], v[72:75]
    v_mfma_f32_16x16x32_bf16 v[72:75], v[144:147], v[204:207], v[72:75]
    v_mfma_f32_16x16x32_bf16 v[80:83], v[124:127], v[208:211], 0
    v_mfma_f32_16x16x32_bf16 v[80:83], v[128:131], v[212:215], v[80:83]
    v_mfma_f32_16x16x32_bf16 v[80:83], v[132:135], v[216:219], v[80:83]
    v_mfma_f32_16x16x32_bf16 v[80:83], v[136:139], v[220:223], v[80:83]
    v_mfma_f32_16x16x32_bf16 v[80:83], v[140:143], v[224:227], v[80:83]
    v_mfma_f32_16x16x32_bf16 v[80:83], v[144:147], v[228:231], v[80:83]
    v_mfma_f32_16x16x32_bf16 v[88:91], v[124:127], v[232:235], 0
    v_mfma_f32_16x16x32_bf16 v[88:91], v[128:131], v[236:239], v[88:91]
    v_mfma_f32_16x16x32_bf16 v[88:91], v[132:135], v[240:243], v[88:91]
    v_mfma_f32_16x16x32_bf16 v[88:91], v[136:139], v[244:247], v[88:91]
    v_mfma_f32_16x16x32_bf16 v[88:91], v[140:143], v[248:251], v[88:91]
    v_mfma_f32_16x16x32_bf16 v[88:91], v[144:147], v[252:255], v[88:91]
    s_nop 15
    v_add_u32 v0, 6144, v10
    buffer_load_dwordx4 v[124:127], v0, s[16:19], s55 offen
    buffer_load_dwordx4 v[128:131], v0, s[16:19], s55 offen offset:64
    buffer_load_dwordx4 v[132:135], v0, s[16:19], s55 offen offset:128
    buffer_load_dwordx4 v[136:139], v0, s[16:19], s55 offen offset:192
    buffer_load_dwordx4 v[140:143], v0, s[16:19], s55 offen offset:256
    buffer_load_dwordx4 v[144:147], v0, s[16:19], s55 offen offset:320
    s_waitcnt vmcnt(0)
    s_waitcnt vmcnt(0)
    v_mfma_f32_16x16x32_bf16 v[68:71], v[124:127], v[160:163], 0
    v_mfma_f32_16x16x32_bf16 v[68:71], v[128:131], v[164:167], v[68:71]
    v_mfma_f32_16x16x32_bf16 v[68:71], v[132:135], v[168:171], v[68:71]
    v_mfma_f32_16x16x32_bf16 v[68:71], v[136:139], v[172:175], v[68:71]
    v_mfma_f32_16x16x32_bf16 v[68:71], v[140:143], v[176:179], v[68:71]
    v_mfma_f32_16x16x32_bf16 v[68:71], v[144:147], v[180:183], v[68:71]
    v_mfma_f32_16x16x32_bf16 v[76:79], v[124:127], v[184:187], 0
    v_mfma_f32_16x16x32_bf16 v[76:79], v[128:131], v[188:191], v[76:79]
    v_mfma_f32_16x16x32_bf16 v[76:79], v[132:135], v[192:195], v[76:79]
    v_mfma_f32_16x16x32_bf16 v[76:79], v[136:139], v[196:199], v[76:79]
    v_mfma_f32_16x16x32_bf16 v[76:79], v[140:143], v[200:203], v[76:79]
    v_mfma_f32_16x16x32_bf16 v[76:79], v[144:147], v[204:207], v[76:79]
    v_mfma_f32_16x16x32_bf16 v[84:87], v[124:127], v[208:211], 0
    v_mfma_f32_16x16x32_bf16 v[84:87], v[128:131], v[212:215], v[84:87]
    v_mfma_f32_16x16x32_bf16 v[84:87], v[132:135], v[216:219], v[84:87]
    v_mfma_f32_16x16x32_bf16 v[84:87], v[136:139], v[220:223], v[84:87]
    v_mfma_f32_16x16x32_bf16 v[84:87], v[140:143], v[224:227], v[84:87]
    v_mfma_f32_16x16x32_bf16 v[84:87], v[144:147], v[228:231], v[84:87]
    v_mfma_f32_16x16x32_bf16 v[92:95], v[124:127], v[232:235], 0
    v_mfma_f32_16x16x32_bf16 v[92:95], v[128:131], v[236:239], v[92:95]
    v_mfma_f32_16x16x32_bf16 v[92:95], v[132:135], v[240:243], v[92:95]
    v_mfma_f32_16x16x32_bf16 v[92:95], v[136:139], v[244:247], v[92:95]
    v_mfma_f32_16x16x32_bf16 v[92:95], v[140:143], v[248:251], v[92:95]
    v_mfma_f32_16x16x32_bf16 v[92:95], v[144:147], v[252:255], v[92:95]
    s_nop 15
    v_max3_f32 v24, v24, v64, v65
    v_max3_f32 v24, v24, v66, v67
    v_max3_f32 v24, v24, v68, v69
    v_max3_f32 v24, v24, v70, v71
    v_max3_f32 v25, v25, v72, v73
    v_max3_f32 v25, v25, v74, v75
    v_max3_f32 v25, v25, v76, v77
    v_max3_f32 v25, v25, v78, v79
    v_max3_f32 v26, v26, v80, v81
    v_max3_f32 v26, v26, v82, v83
    v_max3_f32 v26, v26, v84, v85
    v_max3_f32 v26, v26, v86, v87
    v_max3_f32 v27, v27, v88, v89
    v_max3_f32 v27, v27, v90, v91
    v_max3_f32 v27, v27, v92, v93
    v_max3_f32 v27, v27, v94, v95
    v_add_u32 v0, 0, v10
    buffer_load_dwordx4 v[124:127], v0, s[16:19], s56 offen
    buffer_load_dwordx4 v[128:131], v0, s[16:19], s56 offen offset:64
    buffer_load_dwordx4 v[132:135], v0, s[16:19], s56 offen offset:128
    buffer_load_dwordx4 v[136:139], v0, s[16:19], s56 offen offset:192
    buffer_load_dwordx4 v[140:143], v0, s[16:19], s56 offen offset:256
    buffer_load_dwordx4 v[144:147], v0, s[16:19], s56 offen offset:320
    s_waitcnt vmcnt(0)
    s_waitcnt vmcnt(0)
    v_mfma_f32_16x16x32_bf16 v[64:67], v[124:127], v[160:163], 0
    v_mfma_f32_16x16x32_bf16 v[64:67], v[128:131], v[164:167], v[64:67]
    v_mfma_f32_16x16x32_bf16 v[64:67], v[132:135], v[168:171], v[64:67]
    v_mfma_f32_16x16x32_bf16 v[64:67], v[136:139], v[172:175], v[64:67]
    v_mfma_f32_16x16x32_bf16 v[64:67], v[140:143], v[176:179], v[64:67]
    v_mfma_f32_16x16x32_bf16 v[64:67], v[144:147], v[180:183], v[64:67]
    v_mfma_f32_16x16x32_bf16 v[72:75], v[124:127], v[184:187], 0
    v_mfma_f32_16x16x32_bf16 v[72:75], v[128:131], v[188:191], v[72:75]
    v_mfma_f32_16x16x32_bf16 v[72:75], v[132:135], v[192:195], v[72:75]
    v_mfma_f32_16x16x32_bf16 v[72:75], v[136:139], v[196:199], v[72:75]
    v_mfma_f32_16x16x32_bf16 v[72:75], v[140:143], v[200:203], v[72:75]
    v_mfma_f32_16x16x32_bf16 v[72:75], v[144:147], v[204:207], v[72:75]
    v_mfma_f32_16x16x32_bf16 v[80:83], v[124:127], v[208:211], 0
    v_mfma_f32_16x16x32_bf16 v[80:83], v[128:131], v[212:215], v[80:83]
    v_mfma_f32_16x16x32_bf16 v[80:83], v[132:135], v[216:219], v[80:83]
    v_mfma_f32_16x16x32_bf16 v[80:83], v[136:139], v[220:223], v[80:83]
    v_mfma_f32_16x16x32_bf16 v[80:83], v[140:143], v[224:227], v[80:83]
    v_mfma_f32_16x16x32_bf16 v[80:83], v[144:147], v[228:231], v[80:83]
    s_nop 15
    v_add_u32 v0, 6144, v10
    buffer_load_dwordx4 v[124:127], v0, s[16:19], s56 offen
    buffer_load_dwordx4 v[128:131], v0, s[16:19], s56 offen offset:64
    buffer_load_dwordx4 v[132:135], v0, s[16:19], s56 offen offset:128
    buffer_load_dwordx4 v[136:139], v0, s[16:19], s56 offen offset:192
    buffer_load_dwordx4 v[140:143], v0, s[16:19], s56 offen offset:256
    buffer_load_dwordx4 v[144:147], v0, s[16:19], s56 offen offset:320
    s_waitcnt vmcnt(0)
    s_waitcnt vmcnt(0)
    v_mfma_f32_16x16x32_bf16 v[68:71], v[124:127], v[160:163], 0
    v_mfma_f32_16x16x32_bf16 v[68:71], v[128:131], v[164:167], v[68:71]
    v_mfma_f32_16x16x32_bf16 v[68:71], v[132:135], v[168:171], v[68:71]
    v_mfma_f32_16x16x32_bf16 v[68:71], v[136:139], v[172:175], v[68:71]
    v_mfma_f32_16x16x32_bf16 v[68:71], v[140:143], v[176:179], v[68:71]
    v_mfma_f32_16x16x32_bf16 v[68:71], v[144:147], v[180:183], v[68:71]
    v_mfma_f32_16x16x32_bf16 v[76:79], v[124:127], v[184:187], 0
    v_mfma_f32_16x16x32_bf16 v[76:79], v[128:131], v[188:191], v[76:79]
    v_mfma_f32_16x16x32_bf16 v[76:79], v[132:135], v[192:195], v[76:79]
    v_mfma_f32_16x16x32_bf16 v[76:79], v[136:139], v[196:199], v[76:79]
    v_mfma_f32_16x16x32_bf16 v[76:79], v[140:143], v[200:203], v[76:79]
    v_mfma_f32_16x16x32_bf16 v[76:79], v[144:147], v[204:207], v[76:79]
    v_mfma_f32_16x16x32_bf16 v[84:87], v[124:127], v[208:211], 0
    v_mfma_f32_16x16x32_bf16 v[84:87], v[128:131], v[212:215], v[84:87]
    v_mfma_f32_16x16x32_bf16 v[84:87], v[132:135], v[216:219], v[84:87]
    v_mfma_f32_16x16x32_bf16 v[84:87], v[136:139], v[220:223], v[84:87]
    v_mfma_f32_16x16x32_bf16 v[84:87], v[140:143], v[224:227], v[84:87]
    v_mfma_f32_16x16x32_bf16 v[84:87], v[144:147], v[228:231], v[84:87]
    s_nop 15
    v_max3_f32 v24, v24, v64, v65
    v_max3_f32 v24, v24, v66, v67
    v_max3_f32 v24, v24, v68, v69
    v_max3_f32 v24, v24, v70, v71
    v_max3_f32 v25, v25, v72, v73
    v_max3_f32 v25, v25, v74, v75
    v_max3_f32 v25, v25, v76, v77
    v_max3_f32 v25, v25, v78, v79
    v_max3_f32 v26, v26, v80, v81
    v_max3_f32 v26, v26, v82, v83
    v_max3_f32 v26, v26, v84, v85
    v_max3_f32 v26, v26, v86, v87
    s_mov_b32 s59, 0
    s_nop 4
    s_branch L_rescale
L_rare_0_0_b:
    v_add_u32 v0, 0, v10
    buffer_load_dwordx4 v[124:127], v0, s[16:19], s55 offen
    buffer_load_dwordx4 v[128:131], v0, s[16:19], s55 offen offset:64
    buffer_load_dwordx4 v[132:135], v0, s[16:19], s55 offen offset:128
    buffer_load_dwordx4 v[136:139], v0, s[16:19], s55 offen offset:192
    buffer_load_dwordx4 v[140:143], v0, s[16:19], s55 offen offset:256
    buffer_load_dwordx4 v[144:147], v0, s[16:19], s55 offen offset:320
    s_waitcnt vmcnt(0)
    s_waitcnt vmcnt(0)
    v_mfma_f32_16x16x32_bf16 v[64:67], v[124:127], v[160:163], 0
    v_mfma_f32_16x16x32_bf16 v[64:67], v[128:131], v[164:167], v[64:67]
    v_mfma_f32_16x16x32_bf16 v[64:67], v[132:135], v[168:171], v[64:67]
    v_mfma_f32_16x16x32_bf16 v[64:67], v[136:139], v[172:175], v[64:67]
    v_mfma_f32_16x16x32_bf16 v[64:67], v[140:143], v[176:179], v[64:67]
    v_mfma_f32_16x16x32_bf16 v[64:67], v[144:147], v[180:183], v[64:67]
    v_mfma_f32_16x16x32_bf16 v[72:75], v[124:127], v[184:187], 0
    v_mfma_f32_16x16x32_bf16 v[72:75], v[128:131], v[188:191], v[72:75]
    v_mfma_f32_16x16x32_bf16 v[72:75], v[132:135], v[192:195], v[72:75]
    v_mfma_f32_16x16x32_bf16 v[72:75], v[136:139], v[196:199], v[72:75]
    v_mfma_f32_16x16x32_bf16 v[72:75], v[140:143], v[200:203], v[72:75]
    v_mfma_f32_16x16x32_bf16 v[72:75], v[144:147], v[204:207], v[72:75]
    v_mfma_f32_16x16x32_bf16 v[80:83], v[124:127], v[208:211], 0
    v_mfma_f32_16x16x32_bf16 v[80:83], v[128:131], v[212:215], v[80:83]
    v_mfma_f32_16x16x32_bf16 v[80:83], v[132:135], v[216:219], v[80:83]
    v_mfma_f32_16x16x32_bf16 v[80:83], v[136:139], v[220:223], v[80:83]
    v_mfma_f32_16x16x32_bf16 v[80:83], v[140:143], v[224:227], v[80:83]
    v_mfma_f32_16x16x32_bf16 v[80:83], v[144:147], v[228:231], v[80:83]
    v_mfma_f32_16x16x32_bf16 v[88:91], v[124:127], v[232:235], 0
    v_mfma_f32_16x16x32_bf16 v[88:91], v[128:131], v[236:239], v[88:91]
    v_mfma_f32_16x16x32_bf16 v[88:91], v[132:135], v[240:243], v[88:91]
    v_mfma_f32_16x16x32_bf16 v[88:91], v[136:139], v[244:247], v[88:91]
    v_mfma_f32_16x16x32_bf16 v[88:91], v[140:143], v[248:251], v[88:91]
    v_mfma_f32_16x16x32_bf16 v[88:91], v[144:147], v[252:255], v[88:91]
    s_nop 15
    v_add_u32 v0, 6144, v10
    buffer_load_dwordx4 v[124:127], v0, s[16:19], s55 offen
    buffer_load_dwordx4 v[128:131], v0, s[16:19], s55 offen offset:64
    buffer_load_dwordx4 v[132:135], v0, s[16:19], s55 offen offset:128
    buffer_load_dwordx4 v[136:139], v0, s[16:19], s55 offen offset:192
    buffer_load_dwordx4 v[140:143], v0, s[16:19], s55 offen offset:256
    buffer_load_dwordx4 v[144:147], v0, s[16:19], s55 offen offset:320
    s_waitcnt vmcnt(0)
    s_waitcnt vmcnt(0)
    v_mfma_f32_16x16x32_bf16 v[68:71], v[124:127], v[160:163], 0
    v_mfma_f32_16x16x32_bf16 v[68:71], v[128:131], v[164:167], v[68:71]
    v_mfma_f32_16x16x32_bf16 v[68:71], v[132:135], v[168:171], v[68:71]
    v_mfma_f32_16x16x32_bf16 v[68:71], v[136:139], v[172:175], v[68:71]
    v_mfma_f32_16x16x32_bf16 v[68:71], v[140:143], v[176:179], v[68:71]
    v_mfma_f32_16x16x32_bf16 v[68:71], v[144:147], v[180:183], v[68:71]
    v_mfma_f32_16x16x32_bf16 v[76:79], v[124:127], v[184:187], 0
    v_mfma_f32_16x16x32_bf16 v[76:79], v[128:131], v[188:191], v[76:79]
    v_mfma_f32_16x16x32_bf16 v[76:79], v[132:135], v[192:195], v[76:79]
    v_mfma_f32_16x16x32_bf16 v[76:79], v[136:139], v[196:199], v[76:79]
    v_mfma_f32_16x16x32_bf16 v[76:79], v[140:143], v[200:203], v[76:79]
    v_mfma_f32_16x16x32_bf16 v[76:79], v[144:147], v[204:207], v[76:79]
    v_mfma_f32_16x16x32_bf16 v[84:87], v[124:127], v[208:211], 0
    v_mfma_f32_16x16x32_bf16 v[84:87], v[128:131], v[212:215], v[84:87]
    v_mfma_f32_16x16x32_bf16 v[84:87], v[132:135], v[216:219], v[84:87]
    v_mfma_f32_16x16x32_bf16 v[84:87], v[136:139], v[220:223], v[84:87]
    v_mfma_f32_16x16x32_bf16 v[84:87], v[140:143], v[224:227], v[84:87]
    v_mfma_f32_16x16x32_bf16 v[84:87], v[144:147], v[228:231], v[84:87]
    v_mfma_f32_16x16x32_bf16 v[92:95], v[124:127], v[232:235], 0
    v_mfma_f32_16x16x32_bf16 v[92:95], v[128:131], v[236:239], v[92:95]
    v_mfma_f32_16x16x32_bf16 v[92:95], v[132:135], v[240:243], v[92:95]
    v_mfma_f32_16x16x32_bf16 v[92:95], v[136:139], v[244:247], v[92:95]
    v_mfma_f32_16x16x32_bf16 v[92:95], v[140:143], v[248:251], v[92:95]
    v_mfma_f32_16x16x32_bf16 v[92:95], v[144:147], v[252:255], v[92:95]
    s_nop 15
    v_sub_f32 v64, v64, v24
    v_exp_f32 v64, v64
    v_sub_f32 v65, v65, v24
    v_exp_f32 v65, v65
    v_sub_f32 v66, v66, v24
    v_exp_f32 v66, v66
    v_sub_f32 v67, v67, v24
    v_exp_f32 v67, v67
    v_sub_f32 v68, v68, v24
    v_exp_f32 v68, v68
    v_sub_f32 v69, v69, v24
    v_exp_f32 v69, v69
    v_sub_f32 v70, v70, v24
    v_exp_f32 v70, v70
    v_sub_f32 v71, v71, v24
    v_exp_f32 v71, v71
    v_add_f32 v16, v64, v65
    v_add_f32 v16, v16, v66
    v_add_f32 v16, v16, v67
    v_add_f32 v16, v16, v68
    v_add_f32 v16, v16, v69
    v_add_f32 v16, v16, v70
    v_add_f32 v16, v16, v71
    v_cvt_pk_bf16_f32 v96, v64, v65
    v_cvt_pk_bf16_f32 v97, v66, v67
    v_cvt_pk_bf16_f32 v98, v68, v69
    v_cvt_pk_bf16_f32 v99, v70, v71
    v_sub_f32 v72, v72, v25
    v_exp_f32 v72, v72
    v_sub_f32 v73, v73, v25
    v_exp_f32 v73, v73
    v_sub_f32 v74, v74, v25
    v_exp_f32 v74, v74
    v_sub_f32 v75, v75, v25
    v_exp_f32 v75, v75
    v_sub_f32 v76, v76, v25
    v_exp_f32 v76, v76
    v_sub_f32 v77, v77, v25
    v_exp_f32 v77, v77
    v_sub_f32 v78, v78, v25
    v_exp_f32 v78, v78
    v_sub_f32 v79, v79, v25
    v_exp_f32 v79, v79
    v_add_f32 v17, v72, v73
    v_add_f32 v17, v17, v74
    v_add_f32 v17, v17, v75
    v_add_f32 v17, v17, v76
    v_add_f32 v17, v17, v77
    v_add_f32 v17, v17, v78
    v_add_f32 v17, v17, v79
    v_cvt_pk_bf16_f32 v100, v72, v73
    v_cvt_pk_bf16_f32 v101, v74, v75
    v_cvt_pk_bf16_f32 v102, v76, v77
    v_cvt_pk_bf16_f32 v103, v78, v79
    v_sub_f32 v80, v80, v26
    v_exp_f32 v80, v80
    v_sub_f32 v81, v81, v26
    v_exp_f32 v81, v81
    v_sub_f32 v82, v82, v26
    v_exp_f32 v82, v82
    v_sub_f32 v83, v83, v26
    v_exp_f32 v83, v83
    v_sub_f32 v84, v84, v26
    v_exp_f32 v84, v84
    v_sub_f32 v85, v85, v26
    v_exp_f32 v85, v85
    v_sub_f32 v86, v86, v26
    v_exp_f32 v86, v86
    v_sub_f32 v87, v87, v26
    v_exp_f32 v87, v87
    v_add_f32 v18, v80, v81
    v_add_f32 v18, v18, v82
    v_add_f32 v18, v18, v83
    v_add_f32 v18, v18, v84
    v_add_f32 v18, v18, v85
    v_add_f32 v18, v18, v86
    v_add_f32 v18, v18, v87
    v_cvt_pk_bf16_f32 v104, v80, v81
    v_cvt_pk_bf16_f32 v105, v82, v83
    v_cvt_pk_bf16_f32 v106, v84, v85
    v_cvt_pk_bf16_f32 v107, v86, v87
    v_sub_f32 v88, v88, v27
    v_exp_f32 v88, v88
    v_sub_f32 v89, v89, v27
    v_exp_f32 v89, v89
    v_sub_f32 v90, v90, v27
    v_exp_f32 v90, v90
    v_sub_f32 v91, v91, v27
    v_exp_f32 v91, v91
    v_sub_f32 v92, v92, v27
    v_exp_f32 v92, v92
    v_sub_f32 v93, v93, v27
    v_exp_f32 v93, v93
    v_sub_f32 v94, v94, v27
    v_exp_f32 v94, v94
    v_sub_f32 v95, v95, v27
    v_exp_f32 v95, v95
    v_add_f32 v22, v88, v89
    v_add_f32 v22, v22, v90
    v_add_f32 v22, v22, v91
    v_add_f32 v22, v22, v92
    v_add_f32 v22, v22, v93
    v_add_f32 v22, v22, v94
    v_add_f32 v22, v22, v95
    v_cvt_pk_bf16_f32 v108, v88, v89
    v_cvt_pk_bf16_f32 v109, v90, v91
    v_cvt_pk_bf16_f32 v110, v92, v93
    v_cvt_pk_bf16_f32 v111, v94, v95
    v_add_u32 v0, 0, v10
    buffer_load_dwordx4 v[124:127], v0, s[16:19], s56 offen
    buffer_load_dwordx4 v[128:131], v0, s[16:19], s56 offen offset:64
    buffer_load_dwordx4 v[132:135], v0, s[16:19], s56 offen offset:128
    buffer_load_dwordx4 v[136:139], v0, s[16:19], s56 offen offset:192
    buffer_load_dwordx4 v[140:143], v0, s[16:19], s56 offen offset:256
    buffer_load_dwordx4 v[144:147], v0, s[16:19], s56 offen offset:320
    s_waitcnt vmcnt(0)
    s_waitcnt vmcnt(0)
    v_mfma_f32_16x16x32_bf16 v[64:67], v[124:127], v[160:163], 0
    v_mfma_f32_16x16x32_bf16 v[64:67], v[128:131], v[164:167], v[64:67]
    v_mfma_f32_16x16x32_bf16 v[64:67], v[132:135], v[168:171], v[64:67]
    v_mfma_f32_16x16x32_bf16 v[64:67], v[136:139], v[172:175], v[64:67]
    v_mfma_f32_16x16x32_bf16 v[64:67], v[140:143], v[176:179], v[64:67]
    v_mfma_f32_16x16x32_bf16 v[64:67], v[144:147], v[180:183], v[64:67]
    v_mfma_f32_16x16x32_bf16 v[72:75], v[124:127], v[184:187], 0
    v_mfma_f32_16x16x32_bf16 v[72:75], v[128:131], v[188:191], v[72:75]
    v_mfma_f32_16x16x32_bf16 v[72:75], v[132:135], v[192:195], v[72:75]
    v_mfma_f32_16x16x32_bf16 v[72:75], v[136:139], v[196:199], v[72:75]
    v_mfma_f32_16x16x32_bf16 v[72:75], v[140:143], v[200:203], v[72:75]
    v_mfma_f32_16x16x32_bf16 v[72:75], v[144:147], v[204:207], v[72:75]
    v_mfma_f32_16x16x32_bf16 v[80:83], v[124:127], v[208:211], 0
    v_mfma_f32_16x16x32_bf16 v[80:83], v[128:131], v[212:215], v[80:83]
    v_mfma_f32_16x16x32_bf16 v[80:83], v[132:135], v[216:219], v[80:83]
    v_mfma_f32_16x16x32_bf16 v[80:83], v[136:139], v[220:223], v[80:83]
    v_mfma_f32_16x16x32_bf16 v[80:83], v[140:143], v[224:227], v[80:83]
    v_mfma_f32_16x16x32_bf16 v[80:83], v[144:147], v[228:231], v[80:83]
    s_nop 15
    v_add_u32 v0, 6144, v10
    buffer_load_dwordx4 v[124:127], v0, s[16:19], s56 offen
    buffer_load_dwordx4 v[128:131], v0, s[16:19], s56 offen offset:64
    buffer_load_dwordx4 v[132:135], v0, s[16:19], s56 offen offset:128
    buffer_load_dwordx4 v[136:139], v0, s[16:19], s56 offen offset:192
    buffer_load_dwordx4 v[140:143], v0, s[16:19], s56 offen offset:256
    buffer_load_dwordx4 v[144:147], v0, s[16:19], s56 offen offset:320
    s_waitcnt vmcnt(0)
    s_waitcnt vmcnt(0)
    v_mfma_f32_16x16x32_bf16 v[68:71], v[124:127], v[160:163], 0
    v_mfma_f32_16x16x32_bf16 v[68:71], v[128:131], v[164:167], v[68:71]
    v_mfma_f32_16x16x32_bf16 v[68:71], v[132:135], v[168:171], v[68:71]
    v_mfma_f32_16x16x32_bf16 v[68:71], v[136:139], v[172:175], v[68:71]
    v_mfma_f32_16x16x32_bf16 v[68:71], v[140:143], v[176:179], v[68:71]
    v_mfma_f32_16x16x32_bf16 v[68:71], v[144:147], v[180:183], v[68:71]
    v_mfma_f32_16x16x32_bf16 v[76:79], v[124:127], v[184:187], 0
    v_mfma_f32_16x16x32_bf16 v[76:79], v[128:131], v[188:191], v[76:79]
    v_mfma_f32_16x16x32_bf16 v[76:79], v[132:135], v[192:195], v[76:79]
    v_mfma_f32_16x16x32_bf16 v[76:79], v[136:139], v[196:199], v[76:79]
    v_mfma_f32_16x16x32_bf16 v[76:79], v[140:143], v[200:203], v[76:79]
    v_mfma_f32_16x16x32_bf16 v[76:79], v[144:147], v[204:207], v[76:79]
    v_mfma_f32_16x16x32_bf16 v[84:87], v[124:127], v[208:211], 0
    v_mfma_f32_16x16x32_bf16 v[84:87], v[128:131], v[212:215], v[84:87]
    v_mfma_f32_16x16x32_bf16 v[84:87], v[132:135], v[216:219], v[84:87]
    v_mfma_f32_16x16x32_bf16 v[84:87], v[136:139], v[220:223], v[84:87]
    v_mfma_f32_16x16x32_bf16 v[84:87], v[140:143], v[224:227], v[84:87]
    v_mfma_f32_16x16x32_bf16 v[84:87], v[144:147], v[228:231], v[84:87]
    s_nop 15
    v_sub_f32 v64, v64, v24
    v_exp_f32 v64, v64
    v_sub_f32 v65, v65, v24
    v_exp_f32 v65, v65
    v_sub_f32 v66, v66, v24
    v_exp_f32 v66, v66
    v_sub_f32 v67, v67, v24
    v_exp_f32 v67, v67
    v_sub_f32 v68, v68, v24
    v_exp_f32 v68, v68
    v_sub_f32 v69, v69, v24
    v_exp_f32 v69, v69
    v_sub_f32 v70, v70, v24
    v_exp_f32 v70, v70
    v_sub_f32 v71, v71, v24
    v_exp_f32 v71, v71
    v_add_f32 v16, v16, v64
    v_add_f32 v16, v16, v65
    v_add_f32 v16, v16, v66
    v_add_f32 v16, v16, v67
    v_add_f32 v16, v16, v68
    v_add_f32 v16, v16, v69
    v_add_f32 v16, v16, v70
    v_add_f32 v16, v16, v71
    v_cvt_pk_bf16_f32 v112, v64, v65
    v_cvt_pk_bf16_f32 v113, v66, v67
    v_cvt_pk_bf16_f32 v114, v68, v69
    v_cvt_pk_bf16_f32 v115, v70, v71
    v_sub_f32 v72, v72, v25
    v_exp_f32 v72, v72
    v_sub_f32 v73, v73, v25
    v_exp_f32 v73, v73
    v_sub_f32 v74, v74, v25
    v_exp_f32 v74, v74
    v_sub_f32 v75, v75, v25
    v_exp_f32 v75, v75
    v_sub_f32 v76, v76, v25
    v_exp_f32 v76, v76
    v_sub_f32 v77, v77, v25
    v_exp_f32 v77, v77
    v_sub_f32 v78, v78, v25
    v_exp_f32 v78, v78
    v_sub_f32 v79, v79, v25
    v_exp_f32 v79, v79
    v_add_f32 v17, v17, v72
    v_add_f32 v17, v17, v73
    v_add_f32 v17, v17, v74
    v_add_f32 v17, v17, v75
    v_add_f32 v17, v17, v76
    v_add_f32 v17, v17, v77
    v_add_f32 v17, v17, v78
    v_add_f32 v17, v17, v79
    v_cvt_pk_bf16_f32 v116, v72, v73
    v_cvt_pk_bf16_f32 v117, v74, v75
    v_cvt_pk_bf16_f32 v118, v76, v77
    v_cvt_pk_bf16_f32 v119, v78, v79
    v_sub_f32 v80, v80, v26
    v_exp_f32 v80, v80
    v_sub_f32 v81, v81, v26
    v_exp_f32 v81, v81
    v_sub_f32 v82, v82, v26
    v_exp_f32 v82, v82
    v_sub_f32 v83, v83, v26
    v_exp_f32 v83, v83
    v_sub_f32 v84, v84, v26
    v_exp_f32 v84, v84
    v_sub_f32 v85, v85, v26
    v_exp_f32 v85, v85
    v_sub_f32 v86, v86, v26
    v_exp_f32 v86, v86
    v_sub_f32 v87, v87, v26
    v_exp_f32 v87, v87
    v_add_f32 v18, v18, v80
    v_add_f32 v18, v18, v81
    v_add_f32 v18, v18, v82
    v_add_f32 v18, v18, v83
    v_add_f32 v18, v18, v84
    v_add_f32 v18, v18, v85
    v_add_f32 v18, v18, v86
    v_add_f32 v18, v18, v87
    v_cvt_pk_bf16_f32 v120, v80, v81
    v_cvt_pk_bf16_f32 v121, v82, v83
    v_cvt_pk_bf16_f32 v122, v84, v85
    v_cvt_pk_bf16_f32 v123, v86, v87
    s_cmp_eq_u32 s54, 0
    s_cbranch_scc1 L_rare_0_0_ret
    s_add_u32 s56, s56, 12288
    v_add_u32 v0, 0, v10
    buffer_load_dwordx4 v[124:127], v0, s[16:19], s56 offen
    buffer_load_dwordx4 v[128:131], v0, s[16:19], s56 offen offset:64
    buffer_load_dwordx4 v[132:135], v0, s[16:19], s56 offen offset:128
    buffer_load_dwordx4 v[136:139], v0, s[16:19], s56 offen offset:192
    buffer_load_dwordx4 v[140:143], v0, s[16:19], s56 offen offset:256
    buffer_load_dwordx4 v[144:147], v0, s[16:19], s56 offen offset:320
    s_waitcnt vmcnt(0)
    s_waitcnt vmcnt(0)
    v_mfma_f32_16x16x32_bf16 v[64:67], v[124:127], v[160:163], v[48:51]
    v_mfma_f32_16x16x32_bf16 v[64:67], v[128:131], v[164:167], v[64:67]
    v_mfma_f32_16x16x32_bf16 v[64:67], v[132:135], v[168:171], v[64:67]
    v_mfma_f32_16x16x32_bf16 v[64:67], v[136:139], v[172:175], v[64:67]
    v_mfma_f32_16x16x32_bf16 v[64:67], v[140:143], v[176:179], v[64:67]
    v_mfma_f32_16x16x32_bf16 v[64:67], v[144:147], v[180:183], v[64:67]
    v_mfma_f32_16x16x32_bf16 v[72:75], v[124:127], v[184:187], v[52:55]
    v_mfma_f32_16x16x32_bf16 v[72:75], v[128:131], v[188:191], v[72:75]
    v_mfma_f32_16x16x32_bf16 v[72:75], v[132:135], v[192:195], v[72:75]
    v_mfma_f32_16x16x32_bf16 v[72:75], v[136:139], v[196:199], v[72:75]
    v_mfma_f32_16x16x32_bf16 v[72:75], v[140:143], v[200:203], v[72:75]
    v_mfma_f32_16x16x32_bf16 v[72:75], v[144:147], v[204:207], v[72:75]
    v_mfma_f32_16x16x32_bf16 v[80:83], v[124:127], v[208:211], v[56:59]
    v_mfma_f32_16x16x32_bf16 v[80:83], v[128:131], v[212:215], v[80:83]
    v_mfma_f32_16x16x32_bf16 v[80:83], v[132:135], v[216:219], v[80:83]
    v_mfma_f32_16x16x32_bf16 v[80:83], v[136:139], v[220:223], v[80:83]
    v_mfma_f32_16x16x32_bf16 v[80:83], v[140:143], v[224:227], v[80:83]
    v_mfma_f32_16x16x32_bf16 v[80:83], v[144:147], v[228:231], v[80:83]
    v_mfma_f32_16x16x32_bf16 v[88:91], v[124:127], v[232:235], v[60:63]
    v_mfma_f32_16x16x32_bf16 v[88:91], v[128:131], v[236:239], v[88:91]
    v_mfma_f32_16x16x32_bf16 v[88:91], v[132:135], v[240:243], v[88:91]
    v_mfma_f32_16x16x32_bf16 v[88:91], v[136:139], v[244:247], v[88:91]
    v_mfma_f32_16x16x32_bf16 v[88:91], v[140:143], v[248:251], v[88:91]
    v_mfma_f32_16x16x32_bf16 v[88:91], v[144:147], v[252:255], v[88:91]
    s_nop 15
    v_add_u32 v0, 6144, v10
    buffer_load_dwordx4 v[124:127], v0, s[16:19], s56 offen
    buffer_load_dwordx4 v[128:131], v0, s[16:19], s56 offen offset:64
    buffer_load_dwordx4 v[132:135], v0, s[16:19], s56 offen offset:128
    buffer_load_dwordx4 v[136:139], v0, s[16:19], s56 offen offset:192
    buffer_load_dwordx4 v[140:143], v0, s[16:19], s56 offen offset:256
    buffer_load_dwordx4 v[144:147], v0, s[16:19], s56 offen offset:320
    s_waitcnt vmcnt(0)
    s_waitcnt vmcnt(0)
    v_mfma_f32_16x16x32_bf16 v[68:71], v[124:127], v[160:163], v[48:51]
    v_mfma_f32_16x16x32_bf16 v[68:71], v[128:131], v[164:167], v[68:71]
    v_mfma_f32_16x16x32_bf16 v[68:71], v[132:135], v[168:171], v[68:71]
    v_mfma_f32_16x16x32_bf16 v[68:71], v[136:139], v[172:175], v[68:71]
    v_mfma_f32_16x16x32_bf16 v[68:71], v[140:143], v[176:179], v[68:71]
    v_mfma_f32_16x16x32_bf16 v[68:71], v[144:147], v[180:183], v[68:71]
    v_mfma_f32_16x16x32_bf16 v[76:79], v[124:127], v[184:187], v[52:55]
    v_mfma_f32_16x16x32_bf16 v[76:79], v[128:131], v[188:191], v[76:79]
    v_mfma_f32_16x16x32_bf16 v[76:79], v[132:135], v[192:195], v[76:79]
    v_mfma_f32_16x16x32_bf16 v[76:79], v[136:139], v[196:199], v[76:79]
    v_mfma_f32_16x16x32_bf16 v[76:79], v[140:143], v[200:203], v[76:79]
    v_mfma_f32_16x16x32_bf16 v[76:79], v[144:147], v[204:207], v[76:79]
    v_mfma_f32_16x16x32_bf16 v[84:87], v[124:127], v[208:211], v[56:59]
    v_mfma_f32_16x16x32_bf16 v[84:87], v[128:131], v[212:215], v[84:87]
    v_mfma_f32_16x16x32_bf16 v[84:87], v[132:135], v[216:219], v[84:87]
    v_mfma_f32_16x16x32_bf16 v[84:87], v[136:139], v[220:223], v[84:87]
    v_mfma_f32_16x16x32_bf16 v[84:87], v[140:143], v[224:227], v[84:87]
    v_mfma_f32_16x16x32_bf16 v[84:87], v[144:147], v[228:231], v[84:87]
    v_mfma_f32_16x16x32_bf16 v[92:95], v[124:127], v[232:235], v[60:63]
    v_mfma_f32_16x16x32_bf16 v[92:95], v[128:131], v[236:239], v[92:95]
    v_mfma_f32_16x16x32_bf16 v[92:95], v[132:135], v[240:243], v[92:95]
    v_mfma_f32_16x16x32_bf16 v[92:95], v[136:139], v[244:247], v[92:95]
    v_mfma_f32_16x16x32_bf16 v[92:95], v[140:143], v[248:251], v[92:95]
    v_mfma_f32_16x16x32_bf16 v[92:95], v[144:147], v[252:255], v[92:95]
    s_nop 15
L_rare_0_0_ret:
    s_cmp_eq_u32 s36, 0
    s_cbranch_scc1 L_h0_2c_replay
    s_cmp_eq_u32 s36, 4
    s_cbranch_scc1 L_b00_5cs_replay
    s_cmp_eq_u32 s36, 8
    s_cbranch_scc1 L_b01_5cs_replay
    s_cmp_eq_u32 s36, 12
    s_cbranch_scc1 L_s0_2c_replay
    s_endpgm
L_h0_2c_replay:
    s_nop 4
    s_branch L_h0_2c_back
L_b00_5cs_replay:
    v_exp_f32 v64, v64
    v_exp_f32 v65, v65
    s_nop 4
    s_branch L_b00_5cs_back
L_b01_5cs_replay:
    v_exp_f32 v64, v64
    v_exp_f32 v65, v65
    s_nop 4
    s_branch L_b01_5cs_back
L_s0_2c_replay:
    v_exp_f32 v64, v64
    v_exp_f32 v65, v65
    s_nop 0
    v_cvt_pk_bf16_f32 v124, v64, v65
    v_exp_f32 v66, v66
    v_exp_f32 v67, v67
    s_nop 0
    v_cvt_pk_bf16_f32 v125, v66, v67
    v_add_f32 v19, v64, v65
    v_add_f32 v19, v19, v66
    v_add_f32 v19, v19, v67
    v_exp_f32 v72, v72
    v_exp_f32 v73, v73
    s_nop 0
    v_cvt_pk_bf16_f32 v128, v72, v73
    v_add_f32 v20, v72, v73
    v_exp_f32 v74, v74
    s_nop 0
    v_add_f32 v20, v20, v74
    s_nop 4
    s_branch L_s0_2c_back
L_b00_3cs_rare:
    s_mov_b32 s58, 0
L_b00_3cs_spin:
    ds_read_b32 v30, v46
    s_add_u32 s58, s58, 1
    s_waitcnt lgkmcnt(0)
    v_cmp_gt_u32 s[94:95], s93, v30
    s_cmp_gt_u32 s58, 0x40000
    s_cbranch_scc1 L_b00_3cs_spun
    s_cmp_lg_u64 s[94:95], 0
    s_cbranch_scc1 L_b00_3cs_spin
L_b00_3cs_spun:
    v_cmp_lt_f32 vcc, s35, v28
    s_nop 4
    s_cbranch_vccz L_b00_3cs_back
    s_mov_b32 s36, 2
    s_mov_b32 s54, 1
    s_mov_b32 s55, 0
    s_sub_u32 s56, 6, s31
    s_mul_i32 s56, s56, 49152
    s_add_u32 s55, s55, s56
    s_add_u32 s55, s55, 24576
    s_branch L_rare_0_1
L_b01_3cs_rare:
    s_mov_b32 s58, 0
L_b01_3cs_spin:
    ds_read_b32 v30, v46
    s_add_u32 s58, s58, 1
    s_waitcnt lgkmcnt(0)
    v_cmp_gt_u32 s[94:95], s93, v30
    s_cmp_gt_u32 s58, 0x40000
    s_cbranch_scc1 L_b01_3cs_spun
    s_cmp_lg_u64 s[94:95], 0
    s_cbranch_scc1 L_b01_3cs_spin
L_b01_3cs_spun:
    v_cmp_lt_f32 vcc, s35, v28
    s_nop 4
    s_cbranch_vccz L_b01_3cs_back
    s_mov_b32 s36, 6
    s_mov_b32 s54, 1
    s_mov_b32 s55, 393216
    s_sub_u32 s56, 6, s31
    s_mul_i32 s56, s56, 49152
    s_add_u32 s55, s55, s56
    s_add_u32 s55, s55, 24576
    s_branch L_rare_0_1
L_t00_31c_rare:
    s_mov_b32 s36, 10
    s_mov_b32 s54, 0
    s_mov_b32 s55, 0
    s_add_u32 s55, s55, 368640
    s_branch L_rare_0_1
L_t01_31c_rare:
    s_mov_b32 s36, 11
    s_mov_b32 s54, 0
    s_mov_b32 s55, 393216
    s_add_u32 s55, s55, 368640
    s_branch L_rare_0_1
L_rare_0_1:
    s_waitcnt vmcnt(0) lgkmcnt(0)
    s_nop 15
    s_nop 15
    s_add_u32 s56, s55, 12288
    v_sub_f32 v24, 0, v48
    v_sub_f32 v25, 0, v52
    v_sub_f32 v26, 0, v56
    v_sub_f32 v27, 0, v60
    v_add_u32 v0, 0, v10
    buffer_load_dwordx4 v[96:99], v0, s[16:19], s55 offen
    buffer_load_dwordx4 v[100:103], v0, s[16:19], s55 offen offset:64
    buffer_load_dwordx4 v[104:107], v0, s[16:19], s55 offen offset:128
    buffer_load_dwordx4 v[108:111], v0, s[16:19], s55 offen offset:192
    buffer_load_dwordx4 v[112:115], v0, s[16:19], s55 offen offset:256
    buffer_load_dwordx4 v[116:119], v0, s[16:19], s55 offen offset:320
    s_waitcnt vmcnt(0)
    s_waitcnt vmcnt(0)
    v_mfma_f32_16x16x32_bf16 v[64:67], v[96:99], v[160:163], 0
    v_mfma_f32_16x16x32_bf16 v[64:67], v[100:103], v[164:167], v[64:67]
    v_mfma_f32_16x16x32_bf16 v[64:67], v[104:107], v[168:171], v[64:67]
    v_mfma_f32_16x16x32_bf16 v[64:67], v[108:111], v[172:175], v[64:67]
    v_mfma_f32_16x16x32_bf16 v[64:67], v[112:115], v[176:179], v[64:67]
    v_mfma_f32_16x16x32_bf16 v[64:67], v[116:119], v[180:183], v[64:67]
    v_mfma_f32_16x16x32_bf16 v[72:75], v[96:99], v[184:187], 0
    v_mfma_f32_16x16x32_bf16 v[72:75], v[100:103], v[188:191], v[72:75]
    v_mfma_f32_16x16x32_bf16 v[72:75], v[104:107], v[192:195], v[72:75]
    v_mfma_f32_16x16x32_bf16 v[72:75], v[108:111], v[196:199], v[72:75]
    v_mfma_f32_16x16x32_bf16 v[72:75], v[112:115], v[200:203], v[72:75]
    v_mfma_f32_16x16x32_bf16 v[72:75], v[116:119], v[204:207], v[72:75]
    v_mfma_f32_16x16x32_bf16 v[80:83], v[96:99], v[208:211], 0
    v_mfma_f32_16x16x32_bf16 v[80:83], v[100:103], v[212:215], v[80:83]
    v_mfma_f32_16x16x32_bf16 v[80:83], v[104:107], v[216:219], v[80:83]
    v_mfma_f32_16x16x32_bf16 v[80:83], v[108:111], v[220:223], v[80:83]
    v_mfma_f32_16x16x32_bf16 v[80:83], v[112:115], v[224:227], v[80:83]
    v_mfma_f32_16x16x32_bf16 v[80:83], v[116:119], v[228:231], v[80:83]
    v_mfma_f32_16x16x32_bf16 v[88:91], v[96:99], v[232:235], 0
    v_mfma_f32_16x16x32_bf16 v[88:91], v[100:103], v[236:239], v[88:91]
    v_mfma_f32_16x16x32_bf16 v[88:91], v[104:107], v[240:243], v[88:91]
    v_mfma_f32_16x16x32_bf16 v[88:91], v[108:111], v[244:247], v[88:91]
    v_mfma_f32_16x16x32_bf16 v[88:91], v[112:115], v[248:251], v[88:91]
    v_mfma_f32_16x16x32_bf16 v[88:91], v[116:119], v[252:255], v[88:91]
    s_nop 15
    v_add_u32 v0, 6144, v10
    buffer_load_dwordx4 v[96:99], v0, s[16:19], s55 offen
    buffer_load_dwordx4 v[100:103], v0, s[16:19], s55 offen offset:64
    buffer_load_dwordx4 v[104:107], v0, s[16:19], s55 offen offset:128
    buffer_load_dwordx4 v[108:111], v0, s[16:19], s55 offen offset:192
    buffer_load_dwordx4 v[112:115], v0, s[16:19], s55 offen offset:256
    buffer_load_dwordx4 v[116:119], v0, s[16:19], s55 offen offset:320
    s_waitcnt vmcnt(0)
    s_waitcnt vmcnt(0)
    v_mfma_f32_16x16x32_bf16 v[68:71], v[96:99], v[160:163], 0
    v_mfma_f32_16x16x32_bf16 v[68:71], v[100:103], v[164:167], v[68:71]
    v_mfma_f32_16x16x32_bf16 v[68:71], v[104:107], v[168:171], v[68:71]
    v_mfma_f32_16x16x32_bf16 v[68:71], v[108:111], v[172:175], v[68:71]
    v_mfma_f32_16x16x32_bf16 v[68:71], v[112:115], v[176:179], v[68:71]
    v_mfma_f32_16x16x32_bf16 v[68:71], v[116:119], v[180:183], v[68:71]
    v_mfma_f32_16x16x32_bf16 v[76:79], v[96:99], v[184:187], 0
    v_mfma_f32_16x16x32_bf16 v[76:79], v[100:103], v[188:191], v[76:79]
    v_mfma_f32_16x16x32_bf16 v[76:79], v[104:107], v[192:195], v[76:79]
    v_mfma_f32_16x16x32_bf16 v[76:79], v[108:111], v[196:199], v[76:79]
    v_mfma_f32_16x16x32_bf16 v[76:79], v[112:115], v[200:203], v[76:79]
    v_mfma_f32_16x16x32_bf16 v[76:79], v[116:119], v[204:207], v[76:79]
    v_mfma_f32_16x16x32_bf16 v[84:87], v[96:99], v[208:211], 0
    v_mfma_f32_16x16x32_bf16 v[84:87], v[100:103], v[212:215], v[84:87]
    v_mfma_f32_16x16x32_bf16 v[84:87], v[104:107], v[216:219], v[84:87]
    v_mfma_f32_16x16x32_bf16 v[84:87], v[108:111], v[220:223], v[84:87]
    v_mfma_f32_16x16x32_bf16 v[84:87], v[112:115], v[224:227], v[84:87]
    v_mfma_f32_16x16x32_bf16 v[84:87], v[116:119], v[228:231], v[84:87]
    v_mfma_f32_16x16x32_bf16 v[92:95], v[96:99], v[232:235], 0
    v_mfma_f32_16x16x32_bf16 v[92:95], v[100:103], v[236:239], v[92:95]
    v_mfma_f32_16x16x32_bf16 v[92:95], v[104:107], v[240:243], v[92:95]
    v_mfma_f32_16x16x32_bf16 v[92:95], v[108:111], v[244:247], v[92:95]
    v_mfma_f32_16x16x32_bf16 v[92:95], v[112:115], v[248:251], v[92:95]
    v_mfma_f32_16x16x32_bf16 v[92:95], v[116:119], v[252:255], v[92:95]
    s_nop 15
    v_max3_f32 v24, v24, v64, v65
    v_max3_f32 v24, v24, v66, v67
    v_max3_f32 v24, v24, v68, v69
    v_max3_f32 v24, v24, v70, v71
    v_max3_f32 v25, v25, v72, v73
    v_max3_f32 v25, v25, v74, v75
    v_max3_f32 v25, v25, v76, v77
    v_max3_f32 v25, v25, v78, v79
    v_max3_f32 v26, v26, v80, v81
    v_max3_f32 v26, v26, v82, v83
    v_max3_f32 v26, v26, v84, v85
    v_max3_f32 v26, v26, v86, v87
    v_max3_f32 v27, v27, v88, v89
    v_max3_f32 v27, v27, v90, v91
    v_max3_f32 v27, v27, v92, v93
    v_max3_f32 v27, v27, v94, v95
    v_add_u32 v0, 0, v10
    buffer_load_dwordx4 v[96:99], v0, s[16:19], s56 offen
    buffer_load_dwordx4 v[100:103], v0, s[16:19], s56 offen offset:64
    buffer_load_dwordx4 v[104:107], v0, s[16:19], s56 offen offset:128
    buffer_load_dwordx4 v[108:111], v0, s[16:19], s56 offen offset:192
    buffer_load_dwordx4 v[112:115], v0, s[16:19], s56 offen offset:256
    buffer_load_dwordx4 v[116:119], v0, s[16:19], s56 offen offset:320
    s_waitcnt vmcnt(0)
    s_waitcnt vmcnt(0)
    v_mfma_f32_16x16x32_bf16 v[64:67], v[96:99], v[160:163], 0
    v_mfma_f32_16x16x32_bf16 v[64:67], v[100:103], v[164:167], v[64:67]
    v_mfma_f32_16x16x32_bf16 v[64:67], v[104:107], v[168:171], v[64:67]
    v_mfma_f32_16x16x32_bf16 v[64:67], v[108:111], v[172:175], v[64:67]
    v_mfma_f32_16x16x32_bf16 v[64:67], v[112:115], v[176:179], v[64:67]
    v_mfma_f32_16x16x32_bf16 v[64:67], v[116:119], v[180:183], v[64:67]
    v_mfma_f32_16x16x32_bf16 v[72:75], v[96:99], v[184:187], 0
    v_mfma_f32_16x16x32_bf16 v[72:75], v[100:103], v[188:191], v[72:75]
    v_mfma_f32_16x16x32_bf16 v[72:75], v[104:107], v[192:195], v[72:75]
    v_mfma_f32_16x16x32_bf16 v[72:75], v[108:111], v[196:199], v[72:75]
    v_mfma_f32_16x16x32_bf16 v[72:75], v[112:115], v[200:203], v[72:75]
    v_mfma_f32_16x16x32_bf16 v[72:75], v[116:119], v[204:207], v[72:75]
    v_mfma_f32_16x16x32_bf16 v[80:83], v[96:99], v[208:211], 0
    v_mfma_f32_16x16x32_bf16 v[80:83], v[100:103], v[212:215], v[80:83]
    v_mfma_f32_16x16x32_bf16 v[80:83], v[104:107], v[216:219], v[80:83]
    v_mfma_f32_16x16x32_bf16 v[80:83], v[108:111], v[220:223], v[80:83]
    v_mfma_f32_16x16x32_bf16 v[80:83], v[112:115], v[224:227], v[80:83]
    v_mfma_f32_16x16x32_bf16 v[80:83], v[116:119], v[228:231], v[80:83]
    s_nop 15
    v_add_u32 v0, 6144, v10
    buffer_load_dwordx4 v[96:99], v0, s[16:19], s56 offen
    buffer_load_dwordx4 v[100:103], v0, s[16:19], s56 offen offset:64
    buffer_load_dwordx4 v[104:107], v0, s[16:19], s56 offen offset:128
    buffer_load_dwordx4 v[108:111], v0, s[16:19], s56 offen offset:192
    buffer_load_dwordx4 v[112:115], v0, s[16:19], s56 offen offset:256
    buffer_load_dwordx4 v[116:119], v0, s[16:19], s56 offen offset:320
    s_waitcnt vmcnt(0)
    s_waitcnt vmcnt(0)
    v_mfma_f32_16x16x32_bf16 v[68:71], v[96:99], v[160:163], 0
    v_mfma_f32_16x16x32_bf16 v[68:71], v[100:103], v[164:167], v[68:71]
    v_mfma_f32_16x16x32_bf16 v[68:71], v[104:107], v[168:171], v[68:71]
    v_mfma_f32_16x16x32_bf16 v[68:71], v[108:111], v[172:175], v[68:71]
    v_mfma_f32_16x16x32_bf16 v[68:71], v[112:115], v[176:179], v[68:71]
    v_mfma_f32_16x16x32_bf16 v[68:71], v[116:119], v[180:183], v[68:71]
    v_mfma_f32_16x16x32_bf16 v[76:79], v[96:99], v[184:187], 0
    v_mfma_f32_16x16x32_bf16 v[76:79], v[100:103], v[188:191], v[76:79]
    v_mfma_f32_16x16x32_bf16 v[76:79], v[104:107], v[192:195], v[76:79]
    v_mfma_f32_16x16x32_bf16 v[76:79], v[108:111], v[196:199], v[76:79]
    v_mfma_f32_16x16x32_bf16 v[76:79], v[112:115], v[200:203], v[76:79]
    v_mfma_f32_16x16x32_bf16 v[76:79], v[116:119], v[204:207], v[76:79]
    v_mfma_f32_16x16x32_bf16 v[84:87], v[96:99], v[208:211], 0
    v_mfma_f32_16x16x32_bf16 v[84:87], v[100:103], v[212:215], v[84:87]
    v_mfma_f32_16x16x32_bf16 v[84:87], v[104:107], v[216:219], v[84:87]
    v_mfma_f32_16x16x32_bf16 v[84:87], v[108:111], v[220:223], v[84:87]
    v_mfma_f32_16x16x32_bf16 v[84:87], v[112:115], v[224:227], v[84:87]
    v_mfma_f32_16x16x32_bf16 v[84:87], v[116:119], v[228:231], v[84:87]
    s_nop 15
    v_max3_f32 v24, v24, v64, v65
    v_max3_f32 v24, v24, v66, v67
    v_max3_f32 v24, v24, v68, v69
    v_max3_f32 v24, v24, v70, v71
    v_max3_f32 v25, v25, v72, v73
    v_max3_f32 v25, v25, v74, v75
    v_max3_f32 v25, v25, v76, v77
    v_max3_f32 v25, v25, v78, v79
    v_max3_f32 v26, v26, v80, v81
    v_max3_f32 v26, v26, v82, v83
    v_max3_f32 v26, v26, v84, v85
    v_max3_f32 v26, v26, v86, v87
    s_mov_b32 s59, 1
    s_nop 4
    s_branch L_rescale
L_rare_0_1_b:
    v_add_u32 v0, 0, v10
    buffer_load_dwordx4 v[96:99], v0, s[16:19], s55 offen
    buffer_load_dwordx4 v[100:103], v0, s[16:19], s55 offen offset:64
    buffer_load_dwordx4 v[104:107], v0, s[16:19], s55 offen offset:128
    buffer_load_dwordx4 v[108:111], v0, s[16:19], s55 offen offset:192
    buffer_load_dwordx4 v[112:115], v0, s[16:19], s55 offen offset:256
    buffer_load_dwordx4 v[116:119], v0, s[16:19], s55 offen offset:320
    s_waitcnt vmcnt(0)
    s_waitcnt vmcnt(0)
    v_mfma_f32_16x16x32_bf16 v[64:67], v[96:99], v[160:163], 0
    v_mfma_f32_16x16x32_bf16 v[64:67], v[100:103], v[164:167], v[64:67]
    v_mfma_f32_16x16x32_bf16 v[64:67], v[104:107], v[168:171], v[64:67]
    v_mfma_f32_16x16x32_bf16 v[64:67], v[108:111], v[172:175], v[64:67]
    v_mfma_f32_16x16x32_bf16 v[64:67], v[112:115], v[176:179], v[64:67]
    v_mfma_f32_16x16x32_bf16 v[64:67], v[116:119], v[180:183], v[64:67]
    v_mfma_f32_16x16x32_bf16 v[72:75], v[96:99], v[184:187], 0
    v_mfma_f32_16x16x32_bf16 v[72:75], v[100:103], v[188:191], v[72:75]
    v_mfma_f32_16x16x32_bf16 v[72:75], v[104:107], v[192:195], v[72:75]
    v_mfma_f32_16x16x32_bf16 v[72:75], v[108:111], v[196:199], v[72:75]
    v_mfma_f32_16x16x32_bf16 v[72:75], v[112:115], v[200:203], v[72:75]
    v_mfma_f32_16x16x32_bf16 v[72:75], v[116:119], v[204:207], v[72:75]
    v_mfma_f32_16x16x32_bf16 v[80:83], v[96:99], v[208:211], 0
    v_mfma_f32_16x16x32_bf16 v[80:83], v[100:103], v[212:215], v[80:83]
    v_mfma_f32_16x16x32_bf16 v[80:83], v[104:107], v[216:219], v[80:83]
    v_mfma_f32_16x16x32_bf16 v[80:83], v[108:111], v[220:223], v[80:83]
    v_mfma_f32_16x16x32_bf16 v[80:83], v[112:115], v[224:227], v[80:83]
    v_mfma_f32_16x16x32_bf16 v[80:83], v[116:119], v[228:231], v[80:83]
    v_mfma_f32_16x16x32_bf16 v[88:91], v[96:99], v[232:235], 0
    v_mfma_f32_16x16x32_bf16 v[88:91], v[100:103], v[236:239], v[88:91]
    v_mfma_f32_16x16x32_bf16 v[88:91], v[104:107], v[240:243], v[88:91]
    v_mfma_f32_16x16x32_bf16 v[88:91], v[108:111], v[244:247], v[88:91]
    v_mfma_f32_16x16x32_bf16 v[88:91], v[112:115], v[248:251], v[88:91]
    v_mfma_f32_16x16x32_bf16 v[88:91], v[116:119], v[252:255], v[88:91]
    s_nop 15
    v_add_u32 v0, 6144, v10
    buffer_load_dwordx4 v[96:99], v0, s[16:19], s55 offen
    buffer_load_dwordx4 v[100:103], v0, s[16:19], s55 offen offset:64
    buffer_load_dwordx4 v[104:107], v0, s[16:19], s55 offen offset:128
    buffer_load_dwordx4 v[108:111], v0, s[16:19], s55 offen offset:192
    buffer_load_dwordx4 v[112:115], v0, s[16:19], s55 offen offset:256
    buffer_load_dwordx4 v[116:119], v0, s[16:19], s55 offen offset:320
    s_waitcnt vmcnt(0)
    s_waitcnt vmcnt(0)
    v_mfma_f32_16x16x32_bf16 v[68:71], v[96:99], v[160:163], 0
    v_mfma_f32_16x16x32_bf16 v[68:71], v[100:103], v[164:167], v[68:71]
    v_mfma_f32_16x16x32_bf16 v[68:71], v[104:107], v[168:171], v[68:71]
    v_mfma_f32_16x16x32_bf16 v[68:71], v[108:111], v[172:175], v[68:71]
    v_mfma_f32_16x16x32_bf16 v[68:71], v[112:115], v[176:179], v[68:71]
    v_mfma_f32_16x16x32_bf16 v[68:71], v[116:119], v[180:183], v[68:71]
    v_mfma_f32_16x16x32_bf16 v[76:79], v[96:99], v[184:187], 0
    v_mfma_f32_16x16x32_bf16 v[76:79], v[100:103], v[188:191], v[76:79]
    v_mfma_f32_16x16x32_bf16 v[76:79], v[104:107], v[192:195], v[76:79]
    v_mfma_f32_16x16x32_bf16 v[76:79], v[108:111], v[196:199], v[76:79]
    v_mfma_f32_16x16x32_bf16 v[76:79], v[112:115], v[200:203], v[76:79]
    v_mfma_f32_16x16x32_bf16 v[76:79], v[116:119], v[204:207], v[76:79]
    v_mfma_f32_16x16x32_bf16 v[84:87], v[96:99], v[208:211], 0
    v_mfma_f32_16x16x32_bf16 v[84:87], v[100:103], v[212:215], v[84:87]
    v_mfma_f32_16x16x32_bf16 v[84:87], v[104:107], v[216:219], v[84:87]
    v_mfma_f32_16x16x32_bf16 v[84:87], v[108:111], v[220:223], v[84:87]
    v_mfma_f32_16x16x32_bf16 v[84:87], v[112:115], v[224:227], v[84:87]
    v_mfma_f32_16x16x32_bf16 v[84:87], v[116:119], v[228:231], v[84:87]
    v_mfma_f32_16x16x32_bf16 v[92:95], v[96:99], v[232:235], 0
    v_mfma_f32_16x16x32_bf16 v[92:95], v[100:103], v[236:239], v[92:95]
    v_mfma_f32_16x16x32_bf16 v[92:95], v[104:107], v[240:243], v[92:95]
    v_mfma_f32_16x16x32_bf16 v[92:95], v[108:111], v[244:247], v[92:95]
    v_mfma_f32_16x16x32_bf16 v[92:95], v[112:115], v[248:251], v[92:95]
    v_mfma_f32_16x16x32_bf16 v[92:95], v[116:119], v[252:255], v[92:95]
    s_nop 15
    v_sub_f32 v64, v64, v24
    v_exp_f32 v64, v64
    v_sub_f32 v65, v65, v24
    v_exp_f32 v65, v65
    v_sub_f32 v66, v66, v24
    v_exp_f32 v66, v66
    v_sub_f32 v67, v67, v24
    v_exp_f32 v67, v67
    v_sub_f32 v68, v68, v24
    v_exp_f32 v68, v68
    v_sub_f32 v69, v69, v24
    v_exp_f32 v69, v69
    v_sub_f32 v70, v70, v24
    v_exp_f32 v70, v70
    v_sub_f32 v71, v71, v24
    v_exp_f32 v71, v71
    v_add_f32 v19, v64, v65
    v_add_f32 v19, v19, v66
    v_add_f32 v19, v19, v67
    v_add_f32 v19, v19, v68
    v_add_f32 v19, v19, v69
    v_add_f32 v19, v19, v70
    v_add_f32 v19, v19, v71
    v_cvt_pk_bf16_f32 v124, v64, v65
    v_cvt_pk_bf16_f32 v125, v66, v67
    v_cvt_pk_bf16_f32 v126, v68, v69
    v_cvt_pk_bf16_f32 v127, v70, v71
    v_sub_f32 v72, v72, v25
    v_exp_f32 v72, v72
    v_sub_f32 v73, v73, v25
    v_exp_f32 v73, v73
    v_sub_f32 v74, v74, v25
    v_exp_f32 v74, v74
    v_sub_f32 v75, v75, v25
    v_exp_f32 v75, v75
    v_sub_f32 v76, v76, v25
    v_exp_f32 v76, v76
    v_sub_f32 v77, v77, v25
    v_exp_f32 v77, v77
    v_sub_f32 v78, v78, v25
    v_exp_f32 v78, v78
    v_sub_f32 v79, v79, v25
    v_exp_f32 v79, v79
    v_add_f32 v20, v72, v73
    v_add_f32 v20, v20, v74
    v_add_f32 v20, v20, v75
    v_add_f32 v20, v20, v76
    v_add_f32 v20, v20, v77
    v_add_f32 v20, v20, v78
    v_add_f32 v20, v20, v79
    v_cvt_pk_bf16_f32 v128, v72, v73
    v_cvt_pk_bf16_f32 v129, v74, v75
    v_cvt_pk_bf16_f32 v130, v76, v77
    v_cvt_pk_bf16_f32 v131, v78, v79
    v_sub_f32 v80, v80, v26
    v_exp_f32 v80, v80
    v_sub_f32 v81, v81, v26
    v_exp_f32 v81, v81
    v_sub_f32 v82, v82, v26
    v_exp_f32 v82, v82
    v_sub_f32 v83, v83, v26
    v_exp_f32 v83, v83
    v_sub_f32 v84, v84, v26
    v_exp_f32 v84, v84
    v_sub_f32 v85, v85, v26
    v_exp_f32 v85, v85
    v_sub_f32 v86, v86, v26
    v_exp_f32 v86, v86
    v_sub_f32 v87, v87, v26
    v_exp_f32 v87, v87
    v_add_f32 v21, v80, v81
    v_add_f32 v21, v21, v82
    v_add_f32 v21, v21, v83
    v_add_f32 v21, v21, v84
    v_add_f32 v21, v21, v85
    v_add_f32 v21, v21, v86
    v_add_f32 v21, v21, v87
    v_cvt_pk_bf16_f32 v132, v80, v81
    v_cvt_pk_bf16_f32 v133, v82, v83
    v_cvt_pk_bf16_f32 v134, v84, v85
    v_cvt_pk_bf16_f32 v135, v86, v87
    v_sub_f32 v88, v88, v27
    v_exp_f32 v88, v88
    v_sub_f32 v89, v89, v27
    v_exp_f32 v89, v89
    v_sub_f32 v90, v90, v27
    v_exp_f32 v90, v90
    v_sub_f32 v91, v91, v27
    v_exp_f32 v91, v91
    v_sub_f32 v92, v92, v27
    v_exp_f32 v92, v92
    v_sub_f32 v93, v93, v27
    v_exp_f32 v93, v93
    v_sub_f32 v94, v94, v27
    v_exp_f32 v94, v94
    v_sub_f32 v95, v95, v27
    v_exp_f32 v95, v95
    v_add_f32 v22, v88, v89
    v_add_f32 v22, v22, v90
    v_add_f32 v22, v22, v91
    v_add_f32 v22, v22, v92
    v_add_f32 v22, v22, v93
    v_add_f32 v22, v22, v94
    v_add_f32 v22, v22, v95
    v_cvt_pk_bf16_f32 v136, v88, v89
    v_cvt_pk_bf16_f32 v137, v90, v91
    v_cvt_pk_bf16_f32 v138, v92, v93
    v_cvt_pk_bf16_f32 v139, v94, v95
    v_add_u32 v0, 0, v10
    buffer_load_dwordx4 v[96:99], v0, s[16:19], s56 offen
    buffer_load_dwordx4 v[100:103], v0, s[16:19], s56 offen offset:64
    buffer_load_dwordx4 v[104:107], v0, s[16:19], s56 offen offset:128
    buffer_load_dwordx4 v[108:111], v0, s[16:19], s56 offen offset:192
    buffer_load_dwordx4 v[112:115], v0, s[16:19], s56 offen offset:256
    buffer_load_dwordx4 v[116:119], v0, s[16:19], s56 offen offset:320
    s_waitcnt vmcnt(0)
    s_waitcnt vmcnt(0)
    v_mfma_f32_16x16x32_bf16 v[64:67], v[96:99], v[160:163], 0
    v_mfma_f32_16x16x32_bf16 v[64:67], v[100:103], v[164:167], v[64:67]
    v_mfma_f32_16x16x32_bf16 v[64:67], v[104:107], v[168:171], v[64:67]
    v_mfma_f32_16x16x32_bf16 v[64:67], v[108:111], v[172:175], v[64:67]
    v_mfma_f32_16x16x32_bf16 v[64:67], v[112:115], v[176:179], v[64:67]
    v_mfma_f32_16x16x32_bf16 v[64:67], v[116:119], v[180:183], v[64:67]
    v_mfma_f32_16x16x32_bf16 v[72:75], v[96:99], v[184:187], 0
    v_mfma_f32_16x16x32_bf16 v[72:75], v[100:103], v[188:191], v[72:75]
    v_mfma_f32_16x16x32_bf16 v[72:75], v[104:107], v[192:195], v[72:75]
    v_mfma_f32_16x16x32_bf16 v[72:75], v[108:111], v[196:199], v[72:75]
    v_mfma_f32_16x16x32_bf16 v[72:75], v[112:115], v[200:203], v[72:75]
    v_mfma_f32_16x16x32_bf16 v[72:75], v[116:119], v[204:207], v[72:75]
    v_mfma_f32_16x16x32_bf16 v[80:83], v[96:99], v[208:211], 0
    v_mfma_f32_16x16x32_bf16 v[80:83], v[100:103], v[212:215], v[80:83]
    v_mfma_f32_16x16x32_bf16 v[80:83], v[104:107], v[216:219], v[80:83]
    v_mfma_f32_16x16x32_bf16 v[80:83], v[108:111], v[220:223], v[80:83]
    v_mfma_f32_16x16x32_bf16 v[80:83], v[112:115], v[224:227], v[80:83]
    v_mfma_f32_16x16x32_bf16 v[80:83], v[116:119], v[228:231], v[80:83]
    s_nop 15
    v_add_u32 v0, 6144, v10
    buffer_load_dwordx4 v[96:99], v0, s[16:19], s56 offen
    buffer_load_dwordx4 v[100:103], v0, s[16:19], s56 offen offset:64
    buffer_load_dwordx4 v[104:107], v0, s[16:19], s56 offen offset:128
    buffer_load_dwordx4 v[108:111], v0, s[16:19], s56 offen offset:192
    buffer_load_dwordx4 v[112:115], v0, s[16:19], s56 offen offset:256
    buffer_load_dwordx4 v[116:119], v0, s[16:19], s56 offen offset:320
    s_waitcnt vmcnt(0)
    s_waitcnt vmcnt(0)
    v_mfma_f32_16x16x32_bf16 v[68:71], v[96:99], v[160:163], 0
    v_mfma_f32_16x16x32_bf16 v[68:71], v[100:103], v[164:167], v[68:71]
    v_mfma_f32_16x16x32_bf16 v[68:71], v[104:107], v[168:171], v[68:71]
    v_mfma_f32_16x16x32_bf16 v[68:71], v[108:111], v[172:175], v[68:71]
    v_mfma_f32_16x16x32_bf16 v[68:71], v[112:115], v[176:179], v[68:71]
    v_mfma_f32_16x16x32_bf16 v[68:71], v[116:119], v[180:183], v[68:71]
    v_mfma_f32_16x16x32_bf16 v[76:79], v[96:99], v[184:187], 0
    v_mfma_f32_16x16x32_bf16 v[76:79], v[100:103], v[188:191], v[76:79]
    v_mfma_f32_16x16x32_bf16 v[76:79], v[104:107], v[192:195], v[76:79]
    v_mfma_f32_16x16x32_bf16 v[76:79], v[108:111], v[196:199], v[76:79]
    v_mfma_f32_16x16x32_bf16 v[76:79], v[112:115], v[200:203], v[76:79]
    v_mfma_f32_16x16x32_bf16 v[76:79], v[116:119], v[204:207], v[76:79]
    v_mfma_f32_16x16x32_bf16 v[84:87], v[96:99], v[208:211], 0
    v_mfma_f32_16x16x32_bf16 v[84:87], v[100:103], v[212:215], v[84:87]
    v_mfma_f32_16x16x32_bf16 v[84:87], v[104:107], v[216:219], v[84:87]
    v_mfma_f32_16x16x32_bf16 v[84:87], v[108:111], v[220:223], v[84:87]
    v_mfma_f32_16x16x32_bf16 v[84:87], v[112:115], v[224:227], v[84:87]
    v_mfma_f32_16x16x32_bf16 v[84:87], v[116:119], v[228:231], v[84:87]
    s_nop 15
    v_sub_f32 v64, v64, v24
    v_exp_f32 v64, v64
    v_sub_f32 v65, v65, v24
    v_exp_f32 v65, v65
    v_sub_f32 v66, v66, v24
    v_exp_f32 v66, v66
    v_sub_f32 v67, v67, v24
    v_exp_f32 v67, v67
    v_sub_f32 v68, v68, v24
    v_exp_f32 v68, v68
    v_sub_f32 v69, v69, v24
    v_exp_f32 v69, v69
    v_sub_f32 v70, v70, v24
    v_exp_f32 v70, v70
    v_sub_f32 v71, v71, v24
    v_exp_f32 v71, v71
    v_add_f32 v19, v19, v64
    v_add_f32 v19, v19, v65
    v_add_f32 v19, v19, v66
    v_add_f32 v19, v19, v67
    v_add_f32 v19, v19, v68
    v_add_f32 v19, v19, v69
    v_add_f32 v19, v19, v70
    v_add_f32 v19, v19, v71
    v_cvt_pk_bf16_f32 v140, v64, v65
    v_cvt_pk_bf16_f32 v141, v66, v67
    v_cvt_pk_bf16_f32 v142, v68, v69
    v_cvt_pk_bf16_f32 v143, v70, v71
    v_sub_f32 v72, v72, v25
    v_exp_f32 v72, v72
    v_sub_f32 v73, v73, v25
    v_exp_f32 v73, v73
    v_sub_f32 v74, v74, v25
    v_exp_f32 v74, v74
    v_sub_f32 v75, v75, v25
    v_exp_f32 v75, v75
    v_sub_f32 v76, v76, v25
    v_exp_f32 v76, v76
    v_sub_f32 v77, v77, v25
    v_exp_f32 v77, v77
    v_sub_f32 v78, v78, v25
    v_exp_f32 v78, v78
    v_sub_f32 v79, v79, v25
    v_exp_f32 v79, v79
    v_add_f32 v20, v20, v72
    v_add_f32 v20, v20, v73
    v_add_f32 v20, v20, v74
    v_add_f32 v20, v20, v75
    v_add_f32 v20, v20, v76
    v_add_f32 v20, v20, v77
    v_add_f32 v20, v20, v78
    v_add_f32 v20, v20, v79
    v_cvt_pk_bf16_f32 v144, v72, v73
    v_cvt_pk_bf16_f32 v145, v74, v75
    v_cvt_pk_bf16_f32 v146, v76, v77
    v_cvt_pk_bf16_f32 v147, v78, v79
    v_sub_f32 v80, v80, v26
    v_exp_f32 v80, v80
    v_sub_f32 v81, v81, v26
    v_exp_f32 v81, v81
    v_sub_f32 v82, v82, v26
    v_exp_f32 v82, v82
    v_sub_f32 v83, v83, v26
    v_exp_f32 v83, v83
    v_sub_f32 v84, v84, v26
    v_exp_f32 v84, v84
    v_sub_f32 v85, v85, v26
    v_exp_f32 v85, v85
    v_sub_f32 v86, v86, v26
    v_exp_f32 v86, v86
    v_sub_f32 v87, v87, v26
    v_exp_f32 v87, v87
    v_add_f32 v21, v21, v80
    v_add_f32 v21, v21, v81
    v_add_f32 v21, v21, v82
    v_add_f32 v21, v21, v83
    v_add_f32 v21, v21, v84
    v_add_f32 v21, v21, v85
    v_add_f32 v21, v21, v86
    v_add_f32 v21, v21, v87
    v_cvt_pk_bf16_f32 v148, v80, v81
    v_cvt_pk_bf16_f32 v149, v82, v83
    v_cvt_pk_bf16_f32 v150, v84, v85
    v_cvt_pk_bf16_f32 v151, v86, v87
    s_cmp_eq_u32 s54, 0
    s_cbranch_scc1 L_rare_0_1_ret
    s_add_u32 s56, s56, 12288
    v_add_u32 v0, 0, v10
    buffer_load_dwordx4 v[96:99], v0, s[16:19], s56 offen
    buffer_load_dwordx4 v[100:103], v0, s[16:19], s56 offen offset:64
    buffer_load_dwordx4 v[104:107], v0, s[16:19], s56 offen offset:128
    buffer_load_dwordx4 v[108:111], v0, s[16:19], s56 offen offset:192
    buffer_load_dwordx4 v[112:115], v0, s[16:19], s56 offen offset:256
    buffer_load_dwordx4 v[116:119], v0, s[16:19], s56 offen offset:320
    s_waitcnt vmcnt(0)
    s_waitcnt vmcnt(0)
    v_mfma_f32_16x16x32_bf16 v[64:67], v[96:99], v[160:163], v[48:51]
    v_mfma_f32_16x16x32_bf16 v[64:67], v[100:103], v[164:167], v[64:67]
    v_mfma_f32_16x16x32_bf16 v[64:67], v[104:107], v[168:171], v[64:67]
    v_mfma_f32_16x16x32_bf16 v[64:67], v[108:111], v[172:175], v[64:67]
    v_mfma_f32_16x16x32_bf16 v[64:67], v[112:115], v[176:179], v[64:67]
    v_mfma_f32_16x16x32_bf16 v[64:67], v[116:119], v[180:183], v[64:67]
    v_mfma_f32_16x16x32_bf16 v[72:75], v[96:99], v[184:187], v[52:55]
    v_mfma_f32_16x16x32_bf16 v[72:75], v[100:103], v[188:191], v[72:75]
    v_mfma_f32_16x16x32_bf16 v[72:75], v[104:107], v[192:195], v[72:75]
    v_mfma_f32_16x16x32_bf16 v[72:75], v[108:111], v[196:199], v[72:75]
    v_mfma_f32_16x16x32_bf16 v[72:75], v[112:115], v[200:203], v[72:75]
    v_mfma_f32_16x16x32_bf16 v[72:75], v[116:119], v[204:207], v[72:75]
    v_mfma_f32_16x16x32_bf16 v[80:83], v[96:99], v[208:211], v[56:59]
    v_mfma_f32_16x16x32_bf16 v[80:83], v[100:103], v[212:215], v[80:83]
    v_mfma_f32_16x16x32_bf16 v[80:83], v[104:107], v[216:219], v[80:83]
    v_mfma_f32_16x16x32_bf16 v[80:83], v[108:111], v[220:223], v[80:83]
    v_mfma_f32_16x16x32_bf16 v[80:83], v[112:115], v[224:227], v[80:83]
    v_mfma_f32_16x16x32_bf16 v[80:83], v[116:119], v[228:231], v[80:83]
    v_mfma_f32_16x16x32_bf16 v[88:91], v[96:99], v[232:235], v[60:63]
    v_mfma_f32_16x16x32_bf16 v[88:91], v[100:103], v[236:239], v[88:91]
    v_mfma_f32_16x16x32_bf16 v[88:91], v[104:107], v[240:243], v[88:91]
    v_mfma_f32_16x16x32_bf16 v[88:91], v[108:111], v[244:247], v[88:91]
    v_mfma_f32_16x16x32_bf16 v[88:91], v[112:115], v[248:251], v[88:91]
    v_mfma_f32_16x16x32_bf16 v[88:91], v[116:119], v[252:255], v[88:91]
    s_nop 15
    v_add_u32 v0, 6144, v10
    buffer_load_dwordx4 v[96:99], v0, s[16:19], s56 offen
    buffer_load_dwordx4 v[100:103], v0, s[16:19], s56 offen offset:64
    buffer_load_dwordx4 v[104:107], v0, s[16:19], s56 offen offset:128
    buffer_load_dwordx4 v[108:111], v0, s[16:19], s56 offen offset:192
    buffer_load_dwordx4 v[112:115], v0, s[16:19], s56 offen offset:256
    buffer_load_dwordx4 v[116:119], v0, s[16:19], s56 offen offset:320
    s_waitcnt vmcnt(0)
    s_waitcnt vmcnt(0)
    v_mfma_f32_16x16x32_bf16 v[68:71], v[96:99], v[160:163], v[48:51]
    v_mfma_f32_16x16x32_bf16 v[68:71], v[100:103], v[164:167], v[68:71]
    v_mfma_f32_16x16x32_bf16 v[68:71], v[104:107], v[168:171], v[68:71]
    v_mfma_f32_16x16x32_bf16 v[68:71], v[108:111], v[172:175], v[68:71]
    v_mfma_f32_16x16x32_bf16 v[68:71], v[112:115], v[176:179], v[68:71]
    v_mfma_f32_16x16x32_bf16 v[68:71], v[116:119], v[180:183], v[68:71]
    v_mfma_f32_16x16x32_bf16 v[76:79], v[96:99], v[184:187], v[52:55]
    v_mfma_f32_16x16x32_bf16 v[76:79], v[100:103], v[188:191], v[76:79]
    v_mfma_f32_16x16x32_bf16 v[76:79], v[104:107], v[192:195], v[76:79]
    v_mfma_f32_16x16x32_bf16 v[76:79], v[108:111], v[196:199], v[76:79]
    v_mfma_f32_16x16x32_bf16 v[76:79], v[112:115], v[200:203], v[76:79]
    v_mfma_f32_16x16x32_bf16 v[76:79], v[116:119], v[204:207], v[76:79]
    v_mfma_f32_16x16x32_bf16 v[84:87], v[96:99], v[208:211], v[56:59]
    v_mfma_f32_16x16x32_bf16 v[84:87], v[100:103], v[212:215], v[84:87]
    v_mfma_f32_16x16x32_bf16 v[84:87], v[104:107], v[216:219], v[84:87]
    v_mfma_f32_16x16x32_bf16 v[84:87], v[108:111], v[220:223], v[84:87]
    v_mfma_f32_16x16x32_bf16 v[84:87], v[112:115], v[224:227], v[84:87]
    v_mfma_f32_16x16x32_bf16 v[84:87], v[116:119], v[228:231], v[84:87]
    v_mfma_f32_16x16x32_bf16 v[92:95], v[96:99], v[232:235], v[60:63]
    v_mfma_f32_16x16x32_bf16 v[92:95], v[100:103], v[236:239], v[92:95]
    v_mfma_f32_16x16x32_bf16 v[92:95], v[104:107], v[240:243], v[92:95]
    v_mfma_f32_16x16x32_bf16 v[92:95], v[108:111], v[244:247], v[92:95]
    v_mfma_f32_16x16x32_bf16 v[92:95], v[112:115], v[248:251], v[92:95]
    v_mfma_f32_16x16x32_bf16 v[92:95], v[116:119], v[252:255], v[92:95]
    s_nop 15
L_rare_0_1_ret:
    s_cmp_eq_u32 s36, 2
    s_cbranch_scc1 L_b00_3cs_replay
    s_cmp_eq_u32 s36, 6
    s_cbranch_scc1 L_b01_3cs_replay
    s_cmp_eq_u32 s36, 10
    s_cbranch_scc1 L_t00_31c_replay
    s_cmp_eq_u32 s36, 11
    s_cbranch_scc1 L_t01_31c_replay
    s_endpgm
L_b00_3cs_replay:
    v_exp_f32 v64, v64
    v_exp_f32 v65, v65
    s_nop 4
    s_branch L_b00_3cs_back
L_b01_3cs_replay:
    v_exp_f32 v64, v64
    v_exp_f32 v65, v65
    s_nop 4
    s_branch L_b01_3cs_back
L_t00_31c_replay:
    s_nop 4
    s_branch L_t00_31c_back
L_t01_31c_replay:
    s_nop 4
    s_branch L_t01_31c_back
L_h1_3s_rare:
    s_mov_b32 s58, 0
L_h1_3s_spin:
    ds_read_b32 v30, v46
    s_add_u32 s58, s58, 1
    s_waitcnt lgkmcnt(0)
    v_cmp_gt_u32 s[94:95], s93, v30
    s_cmp_gt_u32 s58, 0x40000
    s_cbranch_scc1 L_h1_3s_spun
    s_cmp_lg_u64 s[94:95], 0
    s_cbranch_scc1 L_h1_3s_spin
L_h1_3s_spun:
    s_branch L_h1_3s_back
L_b10_4s_rare:
    s_mov_b32 s58, 0
L_b10_4s_spin:
    ds_read_b32 v30, v46
    s_add_u32 s58, s58, 1
    s_waitcnt lgkmcnt(0)
    v_cmp_gt_u32 s[94:95], s93, v30
    s_cmp_gt_u32 s58, 0x40000
    s_cbranch_scc1 L_b10_4s_spun
    s_cmp_lg_u64 s[94:95], 0
    s_cbranch_scc1 L_b10_4s_spin
L_b10_4s_spun:
    s_branch L_b10_4s_back
L_b10_6s_rare:
    s_mov_b32 s58, 0
L_b10_6s_spin:
    ds_read_b32 v30, v46
    s_add_u32 s58, s58, 1
    s_waitcnt lgkmcnt(0)
    v_cmp_gt_u32 s[94:95], s93, v30
    s_cmp_gt_u32 s58, 0x40000
    s_cbranch_scc1 L_b10_6s_spun
    s_cmp_lg_u64 s[94:95], 0
    s_cbranch_scc1 L_b10_6s_spin
L_b10_6s_spun:
    s_branch L_b10_6s_back
L_b11_4s_rare:
    s_mov_b32 s58, 0
L_b11_4s_spin:
    ds_read_b32 v30, v46
    s_add_u32 s58, s58, 1
    s_waitcnt lgkmcnt(0)
    v_cmp_gt_u32 s[94:95], s93, v30
    s_cmp_gt_u32 s58, 0x40000
    s_cbranch_scc1 L_b11_4s_spun
    s_cmp_lg_u64 s[94:95], 0
    s_cbranch_scc1 L_b11_4s_spin
L_b11_4s_spun:
    s_branch L_b11_4s_back
L_b11_6s_rare:
    s_mov_b32 s58, 0
L_b11_6s_spin:
    ds_read_b32 v30, v46
    s_add_u32 s58, s58, 1
    s_waitcnt lgkmcnt(0)
    v_cmp_gt_u32 s[94:95], s93, v30
    s_cmp_gt_u32 s58, 0x40000
    s_cbranch_scc1 L_b11_6s_spun
    s_cmp_lg_u64 s[94:95], 0
    s_cbranch_scc1 L_b11_6s_spin
L_b11_6s_spun:
    s_branch L_b11_6s_back
L_s1_3s_rare:
    s_mov_b32 s58, 0
L_s1_3s_spin:
    ds_read_b32 v30, v46
    s_add_u32 s58, s58, 1
    s_waitcnt lgkmcnt(0)
    v_cmp_gt_u32 s[94:95], s93, v30
    s_cmp_gt_u32 s58, 0x40000
    s_cbranch_scc1 L_s1_3s_spun
    s_cmp_lg_u64 s[94:95], 0
    s_cbranch_scc1 L_s1_3s_spin
L_s1_3s_spun:
    s_branch L_s1_3s_back
L_h1_2c_rare:
    s_mov_b32 s36, 0
    s_mov_b32 s54, 1
    s_mov_b32 s55, 393216
    s_add_u32 s55, s55, 0
    s_branch L_rare_1_0
L_b10_5cs_rare:
    s_mov_b32 s58, 0
L_b10_5cs_spin:
    ds_read_b32 v30, v46
    s_add_u32 s58, s58, 1
    s_waitcnt lgkmcnt(0)
    v_cmp_gt_u32 s[94:95], s93, v30
    s_cmp_gt_u32 s58, 0x40000
    s_cbranch_scc1 L_b10_5cs_spun
    s_cmp_lg_u64 s[94:95], 0
    s_cbranch_scc1 L_b10_5cs_spin
L_b10_5cs_spun:
    v_cmp_lt_f32 vcc, s35, v28
    s_nop 4
    s_cbranch_vccz L_b10_5cs_back
    s_mov_b32 s36, 4
    s_mov_b32 s54, 1
    s_mov_b32 s55, 0
    s_sub_u32 s56, 6, s31
    s_mul_i32 s56, s56, 49152
    s_add_u32 s55, s55, s56
    s_add_u32 s55, s55, 49152
    s_branch L_rare_1_0
L_b11_5cs_rare:
    s_mov_b32 s58, 0
L_b11_5cs_spin:
    ds_read_b32 v30, v46
    s_add_u32 s58, s58, 1
    s_waitcnt lgkmcnt(0)
    v_cmp_gt_u32 s[94:95], s93, v30
    s_cmp_gt_u32 s58, 0x40000
    s_cbranch_scc1 L_b11_5cs_spun
    s_cmp_lg_u64 s[94:95], 0
    s_cbranch_scc1 L_b11_5cs_spin
L_b11_5cs_spun:
    v_cmp_lt_f32 vcc, s35, v28
    s_nop 4
    s_cbranch_vccz L_b11_5cs_back
    s_mov_b32 s36, 8
    s_mov_b32 s54, 1
    s_mov_b32 s55, 393216
    s_sub_u32 s56, 6, s31
    s_mul_i32 s56, s56, 49152
    s_add_u32 s55, s55, s56
    s_add_u32 s55, s55, 49152
    s_branch L_rare_1_0
L_s1_2c_rare:
    s_mov_b32 s36, 12
    s_mov_b32 s54, 1
    s_mov_b32 s55, 0
    s_add_u32 s55, s55, 0
    s_branch L_rare_1_0
L_rare_1_0:
    s_waitcnt vmcnt(0) lgkmcnt(0)
    s_nop 15
    s_nop 15
    s_add_u32 s56, s55, 12288
    v_sub_f32 v24, 0, v48
    v_sub_f32 v25, 0, v52
    v_sub_f32 v26, 0, v56
    v_sub_f32 v27, 0, v60
    v_add_u32 v0, 0, v10
    buffer_load_dwordx4 v[124:127], v0, s[16:19], s55 offen
    buffer_load_dwordx4 v[128:131], v0, s[16:19], s55 offen offset:64
    buffer_load_dwordx4 v[132:135], v0, s[16:19], s55 offen offset:128
    buffer_load_dwordx4 v[136:139], v0, s[16:19], s55 offen offset:192
    buffer_load_dwordx4 v[140:143], v0, s[16:19], s55 offen offset:256
    buffer_load_dwordx4 v[144:147], v0, s[16:19], s55 offen offset:320
    s_waitcnt vmcnt(0)
    s_waitcnt vmcnt(0)
    v_mfma_f32_16x16x32_bf16 v[64:67], v[124:127], v[160:163], 0
    v_mfma_f32_16x16x32_bf16 v[64:67], v[128:131], v[164:167], v[64:67]
    v_mfma_f32_16x16x32_bf16 v[64:67], v[132:135], v[168:171], v[64:67]
    v_mfma_f32_16x16x32_bf16 v[64:67], v[136:139], v[172:175], v[64:67]
    v_mfma_f32_16x16x32_bf16 v[64:67], v[140:143], v[176:179], v[64:67]
    v_mfma_f32_16x16x32_bf16 v[64:67], v[144:147], v[180:183], v[64:67]
    v_mfma_f32_16x16x32_bf16 v[72:75], v[124:127], v[184:187], 0
    v_mfma_f32_16x16x32_bf16 v[72:75], v[128:131], v[188:191], v[72:75]
    v_mfma_f32_16x16x32_bf16 v[72:75], v[132:135], v[192:195], v[72:75]
    v_mfma_f32_16x16x32_bf16 v[72:75], v[136:139], v[196:199], v[72:75]
    v_mfma_f32_16x16x32_bf16 v[72:75], v[140:143], v[200:203], v[72:75]
    v_mfma_f32_16x16x32_bf16 v[72:75], v[144:147], v[204:207], v[72:75]
    v_mfma_f32_16x16x32_bf16 v[80:83], v[124:127], v[208:211], 0
    v_mfma_f32_16x16x32_bf16 v[80:83], v[128:131], v[212:215], v[80:83]
    v_mfma_f32_16x16x32_bf16 v[80:83], v[132:135], v[216:219], v[80:83]
    v_mfma_f32_16x16x32_bf16 v[80:83], v[136:139], v[220:223], v[80:83]
    v_mfma_f32_16x16x32_bf16 v[80:83], v[140:143], v[224:227], v[80:83]
    v_mfma_f32_16x16x32_bf16 v[80:83], v[144:147], v[228:231], v[80:83]
    s_nop 15
    v_add_u32 v0, 6144, v10
    buffer_load_dwordx4 v[124:127], v0, s[16:19], s55 offen
    buffer_load_dwordx4 v[128:131], v0, s[16:19], s55 offen offset:64
    buffer_load_dwordx4 v[132:135], v0, s[16:19], s55 offen offset:128
    buffer_load_dwordx4 v[136:139], v0, s[16:19], s55 offen offset:192
    buffer_load_dwordx4 v[140:143], v0, s[16:19], s55 offen offset:256
    buffer_load_dwordx4 v[144:147], v0, s[16:19], s55 offen offset:320
    s_waitcnt vmcnt(0)
    s_waitcnt vmcnt(0)
    v_mfma_f32_16x16x32_bf16 v[68:71], v[124:127], v[160:163], 0
    v_mfma_f32_16x16x32_bf16 v[68:71], v[128:131], v[164:167], v[68:71]
    v_mfma_f32_16x16x32_bf16 v[68:71], v[132:135], v[168:171], v[68:71]
    v_mfma_f32_16x16x32_bf16 v[68:71], v[136:139], v[172:175], v[68:71]
    v_mfma_f32_16x16x32_bf16 v[68:71], v[140:143], v[176:179], v[68:71]
    v_mfma_f32_16x16x32_bf16 v[68:71], v[144:147], v[180:183], v[68:71]
    v_mfma_f32_16x16x32_bf16 v[76:79], v[124:127], v[184:187], 0
    v_mfma_f32_16x16x32_bf16 v[76:79], v[128:131], v[188:191], v[76:79]
    v_mfma_f32_16x16x32_bf16 v[76:79], v[132:135], v[192:195], v[76:79]
    v_mfma_f32_16x16x32_bf16 v[76:79], v[136:139], v[196:199], v[76:79]
    v_mfma_f32_16x16x32_bf16 v[76:79], v[140:143], v[200:203], v[76:79]
    v_mfma_f32_16x16x32_bf16 v[76:79], v[144:147], v[204:207], v[76:79]
    v_mfma_f32_16x16x32_bf16 v[84:87], v[124:127], v[208:211], 0
    v_mfma_f32_16x16x32_bf16 v[84:87], v[128:131], v[212:215], v[84:87]
    v_mfma_f32_16x16x32_bf16 v[84:87], v[132:135], v[216:219], v[84:87]
    v_mfma_f32_16x16x32_bf16 v[84:87], v[136:139], v[220:223], v[84:87]
    v_mfma_f32_16x16x32_bf16 v[84:87], v[140:143], v[224:227], v[84:87]
    v_mfma_f32_16x16x32_bf16 v[84:87], v[144:147], v[228:231], v[84:87]
    s_nop 15
    v_max3_f32 v24, v24, v64, v65
    v_max3_f32 v24, v24, v66, v67
    v_max3_f32 v24, v24, v68, v69
    v_max3_f32 v24, v24, v70, v71
    v_max3_f32 v25, v25, v72, v73
    v_max3_f32 v25, v25, v74, v75
    v_max3_f32 v25, v25, v76, v77
    v_max3_f32 v25, v25, v78, v79
    v_max3_f32 v26, v26, v80, v81
    v_max3_f32 v26, v26, v82, v83
    v_max3_f32 v26, v26, v84, v85
    v_max3_f32 v26, v26, v86, v87
    v_add_u32 v0, 0, v10
    buffer_load_dwordx4 v[124:127], v0, s[16:19], s56 offen
    buffer_load_dwordx4 v[128:131], v0, s[16:19], s56 offen offset:64
    buffer_load_dwordx4 v[132:135], v0, s[16:19], s56 offen offset:128
    buffer_load_dwordx4 v[136:139], v0, s[16:19], s56 offen offset:192
    buffer_load_dwordx4 v[140:143], v0, s[16:19], s56 offen offset:256
    buffer_load_dwordx4 v[144:147], v0, s[16:19], s56 offen offset:320
    s_waitcnt vmcnt(0)
    s_waitcnt vmcnt(0)
    v_mfma_f32_16x16x32_bf16 v[64:67], v[124:127], v[160:163], 0
    v_mfma_f32_16x16x32_bf16 v[64:67], v[128:131], v[164:167], v[64:67]
    v_mfma_f32_16x16x32_bf16 v[64:67], v[132:135], v[168:171], v[64:67]
    v_mfma_f32_16x16x32_bf16 v[64:67], v[136:139], v[172:175], v[64:67]
    v_mfma_f32_16x16x32_bf16 v[64:67], v[140:143], v[176:179], v[64:67]
    v_mfma_f32_16x16x32_bf16 v[64:67], v[144:147], v[180:183], v[64:67]
    v_mfma_f32_16x16x32_bf16 v[72:75], v[124:127], v[184:187], 0
    v_mfma_f32_16x16x32_bf16 v[72:75], v[128:131], v[188:191], v[72:75]
    v_mfma_f32_16x16x32_bf16 v[72:75], v[132:135], v[192:195], v[72:75]
    v_mfma_f32_16x16x32_bf16 v[72:75], v[136:139], v[196:199], v[72:75]
    v_mfma_f32_16x16x32_bf16 v[72:75], v[140:143], v[200:203], v[72:75]
    v_mfma_f32_16x16x32_bf16 v[72:75], v[144:147], v[204:207], v[72:75]
    v_mfma_f32_16x16x32_bf16 v[80:83], v[124:127], v[208:211], 0
    v_mfma_f32_16x16x32_bf16 v[80:83], v[128:131], v[212:215], v[80:83]
    v_mfma_f32_16x16x32_bf16 v[80:83], v[132:135], v[216:219], v[80:83]
    v_mfma_f32_16x16x32_bf16 v[80:83], v[136:139], v[220:223], v[80:83]
    v_mfma_f32_16x16x32_bf16 v[80:83], v[140:143], v[224:227], v[80:83]
    v_mfma_f32_16x16x32_bf16 v[80:83], v[144:147], v[228:231], v[80:83]
    v_mfma_f32_16x16x32_bf16 v[88:91], v[124:127], v[232:235], 0
    v_mfma_f32_16x16x32_bf16 v[88:91], v[128:131], v[236:239], v[88:91]
    v_mfma_f32_16x16x32_bf16 v[88:91], v[132:135], v[240:243], v[88:91]
    v_mfma_f32_16x16x32_bf16 v[88:91], v[136:139], v[244:247], v[88:91]
    v_mfma_f32_16x16x32_bf16 v[88:91], v[140:143], v[248:251], v[88:91]
    v_mfma_f32_16x16x32_bf16 v[88:91], v[144:147], v[252:255], v[88:91]
    s_nop 15
    v_add_u32 v0, 6144, v10
    buffer_load_dwordx4 v[124:127], v0, s[16:19], s56 offen
    buffer_load_dwordx4 v[128:131], v0, s[16:19], s56 offen offset:64
    buffer_load_dwordx4 v[132:135], v0, s[16:19], s56 offen offset:128
    buffer_load_dwordx4 v[136:139], v0, s[16:19], s56 offen offset:192
    buffer_load_dwordx4 v[140:143], v0, s[16:19], s56 offen offset:256
    buffer_load_dwordx4 v[144:147], v0, s[16:19], s56 offen offset:320
    s_waitcnt vmcnt(0)
    s_waitcnt vmcnt(0)
    v_mfma_f32_16x16x32_bf16 v[68:71], v[124:127], v[160:163], 0
    v_mfma_f32_16x16x32_bf16 v[68:71], v[128:131], v[164:167], v[68:71]
    v_mfma_f32_16x16x32_bf16 v[68:71], v[132:135], v[168:171], v[68:71]
    v_mfma_f32_16x16x32_bf16 v[68:71], v[136:139], v[172:175], v[68:71]
    v_mfma_f32_16x16x32_bf16 v[68:71], v[140:143], v[176:179], v[68:71]
    v_mfma_f32_16x16x32_bf16 v[68:71], v[144:147], v[180:183], v[68:71]
    v_mfma_f32_16x16x32_bf16 v[76:79], v[124:127], v[184:187], 0
    v_mfma_f32_16x16x32_bf16 v[76:79], v[128:131], v[188:191], v[76:79]
    v_mfma_f32_16x16x32_bf16 v[76:79], v[132:135], v[192:195], v[76:79]
    v_mfma_f32_16x16x32_bf16 v[76:79], v[136:139], v[196:199], v[76:79]
    v_mfma_f32_16x16x32_bf16 v[76:79], v[140:143], v[200:203], v[76:79]
    v_mfma_f32_16x16x32_bf16 v[76:79], v[144:147], v[204:207], v[76:79]
    v_mfma_f32_16x16x32_bf16 v[84:87], v[124:127], v[208:211], 0
    v_mfma_f32_16x16x32_bf16 v[84:87], v[128:131], v[212:215], v[84:87]
    v_mfma_f32_16x16x32_bf16 v[84:87], v[132:135], v[216:219], v[84:87]
    v_mfma_f32_16x16x32_bf16 v[84:87], v[136:139], v[220:223], v[84:87]
    v_mfma_f32_16x16x32_bf16 v[84:87], v[140:143], v[224:227], v[84:87]
    v_mfma_f32_16x16x32_bf16 v[84:87], v[144:147], v[228:231], v[84:87]
    v_mfma_f32_16x16x32_bf16 v[92:95], v[124:127], v[232:235], 0
    v_mfma_f32_16x16x32_bf16 v[92:95], v[128:131], v[236:239], v[92:95]
    v_mfma_f32_16x16x32_bf16 v[92:95], v[132:135], v[240:243], v[92:95]
    v_mfma_f32_16x16x32_bf16 v[92:95], v[136:139], v[244:247], v[92:95]
    v_mfma_f32_16x16x32_bf16 v[92:95], v[140:143], v[248:251], v[92:95]
    v_mfma_f32_16x16x32_bf16 v[92:95], v[144:147], v[252:255], v[92:95]
    s_nop 15
    v_max3_f32 v24, v24, v64, v65
    v_max3_f32 v24, v24, v66, v67
    v_max3_f32 v24, v24, v68, v69
    v_max3_f32 v24, v24, v70, v71
    v_max3_f32 v25, v25, v72, v73
    v_max3_f32 v25, v25, v74, v75
    v_max3_f32 v25, v25, v76, v77
    v_max3_f32 v25, v25, v78, v79
    v_max3_f32 v26, v26, v80, v81
    v_max3_f32 v26, v26, v82, v83
    v_max3_f32 v26, v26, v84, v85
    v_max3_f32 v26, v26, v86, v87
    v_max3_f32 v27, v27, v88, v89
    v_max3_f32 v27, v27, v90, v91
    v_max3_f32 v27, v27, v92, v93
    v_max3_f32 v27, v27, v94, v95
    s_mov_b32 s59, 2
    s_nop 4
    s_branch L_rescale
L_rare_1_0_b:
    v_add_u32 v0, 0, v10
    buffer_load_dwordx4 v[124:127], v0, s[16:19], s55 offen
    buffer_load_dwordx4 v[128:131], v0, s[16:19], s55 offen offset:64
    buffer_load_dwordx4 v[132:135], v0, s[16:19], s55 offen offset:128
    buffer_load_dwordx4 v[136:139], v0, s[16:19], s55 offen offset:192
    buffer_load_dwordx4 v[140:143], v0, s[16:19], s55 offen offset:256
    buffer_load_dwordx4 v[144:147], v0, s[16:19], s55 offen offset:320
    s_waitcnt vmcnt(0)
    s_waitcnt vmcnt(0)
    v_mfma_f32_16x16x32_bf16 v[64:67], v[124:127], v[160:163], 0
    v_mfma_f32_16x16x32_bf16 v[64:67], v[128:131], v[164:167], v[64:67]
    v_mfma_f32_16x16x32_bf16 v[64:67], v[132:135], v[168:171], v[64:67]
    v_mfma_f32_16x16x32_bf16 v[64:67], v[136:139], v[172:175], v[64:67]
    v_mfma_f32_16x16x32_bf16 v[64:67], v[140:143], v[176:179], v[64:67]
    v_mfma_f32_16x16x32_bf16 v[64:67], v[144:147], v[180:183], v[64:67]
    v_mfma_f32_16x16x32_bf16 v[72:75], v[124:127], v[184:187], 0
    v_mfma_f32_16x16x32_bf16 v[72:75], v[128:131], v[188:191], v[72:75]
    v_mfma_f32_16x16x32_bf16 v[72:75], v[132:135], v[192:195], v[72:75]
    v_mfma_f32_16x16x32_bf16 v[72:75], v[136:139], v[196:199], v[72:75]
    v_mfma_f32_16x16x32_bf16 v[72:75], v[140:143], v[200:203], v[72:75]
    v_mfma_f32_16x16x32_bf16 v[72:75], v[144:147], v[204:207], v[72:75]
    v_mfma_f32_16x16x32_bf16 v[80:83], v[124:127], v[208:211], 0
    v_mfma_f32_16x16x32_bf16 v[80:83], v[128:131], v[212:215], v[80:83]
    v_mfma_f32_16x16x32_bf16 v[80:83], v[132:135], v[216:219], v[80:83]
    v_mfma_f32_16x16x32_bf16 v[80:83], v[136:139], v[220:223], v[80:83]
    v_mfma_f32_16x16x32_bf16 v[80:83], v[140:143], v[224:227], v[80:83]
    v_mfma_f32_16x16x32_bf16 v[80:83], v[144:147], v[228:231], v[80:83]
    s_nop 15
    v_add_u32 v0, 6144, v10
    buffer_load_dwordx4 v[124:127], v0, s[16:19], s55 offen
    buffer_load_dwordx4 v[128:131], v0, s[16:19], s55 offen offset:64
    buffer_load_dwordx4 v[132:135], v0, s[16:19], s55 offen offset:128
    buffer_load_dwordx4 v[136:139], v0, s[16:19], s55 offen offset:192
    buffer_load_dwordx4 v[140:143], v0, s[16:19], s55 offen offset:256
    buffer_load_dwordx4 v[144:147], v0, s[16:19], s55 offen offset:320
    s_waitcnt vmcnt(0)
    s_waitcnt vmcnt(0)
    v_mfma_f32_16x16x32_bf16 v[68:71], v[124:127], v[160:163], 0
    v_mfma_f32_16x16x32_bf16 v[68:71], v[128:131], v[164:167], v[68:71]
    v_mfma_f32_16x16x32_bf16 v[68:71], v[132:135], v[168:171], v[68:71]
    v_mfma_f32_16x16x32_bf16 v[68:71], v[136:139], v[172:175], v[68:71]
    v_mfma_f32_16x16x32_bf16 v[68:71], v[140:143], v[176:179], v[68:71]
    v_mfma_f32_16x16x32_bf16 v[68:71], v[144:147], v[180:183], v[68:71]
    v_mfma_f32_16x16x32_bf16 v[76:79], v[124:127], v[184:187], 0
    v_mfma_f32_16x16x32_bf16 v[76:79], v[128:131], v[188:191], v[76:79]
    v_mfma_f32_16x16x32_bf16 v[76:79], v[132:135], v[192:195], v[76:79]
    v_mfma_f32_16x16x32_bf16 v[76:79], v[136:139], v[196:199], v[76:79]
    v_mfma_f32_16x16x32_bf16 v[76:79], v[140:143], v[200:203], v[76:79]
    v_mfma_f32_16x16x32_bf16 v[76:79], v[144:147], v[204:207], v[76:79]
    v_mfma_f32_16x16x32_bf16 v[84:87], v[124:127], v[208:211], 0
    v_mfma_f32_16x16x32_bf16 v[84:87], v[128:131], v[212:215], v[84:87]
    v_mfma_f32_16x16x32_bf16 v[84:87], v[132:135], v[216:219], v[84:87]
    v_mfma_f32_16x16x32_bf16 v[84:87], v[136:139], v[220:223], v[84:87]
    v_mfma_f32_16x16x32_bf16 v[84:87], v[140:143], v[224:227], v[84:87]
    v_mfma_f32_16x16x32_bf16 v[84:87], v[144:147], v[228:231], v[84:87]
    s_nop 15
    v_sub_f32 v64, v64, v24
    v_exp_f32 v64, v64
    v_sub_f32 v65, v65, v24
    v_exp_f32 v65, v65
    v_sub_f32 v66, v66, v24
    v_exp_f32 v66, v66
    v_sub_f32 v67, v67, v24
    v_exp_f32 v67, v67
    v_sub_f32 v68, v68, v24
    v_exp_f32 v68, v68
    v_sub_f32 v69, v69, v24
    v_exp_f32 v69, v69
    v_sub_f32 v70, v70, v24
    v_exp_f32 v70, v70
    v_sub_f32 v71, v71, v24
    v_exp_f32 v71, v71
    v_add_f32 v16, v64, v65
    v_add_f32 v16, v16, v66
    v_add_f32 v16, v16, v67
    v_add_f32 v16, v16, v68
    v_add_f32 v16, v16, v69
    v_add_f32 v16, v16, v70
    v_add_f32 v16, v16, v71
    v_cvt_pk_bf16_f32 v112, v64, v65
    v_cvt_pk_bf16_f32 v113, v66, v67
    v_cvt_pk_bf16_f32 v114, v68, v69
    v_cvt_pk_bf16_f32 v115, v70, v71
    v_sub_f32 v72, v72, v25
    v_exp_f32 v72, v72
    v_sub_f32 v73, v73, v25
    v_exp_f32 v73, v73
    v_sub_f32 v74, v74, v25
    v_exp_f32 v74, v74
    v_sub_f32 v75, v75, v25
    v_exp_f32 v75, v75
    v_sub_f32 v76, v76, v25
    v_exp_f32 v76, v76
    v_sub_f32 v77, v77, v25
    v_exp_f32 v77, v77
    v_sub_f32 v78, v78, v25
    v_exp_f32 v78, v78
    v_sub_f32 v79, v79, v25
    v_exp_f32 v79, v79
    v_add_f32 v17, v72, v73
    v_add_f32 v17, v17, v74
    v_add_f32 v17, v17, v75
    v_add_f32 v17, v17, v76
    v_add_f32 v17, v17, v77
    v_add_f32 v17, v17, v78
    v_add_f32 v17, v17, v79
    v_cvt_pk_bf16_f32 v116, v72, v73
    v_cvt_pk_bf16_f32 v117, v74, v75
    v_cvt_pk_bf16_f32 v118, v76, v77
    v_cvt_pk_bf16_f32 v119, v78, v79
    v_sub_f32 v80, v80, v26
    v_exp_f32 v80, v80
    v_sub_f32 v81, v81, v26
    v_exp_f32 v81, v81
    v_sub_f32 v82, v82, v26
    v_exp_f32 v82, v82
    v_sub_f32 v83, v83, v26
    v_exp_f32 v83, v83
    v_sub_f32 v84, v84, v26
    v_exp_f32 v84, v84
    v_sub_f32 v85, v85, v26
    v_exp_f32 v85, v85
    v_sub_f32 v86, v86, v26
    v_exp_f32 v86, v86
    v_sub_f32 v87, v87, v26
    v_exp_f32 v87, v87
    v_add_f32 v18, v80, v81
    v_add_f32 v18, v18, v82
    v_add_f32 v18, v18, v83
    v_add_f32 v18, v18, v84
    v_add_f32 v18, v18, v85
    v_add_f32 v18, v18, v86
    v_add_f32 v18, v18, v87
    v_cvt_pk_bf16_f32 v120, v80, v81
    v_cvt_pk_bf16_f32 v121, v82, v83
    v_cvt_pk_bf16_f32 v122, v84, v85
    v_cvt_pk_bf16_f32 v123, v86, v87
    v_add_u32 v0, 0, v10
    buffer_load_dwordx4 v[124:127], v0, s[16:19], s56 offen
    buffer_load_dwordx4 v[128:131], v0, s[16:19], s56 offen offset:64
    buffer_load_dwordx4 v[132:135], v0, s[16:19], s56 offen offset:128
    buffer_load_dwordx4 v[136:139], v0, s[16:19], s56 offen offset:192
    buffer_load_dwordx4 v[140:143], v0, s[16:19], s56 offen offset:256
    buffer_load_dwordx4 v[144:147], v0, s[16:19], s56 offen offset:320
    s_waitcnt vmcnt(0)
    s_waitcnt vmcnt(0)
    v_mfma_f32_16x16x32_bf16 v[64:67], v[124:127], v[160:163], 0
    v_mfma_f32_16x16x32_bf16 v[64:67], v[128:131], v[164:167], v[64:67]
    v_mfma_f32_16x16x32_bf16 v[64:67], v[132:135], v[168:171], v[64:67]
    v_mfma_f32_16x16x32_bf16 v[64:67], v[136:139], v[172:175], v[64:67]
    v_mfma_f32_16x16x32_bf16 v[64:67], v[140:143], v[176:179], v[64:67]
    v_mfma_f32_16x16x32_bf16 v[64:67], v[144:147], v[180:183], v[64:67]
    v_mfma_f32_16x16x32_bf16 v[72:75], v[124:127], v[184:187], 0
    v_mfma_f32_16x16x32_bf16 v[72:75], v[128:131], v[188:191], v[72:75]
    v_mfma_f32_16x16x32_bf16 v[72:75], v[132:135], v[192:195], v[72:75]
    v_mfma_f32_16x16x32_bf16 v[72:75], v[136:139], v[196:199], v[72:75]
    v_mfma_f32_16x16x32_bf16 v[72:75], v[140:143], v[200:203], v[72:75]
    v_mfma_f32_16x16x32_bf16 v[72:75], v[144:147], v[204:207], v[72:75]
    v_mfma_f32_16x16x32_bf16 v[80:83], v[124:127], v[208:211], 0
    v_mfma_f32_16x16x32_bf16 v[80:83], v[128:131], v[212:215], v[80:83]
    v_mfma_f32_16x16x32_bf16 v[80:83], v[132:135], v[216:219], v[80:83]
    v_mfma_f32_16x16x32_bf16 v[80:83], v[136:139], v[220:223], v[80:83]
    v_mfma_f32_16x16x32_bf16 v[80:83], v[140:143], v[224:227], v[80:83]
    v_mfma_f32_16x16x32_bf16 v[80:83], v[144:147], v[228:231], v[80:83]
    v_mfma_f32_16x16x32_bf16 v[88:91], v[124:127], v[232:235], 0
    v_mfma_f32_16x16x32_bf16 v[88:91], v[128:131], v[236:239], v[88:91]
    v_mfma_f32_16x16x32_bf16 v[88:91], v[132:135], v[240:243], v[88:91]
    v_mfma_f32_16x16x32_bf16 v[88:91], v[136:139], v[244:247], v[88:91]
    v_mfma_f32_16x16x32_bf16 v[88:91], v[140:143], v[248:251], v[88:91]
    v_mfma_f32_16x16x32_bf16 v[88:91], v[144:147], v[252:255], v[88:91]
    s_nop 15
    v_add_u32 v0, 6144, v10
    buffer_load_dwordx4 v[124:127], v0, s[16:19], s56 offen
    buffer_load_dwordx4 v[128:131], v0, s[16:19], s56 offen offset:64
    buffer_load_dwordx4 v[132:135], v0, s[16:19], s56 offen offset:128
    buffer_load_dwordx4 v[136:139], v0, s[16:19], s56 offen offset:192
    buffer_load_dwordx4 v[140:143], v0, s[16:19], s56 offen offset:256
    buffer_load_dwordx4 v[144:147], v0, s[16:19], s56 offen offset:320
    s_waitcnt vmcnt(0)
    s_waitcnt vmcnt(0)
    v_mfma_f32_16x16x32_bf16 v[68:71], v[124:127], v[160:163], 0
    v_mfma_f32_16x16x32_bf16 v[68:71], v[128:131], v[164:167], v[68:71]
    v_mfma_f32_16x16x32_bf16 v[68:71], v[132:135], v[168:171], v[68:71]
    v_mfma_f32_16x16x32_bf16 v[68:71], v[136:139], v[172:175], v[68:71]
    v_mfma_f32_16x16x32_bf16 v[68:71], v[140:143], v[176:179], v[68:71]
    v_mfma_f32_16x16x32_bf16 v[68:71], v[144:147], v[180:183], v[68:71]
    v_mfma_f32_16x16x32_bf16 v[76:79], v[124:127], v[184:187], 0
    v_mfma_f32_16x16x32_bf16 v[76:79], v[128:131], v[188:191], v[76:79]
    v_mfma_f32_16x16x32_bf16 v[76:79], v[132:135], v[192:195], v[76:79]
    v_mfma_f32_16x16x32_bf16 v[76:79], v[136:139], v[196:199], v[76:79]
    v_mfma_f32_16x16x32_bf16 v[76:79], v[140:143], v[200:203], v[76:79]
    v_mfma_f32_16x16x32_bf16 v[76:79], v[144:147], v[204:207], v[76:79]
    v_mfma_f32_16x16x32_bf16 v[84:87], v[124:127], v[208:211], 0
    v_mfma_f32_16x16x32_bf16 v[84:87], v[128:131], v[212:215], v[84:87]
    v_mfma_f32_16x16x32_bf16 v[84:87], v[132:135], v[216:219], v[84:87]
    v_mfma_f32_16x16x32_bf16 v[84:87], v[136:139], v[220:223], v[84:87]
    v_mfma_f32_16x16x32_bf16 v[84:87], v[140:143], v[224:227], v[84:87]
    v_mfma_f32_16x16x32_bf16 v[84:87], v[144:147], v[228:231], v[84:87]
    v_mfma_f32_16x16x32_bf16 v[92:95], v[124:127], v[232:235], 0
    v_mfma_f32_16x16x32_bf16 v[92:95], v[128:131], v[236:239], v[92:95]
    v_mfma_f32_16x16x32_bf16 v[92:95], v[132:135], v[240:243], v[92:95]
    v_mfma_f32_16x16x32_bf16 v[92:95], v[136:139], v[244:247], v[92:95]
    v_mfma_f32_16x16x32_bf16 v[92:95], v[140:143], v[248:251], v[92:95]
    v_mfma_f32_16x16x32_bf16 v[92:95], v[144:147], v[252:255], v[92:95]
    s_nop 15
    v_sub_f32 v64, v64, v24
    v_exp_f32 v64, v64
    v_sub_f32 v65, v65, v24
    v_exp_f32 v65, v65
    v_sub_f32 v66, v66, v24
    v_exp_f32 v66, v66
    v_sub_f32 v67, v67, v24
    v_exp_f32 v67, v67
    v_sub_f32 v68, v68, v24
    v_exp_f32 v68, v68
    v_sub_f32 v69, v69, v24
    v_exp_f32 v69, v69
    v_sub_f32 v70, v70, v24
    v_exp_f32 v70, v70
    v_sub_f32 v71, v71, v24
    v_exp_f32 v71, v71
    v_add_f32 v16, v16, v64
    v_add_f32 v16, v16, v65
    v_add_f32 v16, v16, v66
    v_add_f32 v16, v16, v67
    v_add_f32 v16, v16, v68
    v_add_f32 v16, v16, v69
    v_add_f32 v16, v16, v70
    v_add_f32 v16, v16, v71
    v_cvt_pk_bf16_f32 v96, v64, v65
    v_cvt_pk_bf16_f32 v97, v66, v67
    v_cvt_pk_bf16_f32 v98, v68, v69
    v_cvt_pk_bf16_f32 v99, v70, v71
    v_sub_f32 v72, v72, v25
    v_exp_f32 v72, v72
    v_sub_f32 v73, v73, v25
    v_exp_f32 v73, v73
    v_sub_f32 v74, v74, v25
    v_exp_f32 v74, v74
    v_sub_f32 v75, v75, v25
    v_exp_f32 v75, v75
    v_sub_f32 v76, v76, v25
    v_exp_f32 v76, v76
    v_sub_f32 v77, v77, v25
    v_exp_f32 v77, v77
    v_sub_f32 v78, v78, v25
    v_exp_f32 v78, v78
    v_sub_f32 v79, v79, v25
    v_exp_f32 v79, v79
    v_add_f32 v17, v17, v72
    v_add_f32 v17, v17, v73
    v_add_f32 v17, v17, v74
    v_add_f32 v17, v17, v75
    v_add_f32 v17, v17, v76
    v_add_f32 v17, v17, v77
    v_add_f32 v17, v17, v78
    v_add_f32 v17, v17, v79
    v_cvt_pk_bf16_f32 v100, v72, v73
    v_cvt_pk_bf16_f32 v101, v74, v75
    v_cvt_pk_bf16_f32 v102, v76, v77
    v_cvt_pk_bf16_f32 v103, v78, v79
    v_sub_f32 v80, v80, v26
    v_exp_f32 v80, v80
    v_sub_f32 v81, v81, v26
    v_exp_f32 v81, v81
    v_sub_f32 v82, v82, v26
    v_exp_f32 v82, v82
    v_sub_f32 v83, v83, v26
    v_exp_f32 v83, v83
    v_sub_f32 v84, v84, v26
    v_exp_f32 v84, v84
    v_sub_f32 v85, v85, v26
    v_exp_f32 v85, v85
    v_sub_f32 v86, v86, v26
    v_exp_f32 v86, v86
    v_sub_f32 v87, v87, v26
    v_exp_f32 v87, v87
    v_add_f32 v18, v18, v80
    v_add_f32 v18, v18, v81
    v_add_f32 v18, v18, v82
    v_add_f32 v18, v18, v83
    v_add_f32 v18, v18, v84
    v_add_f32 v18, v18, v85
    v_add_f32 v18, v18, v86
    v_add_f32 v18, v18, v87
    v_cvt_pk_bf16_f32 v104, v80, v81
    v_cvt_pk_bf16_f32 v105, v82, v83
    v_cvt_pk_bf16_f32 v106, v84, v85
    v_cvt_pk_bf16_f32 v107, v86, v87
    v_sub_f32 v88, v88, v27
    v_exp_f32 v88, v88
    v_sub_f32 v89, v89, v27
    v_exp_f32 v89, v89
    v_sub_f32 v90, v90, v27
    v_exp_f32 v90, v90
    v_sub_f32 v91, v91, v27
    v_exp_f32 v91, v91
    v_sub_f32 v92, v92, v27
    v_exp_f32 v92, v92
    v_sub_f32 v93, v93, v27
    v_exp_f32 v93, v93
    v_sub_f32 v94, v94, v27
    v_exp_f32 v94, v94
    v_sub_f32 v95, v95, v27
    v_exp_f32 v95, v95
    v_add_f32 v22, v88, v89
    v_add_f32 v22, v22, v90
    v_add_f32 v22, v22, v91
    v_add_f32 v22, v22, v92
    v_add_f32 v22, v22, v93
    v_add_f32 v22, v22, v94
    v_add_f32 v22, v22, v95
    v_cvt_pk_bf16_f32 v108, v88, v89
    v_cvt_pk_bf16_f32 v109, v90, v91
    v_cvt_pk_bf16_f32 v110, v92, v93
    v_cvt_pk_bf16_f32 v111, v94, v95
    s_cmp_eq_u32 s54, 0
    s_cbranch_scc1 L_rare_1_0_ret
    s_add_u32 s56, s56, 12288
    v_add_u32 v0, 0, v10
    buffer_load_dwordx4 v[124:127], v0, s[16:19], s56 offen
    buffer_load_dwordx4 v[128:131], v0, s[16:19], s56 offen offset:64
    buffer_load_dwordx4 v[132:135], v0, s[16:19], s56 offen offset:128
    buffer_load_dwordx4 v[136:139], v0, s[16:19], s56 offen offset:192
    buffer_load_dwordx4 v[140:143], v0, s[16:19], s56 offen offset:256
    buffer_load_dwordx4 v[144:147], v0, s[16:19], s56 offen offset:320
    s_waitcnt vmcnt(0)
    s_waitcnt vmcnt(0)
    v_mfma_f32_16x16x32_bf16 v[64:67], v[124:127], v[160:163], v[48:51]
    v_mfma_f32_16x16x32_bf16 v[64:67], v[128:131], v[164:167], v[64:67]
    v_mfma_f32_16x16x32_bf16 v[64:67], v[132:135], v[168:171], v[64:67]
    v_mfma_f32_16x16x32_bf16 v[64:67], v[136:139], v[172:175], v[64:67]
    v_mfma_f32_16x16x32_bf16 v[64:67], v[140:143], v[176:179], v[64:67]
    v_mfma_f32_16x16x32_bf16 v[64:67], v[144:147], v[180:183], v[64:67]
    v_mfma_f32_16x16x32_bf16 v[72:75], v[124:127], v[184:187], v[52:55]
    v_mfma_f32_16x16x32_bf16 v[72:75], v[128:131], v[188:191], v[72:75]
    v_mfma_f32_16x16x32_bf16 v[72:75], v[132:135], v[192:195], v[72:75]
    v_mfma_f32_16x16x32_bf16 v[72:75], v[136:139], v[196:199], v[72:75]
    v_mfma_f32_16x16x32_bf16 v[72:75], v[140:143], v[200:203], v[72:75]
    v_mfma_f32_16x16x32_bf16 v[72:75], v[144:147], v[204:207], v[72:75]
    v_mfma_f32_16x16x32_bf16 v[80:83], v[124:127], v[208:211], v[56:59]
    v_mfma_f32_16x16x32_bf16 v[80:83], v[128:131], v[212:215], v[80:83]
    v_mfma_f32_16x16x32_bf16 v[80:83], v[132:135], v[216:219], v[80:83]
    v_mfma_f32_16x16x32_bf16 v[80:83], v[136:139], v[220:223], v[80:83]
    v_mfma_f32_16x16x32_bf16 v[80:83], v[140:143], v[224:227], v[80:83]
    v_mfma_f32_16x16x32_bf16 v[80:83], v[144:147], v[228:231], v[80:83]
    s_nop 15
    v_add_u32 v0, 6144, v10
    buffer_load_dwordx4 v[124:127], v0, s[16:19], s56 offen
    buffer_load_dwordx4 v[128:131], v0, s[16:19], s56 offen offset:64
    buffer_load_dwordx4 v[132:135], v0, s[16:19], s56 offen offset:128
    buffer_load_dwordx4 v[136:139], v0, s[16:19], s56 offen offset:192
    buffer_load_dwordx4 v[140:143], v0, s[16:19], s56 offen offset:256
    buffer_load_dwordx4 v[144:147], v0, s[16:19], s56 offen offset:320
    s_waitcnt vmcnt(0)
    s_waitcnt vmcnt(0)
    v_mfma_f32_16x16x32_bf16 v[68:71], v[124:127], v[160:163], v[48:51]
    v_mfma_f32_16x16x32_bf16 v[68:71], v[128:131], v[164:167], v[68:71]
    v_mfma_f32_16x16x32_bf16 v[68:71], v[132:135], v[168:171], v[68:71]
    v_mfma_f32_16x16x32_bf16 v[68:71], v[136:139], v[172:175], v[68:71]
    v_mfma_f32_16x16x32_bf16 v[68:71], v[140:143], v[176:179], v[68:71]
    v_mfma_f32_16x16x32_bf16 v[68:71], v[144:147], v[180:183], v[68:71]
    v_mfma_f32_16x16x32_bf16 v[76:79], v[124:127], v[184:187], v[52:55]
    v_mfma_f32_16x16x32_bf16 v[76:79], v[128:131], v[188:191], v[76:79]
    v_mfma_f32_16x16x32_bf16 v[76:79], v[132:135], v[192:195], v[76:79]
    v_mfma_f32_16x16x32_bf16 v[76:79], v[136:139], v[196:199], v[76:79]
    v_mfma_f32_16x16x32_bf16 v[76:79], v[140:143], v[200:203], v[76:79]
    v_mfma_f32_16x16x32_bf16 v[76:79], v[144:147], v[204:207], v[76:79]
    v_mfma_f32_16x16x32_bf16 v[84:87], v[124:127], v[208:211], v[56:59]
    v_mfma_f32_16x16x32_bf16 v[84:87], v[128:131], v[212:215], v[84:87]
    v_mfma_f32_16x16x32_bf16 v[84:87], v[132:135], v[216:219], v[84:87]
    v_mfma_f32_16x16x32_bf16 v[84:87], v[136:139], v[220:223], v[84:87]
    v_mfma_f32_16x16x32_bf16 v[84:87], v[140:143], v[224:227], v[84:87]
    v_mfma_f32_16x16x32_bf16 v[84:87], v[144:147], v[228:231], v[84:87]
    s_nop 15
L_rare_1_0_ret:
    s_cmp_eq_u32 s36, 0
    s_cbranch_scc1 L_h1_2c_replay
    s_cmp_eq_u32 s36, 4
    s_cbranch_scc1 L_b10_5cs_replay
    s_cmp_eq_u32 s36, 8
    s_cbranch_scc1 L_b11_5cs_replay
    s_cmp_eq_u32 s36, 12
    s_cbranch_scc1 L_s1_2c_replay
    s_endpgm
L_h1_2c_replay:
    s_nop 4
    s_branch L_h1_2c_back
L_b10_5cs_replay:
    v_exp_f32 v64, v64
    v_exp_f32 v65, v65
    s_nop 4
    s_branch L_b10_5cs_back
L_b11_5cs_replay:
    v_exp_f32 v64, v64
    v_exp_f32 v65, v65
    s_nop 4
    s_branch L_b11_5cs_back
L_s1_2c_replay:
    v_exp_f32 v64, v64
    v_exp_f32 v65, v65
    s_nop 0
    v_cvt_pk_bf16_f32 v140, v64, v65
    v_add_f32 v19, v64, v65
    v_exp_f32 v66, v66
    s_nop 0
    v_add_f32 v19, v19, v66
    v_exp_f32 v67, v67
    s_nop 0
    v_cvt_pk_bf16_f32 v141, v66, v67
    v_add_f32 v19, v19, v67
    v_exp_f32 v72, v72
    s_nop 4
    s_branch L_s1_2c_back
L_b10_3cs_rare:
    s_mov_b32 s58, 0
L_b10_3cs_spin:
    ds_read_b32 v30, v46
    s_add_u32 s58, s58, 1
    s_waitcnt lgkmcnt(0)
    v_cmp_gt_u32 s[94:95], s93, v30
    s_cmp_gt_u32 s58, 0x40000
    s_cbranch_scc1 L_b10_3cs_spun
    s_cmp_lg_u64 s[94:95], 0
    s_cbranch_scc1 L_b10_3cs_spin
L_b10_3cs_spun:
    v_cmp_lt_f32 vcc, s35, v28
    s_nop 4
    s_cbranch_vccz L_b10_3cs_back
    s_mov_b32 s36, 2
    s_mov_b32 s54, 1
    s_mov_b32 s55, 0
    s_sub_u32 s56, 6, s31
    s_mul_i32 s56, s56, 49152
    s_add_u32 s55, s55, s56
    s_add_u32 s55, s55, 24576
    s_branch L_rare_1_1
L_b11_3cs_rare:
    s_mov_b32 s58, 0
L_b11_3cs_spin:
    ds_read_b32 v30, v46
    s_add_u32 s58, s58, 1
    s_waitcnt lgkmcnt(0)
    v_cmp_gt_u32 s[94:95], s93, v30
    s_cmp_gt_u32 s58, 0x40000
    s_cbranch_scc1 L_b11_3cs_spun
    s_cmp_lg_u64 s[94:95], 0
    s_cbranch_scc1 L_b11_3cs_spin
L_b11_3cs_spun:
    v_cmp_lt_f32 vcc, s35, v28
    s_nop 4
    s_cbranch_vccz L_b11_3cs_back
    s_mov_b32 s36, 6
    s_mov_b32 s54, 1
    s_mov_b32 s55, 393216
    s_sub_u32 s56, 6, s31
    s_mul_i32 s56, s56, 49152
    s_add_u32 s55, s55, s56
    s_add_u32 s55, s55, 24576
    s_branch L_rare_1_1
L_t10_31c_rare:
    s_mov_b32 s36, 10
    s_mov_b32 s54, 0
    s_mov_b32 s55, 0
    s_add_u32 s55, s55, 368640
    s_branch L_rare_1_1
L_t11_31c_rare:
    s_mov_b32 s36, 11
    s_mov_b32 s54, 0
    s_mov_b32 s55, 393216
    s_add_u32 s55, s55, 368640
    s_branch L_rare_1_1
L_rare_1_1:
    s_waitcnt vmcnt(0) lgkmcnt(0)
    s_nop 15
    s_nop 15
    s_add_u32 s56, s55, 12288
    v_sub_f32 v24, 0, v48
    v_sub_f32 v25, 0, v52
    v_sub_f32 v26, 0, v56
    v_sub_f32 v27, 0, v60
    v_add_u32 v0, 0, v10
    buffer_load_dwordx4 v[96:99], v0, s[16:19], s55 offen
    buffer_load_dwordx4 v[100:103], v0, s[16:19], s55 offen offset:64
    buffer_load_dwordx4 v[104:107], v0, s[16:19], s55 offen offset:128
    buffer_load_dwordx4 v[108:111], v0, s[16:19], s55 offen offset:192
    buffer_load_dwordx4 v[112:115], v0, s[16:19], s55 offen offset:256
    buffer_load_dwordx4 v[116:119], v0, s[16:19], s55 offen offset:320
    s_waitcnt vmcnt(0)
    s_waitcnt vmcnt(0)
    v_mfma_f32_16x16x32_bf16 v[64:67], v[96:99], v[160:163], 0
    v_mfma_f32_16x16x32_bf16 v[64:67], v[100:103], v[164:167], v[64:67]
    v_mfma_f32_16x16x32_bf16 v[64:67], v[104:107], v[168:171], v[64:67]
    v_mfma_f32_16x16x32_bf16 v[64:67], v[108:111], v[172:175], v[64:67]
    v_mfma_f32_16x16x32_bf16 v[64:67], v[112:115], v[176:179], v[64:67]
    v_mfma_f32_16x16x32_bf16 v[64:67], v[116:119], v[180:183], v[64:67]
    v_mfma_f32_16x16x32_bf16 v[72:75], v[96:99], v[184:187], 0
    v_mfma_f32_16x16x32_bf16 v[72:75], v[100:103], v[188:191], v[72:75]
    v_mfma_f32_16x16x32_bf16 v[72:75], v[104:107], v[192:195], v[72:75]
    v_mfma_f32_16x16x32_bf16 v[72:75], v[108:111], v[196:199], v[72:75]
    v_mfma_f32_16x16x32_bf16 v[72:75], v[112:115], v[200:203], v[72:75]
    v_mfma_f32_16x16x32_bf16 v[72:75], v[116:119], v[204:207], v[72:75]
    v_mfma_f32_16x16x32_bf16 v[80:83], v[96:99], v[208:211], 0
    v_mfma_f32_16x16x32_bf16 v[80:83], v[100:103], v[212:215], v[80:83]
    v_mfma_f32_16x16x32_bf16 v[80:83], v[104:107], v[216:219], v[80:83]
    v_mfma_f32_16x16x32_bf16 v[80:83], v[108:111], v[220:223], v[80:83]
    v_mfma_f32_16x16x32_bf16 v[80:83], v[112:115], v[224:227], v[80:83]
    v_mfma_f32_16x16x32_bf16 v[80:83], v[116:119], v[228:231], v[80:83]
    s_nop 15
    v_add_u32 v0, 6144, v10
    buffer_load_dwordx4 v[96:99], v0, s[16:19], s55 offen
    buffer_load_dwordx4 v[100:103], v0, s[16:19], s55 offen offset:64
    buffer_load_dwordx4 v[104:107], v0, s[16:19], s55 offen offset:128
    buffer_load_dwordx4 v[108:111], v0, s[16:19], s55 offen offset:192
    buffer_load_dwordx4 v[112:115], v0, s[16:19], s55 offen offset:256
    buffer_load_dwordx4 v[116:119], v0, s[16:19], s55 offen offset:320
    s_waitcnt vmcnt(0)
    s_waitcnt vmcnt(0)
    v_mfma_f32_16x16x32_bf16 v[68:71], v[96:99], v[160:163], 0
    v_mfma_f32_16x16x32_bf16 v[68:71], v[100:103], v[164:167], v[68:71]
    v_mfma_f32_16x16x32_bf16 v[68:71], v[104:107], v[168:171], v[68:71]
    v_mfma_f32_16x16x32_bf16 v[68:71], v[108:111], v[172:175], v[68:71]
    v_mfma_f32_16x16x32_bf16 v[68:71], v[112:115], v[176:179], v[68:71]
    v_mfma_f32_16x16x32_bf16 v[68:71], v[116:119], v[180:183], v[68:71]
    v_mfma_f32_16x16x32_bf16 v[76:79], v[96:99], v[184:187], 0
    v_mfma_f32_16x16x32_bf16 v[76:79], v[100:103], v[188:191], v[76:79]
    v_mfma_f32_16x16x32_bf16 v[76:79], v[104:107], v[192:195], v[76:79]
    v_mfma_f32_16x16x32_bf16 v[76:79], v[108:111], v[196:199], v[76:79]
    v_mfma_f32_16x16x32_bf16 v[76:79], v[112:115], v[200:203], v[76:79]
    v_mfma_f32_16x16x32_bf16 v[76:79], v[116:119], v[204:207], v[76:79]
    v_mfma_f32_16x16x32_bf16 v[84:87], v[96:99], v[208:211], 0
    v_mfma_f32_16x16x32_bf16 v[84:87], v[100:103], v[212:215], v[84:87]
    v_mfma_f32_16x16x32_bf16 v[84:87], v[104:107], v[216:219], v[84:87]
    v_mfma_f32_16x16x32_bf16 v[84:87], v[108:111], v[220:223], v[84:87]
    v_mfma_f32_16x16x32_bf16 v[84:87], v[112:115], v[224:227], v[84:87]
    v_mfma_f32_16x16x32_bf16 v[84:87], v[116:119], v[228:231], v[84:87]
    s_nop 15
    v_max3_f32 v24, v24, v64, v65
    v_max3_f32 v24, v24, v66, v67
    v_max3_f32 v24, v24, v68, v69
    v_max3_f32 v24, v24, v70, v71
    v_max3_f32 v25, v25, v72, v73
    v_max3_f32 v25, v25, v74, v75
    v_max3_f32 v25, v25, v76, v77
    v_max3_f32 v25, v25, v78, v79
    v_max3_f32 v26, v26, v80, v81
    v_max3_f32 v26, v26, v82, v83
    v_max3_f32 v26, v26, v84, v85
    v_max3_f32 v26, v26, v86, v87
    v_add_u32 v0, 0, v10
    buffer_load_dwordx4 v[96:99], v0, s[16:19], s56 offen
    buffer_load_dwordx4 v[100:103], v0, s[16:19], s56 offen offset:64
    buffer_load_dwordx4 v[104:107], v0, s[16:19], s56 offen offset:128
    buffer_load_dwordx4 v[108:111], v0, s[16:19], s56 offen offset:192
    buffer_load_dwordx4 v[112:115], v0, s[16:19], s56 offen offset:256
    buffer_load_dwordx4 v[116:119], v0, s[16:19], s56 offen offset:320
    s_waitcnt vmcnt(0)
    s_waitcnt vmcnt(0)
    v_mfma_f32_16x16x32_bf16 v[64:67], v[96:99], v[160:163], 0
    v_mfma_f32_16x16x32_bf16 v[64:67], v[100:103], v[164:167], v[64:67]
    v_mfma_f32_16x16x32_bf16 v[64:67], v[104:107], v[168:171], v[64:67]
    v_mfma_f32_16x16x32_bf16 v[64:67], v[108:111], v[172:175], v[64:67]
    v_mfma_f32_16x16x32_bf16 v[64:67], v[112:115], v[176:179], v[64:67]
    v_mfma_f32_16x16x32_bf16 v[64:67], v[116:119], v[180:183], v[64:67]
    v_mfma_f32_16x16x32_bf16 v[72:75], v[96:99], v[184:187], 0
    v_mfma_f32_16x16x32_bf16 v[72:75], v[100:103], v[188:191], v[72:75]
    v_mfma_f32_16x16x32_bf16 v[72:75], v[104:107], v[192:195], v[72:75]
    v_mfma_f32_16x16x32_bf16 v[72:75], v[108:111], v[196:199], v[72:75]
    v_mfma_f32_16x16x32_bf16 v[72:75], v[112:115], v[200:203], v[72:75]
    v_mfma_f32_16x16x32_bf16 v[72:75], v[116:119], v[204:207], v[72:75]
    v_mfma_f32_16x16x32_bf16 v[80:83], v[96:99], v[208:211], 0
    v_mfma_f32_16x16x32_bf16 v[80:83], v[100:103], v[212:215], v[80:83]
    v_mfma_f32_16x16x32_bf16 v[80:83], v[104:107], v[216:219], v[80:83]
    v_mfma_f32_16x16x32_bf16 v[80:83], v[108:111], v[220:223], v[80:83]
    v_mfma_f32_16x16x32_bf16 v[80:83], v[112:115], v[224:227], v[80:83]
    v_mfma_f32_16x16x32_bf16 v[80:83], v[116:119], v[228:231], v[80:83]
    v_mfma_f32_16x16x32_bf16 v[88:91], v[96:99], v[232:235], 0
    v_mfma_f32_16x16x32_bf16 v[88:91], v[100:103], v[236:239], v[88:91]
    v_mfma_f32_16x16x32_bf16 v[88:91], v[104:107], v[240:243], v[88:91]
    v_mfma_f32_16x16x32_bf16 v[88:91], v[108:111], v[244:247], v[88:91]
    v_mfma_f32_16x16x32_bf16 v[88:91], v[112:115], v[248:251], v[88:91]
    v_mfma_f32_16x16x32_bf16 v[88:91], v[116:119], v[252:255], v[88:91]
    s_nop 15
    v_add_u32 v0, 6144, v10
    buffer_load_dwordx4 v[96:99], v0, s[16:19], s56 offen
    buffer_load_dwordx4 v[100:103], v0, s[16:19], s56 offen offset:64
    buffer_load_dwordx4 v[104:107], v0, s[16:19], s56 offen offset:128
    buffer_load_dwordx4 v[108:111], v0, s[16:19], s56 offen offset:192
    buffer_load_dwordx4 v[112:115], v0, s[16:19], s56 offen offset:256
    buffer_load_dwordx4 v[116:119], v0, s[16:19], s56 offen offset:320
    s_waitcnt vmcnt(0)
    s_waitcnt vmcnt(0)
    v_mfma_f32_16x16x32_bf16 v[68:71], v[96:99], v[160:163], 0
    v_mfma_f32_16x16x32_bf16 v[68:71], v[100:103], v[164:167], v[68:71]
    v_mfma_f32_16x16x32_bf16 v[68:71], v[104:107], v[168:171], v[68:71]
    v_mfma_f32_16x16x32_bf16 v[68:71], v[108:111], v[172:175], v[68:71]
    v_mfma_f32_16x16x32_bf16 v[68:71], v[112:115], v[176:179], v[68:71]
    v_mfma_f32_16x16x32_bf16 v[68:71], v[116:119], v[180:183], v[68:71]
    v_mfma_f32_16x16x32_bf16 v[76:79], v[96:99], v[184:187], 0
    v_mfma_f32_16x16x32_bf16 v[76:79], v[100:103], v[188:191], v[76:79]
    v_mfma_f32_16x16x32_bf16 v[76:79], v[104:107], v[192:195], v[76:79]
    v_mfma_f32_16x16x32_bf16 v[76:79], v[108:111], v[196:199], v[76:79]
    v_mfma_f32_16x16x32_bf16 v[76:79], v[112:115], v[200:203], v[76:79]
    v_mfma_f32_16x16x32_bf16 v[76:79], v[116:119], v[204:207], v[76:79]
    v_mfma_f32_16x16x32_bf16 v[84:87], v[96:99], v[208:211], 0
    v_mfma_f32_16x16x32_bf16 v[84:87], v[100:103], v[212:215], v[84:87]
    v_mfma_f32_16x16x32_bf16 v[84:87], v[104:107], v[216:219], v[84:87]
    v_mfma_f32_16x16x32_bf16 v[84:87], v[108:111], v[220:223], v[84:87]
    v_mfma_f32_16x16x32_bf16 v[84:87], v[112:115], v[224:227], v[84:87]
    v_mfma_f32_16x16x32_bf16 v[84:87], v[116:119], v[228:231], v[84:87]
    v_mfma_f32_16x16x32_bf16 v[92:95], v[96:99], v[232:235], 0
    v_mfma_f32_16x16x32_bf16 v[92:95], v[100:103], v[236:239], v[92:95]
    v_mfma_f32_16x16x32_bf16 v[92:95], v[104:107], v[240:243], v[92:95]
    v_mfma_f32_16x16x32_bf16 v[92:95], v[108:111], v[244:247], v[92:95]
    v_mfma_f32_16x16x32_bf16 v[92:95], v[112:115], v[248:251], v[92:95]
    v_mfma_f32_16x16x32_bf16 v[92:95], v[116:119], v[252:255], v[92:95]
    s_nop 15
    v_max3_f32 v24, v24, v64, v65
    v_max3_f32 v24, v24, v66, v67
    v_max3_f32 v24, v24, v68, v69
    v_max3_f32 v24, v24, v70, v71
    v_max3_f32 v25, v25, v72, v73
    v_max3_f32 v25, v25, v74, v75
    v_max3_f32 v25, v25, v76, v77
    v_max3_f32 v25, v25, v78, v79
    v_max3_f32 v26, v26, v80, v81
    v_max3_f32 v26, v26, v82, v83
    v_max3_f32 v26, v26, v84, v85
    v_max3_f32 v26, v26, v86, v87
    v_max3_f32 v27, v27, v88, v89
    v_max3_f32 v27, v27, v90, v91
    v_max3_f32 v27, v27, v92, v93
    v_max3_f32 v27, v27, v94, v95
    s_mov_b32 s59, 3
    s_nop 4
    s_branch L_rescale
L_rare_1_1_b:
    v_add_u32 v0, 0, v10
    buffer_load_dwordx4 v[96:99], v0, s[16:19], s55 offen
    buffer_load_dwordx4 v[100:103], v0, s[16:19], s55 offen offset:64
    buffer_load_dwordx4 v[104:107], v0, s[16:19], s55 offen offset:128
    buffer_load_dwordx4 v[108:111], v0, s[16:19], s55 offen offset:192
    buffer_load_dwordx4 v[112:115], v0, s[16:19], s55 offen offset:256
    buffer_load_dwordx4 v[116:119], v0, s[16:19], s55 offen offset:320
    s_waitcnt vmcnt(0)
    s_waitcnt vmcnt(0)
    v_mfma_f32_16x16x32_bf16 v[64:67], v[96:99], v[160:163], 0
    v_mfma_f32_16x16x32_bf16 v[64:67], v[100:103], v[164:167], v[64:67]
    v_mfma_f32_16x16x32_bf16 v[64:67], v[104:107], v[168:171], v[64:67]
    v_mfma_f32_16x16x32_bf16 v[64:67], v[108:111], v[172:175], v[64:67]
    v_mfma_f32_16x16x32_bf16 v[64:67], v[112:115], v[176:179], v[64:67]
    v_mfma_f32_16x16x32_bf16 v[64:67], v[116:119], v[180:183], v[64:67]
    v_mfma_f32_16x16x32_bf16 v[72:75], v[96:99], v[184:187], 0
    v_mfma_f32_16x16x32_bf16 v[72:75], v[100:103], v[188:191], v[72:75]
    v_mfma_f32_16x16x32_bf16 v[72:75], v[104:107], v[192:195], v[72:75]
    v_mfma_f32_16x16x32_bf16 v[72:75], v[108:111], v[196:199], v[72:75]
    v_mfma_f32_16x16x32_bf16 v[72:75], v[112:115], v[200:203], v[72:75]
    v_mfma_f32_16x16x32_bf16 v[72:75], v[116:119], v[204:207], v[72:75]
    v_mfma_f32_16x16x32_bf16 v[80:83], v[96:99], v[208:211], 0
    v_mfma_f32_16x16x32_bf16 v[80:83], v[100:103], v[212:215], v[80:83]
    v_mfma_f32_16x16x32_bf16 v[80:83], v[104:107], v[216:219], v[80:83]
    v_mfma_f32_16x16x32_bf16 v[80:83], v[108:111], v[220:223], v[80:83]
    v_mfma_f32_16x16x32_bf16 v[80:83], v[112:115], v[224:227], v[80:83]
    v_mfma_f32_16x16x32_bf16 v[80:83], v[116:119], v[228:231], v[80:83]
    s_nop 15
    v_add_u32 v0, 6144, v10
    buffer_load_dwordx4 v[96:99], v0, s[16:19], s55 offen
    buffer_load_dwordx4 v[100:103], v0, s[16:19], s55 offen offset:64
    buffer_load_dwordx4 v[104:107], v0, s[16:19], s55 offen offset:128
    buffer_load_dwordx4 v[108:111], v0, s[16:19], s55 offen offset:192
    buffer_load_dwordx4 v[112:115], v0, s[16:19], s55 offen offset:256
    buffer_load_dwordx4 v[116:119], v0, s[16:19], s55 offen offset:320
    s_waitcnt vmcnt(0)
    s_waitcnt vmcnt(0)
    v_mfma_f32_16x16x32_bf16 v[68:71], v[96:99], v[160:163], 0
    v_mfma_f32_16x16x32_bf16 v[68:71], v[100:103], v[164:167], v[68:71]
    v_mfma_f32_16x16x32_bf16 v[68:71], v[104:107], v[168:171], v[68:71]
    v_mfma_f32_16x16x32_bf16 v[68:71], v[108:111], v[172:175], v[68:71]
    v_mfma_f32_16x16x32_bf16 v[68:71], v[112:115], v[176:179], v[68:71]
    v_mfma_f32_16x16x32_bf16 v[68:71], v[116:119], v[180:183], v[68:71]
    v_mfma_f32_16x16x32_bf16 v[76:79], v[96:99], v[184:187], 0
    v_mfma_f32_16x16x32_bf16 v[76:79], v[100:103], v[188:191], v[76:79]
    v_mfma_f32_16x16x32_bf16 v[76:79], v[104:107], v[192:195], v[76:79]
    v_mfma_f32_16x16x32_bf16 v[76:79], v[108:111], v[196:199], v[76:79]
    v_mfma_f32_16x16x32_bf16 v[76:79], v[112:115], v[200:203], v[76:79]
    v_mfma_f32_16x16x32_bf16 v[76:79], v[116:119], v[204:207], v[76:79]
    v_mfma_f32_16x16x32_bf16 v[84:87], v[96:99], v[208:211], 0
    v_mfma_f32_16x16x32_bf16 v[84:87], v[100:103], v[212:215], v[84:87]
    v_mfma_f32_16x16x32_bf16 v[84:87], v[104:107], v[216:219], v[84:87]
    v_mfma_f32_16x16x32_bf16 v[84:87], v[108:111], v[220:223], v[84:87]
    v_mfma_f32_16x16x32_bf16 v[84:87], v[112:115], v[224:227], v[84:87]
    v_mfma_f32_16x16x32_bf16 v[84:87], v[116:119], v[228:231], v[84:87]
    s_nop 15
    v_sub_f32 v64, v64, v24
    v_exp_f32 v64, v64
    v_sub_f32 v65, v65, v24
    v_exp_f32 v65, v65
    v_sub_f32 v66, v66, v24
    v_exp_f32 v66, v66
    v_sub_f32 v67, v67, v24
    v_exp_f32 v67, v67
    v_sub_f32 v68, v68, v24
    v_exp_f32 v68, v68
    v_sub_f32 v69, v69, v24
    v_exp_f32 v69, v69
    v_sub_f32 v70, v70, v24
    v_exp_f32 v70, v70
    v_sub_f32 v71, v71, v24
    v_exp_f32 v71, v71
    v_add_f32 v19, v64, v65
    v_add_f32 v19, v19, v66
    v_add_f32 v19, v19, v67
    v_add_f32 v19, v19, v68
    v_add_f32 v19, v19, v69
    v_add_f32 v19, v19, v70
    v_add_f32 v19, v19, v71
    v_cvt_pk_bf16_f32 v140, v64, v65
    v_cvt_pk_bf16_f32 v141, v66, v67
    v_cvt_pk_bf16_f32 v142, v68, v69
    v_cvt_pk_bf16_f32 v143, v70, v71
    v_sub_f32 v72, v72, v25
    v_exp_f32 v72, v72
    v_sub_f32 v73, v73, v25
    v_exp_f32 v73, v73
    v_sub_f32 v74, v74, v25
    v_exp_f32 v74, v74
    v_sub_f32 v75, v75, v25
    v_exp_f32 v75, v75
    v_sub_f32 v76, v76, v25
    v_exp_f32 v76, v76
    v_sub_f32 v77, v77, v25
    v_exp_f32 v77, v77
    v_sub_f32 v78, v78, v25
    v_exp_f32 v78, v78
    v_sub_f32 v79, v79, v25
    v_exp_f32 v79, v79
    v_add_f32 v20, v72, v73
    v_add_f32 v20, v20, v74
    v_add_f32 v20, v20, v75
    v_add_f32 v20, v20, v76
    v_add_f32 v20, v20, v77
    v_add_f32 v20, v20, v78
    v_add_f32 v20, v20, v79
    v_cvt_pk_bf16_f32 v144, v72, v73
    v_cvt_pk_bf16_f32 v145, v74, v75
    v_cvt_pk_bf16_f32 v146, v76, v77
    v_cvt_pk_bf16_f32 v147, v78, v79
    v_sub_f32 v80, v80, v26
    v_exp_f32 v80, v80
    v_sub_f32 v81, v81, v26
    v_exp_f32 v81, v81
    v_sub_f32 v82, v82, v26
    v_exp_f32 v82, v82
    v_sub_f32 v83, v83, v26
    v_exp_f32 v83, v83
    v_sub_f32 v84, v84, v26
    v_exp_f32 v84, v84
    v_sub_f32 v85, v85, v26
    v_exp_f32 v85, v85
    v_sub_f32 v86, v86, v26
    v_exp_f32 v86, v86
    v_sub_f32 v87, v87, v26
    v_exp_f32 v87, v87
    v_add_f32 v21, v80, v81
    v_add_f32 v21, v21, v82
    v_add_f32 v21, v21, v83
    v_add_f32 v21, v21, v84
    v_add_f32 v21, v21, v85
    v_add_f32 v21, v21, v86
    v_add_f32 v21, v21, v87
    v_cvt_pk_bf16_f32 v148, v80, v81
    v_cvt_pk_bf16_f32 v149, v82, v83
    v_cvt_pk_bf16_f32 v150, v84, v85
    v_cvt_pk_bf16_f32 v151, v86, v87
    v_add_u32 v0, 0, v10
    buffer_load_dwordx4 v[96:99], v0, s[16:19], s56 offen
    buffer_load_dwordx4 v[100:103], v0, s[16:19], s56 offen offset:64
    buffer_load_dwordx4 v[104:107], v0, s[16:19], s56 offen offset:128
    buffer_load_dwordx4 v[108:111], v0, s[16:19], s56 offen offset:192
    buffer_load_dwordx4 v[112:115], v0, s[16:19], s56 offen offset:256
    buffer_load_dwordx4 v[116:119], v0, s[16:19], s56 offen offset:320
    s_waitcnt vmcnt(0)
    s_waitcnt vmcnt(0)
    v_mfma_f32_16x16x32_bf16 v[64:67], v[96:99], v[160:163], 0
    v_mfma_f32_16x16x32_bf16 v[64:67], v[100:103], v[164:167], v[64:67]
    v_mfma_f32_16x16x32_bf16 v[64:67], v[104:107], v[168:171], v[64:67]
    v_mfma_f32_16x16x32_bf16 v[64:67], v[108:111], v[172:175], v[64:67]
    v_mfma_f32_16x16x32_bf16 v[64:67], v[112:115], v[176:179], v[64:67]
    v_mfma_f32_16x16x32_bf16 v[64:67], v[116:119], v[180:183], v[64:67]
    v_mfma_f32_16x16x32_bf16 v[72:75], v[96:99], v[184:187], 0
    v_mfma_f32_16x16x32_bf16 v[72:75], v[100:103], v[188:191], v[72:75]
    v_mfma_f32_16x16x32_bf16 v[72:75], v[104:107], v[192:195], v[72:75]
    v_mfma_f32_16x16x32_bf16 v[72:75], v[108:111], v[196:199], v[72:75]
    v_mfma_f32_16x16x32_bf16 v[72:75], v[112:115], v[200:203], v[72:75]
    v_mfma_f32_16x16x32_bf16 v[72:75], v[116:119], v[204:207], v[72:75]
    v_mfma_f32_16x16x32_bf16 v[80:83], v[96:99], v[208:211], 0
    v_mfma_f32_16x16x32_bf16 v[80:83], v[100:103], v[212:215], v[80:83]
    v_mfma_f32_16x16x32_bf16 v[80:83], v[104:107], v[216:219], v[80:83]
    v_mfma_f32_16x16x32_bf16 v[80:83], v[108:111], v[220:223], v[80:83]
    v_mfma_f32_16x16x32_bf16 v[80:83], v[112:115], v[224:227], v[80:83]
    v_mfma_f32_16x16x32_bf16 v[80:83], v[116:119], v[228:231], v[80:83]
    v_mfma_f32_16x16x32_bf16 v[88:91], v[96:99], v[232:235], 0
    v_mfma_f32_16x16x32_bf16 v[88:91], v[100:103], v[236:239], v[88:91]
    v_mfma_f32_16x16x32_bf16 v[88:91], v[104:107], v[240:243], v[88:91]
    v_mfma_f32_16x16x32_bf16 v[88:91], v[108:111], v[244:247], v[88:91]
    v_mfma_f32_16x16x32_bf16 v[88:91], v[112:115], v[248:251], v[88:91]
    v_mfma_f32_16x16x32_bf16 v[88:91], v[116:119], v[252:255], v[88:91]
    s_nop 15
    v_add_u32 v0, 6144, v10
    buffer_load_dwordx4 v[96:99], v0, s[16:19], s56 offen
    buffer_load_dwordx4 v[100:103], v0, s[16:19], s56 offen offset:64
    buffer_load_dwordx4 v[104:107], v0, s[16:19], s56 offen offset:128
    buffer_load_dwordx4 v[108:111], v0, s[16:19], s56 offen offset:192
    buffer_load_dwordx4 v[112:115], v0, s[16:19], s56 offen offset:256
    buffer_load_dwordx4 v[116:119], v0, s[16:19], s56 offen offset:320
    s_waitcnt vmcnt(0)
    s_waitcnt vmcnt(0)
    v_mfma_f32_16x16x32_bf16 v[68:71], v[96:99], v[160:163], 0
    v_mfma_f32_16x16x32_bf16 v[68:71], v[100:103], v[164:167], v[68:71]
    v_mfma_f32_16x16x32_bf16 v[68:71], v[104:107], v[168:171], v[68:71]
    v_mfma_f32_16x16x32_bf16 v[68:71], v[108:111], v[172:175], v[68:71]
    v_mfma_f32_16x16x32_bf16 v[68:71], v[112:115], v[176:179], v[68:71]
    v_mfma_f32_16x16x32_bf16 v[68:71], v[116:119], v[180:183], v[68:71]
    v_mfma_f32_16x16x32_bf16 v[76:79], v[96:99], v[184:187], 0
    v_mfma_f32_16x16x32_bf16 v[76:79], v[100:103], v[188:191], v[76:79]
    v_mfma_f32_16x16x32_bf16 v[76:79], v[104:107], v[192:195], v[76:79]
    v_mfma_f32_16x16x32_bf16 v[76:79], v[108:111], v[196:199], v[76:79]
    v_mfma_f32_16x16x32_bf16 v[76:79], v[112:115], v[200:203], v[76:79]
    v_mfma_f32_16x16x32_bf16 v[76:79], v[116:119], v[204:207], v[76:79]
    v_mfma_f32_16x16x32_bf16 v[84:87], v[96:99], v[208:211], 0
    v_mfma_f32_16x16x32_bf16 v[84:87], v[100:103], v[212:215], v[84:87]
    v_mfma_f32_16x16x32_bf16 v[84:87], v[104:107], v[216:219], v[84:87]
    v_mfma_f32_16x16x32_bf16 v[84:87], v[108:111], v[220:223], v[84:87]
    v_mfma_f32_16x16x32_bf16 v[84:87], v[112:115], v[224:227], v[84:87]
    v_mfma_f32_16x16x32_bf16 v[84:87], v[116:119], v[228:231], v[84:87]
    v_mfma_f32_16x16x32_bf16 v[92:95], v[96:99], v[232:235], 0
    v_mfma_f32_16x16x32_bf16 v[92:95], v[100:103], v[236:239], v[92:95]
    v_mfma_f32_16x16x32_bf16 v[92:95], v[104:107], v[240:243], v[92:95]
    v_mfma_f32_16x16x32_bf16 v[92:95], v[108:111], v[244:247], v[92:95]
    v_mfma_f32_16x16x32_bf16 v[92:95], v[112:115], v[248:251], v[92:95]
    v_mfma_f32_16x16x32_bf16 v[92:95], v[116:119], v[252:255], v[92:95]
    s_nop 15
    v_sub_f32 v64, v64, v24
    v_exp_f32 v64, v64
    v_sub_f32 v65, v65, v24
    v_exp_f32 v65, v65
    v_sub_f32 v66, v66, v24
    v_exp_f32 v66, v66
    v_sub_f32 v67, v67, v24
    v_exp_f32 v67, v67
    v_sub_f32 v68, v68, v24
    v_exp_f32 v68, v68
    v_sub_f32 v69, v69, v24
    v_exp_f32 v69, v69
    v_sub_f32 v70, v70, v24
    v_exp_f32 v70, v70
    v_sub_f32 v71, v71, v24
    v_exp_f32 v71, v71
    v_add_f32 v19, v19, v64
    v_add_f32 v19, v19, v65
    v_add_f32 v19, v19, v66
    v_add_f32 v19, v19, v67
    v_add_f32 v19, v19, v68
    v_add_f32 v19, v19, v69
    v_add_f32 v19, v19, v70
    v_add_f32 v19, v19, v71
    v_cvt_pk_bf16_f32 v124, v64, v65
    v_cvt_pk_bf16_f32 v125, v66, v67
    v_cvt_pk_bf16_f32 v126, v68, v69
    v_cvt_pk_bf16_f32 v127, v70, v71
    v_sub_f32 v72, v72, v25
    v_exp_f32 v72, v72
    v_sub_f32 v73, v73, v25
    v_exp_f32 v73, v73
    v_sub_f32 v74, v74, v25
    v_exp_f32 v74, v74
    v_sub_f32 v75, v75, v25
    v_exp_f32 v75, v75
    v_sub_f32 v76, v76, v25
    v_exp_f32 v76, v76
    v_sub_f32 v77, v77, v25
    v_exp_f32 v77, v77
    v_sub_f32 v78, v78, v25
    v_exp_f32 v78, v78
    v_sub_f32 v79, v79, v25
    v_exp_f32 v79, v79
    v_add_f32 v20, v20, v72
    v_add_f32 v20, v20, v73
    v_add_f32 v20, v20, v74
    v_add_f32 v20, v20, v75
    v_add_f32 v20, v20, v76
    v_add_f32 v20, v20, v77
    v_add_f32 v20, v20, v78
    v_add_f32 v20, v20, v79
    v_cvt_pk_bf16_f32 v128, v72, v73
    v_cvt_pk_bf16_f32 v129, v74, v75
    v_cvt_pk_bf16_f32 v130, v76, v77
    v_cvt_pk_bf16_f32 v131, v78, v79
    v_sub_f32 v80, v80, v26
    v_exp_f32 v80, v80
    v_sub_f32 v81, v81, v26
    v_exp_f32 v81, v81
    v_sub_f32 v82, v82, v26
    v_exp_f32 v82, v82
    v_sub_f32 v83, v83, v26
    v_exp_f32 v83, v83
    v_sub_f32 v84, v84, v26
    v_exp_f32 v84, v84
    v_sub_f32 v85, v85, v26
    v_exp_f32 v85, v85
    v_sub_f32 v86, v86, v26
    v_exp_f32 v86, v86
    v_sub_f32 v87, v87, v26
    v_exp_f32 v87, v87
    v_add_f32 v21, v21, v80
    v_add_f32 v21, v21, v81
    v_add_f32 v21, v21, v82
    v_add_f32 v21, v21, v83
    v_add_f32 v21, v21, v84
    v_add_f32 v21, v21, v85
    v_add_f32 v21, v21, v86
    v_add_f32 v21, v21, v87
    v_cvt_pk_bf16_f32 v132, v80, v81
    v_cvt_pk_bf16_f32 v133, v82, v83
    v_cvt_pk_bf16_f32 v134, v84, v85
    v_cvt_pk_bf16_f32 v135, v86, v87
    v_sub_f32 v88, v88, v27
    v_exp_f32 v88, v88
    v_sub_f32 v89, v89, v27
    v_exp_f32 v89, v89
    v_sub_f32 v90, v90, v27
    v_exp_f32 v90, v90
    v_sub_f32 v91, v91, v27
    v_exp_f32 v91, v91
    v_sub_f32 v92, v92, v27
    v_exp_f32 v92, v92
    v_sub_f32 v93, v93, v27
    v_exp_f32 v93, v93
    v_sub_f32 v94, v94, v27
    v_exp_f32 v94, v94
    v_sub_f32 v95, v95, v27
    v_exp_f32 v95, v95
    v_add_f32 v22, v88, v89
    v_add_f32 v22, v22, v90
    v_add_f32 v22, v22, v91
    v_add_f32 v22, v22, v92
    v_add_f32 v22, v22, v93
    v_add_f32 v22, v22, v94
    v_add_f32 v22, v22, v95
    v_cvt_pk_bf16_f32 v136, v88, v89
    v_cvt_pk_bf16_f32 v137, v90, v91
    v_cvt_pk_bf16_f32 v138, v92, v93
    v_cvt_pk_bf16_f32 v139, v94, v95
    s_cmp_eq_u32 s54, 0
    s_cbranch_scc1 L_rare_1_1_ret
    s_add_u32 s56, s56, 12288
    v_add_u32 v0, 0, v10
    buffer_load_dwordx4 v[96:99], v0, s[16:19], s56 offen
    buffer_load_dwordx4 v[100:103], v0, s[16:19], s56 offen offset:64
    buffer_load_dwordx4 v[104:107], v0, s[16:19], s56 offen offset:128
    buffer_load_dwordx4 v[108:111], v0, s[16:19], s56 offen offset:192
    buffer_load_dwordx4 v[112:115], v0, s[16:19], s56 offen offset:256
    buffer_load_dwordx4 v[116:119], v0, s[16:19], s56 offen offset:320
    s_waitcnt vmcnt(0)
    s_waitcnt vmcnt(0)
    v_mfma_f32_16x16x32_bf16 v[64:67], v[96:99], v[160:163], v[48:51]
    v_mfma_f32_16x16x32_bf16 v[64:67], v[100:103], v[164:167], v[64:67]
    v_mfma_f32_16x16x32_bf16 v[64:67], v[104:107], v[168:171], v[64:67]
    v_mfma_f32_16x16x32_bf16 v[64:67], v[108:111], v[172:175], v[64:67]
    v_mfma_f32_16x16x32_bf16 v[64:67], v[112:115], v[176:179], v[64:67]
    v_mfma_f32_16x16x32_bf16 v[64:67], v[116:119], v[180:183], v[64:67]
    v_mfma_f32_16x16x32_bf16 v[72:75], v[96:99], v[184:187], v[52:55]
    v_mfma_f32_16x16x32_bf16 v[72:75], v[100:103], v[188:191], v[72:75]
    v_mfma_f32_16x16x32_bf16 v[72:75], v[104:107], v[192:195], v[72:75]
    v_mfma_f32_16x16x32_bf16 v[72:75], v[108:111], v[196:199], v[72:75]
    v_mfma_f32_16x16x32_bf16 v[72:75], v[112:115], v[200:203], v[72:75]
    v_mfma_f32_16x16x32_bf16 v[72:75], v[116:119], v[204:207], v[72:75]
    v_mfma_f32_16x16x32_bf16 v[80:83], v[96:99], v[208:211], v[56:59]
    v_mfma_f32_16x16x32_bf16 v[80:83], v[100:103], v[212:215], v[80:83]
    v_mfma_f32_16x16x32_bf16 v[80:83], v[104:107], v[216:219], v[80:83]
    v_mfma_f32_16x16x32_bf16 v[80:83], v[108:111], v[220:223], v[80:83]
    v_mfma_f32_16x16x32_bf16 v[80:83], v[112:115], v[224:227], v[80:83]
    v_mfma_f32_16x16x32_bf16 v[80:83], v[116:119], v[228:231], v[80:83]
    s_nop 15
    v_add_u32 v0, 6144, v10
    buffer_load_dwordx4 v[96:99], v0, s[16:19], s56 offen
    buffer_load_dwordx4 v[100:103], v0, s[16:19], s56 offen offset:64
    buffer_load_dwordx4 v[104:107], v0, s[16:19], s56 offen offset:128
    buffer_load_dwordx4 v[108:111], v0, s[16:19], s56 offen offset:192
    buffer_load_dwordx4 v[112:115], v0, s[16:19], s56 offen offset:256
    buffer_load_dwordx4 v[116:119], v0, s[16:19], s56 offen offset:320
    s_waitcnt vmcnt(0)
    s_waitcnt vmcnt(0)
    v_mfma_f32_16x16x32_bf16 v[68:71], v[96:99], v[160:163], v[48:51]
    v_mfma_f32_16x16x32_bf16 v[68:71], v[100:103], v[164:167], v[68:71]
    v_mfma_f32_16x16x32_bf16 v[68:71], v[104:107], v[168:171], v[68:71]
    v_mfma_f32_16x16x32_bf16 v[68:71], v[108:111], v[172:175], v[68:71]
    v_mfma_f32_16x16x32_bf16 v[68:71], v[112:115], v[176:179], v[68:71]
    v_mfma_f32_16x16x32_bf16 v[68:71], v[116:119], v[180:183], v[68:71]
    v_mfma_f32_16x16x32_bf16 v[76:79], v[96:99], v[184:187], v[52:55]
    v_mfma_f32_16x16x32_bf16 v[76:79], v[100:103], v[188:191], v[76:79]
    v_mfma_f32_16x16x32_bf16 v[76:79], v[104:107], v[192:195], v[76:79]
    v_mfma_f32_16x16x32_bf16 v[76:79], v[108:111], v[196:199], v[76:79]
    v_mfma_f32_16x16x32_bf16 v[76:79], v[112:115], v[200:203], v[76:79]
    v_mfma_f32_16x16x32_bf16 v[76:79], v[116:119], v[204:207], v[76:79]
    v_mfma_f32_16x16x32_bf16 v[84:87], v[96:99], v[208:211], v[56:59]
    v_mfma_f32_16x16x32_bf16 v[84:87], v[100:103], v[212:215], v[84:87]
    v_mfma_f32_16x16x32_bf16 v[84:87], v[104:107], v[216:219], v[84:87]
    v_mfma_f32_16x16x32_bf16 v[84:87], v[108:111], v[220:223], v[84:87]
    v_mfma_f32_16x16x32_bf16 v[84:87], v[112:115], v[224:227], v[84:87]
    v_mfma_f32_16x16x32_bf16 v[84:87], v[116:119], v[228:231], v[84:87]
    s_nop 15
L_rare_1_1_ret:
    s_cmp_eq_u32 s36, 2
    s_cbranch_scc1 L_b10_3cs_replay
    s_cmp_eq_u32 s36, 6
    s_cbranch_scc1 L_b11_3cs_replay
    s_cmp_eq_u32 s36, 10
    s_cbranch_scc1 L_t10_31c_replay
    s_cmp_eq_u32 s36, 11
    s_cbranch_scc1 L_t11_31c_replay
    s_endpgm
L_b10_3cs_replay:
    v_exp_f32 v64, v64
    v_exp_f32 v65, v65
    s_nop 4
    s_branch L_b10_3cs_back
L_b11_3cs_replay:
    v_exp_f32 v64, v64
    v_exp_f32 v65, v65
    s_nop 4
    s_branch L_b11_3cs_back
L_t10_31c_replay:
    s_nop 4
    s_branch L_t10_31c_back
L_t11_31c_replay:
    s_nop 4
    s_branch L_t11_31c_back
L_hot_end:
L_rescale:
    v_mov_b32 v28, v24
    s_nop 1
    v_permlane32_swap_b32 v24, v28
    v_max_f32 v24, v24, v28
    v_mov_b32 v28, v24
    s_nop 1
    v_permlane16_swap_b32 v24, v28
    v_max_f32 v24, v24, v28
    v_add_f32 v0, v48, v24
    v_exp_f32 v0, -v0
    v_sub_f32 v48, 0, v24
    v_sub_f32 v49, 0, v24
    v_sub_f32 v50, 0, v24
    v_sub_f32 v51, 0, v24
    v_mul_f32 v12, v12, v0
    v_accvgpr_read_b32 v28, a0
    v_accvgpr_read_b32 v29, a1
    v_accvgpr_read_b32 v30, a2
    v_accvgpr_read_b32 v31, a3
    v_mul_f32 v28, v28, v0
    v_mul_f32 v29, v29, v0
    v_mul_f32 v30, v30, v0
    v_mul_f32 v31, v31, v0
    v_accvgpr_write_b32 a0, v28
    v_accvgpr_write_b32 a1, v29
    v_accvgpr_write_b32 a2, v30
    v_accvgpr_write_b32 a3, v31
    v_accvgpr_read_b32 v28, a4
    v_accvgpr_read_b32 v29, a5
    v_accvgpr_read_b32 v30, a6
    v_accvgpr_read_b32 v31, a7
    v_mul_f32 v28, v28, v0
    v_mul_f32 v29, v29, v0
    v_mul_f32 v30, v30, v0
    v_mul_f32 v31, v31, v0
    v_accvgpr_write_b32 a4, v28
    v_accvgpr_write_b32 a5, v29
    v_accvgpr_write_b32 a6, v30
    v_accvgpr_write_b32 a7, v31
    v_accvgpr_read_b32 v28, a8
    v_accvgpr_read_b32 v29, a9
    v_accvgpr_read_b32 v30, a10
    v_accvgpr_read_b32 v31, a11
    v_mul_f32 v28, v28, v0
    v_mul_f32 v29, v29, v0
    v_mul_f32 v30, v30, v0
    v_mul_f32 v31, v31, v0
    v_accvgpr_write_b32 a8, v28
    v_accvgpr_write_b32 a9, v29
    v_accvgpr_write_b32 a10, v30
    v_accvgpr_write_b32 a11, v31
    v_accvgpr_read_b32 v28, a12
    v_accvgpr_read_b32 v29, a13
    v_accvgpr_read_b32 v30, a14
    v_accvgpr_read_b32 v31, a15
    v_mul_f32 v28, v28, v0
    v_mul_f32 v29, v29, v0
    v_mul_f32 v30, v30, v0
    v_mul_f32 v31, v31, v0
    v_accvgpr_write_b32 a12, v28
    v_accvgpr_write_b32 a13, v29
    v_accvgpr_write_b32 a14, v30
    v_accvgpr_write_b32 a15, v31
    v_accvgpr_read_b32 v28, a16
    v_accvgpr_read_b32 v29, a17
    v_accvgpr_read_b32 v30, a18
    v_accvgpr_read_b32 v31, a19
    v_mul_f32 v28, v28, v0
    v_mul_f32 v29, v29, v0
    v_mul_f32 v30, v30, v0
    v_mul_f32 v31, v31, v0
    v_accvgpr_write_b32 a16, v28
    v_accvgpr_write_b32 a17, v29
    v_accvgpr_write_b32 a18, v30
    v_accvgpr_write_b32 a19, v31
    v_accvgpr_read_b32 v28, a20
    v_accvgpr_read_b32 v29, a21
    v_accvgpr_read_b32 v30, a22
    v_accvgpr_read_b32 v31, a23
    v_mul_f32 v28, v28, v0
    v_mul_f32 v29, v29, v0
    v_mul_f32 v30, v30, v0
    v_mul_f32 v31, v31, v0
    v_accvgpr_write_b32 a20, v28
    v_accvgpr_write_b32 a21, v29
    v_accvgpr_write_b32 a22, v30
    v_accvgpr_write_b32 a23, v31
    v_accvgpr_read_b32 v28, a24
    v_accvgpr_read_b32 v29, a25
    v_accvgpr_read_b32 v30, a26
    v_accvgpr_read_b32 v31, a27
    v_mul_f32 v28, v28, v0
    v_mul_f32 v29, v29, v0
    v_mul_f32 v30, v30, v0
    v_mul_f32 v31, v31, v0
    v_accvgpr_write_b32 a24, v28
    v_accvgpr_write_b32 a25, v29
    v_accvgpr_write_b32 a26, v30
    v_accvgpr_write_b32 a27, v31
    v_accvgpr_read_b32 v28, a28
    v_accvgpr_read_b32 v29, a29
    v_accvgpr_read_b32 v30, a30
    v_accvgpr_read_b32 v31, a31
    v_mul_f32 v28, v28, v0
    v_mul_f32 v29, v29, v0
    v_mul_f32 v30, v30, v0
    v_mul_f32 v31, v31, v0
    v_accvgpr_write_b32 a28, v28
    v_accvgpr_write_b32 a29, v29
    v_accvgpr_write_b32 a30, v30
    v_accvgpr_write_b32 a31, v31
    v_accvgpr_read_b32 v28, a32
    v_accvgpr_read_b32 v29, a33
    v_accvgpr_read_b32 v30, a34
    v_accvgpr_read_b32 v31, a35
    v_mul_f32 v28, v28, v0
    v_mul_f32 v29, v29, v0
    v_mul_f32 v30, v30, v0
    v_mul_f32 v31, v31, v0
    v_accvgpr_write_b32 a32, v28
    v_accvgpr_write_b32 a33, v29
    v_accvgpr_write_b32 a34, v30
    v_accvgpr_write_b32 a35, v31
    v_accvgpr_read_b32 v28, a36
    v_accvgpr_read_b32 v29, a37
    v_accvgpr_read_b32 v30, a38
    v_accvgpr_read_b32 v31, a39
    v_mul_f32 v28, v28, v0
    v_mul_f32 v29, v29, v0
    v_mul_f32 v30, v30, v0
    v_mul_f32 v31, v31, v0
    v_accvgpr_write_b32 a36, v28
    v_accvgpr_write_b32 a37, v29
    v_accvgpr_write_b32 a38, v30
    v_accvgpr_write_b32 a39, v31
    v_accvgpr_read_b32 v28, a40
    v_accvgpr_read_b32 v29, a41
    v_accvgpr_read_b32 v30, a42
    v_accvgpr_read_b32 v31, a43
    v_mul_f32 v28, v28, v0
    v_mul_f32 v29, v29, v0
    v_mul_f32 v30, v30, v0
    v_mul_f32 v31, v31, v0
    v_accvgpr_write_b32 a40, v28
    v_accvgpr_write_b32 a41, v29
    v_accvgpr_write_b32 a42, v30
    v_accvgpr_write_b32 a43, v31
    v_accvgpr_read_b32 v28, a44
    v_accvgpr_read_b32 v29, a45
    v_accvgpr_read_b32 v30, a46
    v_accvgpr_read_b32 v31, a47
    v_mul_f32 v28, v28, v0
    v_mul_f32 v29, v29, v0
    v_mul_f32 v30, v30, v0
    v_mul_f32 v31, v31, v0
    v_accvgpr_write_b32 a44, v28
    v_accvgpr_write_b32 a45, v29
    v_accvgpr_write_b32 a46, v30
    v_accvgpr_write_b32 a47, v31
    v_mov_b32 v28, v25
    s_nop 1
    v_permlane32_swap_b32 v25, v28
    v_max_f32 v25, v25, v28
    v_mov_b32 v28, v25
    s_nop 1
    v_permlane16_swap_b32 v25, v28
    v_max_f32 v25, v25, v28
    v_add_f32 v0, v52, v25
    v_exp_f32 v0, -v0
    v_sub_f32 v52, 0, v25
    v_sub_f32 v53, 0, v25
    v_sub_f32 v54, 0, v25
    v_sub_f32 v55, 0, v25
    v_mul_f32 v13, v13, v0
    v_accvgpr_read_b32 v28, a48
    v_accvgpr_read_b32 v29, a49
    v_accvgpr_read_b32 v30, a50
    v_accvgpr_read_b32 v31, a51
    v_mul_f32 v28, v28, v0
    v_mul_f32 v29, v29, v0
    v_mul_f32 v30, v30, v0
    v_mul_f32 v31, v31, v0
    v_accvgpr_write_b32 a48, v28
    v_accvgpr_write_b32 a49, v29
    v_accvgpr_write_b32 a50, v30
    v_accvgpr_write_b32 a51, v31
    v_accvgpr_read_b32 v28, a52
    v_accvgpr_read_b32 v29, a53
    v_accvgpr_read_b32 v30, a54
    v_accvgpr_read_b32 v31, a55
    v_mul_f32 v28, v28, v0
    v_mul_f32 v29, v29, v0
    v_mul_f32 v30, v30, v0
    v_mul_f32 v31, v31, v0
    v_accvgpr_write_b32 a52, v28
    v_accvgpr_write_b32 a53, v29
    v_accvgpr_write_b32 a54, v30
    v_accvgpr_write_b32 a55, v31
    v_accvgpr_read_b32 v28, a56
    v_accvgpr_read_b32 v29, a57
    v_accvgpr_read_b32 v30, a58
    v_accvgpr_read_b32 v31, a59
    v_mul_f32 v28, v28, v0
    v_mul_f32 v29, v29, v0
    v_mul_f32 v30, v30, v0
    v_mul_f32 v31, v31, v0
    v_accvgpr_write_b32 a56, v28
    v_accvgpr_write_b32 a57, v29
    v_accvgpr_write_b32 a58, v30
    v_accvgpr_write_b32 a59, v31
    v_accvgpr_read_b32 v28, a60
    v_accvgpr_read_b32 v29, a61
    v_accvgpr_read_b32 v30, a62
    v_accvgpr_read_b32 v31, a63
    v_mul_f32 v28, v28, v0
    v_mul_f32 v29, v29, v0
    v_mul_f32 v30, v30, v0
    v_mul_f32 v31, v31, v0
    v_accvgpr_write_b32 a60, v28
    v_accvgpr_write_b32 a61, v29
    v_accvgpr_write_b32 a62, v30
    v_accvgpr_write_b32 a63, v31
    v_accvgpr_read_b32 v28, a64
    v_accvgpr_read_b32 v29, a65
    v_accvgpr_read_b32 v30, a66
    v_accvgpr_read_b32 v31, a67
    v_mul_f32 v28, v28, v0
    v_mul_f32 v29, v29, v0
    v_mul_f32 v30, v30, v0
    v_mul_f32 v31, v31, v0
    v_accvgpr_write_b32 a64, v28
    v_accvgpr_write_b32 a65, v29
    v_accvgpr_write_b32 a66, v30
    v_accvgpr_write_b32 a67, v31
    v_accvgpr_read_b32 v28, a68
    v_accvgpr_read_b32 v29, a69
    v_accvgpr_read_b32 v30, a70
    v_accvgpr_read_b32 v31, a71
    v_mul_f32 v28, v28, v0
    v_mul_f32 v29, v29, v0
    v_mul_f32 v30, v30, v0
    v_mul_f32 v31, v31, v0
    v_accvgpr_write_b32 a68, v28
    v_accvgpr_write_b32 a69, v29
    v_accvgpr_write_b32 a70, v30
    v_accvgpr_write_b32 a71, v31
    v_accvgpr_read_b32 v28, a72
    v_accvgpr_read_b32 v29, a73
    v_accvgpr_read_b32 v30, a74
    v_accvgpr_read_b32 v31, a75
    v_mul_f32 v28, v28, v0
    v_mul_f32 v29, v29, v0
    v_mul_f32 v30, v30, v0
    v_mul_f32 v31, v31, v0
    v_accvgpr_write_b32 a72, v28
    v_accvgpr_write_b32 a73, v29
    v_accvgpr_write_b32 a74, v30
    v_accvgpr_write_b32 a75, v31
    v_accvgpr_read_b32 v28, a76
    v_accvgpr_read_b32 v29, a77
    v_accvgpr_read_b32 v30, a78
    v_accvgpr_read_b32 v31, a79
    v_mul_f32 v28, v28, v0
    v_mul_f32 v29, v29, v0
    v_mul_f32 v30, v30, v0
    v_mul_f32 v31, v31, v0
    v_accvgpr_write_b32 a76, v28
    v_accvgpr_write_b32 a77, v29
    v_accvgpr_write_b32 a78, v30
    v_accvgpr_write_b32 a79, v31
    v_accvgpr_read_b32 v28, a80
    v_accvgpr_read_b32 v29, a81
    v_accvgpr_read_b32 v30, a82
    v_accvgpr_read_b32 v31, a83
    v_mul_f32 v28, v28, v0
    v_mul_f32 v29, v29, v0
    v_mul_f32 v30, v30, v0
    v_mul_f32 v31, v31, v0
    v_accvgpr_write_b32 a80, v28
    v_accvgpr_write_b32 a81, v29
    v_accvgpr_write_b32 a82, v30
    v_accvgpr_write_b32 a83, v31
    v_accvgpr_read_b32 v28, a84
    v_accvgpr_read_b32 v29, a85
    v_accvgpr_read_b32 v30, a86
    v_accvgpr_read_b32 v31, a87
    v_mul_f32 v28, v28, v0
    v_mul_f32 v29, v29, v0
    v_mul_f32 v30, v30, v0
    v_mul_f32 v31, v31, v0
    v_accvgpr_write_b32 a84, v28
    v_accvgpr_write_b32 a85, v29
    v_accvgpr_write_b32 a86, v30
    v_accvgpr_write_b32 a87, v31
    v_accvgpr_read_b32 v28, a88
    v_accvgpr_read_b32 v29, a89
    v_accvgpr_read_b32 v30, a90
    v_accvgpr_read_b32 v31, a91
    v_mul_f32 v28, v28, v0
    v_mul_f32 v29, v29, v0
    v_mul_f32 v30, v30, v0
    v_mul_f32 v31, v31, v0
    v_accvgpr_write_b32 a88, v28
    v_accvgpr_write_b32 a89, v29
    v_accvgpr_write_b32 a90, v30
    v_accvgpr_write_b32 a91, v31
    v_accvgpr_read_b32 v28, a92
    v_accvgpr_read_b32 v29, a93
    v_accvgpr_read_b32 v30, a94
    v_accvgpr_read_b32 v31, a95
    v_mul_f32 v28, v28, v0
    v_mul_f32 v29, v29, v0
    v_mul_f32 v30, v30, v0
    v_mul_f32 v31, v31, v0
    v_accvgpr_write_b32 a92, v28
    v_accvgpr_write_b32 a93, v29
    v_accvgpr_write_b32 a94, v30
    v_accvgpr_write_b32 a95, v31
    v_mov_b32 v28, v26
    s_nop 1
    v_permlane32_swap_b32 v26, v28
    v_max_f32 v26, v26, v28
    v_mov_b32 v28, v26
    s_nop 1
    v_permlane16_swap_b32 v26, v28
    v_max_f32 v26, v26, v28
    v_add_f32 v0, v56, v26
    v_exp_f32 v0, -v0
    v_sub_f32 v56, 0, v26
    v_sub_f32 v57, 0, v26
    v_sub_f32 v58, 0, v26
    v_sub_f32 v59, 0, v26
    v_mul_f32 v14, v14, v0
    v_accvgpr_read_b32 v28, a96
    v_accvgpr_read_b32 v29, a97
    v_accvgpr_read_b32 v30, a98
    v_accvgpr_read_b32 v31, a99
    v_mul_f32 v28, v28, v0
    v_mul_f32 v29, v29, v0
    v_mul_f32 v30, v30, v0
    v_mul_f32 v31, v31, v0
    v_accvgpr_write_b32 a96, v28
    v_accvgpr_write_b32 a97, v29
    v_accvgpr_write_b32 a98, v30
    v_accvgpr_write_b32 a99, v31
    v_accvgpr_read_b32 v28, a100
    v_accvgpr_read_b32 v29, a101
    v_accvgpr_read_b32 v30, a102
    v_accvgpr_read_b32 v31, a103
    v_mul_f32 v28, v28, v0
    v_mul_f32 v29, v29, v0
    v_mul_f32 v30, v30, v0
    v_mul_f32 v31, v31, v0
    v_accvgpr_write_b32 a100, v28
    v_accvgpr_write_b32 a101, v29
    v_accvgpr_write_b32 a102, v30
    v_accvgpr_write_b32 a103, v31
    v_accvgpr_read_b32 v28, a104
    v_accvgpr_read_b32 v29, a105
    v_accvgpr_read_b32 v30, a106
    v_accvgpr_read_b32 v31, a107
    v_mul_f32 v28, v28, v0
    v_mul_f32 v29, v29, v0
    v_mul_f32 v30, v30, v0
    v_mul_f32 v31, v31, v0
    v_accvgpr_write_b32 a104, v28
    v_accvgpr_write_b32 a105, v29
    v_accvgpr_write_b32 a106, v30
    v_accvgpr_write_b32 a107, v31
    v_accvgpr_read_b32 v28, a108
    v_accvgpr_read_b32 v29, a109
    v_accvgpr_read_b32 v30, a110
    v_accvgpr_read_b32 v31, a111
    v_mul_f32 v28, v28, v0
    v_mul_f32 v29, v29, v0
    v_mul_f32 v30, v30, v0
    v_mul_f32 v31, v31, v0
    v_accvgpr_write_b32 a108, v28
    v_accvgpr_write_b32 a109, v29
    v_accvgpr_write_b32 a110, v30
    v_accvgpr_write_b32 a111, v31
    v_accvgpr_read_b32 v28, a112
    v_accvgpr_read_b32 v29, a113
    v_accvgpr_read_b32 v30, a114
    v_accvgpr_read_b32 v31, a115
    v_mul_f32 v28, v28, v0
    v_mul_f32 v29, v29, v0
    v_mul_f32 v30, v30, v0
    v_mul_f32 v31, v31, v0
    v_accvgpr_write_b32 a112, v28
    v_accvgpr_write_b32 a113, v29
    v_accvgpr_write_b32 a114, v30
    v_accvgpr_write_b32 a115, v31
    v_accvgpr_read_b32 v28, a116
    v_accvgpr_read_b32 v29, a117
    v_accvgpr_read_b32 v30, a118
    v_accvgpr_read_b32 v31, a119
    v_mul_f32 v28, v28, v0
    v_mul_f32 v29, v29, v0
    v_mul_f32 v30, v30, v0
    v_mul_f32 v31, v31, v0
    v_accvgpr_write_b32 a116, v28
    v_accvgpr_write_b32 a117, v29
    v_accvgpr_write_b32 a118, v30
    v_accvgpr_write_b32 a119, v31
    v_accvgpr_read_b32 v28, a120
    v_accvgpr_read_b32 v29, a121
    v_accvgpr_read_b32 v30, a122
    v_accvgpr_read_b32 v31, a123
    v_mul_f32 v28, v28, v0
    v_mul_f32 v29, v29, v0
    v_mul_f32 v30, v30, v0
    v_mul_f32 v31, v31, v0
    v_accvgpr_write_b32 a120, v28
    v_accvgpr_write_b32 a121, v29
    v_accvgpr_write_b32 a122, v30
    v_accvgpr_write_b32 a123, v31
    v_accvgpr_read_b32 v28, a124
    v_accvgpr_read_b32 v29, a125
    v_accvgpr_read_b32 v30, a126
    v_accvgpr_read_b32 v31, a127
    v_mul_f32 v28, v28, v0
    v_mul_f32 v29, v29, v0
    v_mul_f32 v30, v30, v0
    v_mul_f32 v31, v31, v0
    v_accvgpr_write_b32 a124, v28
    v_accvgpr_write_b32 a125, v29
    v_accvgpr_write_b32 a126, v30
    v_accvgpr_write_b32 a127, v31
    v_accvgpr_read_b32 v28, a128
    v_accvgpr_read_b32 v29, a129
    v_accvgpr_read_b32 v30, a130
    v_accvgpr_read_b32 v31, a131
    v_mul_f32 v28, v28, v0
    v_mul_f32 v29, v29, v0
    v_mul_f32 v30, v30, v0
    v_mul_f32 v31, v31, v0
    v_accvgpr_write_b32 a128, v28
    v_accvgpr_write_b32 a129, v29
    v_accvgpr_write_b32 a130, v30
    v_accvgpr_write_b32 a131, v31
    v_accvgpr_read_b32 v28, a132
    v_accvgpr_read_b32 v29, a133
    v_accvgpr_read_b32 v30, a134
    v_accvgpr_read_b32 v31, a135
    v_mul_f32 v28, v28, v0
    v_mul_f32 v29, v29, v0
    v_mul_f32 v30, v30, v0
    v_mul_f32 v31, v31, v0
    v_accvgpr_write_b32 a132, v28
    v_accvgpr_write_b32 a133, v29
    v_accvgpr_write_b32 a134, v30
    v_accvgpr_write_b32 a135, v31
    v_accvgpr_read_b32 v28, a136
    v_accvgpr_read_b32 v29, a137
    v_accvgpr_read_b32 v30, a138
    v_accvgpr_read_b32 v31, a139
    v_mul_f32 v28, v28, v0
    v_mul_f32 v29, v29, v0
    v_mul_f32 v30, v30, v0
    v_mul_f32 v31, v31, v0
    v_accvgpr_write_b32 a136, v28
    v_accvgpr_write_b32 a137, v29
    v_accvgpr_write_b32 a138, v30
    v_accvgpr_write_b32 a139, v31
    v_accvgpr_read_b32 v28, a140
    v_accvgpr_read_b32 v29, a141
    v_accvgpr_read_b32 v30, a142
    v_accvgpr_read_b32 v31, a143
    v_mul_f32 v28, v28, v0
    v_mul_f32 v29, v29, v0
    v_mul_f32 v30, v30, v0
    v_mul_f32 v31, v31, v0
    v_accvgpr_write_b32 a140, v28
    v_accvgpr_write_b32 a141, v29
    v_accvgpr_write_b32 a142, v30
    v_accvgpr_write_b32 a143, v31
    v_mov_b32 v28, v27
    s_nop 1
    v_permlane32_swap_b32 v27, v28
    v_max_f32 v27, v27, v28
    v_mov_b32 v28, v27
    s_nop 1
    v_permlane16_swap_b32 v27, v28
    v_max_f32 v27, v27, v28
    v_add_f32 v0, v60, v27
    v_exp_f32 v0, -v0
    v_sub_f32 v60, 0, v27
    v_sub_f32 v61, 0, v27
    v_sub_f32 v62, 0, v27
    v_sub_f32 v63, 0, v27
    v_mul_f32 v15, v15, v0
    v_accvgpr_read_b32 v28, a144
    v_accvgpr_read_b32 v29, a145
    v_accvgpr_read_b32 v30, a146
    v_accvgpr_read_b32 v31, a147
    v_mul_f32 v28, v28, v0
    v_mul_f32 v29, v29, v0
    v_mul_f32 v30, v30, v0
    v_mul_f32 v31, v31, v0
    v_accvgpr_write_b32 a144, v28
    v_accvgpr_write_b32 a145, v29
    v_accvgpr_write_b32 a146, v30
    v_accvgpr_write_b32 a147, v31
    v_accvgpr_read_b32 v28, a148
    v_accvgpr_read_b32 v29, a149
    v_accvgpr_read_b32 v30, a150
    v_accvgpr_read_b32 v31, a151
    v_mul_f32 v28, v28, v0
    v_mul_f32 v29, v29, v0
    v_mul_f32 v30, v30, v0
    v_mul_f32 v31, v31, v0
    v_accvgpr_write_b32 a148, v28
    v_accvgpr_write_b32 a149, v29
    v_accvgpr_write_b32 a150, v30
    v_accvgpr_write_b32 a151, v31
    v_accvgpr_read_b32 v28, a152
    v_accvgpr_read_b32 v29, a153
    v_accvgpr_read_b32 v30, a154
    v_accvgpr_read_b32 v31, a155
    v_mul_f32 v28, v28, v0
    v_mul_f32 v29, v29, v0
    v_mul_f32 v30, v30, v0
    v_mul_f32 v31, v31, v0
    v_accvgpr_write_b32 a152, v28
    v_accvgpr_write_b32 a153, v29
    v_accvgpr_write_b32 a154, v30
    v_accvgpr_write_b32 a155, v31
    v_accvgpr_read_b32 v28, a156
    v_accvgpr_read_b32 v29, a157
    v_accvgpr_read_b32 v30, a158
    v_accvgpr_read_b32 v31, a159
    v_mul_f32 v28, v28, v0
    v_mul_f32 v29, v29, v0
    v_mul_f32 v30, v30, v0
    v_mul_f32 v31, v31, v0
    v_accvgpr_write_b32 a156, v28
    v_accvgpr_write_b32 a157, v29
    v_accvgpr_write_b32 a158, v30
    v_accvgpr_write_b32 a159, v31
    v_accvgpr_read_b32 v28, a160
    v_accvgpr_read_b32 v29, a161
    v_accvgpr_read_b32 v30, a162
    v_accvgpr_read_b32 v31, a163
    v_mul_f32 v28, v28, v0
    v_mul_f32 v29, v29, v0
    v_mul_f32 v30, v30, v0
    v_mul_f32 v31, v31, v0
    v_accvgpr_write_b32 a160, v28
    v_accvgpr_write_b32 a161, v29
    v_accvgpr_write_b32 a162, v30
    v_accvgpr_write_b32 a163, v31
    v_accvgpr_read_b32 v28, a164
    v_accvgpr_read_b32 v29, a165
    v_accvgpr_read_b32 v30, a166
    v_accvgpr_read_b32 v31, a167
    v_mul_f32 v28, v28, v0
    v_mul_f32 v29, v29, v0
    v_mul_f32 v30, v30, v0
    v_mul_f32 v31, v31, v0
    v_accvgpr_write_b32 a164, v28
    v_accvgpr_write_b32 a165, v29
    v_accvgpr_write_b32 a166, v30
    v_accvgpr_write_b32 a167, v31
    v_accvgpr_read_b32 v28, a168
    v_accvgpr_read_b32 v29, a169
    v_accvgpr_read_b32 v30, a170
    v_accvgpr_read_b32 v31, a171
    v_mul_f32 v28, v28, v0
    v_mul_f32 v29, v29, v0
    v_mul_f32 v30, v30, v0
    v_mul_f32 v31, v31, v0
    v_accvgpr_write_b32 a168, v28
    v_accvgpr_write_b32 a169, v29
    v_accvgpr_write_b32 a170, v30
    v_accvgpr_write_b32 a171, v31
    v_accvgpr_read_b32 v28, a172
    v_accvgpr_read_b32 v29, a173
    v_accvgpr_read_b32 v30, a174
    v_accvgpr_read_b32 v31, a175
    v_mul_f32 v28, v28, v0
    v_mul_f32 v29, v29, v0
    v_mul_f32 v30, v30, v0
    v_mul_f32 v31, v31, v0
    v_accvgpr_write_b32 a172, v28
    v_accvgpr_write_b32 a173, v29
    v_accvgpr_write_b32 a174, v30
    v_accvgpr_write_b32 a175, v31
    v_accvgpr_read_b32 v28, a176
    v_accvgpr_read_b32 v29, a177
    v_accvgpr_read_b32 v30, a178
    v_accvgpr_read_b32 v31, a179
    v_mul_f32 v28, v28, v0
    v_mul_f32 v29, v29, v0
    v_mul_f32 v30, v30, v0
    v_mul_f32 v31, v31, v0
    v_accvgpr_write_b32 a176, v28
    v_accvgpr_write_b32 a177, v29
    v_accvgpr_write_b32 a178, v30
    v_accvgpr_write_b32 a179, v31
    v_accvgpr_read_b32 v28, a180
    v_accvgpr_read_b32 v29, a181
    v_accvgpr_read_b32 v30, a182
    v_accvgpr_read_b32 v31, a183
    v_mul_f32 v28, v28, v0
    v_mul_f32 v29, v29, v0
    v_mul_f32 v30, v30, v0
    v_mul_f32 v31, v31, v0
    v_accvgpr_write_b32 a180, v28
    v_accvgpr_write_b32 a181, v29
    v_accvgpr_write_b32 a182, v30
    v_accvgpr_write_b32 a183, v31
    v_accvgpr_read_b32 v28, a184
    v_accvgpr_read_b32 v29, a185
    v_accvgpr_read_b32 v30, a186
    v_accvgpr_read_b32 v31, a187
    v_mul_f32 v28, v28, v0
    v_mul_f32 v29, v29, v0
    v_mul_f32 v30, v30, v0
    v_mul_f32 v31, v31, v0
    v_accvgpr_write_b32 a184, v28
    v_accvgpr_write_b32 a185, v29
    v_accvgpr_write_b32 a186, v30
    v_accvgpr_write_b32 a187, v31
    v_accvgpr_read_b32 v28, a188
    v_accvgpr_read_b32 v29, a189
    v_accvgpr_read_b32 v30, a190
    v_accvgpr_read_b32 v31, a191
    v_mul_f32 v28, v28, v0
    v_mul_f32 v29, v29, v0
    v_mul_f32 v30, v30, v0
    v_mul_f32 v31, v31, v0
    v_accvgpr_write_b32 a188, v28
    v_accvgpr_write_b32 a189, v29
    v_accvgpr_write_b32 a190, v30
    v_accvgpr_write_b32 a191, v31
    s_nop 4
    s_cmp_eq_u32 s59, 0
    s_cbranch_scc1 L_rare_0_0_b
    s_cmp_eq_u32 s59, 1
    s_cbranch_scc1 L_rare_0_1_b
    s_cmp_eq_u32 s59, 2
    s_cbranch_scc1 L_rare_1_0_b
    s_branch L_rare_1_1_b
.section .rodata,"a"
.p2align 6
.amdhsa_kernel standalone__gqa_softmax__near_ridge_kernel
  .amdhsa_next_free_vgpr 512
  .amdhsa_next_free_sgpr 102
  .amdhsa_accum_offset 256
  .amdhsa_group_segment_fixed_size 0
  .amdhsa_kernarg_size 48
  .amdhsa_user_sgpr_count 2
  .amdhsa_user_sgpr_kernarg_segment_ptr 1
  .amdhsa_system_sgpr_workgroup_id_x 1
.end_amdhsa_kernel
```
